```python
import torch

def _softmax(x, axis=-1):
    return torch.softmax(x, dim=axis)
def _gelu(x):
    return torch.nn.functional.gelu(x, approximate="tanh")
def _silu(x):
    return torch.nn.functional.silu(x)
def _sigmoid(x):
    return torch.sigmoid(x)
def _layernorm(x, axis=-1, eps=1e-5):
    m = x.mean(dim=axis, keepdim=True)
    v = x.var(dim=axis, keepdim=True, unbiased=False)
    return (x - m) / torch.sqrt(v + eps)
def _scatter_add(tgt, idx, src, axis=0):
    return tgt.clone().index_add_(axis, idx, src)
def _segment_sum(src, seg, n):
    out = torch.zeros((n,) + src.shape[1:], dtype=src.dtype)
    return out.index_add_(0, seg, src)
def _pad(x, pw):
    flat = tuple(v for pair in reversed(pw) for v in pair)
    return torch.nn.functional.pad(x, flat)

kernel_name = 'recurrent_scan__mha_block_cached__glu_gated_swiglu__prompt'

def setup_inputs():

    _w = (lambda a: (lambda t: t.to(torch.bfloat16) if t.is_floating_point() else t)(torch.as_tensor(a)))
    def _A_setup():
        B, Sq, D = 1, 2048, 576
        H, Sk, Dh = 32, 2048, 128
        return {
            "x": _w((lambda *s: torch.randn(*s, dtype=torch.bfloat16) * 0.05)(B, Sq, D)),
            "k_cache": _w((lambda *s: torch.randn(*s, dtype=torch.bfloat16) * 1.6)(B, H, Sk, Dh)),
            "v_cache": _w((lambda *s: torch.randn(*s, dtype=torch.bfloat16) * 1.6)(B, H, Sk, Dh)),
            "wq": _w((lambda *s: torch.randn(*s, dtype=torch.bfloat16) * 1.6)(D, H * Dh) * (D ** -0.5)),
            "wo": _w((lambda *s: torch.randn(*s, dtype=torch.bfloat16) * 1.6)(H * Dh, D) * ((H * Dh) ** -0.5)),
        }
    _A_in = _A_setup()

    def _B_setup():
        B, S, D, F = 1, 2048, 576, 4608
        return {
            "x": _w((lambda *s: torch.randn(*s, dtype=torch.bfloat16) * 0.05)(B, S, D)),
            "w1": _w((lambda *s: torch.randn(*s, dtype=torch.bfloat16) * 0.2)(D, F) * (2.0 / D) ** 0.5),
            "w3": _w((lambda *s: torch.randn(*s, dtype=torch.bfloat16) * 0.2)(D, F) * (2.0 / D) ** 0.5),
            "w2": _w((lambda *s: torch.randn(*s, dtype=torch.bfloat16) * 0.2)(F, D) * (2.0 / F) ** 0.5),
        }
    _B_in = _B_setup()

    return {
        "A_x": _A_in["x"],
        "A_k_cache": _A_in["k_cache"],
        "A_v_cache": _A_in["v_cache"],
        "A_wq": _A_in["wq"],
        "A_wo": _A_in["wo"],
        "B_x": _B_in["x"],
        "B_w1": _B_in["w1"],
        "B_w3": _B_in["w3"],
        "B_w2": _B_in["w2"],
    }

def reference(A_x, A_k_cache, A_v_cache, A_wq, A_wo, B_x, B_w1, B_w3, B_w2):
    def _A_ref(x, k_cache, v_cache, wq, wo):
        B, Sq, D = x.shape
        H, Dh = 32, 128
        q = (lambda x, *d: x.permute(*d))((x @ wq).reshape(B, Sq, H, Dh), 0, 2, 1, 3)
        scores = torch.einsum("bhqd,bhkd->bhqk", q, k_cache) * (Dh ** -0.5)
        p = _softmax(scores, axis=-1)
        o = torch.einsum("bhqk,bhkd->bhqd", p, v_cache)
        return (lambda x, *d: x.permute(*d))(o, 0, 2, 1, 3).reshape(B, Sq, H * Dh) @ wo

    def _B_ref(x, w1, w3, w2):
        gate = torch.einsum("bsd,df->bsf", x, w1)
        up = torch.einsum("bsd,df->bsf", x, w3)
        h = _silu(gate) * up
        out = torch.einsum("bsf,fd->bsd", h, w2)
        return out

    x = A_x
    xn = _layernorm(x, axis=-1)
    s = _A_ref(xn, A_k_cache, A_v_cache, A_wq, A_wo)
    g = _silu(_B_ref(xn, B_w1, B_w3, B_w2))
    return x + s * g
```

```asm
; @launch grid=(256,1,1) block=(256,1,1) lds=163840
.amdgcn_target "amdgcn-amd-amdhsa--gfx950"
.text
.globl recurrent_scan__mha_block_cached__glu_gated_swiglu__prompt_kernel
.p2align 8
.type recurrent_scan__mha_block_cached__glu_gated_swiglu__prompt_kernel,@function
recurrent_scan__mha_block_cached__glu_gated_swiglu__prompt_kernel:
 s_cmp_ge_u32 s2, 256
 s_cbranch_scc1 L_end
 s_load_dwordx4 s[44:47], s[0:1], 48
 s_load_dwordx2 s[100:101], s[0:1], 88
 s_load_dwordx4 s[36:39], s[0:1], 8
 s_load_dwordx2 s[40:41], s[0:1], 24
 s_load_dwordx2 s[92:93], s[0:1], 0
 s_load_dwordx2 s[94:95], s[0:1], 32
 s_load_dwordx4 s[96:99], s[0:1], 64
 s_load_dwordx2 s[50:51], s[0:1], 80
 v_and_b32 v3, 63, v0
 v_lshrrev_b32 v34, 6, v0
 s_nop 0
 v_readfirstlane_b32 s52, v34
 s_and_b32 s79, s2, 7
 s_lshl_b32 s79, s79, 2
 s_bfe_u32 s80, s2, 0x20003
 s_add_u32 s58, s79, s80
 s_lshr_b32 s59, s2, 5
 s_memrealtime s[24:25]
 s_nop 4
 s_cmp_ge_u32 s52, 2
 s_cbranch_scc1 L_role_b
 s_lshl_b32 s3, s59, 5
 s_add_u32 s3, s3, s58
 s_lshl_b32 s79, s3, 3
 v_lshrrev_b32 v65, 4, v0
 v_add_u32 v65, s79, v65
 v_and_b32 v66, 15, v0
 v_lshrrev_b32 v67, 2, v66
 v_and_b32 v68, 3, v66
 v_mul_u32_u24 v69, 1152, v65
 v_lshl_add_u32 v69, v67, 6, v69
 v_lshl_add_u32 v69, v68, 3, v69
 v_mov_b32 v88, 0
 v_mov_b32 v89, 0
 v_mov_b32 v90, 0
 v_mov_b32 v91, 0
 v_cmp_gt_u32 vcc, 8, v66
 v_or_b32 v144, s2, v0
 v_min_u32 v144, 1, v144
 v_lshlrev_b32 v144, 20, v144
 s_nop 0
 s_mov_b64 s[26:27], vcc
 s_waitcnt lgkmcnt(0)
 s_mov_b32 s28, s92
 s_mov_b32 s29, s93
 s_mov_b32 s30, 0x240000
 s_mov_b32 s31, 0x00020000
 buffer_load_dwordx2 v[72:73], v69, s[28:31], 0 offen offset:0
 buffer_load_dwordx2 v[74:75], v69, s[28:31], 0 offen offset:32
 buffer_load_dwordx2 v[76:77], v69, s[28:31], 0 offen offset:256
 buffer_load_dwordx2 v[78:79], v69, s[28:31], 0 offen offset:288
 buffer_load_dwordx2 v[80:81], v69, s[28:31], 0 offen offset:512
 buffer_load_dwordx2 v[82:83], v69, s[28:31], 0 offen offset:544
 buffer_load_dwordx2 v[84:85], v69, s[28:31], 0 offen offset:768
 buffer_load_dwordx2 v[86:87], v69, s[28:31], 0 offen offset:800
 s_mov_b64 exec, s[26:27]
 buffer_load_dwordx2 v[88:89], v69, s[28:31], 0 offen offset:1024
 buffer_load_dwordx2 v[90:91], v69, s[28:31], 0 offen offset:1056
 s_mov_b64 exec, -1
 s_mov_b32 s20, s50
 s_mov_b32 s21, s51
 s_mov_b32 s22, 0x100
 s_mov_b32 s23, 0x00020000
 s_or_b32 s80, s24, 1
 v_mov_b32 v145, s80
 buffer_store_dword v145, v144, s[20:23], 0 offen sc1
 v_lshrrev_b32 v70, 4, v65
 v_mul_u32_u24 v70, 18, v70
 v_add_u32 v70, v70, v67
 v_lshlrev_b32 v70, 10, v70
 v_lshl_add_u32 v70, v68, 8, v70
 v_and_b32 v71, 15, v65
 v_lshl_add_u32 v70, v71, 4, v70
 s_mov_b32 s12, s100
 s_mov_b32 s13, s101
 s_mov_b32 s14, 0x240000
 s_mov_b32 s15, 0x00020000
 s_mov_b32 s82, 0x320000
 s_add_u32 s32, s100, s82
 s_addc_u32 s33, s101, 0
 s_mov_b32 s34, 0x10000
 s_mov_b32 s35, 0x00020000
 s_lshl_b32 s81, s59, 13
 s_lshl_b32 s82, s3, 1
 s_add_u32 s82, s82, s52
 s_lshl_b32 s82, s82, 7
 v_lshlrev_b32 v146, 20, v3
 v_lshlrev_b32 v147, 7, v3
 v_mov_b32 v148, 0
 s_mov_b32 s83, 4096
 s_mov_b32 s84, 8192
 s_mov_b32 s85, 12288
 s_mov_b32 s86, 16384
 s_waitcnt vmcnt(10)
 v_lshlrev_b32 v94, 16, v72
 v_and_b32 v95, 0xffff0000, v72
 v_lshlrev_b32 v96, 16, v73
 v_and_b32 v97, 0xffff0000, v73
 s_waitcnt vmcnt(9)
 v_lshlrev_b32 v98, 16, v74
 v_and_b32 v99, 0xffff0000, v74
 v_lshlrev_b32 v100, 16, v75
 v_and_b32 v101, 0xffff0000, v75
 s_waitcnt vmcnt(8)
 v_lshlrev_b32 v102, 16, v76
 v_and_b32 v103, 0xffff0000, v76
 v_lshlrev_b32 v104, 16, v77
 v_and_b32 v105, 0xffff0000, v77
 s_waitcnt vmcnt(7)
 v_lshlrev_b32 v106, 16, v78
 v_and_b32 v107, 0xffff0000, v78
 v_lshlrev_b32 v108, 16, v79
 v_and_b32 v109, 0xffff0000, v79
 s_waitcnt vmcnt(6)
 v_lshlrev_b32 v110, 16, v80
 v_and_b32 v111, 0xffff0000, v80
 v_lshlrev_b32 v112, 16, v81
 v_and_b32 v113, 0xffff0000, v81
 s_waitcnt vmcnt(5)
 v_lshlrev_b32 v114, 16, v82
 v_and_b32 v115, 0xffff0000, v82
 v_lshlrev_b32 v116, 16, v83
 v_and_b32 v117, 0xffff0000, v83
 s_waitcnt vmcnt(4)
 v_lshlrev_b32 v118, 16, v84
 v_and_b32 v119, 0xffff0000, v84
 v_lshlrev_b32 v120, 16, v85
 v_and_b32 v121, 0xffff0000, v85
 s_waitcnt vmcnt(3)
 v_lshlrev_b32 v122, 16, v86
 v_and_b32 v123, 0xffff0000, v86
 v_lshlrev_b32 v124, 16, v87
 v_and_b32 v125, 0xffff0000, v87
 s_waitcnt vmcnt(2)
 v_lshlrev_b32 v126, 16, v88
 v_and_b32 v127, 0xffff0000, v88
 v_lshlrev_b32 v128, 16, v89
 v_and_b32 v129, 0xffff0000, v89
 s_waitcnt vmcnt(1)
 v_lshlrev_b32 v130, 16, v90
 v_and_b32 v131, 0xffff0000, v90
 v_lshlrev_b32 v132, 16, v91
 v_and_b32 v133, 0xffff0000, v91
 buffer_load_dword v149, v148, s[20:23], 0 offen sc1
 v_add_f32 v134, v94, v95
 v_add_f32 v135, v96, v97
 v_add_f32 v134, v134, v98
 v_add_f32 v135, v135, v99
 v_add_f32 v134, v134, v100
 v_add_f32 v135, v135, v101
 v_add_f32 v134, v134, v102
 v_add_f32 v135, v135, v103
 v_add_f32 v134, v134, v104
 v_add_f32 v135, v135, v105
 v_add_f32 v134, v134, v106
 v_add_f32 v135, v135, v107
 v_add_f32 v134, v134, v108
 v_add_f32 v135, v135, v109
 v_add_f32 v134, v134, v110
 v_add_f32 v135, v135, v111
 v_add_f32 v134, v134, v112
 v_add_f32 v135, v135, v113
 v_add_f32 v134, v134, v114
 v_add_f32 v135, v135, v115
 v_add_f32 v134, v134, v116
 v_add_f32 v135, v135, v117
 v_add_f32 v134, v134, v118
 v_add_f32 v135, v135, v119
 v_add_f32 v134, v134, v120
 v_add_f32 v135, v135, v121
 v_add_f32 v134, v134, v122
 v_add_f32 v135, v135, v123
 v_add_f32 v134, v134, v124
 v_add_f32 v135, v135, v125
 v_add_f32 v134, v134, v126
 v_add_f32 v135, v135, v127
 v_add_f32 v134, v134, v128
 v_add_f32 v135, v135, v129
 v_add_f32 v134, v134, v130
 v_add_f32 v135, v135, v131
 v_add_f32 v134, v134, v132
 v_add_f32 v135, v135, v133
 v_add_f32 v134, v134, v135
 s_nop 1
 v_add_f32_dpp v134, v134, v134 row_ror:8 row_mask:0xf bank_mask:0xf
 s_nop 1
 v_add_f32_dpp v134, v134, v134 row_ror:4 row_mask:0xf bank_mask:0xf
 s_nop 1
 v_add_f32_dpp v134, v134, v134 row_ror:2 row_mask:0xf bank_mask:0xf
 s_nop 1
 v_add_f32_dpp v134, v134, v134 row_ror:1 row_mask:0xf bank_mask:0xf
 v_mul_f32 v134, 0x3ae38e39, v134
 v_mov_b32 v136, 0
 v_mov_b32 v137, 0
 v_sub_f32 v138, v94, v134
 v_fmac_f32 v136, v138, v138
 v_sub_f32 v138, v95, v134
 v_fmac_f32 v137, v138, v138
 v_sub_f32 v138, v96, v134
 v_fmac_f32 v136, v138, v138
 v_sub_f32 v138, v97, v134
 v_fmac_f32 v137, v138, v138
 v_sub_f32 v138, v98, v134
 v_fmac_f32 v136, v138, v138
 v_sub_f32 v138, v99, v134
 v_fmac_f32 v137, v138, v138
 v_sub_f32 v138, v100, v134
 v_fmac_f32 v136, v138, v138
 v_sub_f32 v138, v101, v134
 v_fmac_f32 v137, v138, v138
 v_sub_f32 v138, v102, v134
 v_fmac_f32 v136, v138, v138
 v_sub_f32 v138, v103, v134
 v_fmac_f32 v137, v138, v138
 v_sub_f32 v138, v104, v134
 v_fmac_f32 v136, v138, v138
 v_sub_f32 v138, v105, v134
 v_fmac_f32 v137, v138, v138
 v_sub_f32 v138, v106, v134
 v_fmac_f32 v136, v138, v138
 v_sub_f32 v138, v107, v134
 v_fmac_f32 v137, v138, v138
 v_sub_f32 v138, v108, v134
 v_fmac_f32 v136, v138, v138
 v_sub_f32 v138, v109, v134
 v_fmac_f32 v137, v138, v138
 v_sub_f32 v138, v110, v134
 v_fmac_f32 v136, v138, v138
 v_sub_f32 v138, v111, v134
 v_fmac_f32 v137, v138, v138
 v_sub_f32 v138, v112, v134
 v_fmac_f32 v136, v138, v138
 v_sub_f32 v138, v113, v134
 v_fmac_f32 v137, v138, v138
 v_sub_f32 v138, v114, v134
 v_fmac_f32 v136, v138, v138
 v_sub_f32 v138, v115, v134
 v_fmac_f32 v137, v138, v138
 v_sub_f32 v138, v116, v134
 v_fmac_f32 v136, v138, v138
 v_sub_f32 v138, v117, v134
 v_fmac_f32 v137, v138, v138
 v_sub_f32 v138, v118, v134
 v_fmac_f32 v136, v138, v138
 v_sub_f32 v138, v119, v134
 v_fmac_f32 v137, v138, v138
 v_sub_f32 v138, v120, v134
 v_fmac_f32 v136, v138, v138
 v_sub_f32 v138, v121, v134
 v_fmac_f32 v137, v138, v138
 v_sub_f32 v138, v122, v134
 v_fmac_f32 v136, v138, v138
 v_sub_f32 v138, v123, v134
 v_fmac_f32 v137, v138, v138
 v_sub_f32 v138, v124, v134
 v_fmac_f32 v136, v138, v138
 v_sub_f32 v138, v125, v134
 v_fmac_f32 v137, v138, v138
 s_mov_b64 exec, s[26:27]
 v_sub_f32 v138, v126, v134
 v_fmac_f32 v136, v138, v138
 v_sub_f32 v138, v127, v134
 v_fmac_f32 v137, v138, v138
 v_sub_f32 v138, v128, v134
 v_fmac_f32 v136, v138, v138
 v_sub_f32 v138, v129, v134
 v_fmac_f32 v137, v138, v138
 v_sub_f32 v138, v130, v134
 v_fmac_f32 v136, v138, v138
 v_sub_f32 v138, v131, v134
 v_fmac_f32 v137, v138, v138
 v_sub_f32 v138, v132, v134
 v_fmac_f32 v136, v138, v138
 v_sub_f32 v138, v133, v134
 v_fmac_f32 v137, v138, v138
 s_mov_b64 exec, -1
 v_add_f32 v136, v136, v137
 s_nop 1
 v_add_f32_dpp v136, v136, v136 row_ror:8 row_mask:0xf bank_mask:0xf
 s_nop 1
 v_add_f32_dpp v136, v136, v136 row_ror:4 row_mask:0xf bank_mask:0xf
 s_nop 1
 v_add_f32_dpp v136, v136, v136 row_ror:2 row_mask:0xf bank_mask:0xf
 s_nop 1
 v_add_f32_dpp v136, v136, v136 row_ror:1 row_mask:0xf bank_mask:0xf
 v_mul_f32 v136, 0x3ae38e39, v136
 v_cvt_pk_bf16_f32 v134, v134, v134
 v_lshlrev_b32 v134, 16, v134
 v_cvt_pk_bf16_f32 v136, v136, v136
 v_lshlrev_b32 v136, 16, v136
 v_add_f32 v136, 0x3727c5ac, v136
 v_cvt_pk_bf16_f32 v136, v136, v136
 v_lshlrev_b32 v136, 16, v136
 v_sqrt_f32 v136, v136
 s_nop 0
 v_cvt_pk_bf16_f32 v136, v136, v136
 v_lshlrev_b32 v136, 16, v136
 v_rcp_f32 v136, v136
 v_sub_f32 v94, v94, v134
 v_sub_f32 v95, v95, v134
 v_cvt_pk_bf16_f32 v72, v94, v95
 v_lshlrev_b32 v94, 16, v72
 v_and_b32 v95, 0xffff0000, v72
 v_mul_f32 v94, v94, v136
 v_mul_f32 v95, v95, v136
 v_cvt_pk_bf16_f32 v72, v94, v95
 v_sub_f32 v96, v96, v134
 v_sub_f32 v97, v97, v134
 v_cvt_pk_bf16_f32 v73, v96, v97
 v_lshlrev_b32 v96, 16, v73
 v_and_b32 v97, 0xffff0000, v73
 v_mul_f32 v96, v96, v136
 v_mul_f32 v97, v97, v136
 v_cvt_pk_bf16_f32 v73, v96, v97
 v_sub_f32 v98, v98, v134
 v_sub_f32 v99, v99, v134
 v_cvt_pk_bf16_f32 v74, v98, v99
 v_lshlrev_b32 v98, 16, v74
 v_and_b32 v99, 0xffff0000, v74
 v_mul_f32 v98, v98, v136
 v_mul_f32 v99, v99, v136
 v_cvt_pk_bf16_f32 v74, v98, v99
 v_sub_f32 v100, v100, v134
 v_sub_f32 v101, v101, v134
 v_cvt_pk_bf16_f32 v75, v100, v101
 v_lshlrev_b32 v100, 16, v75
 v_and_b32 v101, 0xffff0000, v75
 v_mul_f32 v100, v100, v136
 v_mul_f32 v101, v101, v136
 v_cvt_pk_bf16_f32 v75, v100, v101
 buffer_store_dwordx4 v[72:75], v70, s[12:15], 0 offen sc1
 v_sub_f32 v102, v102, v134
 v_sub_f32 v103, v103, v134
 v_cvt_pk_bf16_f32 v76, v102, v103
 v_lshlrev_b32 v102, 16, v76
 v_and_b32 v103, 0xffff0000, v76
 v_mul_f32 v102, v102, v136
 v_mul_f32 v103, v103, v136
 v_cvt_pk_bf16_f32 v76, v102, v103
 v_sub_f32 v104, v104, v134
 v_sub_f32 v105, v105, v134
 v_cvt_pk_bf16_f32 v77, v104, v105
 v_lshlrev_b32 v104, 16, v77
 v_and_b32 v105, 0xffff0000, v77
 v_mul_f32 v104, v104, v136
 v_mul_f32 v105, v105, v136
 v_cvt_pk_bf16_f32 v77, v104, v105
 v_sub_f32 v106, v106, v134
 v_sub_f32 v107, v107, v134
 v_cvt_pk_bf16_f32 v78, v106, v107
 v_lshlrev_b32 v106, 16, v78
 v_and_b32 v107, 0xffff0000, v78
 v_mul_f32 v106, v106, v136
 v_mul_f32 v107, v107, v136
 v_cvt_pk_bf16_f32 v78, v106, v107
 v_sub_f32 v108, v108, v134
 v_sub_f32 v109, v109, v134
 v_cvt_pk_bf16_f32 v79, v108, v109
 v_lshlrev_b32 v108, 16, v79
 v_and_b32 v109, 0xffff0000, v79
 v_mul_f32 v108, v108, v136
 v_mul_f32 v109, v109, v136
 v_cvt_pk_bf16_f32 v79, v108, v109
 buffer_store_dwordx4 v[76:79], v70, s[12:15], s83 offen sc1
 v_sub_f32 v110, v110, v134
 v_sub_f32 v111, v111, v134
 v_cvt_pk_bf16_f32 v80, v110, v111
 v_lshlrev_b32 v110, 16, v80
 v_and_b32 v111, 0xffff0000, v80
 v_mul_f32 v110, v110, v136
 v_mul_f32 v111, v111, v136
 v_cvt_pk_bf16_f32 v80, v110, v111
 v_sub_f32 v112, v112, v134
 v_sub_f32 v113, v113, v134
 v_cvt_pk_bf16_f32 v81, v112, v113
 v_lshlrev_b32 v112, 16, v81
 v_and_b32 v113, 0xffff0000, v81
 v_mul_f32 v112, v112, v136
 v_mul_f32 v113, v113, v136
 v_cvt_pk_bf16_f32 v81, v112, v113
 v_sub_f32 v114, v114, v134
 v_sub_f32 v115, v115, v134
 v_cvt_pk_bf16_f32 v82, v114, v115
 v_lshlrev_b32 v114, 16, v82
 v_and_b32 v115, 0xffff0000, v82
 v_mul_f32 v114, v114, v136
 v_mul_f32 v115, v115, v136
 v_cvt_pk_bf16_f32 v82, v114, v115
 v_sub_f32 v116, v116, v134
 v_sub_f32 v117, v117, v134
 v_cvt_pk_bf16_f32 v83, v116, v117
 v_lshlrev_b32 v116, 16, v83
 v_and_b32 v117, 0xffff0000, v83
 v_mul_f32 v116, v116, v136
 v_mul_f32 v117, v117, v136
 v_cvt_pk_bf16_f32 v83, v116, v117
 buffer_store_dwordx4 v[80:83], v70, s[12:15], s84 offen sc1
 v_sub_f32 v118, v118, v134
 v_sub_f32 v119, v119, v134
 v_cvt_pk_bf16_f32 v84, v118, v119
 v_lshlrev_b32 v118, 16, v84
 v_and_b32 v119, 0xffff0000, v84
 v_mul_f32 v118, v118, v136
 v_mul_f32 v119, v119, v136
 v_cvt_pk_bf16_f32 v84, v118, v119
 v_sub_f32 v120, v120, v134
 v_sub_f32 v121, v121, v134
 v_cvt_pk_bf16_f32 v85, v120, v121
 v_lshlrev_b32 v120, 16, v85
 v_and_b32 v121, 0xffff0000, v85
 v_mul_f32 v120, v120, v136
 v_mul_f32 v121, v121, v136
 v_cvt_pk_bf16_f32 v85, v120, v121
 v_sub_f32 v122, v122, v134
 v_sub_f32 v123, v123, v134
 v_cvt_pk_bf16_f32 v86, v122, v123
 v_lshlrev_b32 v122, 16, v86
 v_and_b32 v123, 0xffff0000, v86
 v_mul_f32 v122, v122, v136
 v_mul_f32 v123, v123, v136
 v_cvt_pk_bf16_f32 v86, v122, v123
 v_sub_f32 v124, v124, v134
 v_sub_f32 v125, v125, v134
 v_cvt_pk_bf16_f32 v87, v124, v125
 v_lshlrev_b32 v124, 16, v87
 v_and_b32 v125, 0xffff0000, v87
 v_mul_f32 v124, v124, v136
 v_mul_f32 v125, v125, v136
 v_cvt_pk_bf16_f32 v87, v124, v125
 buffer_store_dwordx4 v[84:87], v70, s[12:15], s85 offen sc1
 v_sub_f32 v126, v126, v134
 v_sub_f32 v127, v127, v134
 v_cvt_pk_bf16_f32 v88, v126, v127
 v_lshlrev_b32 v126, 16, v88
 v_and_b32 v127, 0xffff0000, v88
 v_mul_f32 v126, v126, v136
 v_mul_f32 v127, v127, v136
 v_cvt_pk_bf16_f32 v88, v126, v127
 v_sub_f32 v128, v128, v134
 v_sub_f32 v129, v129, v134
 v_cvt_pk_bf16_f32 v89, v128, v129
 v_lshlrev_b32 v128, 16, v89
 v_and_b32 v129, 0xffff0000, v89
 v_mul_f32 v128, v128, v136
 v_mul_f32 v129, v129, v136
 v_cvt_pk_bf16_f32 v89, v128, v129
 v_sub_f32 v130, v130, v134
 v_sub_f32 v131, v131, v134
 v_cvt_pk_bf16_f32 v90, v130, v131
 v_lshlrev_b32 v130, 16, v90
 v_and_b32 v131, 0xffff0000, v90
 v_mul_f32 v130, v130, v136
 v_mul_f32 v131, v131, v136
 v_cvt_pk_bf16_f32 v90, v130, v131
 v_sub_f32 v132, v132, v134
 v_sub_f32 v133, v133, v134
 v_cvt_pk_bf16_f32 v91, v132, v133
 v_lshlrev_b32 v132, 16, v91
 v_and_b32 v133, 0xffff0000, v91
 v_mul_f32 v132, v132, v136
 v_mul_f32 v133, v133, v136
 v_cvt_pk_bf16_f32 v91, v132, v133
 s_mov_b64 exec, s[26:27]
 buffer_store_dwordx4 v[88:91], v70, s[12:15], s86 offen sc1
 s_mov_b64 exec, -1
 s_mov_b32 s3, 0
L_ep_l:
 s_memrealtime s[24:25]
 s_waitcnt vmcnt(0) lgkmcnt(0)
 v_readfirstlane_b32 s79, v149
 s_add_u32 s80, s24, 100
 s_nop 2
 s_sub_u32 s80, s80, s79
 s_bitcmp0_b32 s79, 0
 s_cselect_b32 s80, -1, s80
 s_cmp_lt_u32 s80, 5100
 s_cbranch_scc1 L_ep_ok
 s_and_b32 s79, s79, 1
 s_mul_i32 s79, s79, 127
 s_add_u32 s3, s3, s79
 s_add_u32 s3, s3, 1
 s_cmp_gt_u32 s3, 0x40000
 s_cbranch_scc1 L_ep_ok
 buffer_load_dword v149, v148, s[20:23], 0 offen sc1
 s_branch L_ep_l
L_ep_ok:
 s_waitcnt vmcnt(0)
 buffer_store_dword v149, v146, s[32:35], s82 offen sc1
 v_mov_b32 v148, 163836
 ds_write_b32 v148, v149
 s_mov_b32 s57, s81
 s_branch L_join
L_role_b:
 s_getpc_b64 s[28:29]
L_ct1:
 s_add_u32 s28, s28, L_join-L_ct1
 s_addc_u32 s29, s29, 0
 s_lshr_b32 s3, s2, 3
 s_lshl_b32 s3, s3, 12
 v_and_b32 v154, 31, v3
 v_lshlrev_b32 v154, 7, v154
 v_add_u32 v154, s3, v154
 v_min_u32 v154, L_code_end-L_join-4, v154
 v_mov_b32 v155, s29
 v_add_co_u32 v154, vcc, s28, v154
 s_nop 1
 v_addc_co_u32 v155, vcc, 0, v155, vcc
 global_load_dword v153, v[154:155], off
 s_lshr_b32 s79, s2, 3
 s_mul_i32 s79, s79, 110592
 s_and_b32 s80, s2, 7
 s_mul_i32 s80, s80, 1152
 s_add_u32 s79, s79, s80
 s_waitcnt lgkmcnt(0)
 s_cmp_eq_u32 s52, 3
 s_cselect_b32 s24, s46, s44
 s_cselect_b32 s25, s47, s45
 s_add_u32 s24, s24, s79
 s_addc_u32 s25, s25, 0
 s_mov_b32 s26, 0x19080
 s_mov_b32 s27, 0x00020000
 v_add_u32 v156, 0, v3
 v_mul_u32_u24 v157, 7282, v156
 v_lshrrev_b32 v157, 16, v157
 v_mul_u32_u24 v157, 8064, v157
 v_lshl_add_u32 v157, v156, 7, v157
 buffer_load_dword v159, v157, s[24:27], 0 offen
 v_add_u32 v156, 64, v3
 v_mul_u32_u24 v157, 7282, v156
 v_lshrrev_b32 v157, 16, v157
 v_mul_u32_u24 v157, 8064, v157
 v_lshl_add_u32 v157, v156, 7, v157
 buffer_load_dword v160, v157, s[24:27], 0 offen
 s_mov_b32 s82, 0x320000
 s_add_u32 s32, s100, s82
 s_addc_u32 s33, s101, 0
 s_mov_b32 s34, 0x10000
 s_mov_b32 s35, 0x00020000
 v_lshlrev_b32 v147, 7, v3
 s_mov_b32 s57, 0
L_join:
 v_lshlrev_b32 v2, 4, v3
 s_and_b32 s81, s58, 1
 s_lshl_b32 s81, s81, 1
 v_add_u32 v37, s81, v3
 v_mul_u32_u24 v38, 3641, v3
 v_mul_u32_u24 v39, 3641, v37
 s_movk_i32 s88, 9216
 s_movk_i32 s89, -288
 v_add_u32 v34, 0, v38
 v_add_u32 v35, 0, v39
 v_lshrrev_b32 v34, 16, v34
 v_lshrrev_b32 v35, 16, v35
 v_lshlrev_b32 v36, 4, v37
 v_mad_u32_u24 v34, v34, s88, v36
 v_mad_i32_i24 v8, v35, s89, v34
 v_add_u32 v34, 233024, v38
 v_add_u32 v35, 233024, v39
 v_lshrrev_b32 v34, 16, v34
 v_lshrrev_b32 v35, 16, v35
 v_mad_u32_u24 v34, v34, s88, v36
 v_mad_i32_i24 v9, v35, s89, v34
 v_add_u32 v34, 466048, v38
 v_add_u32 v35, 466048, v39
 v_lshrrev_b32 v34, 16, v34
 v_lshrrev_b32 v35, 16, v35
 v_mad_u32_u24 v34, v34, s88, v36
 v_mad_i32_i24 v10, v35, s89, v34
 v_add_u32 v34, 699072, v38
 v_add_u32 v35, 699072, v39
 v_lshrrev_b32 v34, 16, v34
 v_lshrrev_b32 v35, 16, v35
 v_mad_u32_u24 v34, v34, s88, v36
 v_mad_i32_i24 v11, v35, s89, v34
 s_mul_i32 s60, s52, 9216
 s_and_b32 s82, s52, 1
 s_mul_i32 s61, s82, 294912
 s_mul_i32 s81, s58, 288
 s_sub_u32 s82, 5308416, s81
 s_lshl_b32 s85, s59, 2
 s_add_u32 s85, s85, s52
 s_mul_i32 s86, s85, 73728
 s_cmp_lt_u32 s52, 2
 s_waitcnt lgkmcnt(0)
 s_cselect_b32 s48, s44, s46
 s_cselect_b32 s49, s45, s47
 s_add_u32 s16, s48, s81
 s_addc_u32 s17, s49, 0
 s_mov_b32 s18, s82
 s_mov_b32 s19, 0x00020000
 s_add_u32 s12, s100, s86
 s_addc_u32 s13, s101, 0
 s_mov_b32 s14, 0x12000
 s_mov_b32 s15, 0x00020000
 s_add_u32 s87, s61, 0
 s_add_u32 m0, s60, 0
 s_nop 0
 buffer_load_dwordx4 v8, s[16:19], s87 offen offset:0 lds
 buffer_load_dwordx4 v9, s[16:19], s87 offen offset:1024 lds
 buffer_load_dwordx4 v10, s[16:19], s87 offen offset:2048 lds
 buffer_load_dwordx4 v11, s[16:19], s87 offen offset:3072 lds
 v_add_u32 v34, 932096, v38
 v_add_u32 v35, 932096, v39
 v_lshrrev_b32 v34, 16, v34
 v_lshrrev_b32 v35, 16, v35
 v_add_u32 v36, 4096, v36
 v_mad_u32_u24 v34, v34, s88, v36
 v_mad_i32_i24 v12, v35, s89, v34
 v_add_u32 v34, 1165120, v38
 v_add_u32 v35, 1165120, v39
 v_lshrrev_b32 v34, 16, v34
 v_lshrrev_b32 v35, 16, v35
 v_mad_u32_u24 v34, v34, s88, v36
 v_mad_i32_i24 v13, v35, s89, v34
 v_add_u32 v34, 1398144, v38
 v_add_u32 v35, 1398144, v39
 v_lshrrev_b32 v34, 16, v34
 v_lshrrev_b32 v35, 16, v35
 v_mad_u32_u24 v34, v34, s88, v36
 v_mad_i32_i24 v14, v35, s89, v34
 v_add_u32 v34, 1631168, v38
 v_add_u32 v35, 1631168, v39
 v_lshrrev_b32 v34, 16, v34
 v_lshrrev_b32 v35, 16, v35
 v_mad_u32_u24 v34, v34, s88, v36
 v_mad_i32_i24 v15, v35, s89, v34
 v_add_u32 v34, 1864192, v38
 v_add_u32 v35, 1864192, v39
 v_lshrrev_b32 v34, 16, v34
 v_lshrrev_b32 v35, 16, v35
 v_add_u32 v36, 4096, v36
 v_mad_u32_u24 v34, v34, s88, v36
 v_mad_i32_i24 v16, v35, s89, v34
 s_add_u32 m0, s60, 4096
 s_nop 0
 buffer_load_dwordx4 v12, s[16:19], s87 offen offset:0 lds
 buffer_load_dwordx4 v13, s[16:19], s87 offen offset:1024 lds
 buffer_load_dwordx4 v14, s[16:19], s87 offen offset:2048 lds
 buffer_load_dwordx4 v15, s[16:19], s87 offen offset:3072 lds
 s_add_u32 m0, s60, 8192
 s_nop 0
 buffer_load_dwordx4 v16, s[16:19], s87 offen offset:0 lds
 s_cmp_eq_u32 s52, 0
 s_cbranch_scc1 L_lnp
L_lnp_ok:
 s_waitcnt lgkmcnt(0)
 s_barrier
 s_mov_b32 s79, 0
 buffer_load_dwordx4 a[160:163], v2, s[12:15], s79 offen offset:0 sc1
 buffer_load_dwordx4 a[164:167], v2, s[12:15], s79 offen offset:1024 sc1
 s_mov_b32 s80, 18432
 buffer_load_dwordx4 a[168:171], v2, s[12:15], s80 offen offset:0 sc1
 buffer_load_dwordx4 a[172:175], v2, s[12:15], s80 offen offset:1024 sc1
 s_mov_b32 s81, 36864
 buffer_load_dwordx4 a[176:179], v2, s[12:15], s81 offen offset:0 sc1
 buffer_load_dwordx4 a[180:183], v2, s[12:15], s81 offen offset:1024 sc1
 s_mov_b32 s82, 55296
 buffer_load_dwordx4 a[184:187], v2, s[12:15], s82 offen offset:0 sc1
 buffer_load_dwordx4 a[188:191], v2, s[12:15], s82 offen offset:1024 sc1
 v_mov_b32 v64, 163836
 ds_read_b32 v65, v64
 s_waitcnt lgkmcnt(0)
 v_readfirstlane_b32 s54, v65
 s_lshr_b32 s79, s2, 3
 s_and_b32 s80, s2, 7
 s_lshl_b32 s81, s79, 1
 s_and_b32 s82, s52, 1
 s_add_u32 s81, s81, s82
 s_mul_i32 s81, s81, 9216
 s_mul_i32 s82, s80, 1152
 s_add_u32 s81, s81, s82
 s_sub_u32 s88, 5308416, s81
 s_lshl_b32 s83, s79, 2
 s_add_u32 s83, s83, s52
 s_lshl_b32 s83, s83, 13
 s_lshl_b32 s82, s80, 10
 s_add_u32 s83, s83, s82
 s_sub_u32 s89, 4718592, s83
 s_lshl_b32 s84, s58, 19
 s_add_u32 s4, s36, s84
 s_addc_u32 s5, s37, 0
 s_mov_b32 s6, 0x80000
 s_mov_b32 s7, 0x00020000
 s_add_u32 s8, s38, s84
 s_addc_u32 s9, s39, 0
 s_mov_b32 s10, 0x80000
 s_mov_b32 s11, 0x00020000
 s_lshl_b32 s84, s58, 8
 s_sub_u32 s82, 4718592, s84
 s_add_u32 s20, s40, s84
 s_addc_u32 s21, s41, 0
 s_mov_b32 s22, s82
 s_mov_b32 s23, 0x00020000
 s_add_u32 s36, s48, s81
 s_addc_u32 s37, s49, 0
 s_mov_b32 s38, s88
 s_mov_b32 s39, 0x00020000
 s_add_u32 s40, s40, s83
 s_addc_u32 s41, s41, 0
 s_mov_b32 s42, s89
 s_mov_b32 s43, 0x00020000
 v_lshlrev_b32 v35, 7, v3
 v_mov_b32 v36, 0x7f000000
 v_cmp_gt_u32 vcc, 9, v3
 s_nop 1
 v_cndmask_b32 v28, v36, v35, vcc
 v_cmp_gt_u32 vcc, 8, v3
 s_nop 1
 v_cndmask_b32 v29, v36, v35, vcc
 s_mov_b32 s63, 0x3e0293ee
 s_mov_b32 s64, 0xbfb8aa3b
 s_lshl_b32 s53, s52, 12
 s_mov_b32 s55, 0
 s_mov_b32 s56, 0
 v_lshrrev_b32 v34, 2, v3
 v_mul_u32_u24 v35, 288, v34
 v_and_b32 v36, 3, v3
 v_lshl_add_u32 v4, v36, 3, v35
 v_add_u32 v5, 36864, v4
 v_add_u32 v6, 73728, v4
 v_add_u32 v7, 110592, v4
 v_and_b32 v34, 15, v3
 v_lshrrev_b32 v35, 4, v3
 v_lshlrev_b32 v37, 1, v35
 v_xor_b32 v37, v34, v37
 v_lshlrev_b32 v37, 4, v37
 v_lshl_add_u32 v20, v35, 13, v37
 v_xor_b32 v21, 128, v20
 s_lshl_b32 s62, s52, 17
 v_and_b32 v34, 15, v3
 v_lshrrev_b32 v35, 4, v3
 v_lshlrev_b32 v36, 8, v35
 v_add_u32 v36, s53, v36
 v_xor_b32 v37, v34, v35
 v_lshl_add_u32 v22, v37, 4, v36
 v_xor_b32 v23, 64, v22
 v_xor_b32 v24, 128, v22
 v_xor_b32 v25, 192, v22
 v_lshlrev_b32 v37, 1, v35
 v_xor_b32 v37, v34, v37
 v_lshl_add_u32 v26, v37, 4, v36
 v_xor_b32 v27, 128, v26
 s_mul_i32 s82, s85, 594944
 s_add_u32 s82, s82, 0x1800000
 s_add_u32 s24, s100, s82
 s_addc_u32 s25, s101, 0
 s_mov_b32 s26, 0x91400
 s_mov_b32 s27, 0x00020000
 s_mul_i32 s82, s59, 2117632
 s_lshl_b32 s83, s58, 12
 s_add_u32 s82, s82, s83
 s_add_u32 s82, s82, 0x400000
 s_sub_u32 s84, 2117632, s83
 s_add_u32 s28, s100, s82
 s_addc_u32 s29, s101, 0
 s_mov_b32 s30, s84
 s_mov_b32 s31, 0x00020000
 s_mov_b32 s82, 0x300000
 s_add_u32 s32, s100, s82
 s_addc_u32 s33, s101, 0
 s_mov_b32 s34, 0x28000
 s_mov_b32 s35, 0x00020000
 s_lshr_b32 s69, s58, 3
 s_and_b32 s79, s58, 7
 s_lshl_b32 s70, s59, 3
 s_add_u32 s70, s70, s79
 s_lshl_b32 s79, s69, 6
 s_add_u32 s79, s79, s70
 s_lshl_b32 s65, s79, 7
 s_lshl_b32 s66, s69, 13
 s_mul_i32 s81, s58, 9
 s_add_u32 s81, s81, 1
 s_lshr_b32 s81, s81, 1
 s_lshl_b32 s71, s81, 10
 s_bitcmp1_b32 s58, 0
 s_mov_b32 s82, 4096
 s_cselect_b32 s82, -1016, s82
 s_add_u32 s75, s71, s82
 s_add_u32 s72, s71, 148736
 s_add_u32 s76, s75, 148736
 s_add_u32 s73, s71, 297472
 s_add_u32 s77, s75, 297472
 s_add_u32 s74, s71, 446208
 s_add_u32 s78, s75, 446208
 s_add_u32 s87, s61, 589824
 s_add_u32 m0, s60, 36864
 s_nop 0
 buffer_load_dwordx4 v8, s[16:19], s87 offen offset:0 lds
 buffer_load_dwordx4 v9, s[16:19], s87 offen offset:1024 lds
 buffer_load_dwordx4 v10, s[16:19], s87 offen offset:2048 lds
 buffer_load_dwordx4 v11, s[16:19], s87 offen offset:3072 lds
 s_add_u32 m0, s60, 40960
 s_nop 0
 buffer_load_dwordx4 v12, s[16:19], s87 offen offset:0 lds
 buffer_load_dwordx4 v13, s[16:19], s87 offen offset:1024 lds
 buffer_load_dwordx4 v14, s[16:19], s87 offen offset:2048 lds
 buffer_load_dwordx4 v15, s[16:19], s87 offen offset:3072 lds
 s_add_u32 m0, s60, 45056
 s_nop 0
 buffer_load_dwordx4 v16, s[16:19], s87 offen offset:0 lds
 s_waitcnt vmcnt(17)
 s_barrier
 ds_read_b64_tr_b16 a[128:129], v4 offset:0
 ds_read_b64_tr_b16 a[130:131], v4 offset:4608
 ds_read_b64_tr_b16 a[132:133], v4 offset:9216
 ds_read_b64_tr_b16 a[134:135], v4 offset:13824
 s_waitcnt vmcnt(16) lgkmcnt(2)
 v_mfma_f32_16x16x32_bf16 v[40:43], a[128:131], a[160:163], 0
 s_mov_b32 s79, 2048
 ds_read_b64_tr_b16 a[136:137], v4 offset:18432
 ds_read_b64_tr_b16 a[138:139], v4 offset:23040
 s_waitcnt vmcnt(15) lgkmcnt(2)
 v_mfma_f32_16x16x32_bf16 v[40:43], a[132:135], a[164:167], v[40:43]
 ds_read_b64_tr_b16 a[140:141], v4 offset:27648
 ds_read_b64_tr_b16 a[142:143], v4 offset:32256
 s_waitcnt vmcnt(14)
 v_mfma_f32_16x16x32_bf16 v[44:47], a[128:131], a[168:171], 0
 ds_read_b64_tr_b16 a[144:145], v4 offset:32
 ds_read_b64_tr_b16 a[146:147], v4 offset:4640
 s_waitcnt vmcnt(13)
 v_mfma_f32_16x16x32_bf16 v[44:47], a[132:135], a[172:175], v[44:47]
 ds_read_b64_tr_b16 a[148:149], v4 offset:9248
 ds_read_b64_tr_b16 a[150:151], v4 offset:13856
 s_waitcnt vmcnt(12)
 v_mfma_f32_16x16x32_bf16 v[48:51], a[128:131], a[176:179], 0
 buffer_load_dwordx4 a[192:195], v2, s[12:15], s79 offen offset:0 sc1
 s_waitcnt vmcnt(12)
 v_mfma_f32_16x16x32_bf16 v[48:51], a[132:135], a[180:183], v[48:51]
 s_waitcnt vmcnt(11)
 v_mfma_f32_16x16x32_bf16 v[52:55], a[128:131], a[184:187], 0
 s_waitcnt vmcnt(10)
 v_mfma_f32_16x16x32_bf16 v[52:55], a[132:135], a[188:191], v[52:55]
 s_waitcnt lgkmcnt(4)
 v_mfma_f32_16x16x32_bf16 a[0:3], a[136:139], a[160:163], 0
 ds_read_b64_tr_b16 a[152:153], v4 offset:18464
 ds_read_b64_tr_b16 a[154:155], v4 offset:23072
 v_mfma_f32_16x16x32_bf16 a[0:3], a[140:143], a[164:167], a[0:3]
 buffer_load_dwordx4 a[196:199], v2, s[12:15], s79 offen offset:1024 sc1
 v_mfma_f32_16x16x32_bf16 a[4:7], a[136:139], a[168:171], 0
 s_mov_b32 s80, 20480
 ds_read_b64_tr_b16 a[156:157], v4 offset:27680
 ds_read_b64_tr_b16 a[158:159], v4 offset:32288
 v_mfma_f32_16x16x32_bf16 a[4:7], a[140:143], a[172:175], a[4:7]
 v_mfma_f32_16x16x32_bf16 a[8:11], a[136:139], a[176:179], 0
 v_mfma_f32_16x16x32_bf16 a[8:11], a[140:143], a[180:183], a[8:11]
 v_mfma_f32_16x16x32_bf16 a[12:15], a[136:139], a[184:187], 0
 buffer_load_dwordx4 a[200:203], v2, s[12:15], s80 offen offset:0 sc1
 v_mfma_f32_16x16x32_bf16 a[12:15], a[140:143], a[188:191], a[12:15]
 s_waitcnt lgkmcnt(4)
 v_mfma_f32_16x16x32_bf16 v[56:59], a[144:147], a[160:163], 0
 ds_read_b64_tr_b16 a[128:129], v4 offset:64
 ds_read_b64_tr_b16 a[130:131], v4 offset:4672
 v_mfma_f32_16x16x32_bf16 v[56:59], a[148:151], a[164:167], v[56:59]
 v_mfma_f32_16x16x32_bf16 v[60:63], a[144:147], a[168:171], 0
 ds_read_b64_tr_b16 a[132:133], v4 offset:9280
 ds_read_b64_tr_b16 a[134:135], v4 offset:13888
 v_mfma_f32_16x16x32_bf16 v[60:63], a[148:151], a[172:175], v[60:63]
 buffer_load_dwordx4 a[204:207], v2, s[12:15], s80 offen offset:1024 sc1
 v_mfma_f32_16x16x32_bf16 v[64:67], a[144:147], a[176:179], 0
 s_mov_b32 s81, 38912
 v_mfma_f32_16x16x32_bf16 v[64:67], a[148:151], a[180:183], v[64:67]
 v_mfma_f32_16x16x32_bf16 v[68:71], a[144:147], a[184:187], 0
 v_mfma_f32_16x16x32_bf16 v[68:71], a[148:151], a[188:191], v[68:71]
 s_waitcnt lgkmcnt(4)
 v_mfma_f32_16x16x32_bf16 a[16:19], a[152:155], a[160:163], 0
 ds_read_b64_tr_b16 a[136:137], v4 offset:18496
 ds_read_b64_tr_b16 a[138:139], v4 offset:23104
 v_mfma_f32_16x16x32_bf16 a[16:19], a[156:159], a[164:167], a[16:19]
 buffer_load_dwordx4 a[208:211], v2, s[12:15], s81 offen offset:0 sc1
 v_mfma_f32_16x16x32_bf16 a[20:23], a[152:155], a[168:171], 0
 ds_read_b64_tr_b16 a[140:141], v4 offset:27712
 ds_read_b64_tr_b16 a[142:143], v4 offset:32320
 v_mfma_f32_16x16x32_bf16 a[20:23], a[156:159], a[172:175], a[20:23]
 v_mfma_f32_16x16x32_bf16 a[24:27], a[152:155], a[176:179], 0
 v_mfma_f32_16x16x32_bf16 a[24:27], a[156:159], a[180:183], a[24:27]
 v_mfma_f32_16x16x32_bf16 a[28:31], a[152:155], a[184:187], 0
 buffer_load_dwordx4 a[212:215], v2, s[12:15], s81 offen offset:1024 sc1
 v_mfma_f32_16x16x32_bf16 a[28:31], a[156:159], a[188:191], a[28:31]
 s_waitcnt lgkmcnt(4)
 v_mfma_f32_16x16x32_bf16 v[72:75], a[128:131], a[160:163], 0
 s_mov_b32 s82, 57344
 ds_read_b64_tr_b16 a[144:145], v4 offset:96
 ds_read_b64_tr_b16 a[146:147], v4 offset:4704
 v_mfma_f32_16x16x32_bf16 v[72:75], a[132:135], a[164:167], v[72:75]
 v_mfma_f32_16x16x32_bf16 v[76:79], a[128:131], a[168:171], 0
 ds_read_b64_tr_b16 a[148:149], v4 offset:9312
 ds_read_b64_tr_b16 a[150:151], v4 offset:13920
 v_mfma_f32_16x16x32_bf16 v[76:79], a[132:135], a[172:175], v[76:79]
 buffer_load_dwordx4 a[216:219], v2, s[12:15], s82 offen offset:0 sc1
 v_mfma_f32_16x16x32_bf16 v[80:83], a[128:131], a[176:179], 0
 v_mfma_f32_16x16x32_bf16 v[80:83], a[132:135], a[180:183], v[80:83]
 v_mfma_f32_16x16x32_bf16 v[84:87], a[128:131], a[184:187], 0
 v_mfma_f32_16x16x32_bf16 v[84:87], a[132:135], a[188:191], v[84:87]
 s_waitcnt lgkmcnt(4)
 v_mfma_f32_16x16x32_bf16 a[32:35], a[136:139], a[160:163], 0
 ds_read_b64_tr_b16 a[152:153], v4 offset:18528
 ds_read_b64_tr_b16 a[154:155], v4 offset:23136
 v_mfma_f32_16x16x32_bf16 a[32:35], a[140:143], a[164:167], a[32:35]
 buffer_load_dwordx4 a[220:223], v2, s[12:15], s82 offen offset:1024 sc1
 v_mfma_f32_16x16x32_bf16 a[36:39], a[136:139], a[168:171], 0
 s_add_u32 s87, s61, 1179648
 ds_read_b64_tr_b16 a[156:157], v4 offset:27744
 ds_read_b64_tr_b16 a[158:159], v4 offset:32352
 v_mfma_f32_16x16x32_bf16 a[36:39], a[140:143], a[172:175], a[36:39]
 s_add_u32 m0, s60, 73728
 v_mfma_f32_16x16x32_bf16 a[40:43], a[136:139], a[176:179], 0
 v_mfma_f32_16x16x32_bf16 a[40:43], a[140:143], a[180:183], a[40:43]
 v_mfma_f32_16x16x32_bf16 a[44:47], a[136:139], a[184:187], 0
 buffer_load_dwordx4 v8, s[16:19], s87 offen offset:0 lds
 v_mfma_f32_16x16x32_bf16 a[44:47], a[140:143], a[188:191], a[44:47]
 s_waitcnt lgkmcnt(4)
 v_mfma_f32_16x16x32_bf16 v[88:91], a[144:147], a[160:163], 0
 ds_read_b64_tr_b16 a[128:129], v4 offset:128
 ds_read_b64_tr_b16 a[130:131], v4 offset:4736
 v_mfma_f32_16x16x32_bf16 v[88:91], a[148:151], a[164:167], v[88:91]
 v_mfma_f32_16x16x32_bf16 v[92:95], a[144:147], a[168:171], 0
 ds_read_b64_tr_b16 a[132:133], v4 offset:9344
 ds_read_b64_tr_b16 a[134:135], v4 offset:13952
 v_mfma_f32_16x16x32_bf16 v[92:95], a[148:151], a[172:175], v[92:95]
 buffer_load_dwordx4 v9, s[16:19], s87 offen offset:1024 lds
 v_mfma_f32_16x16x32_bf16 v[96:99], a[144:147], a[176:179], 0
 v_mfma_f32_16x16x32_bf16 v[96:99], a[148:151], a[180:183], v[96:99]
 v_mfma_f32_16x16x32_bf16 v[100:103], a[144:147], a[184:187], 0
 v_mfma_f32_16x16x32_bf16 v[100:103], a[148:151], a[188:191], v[100:103]
 s_waitcnt lgkmcnt(4)
 v_mfma_f32_16x16x32_bf16 a[48:51], a[152:155], a[160:163], 0
 ds_read_b64_tr_b16 a[136:137], v4 offset:18560
 ds_read_b64_tr_b16 a[138:139], v4 offset:23168
 v_mfma_f32_16x16x32_bf16 a[48:51], a[156:159], a[164:167], a[48:51]
 buffer_load_dwordx4 v10, s[16:19], s87 offen offset:2048 lds
 v_mfma_f32_16x16x32_bf16 a[52:55], a[152:155], a[168:171], 0
 ds_read_b64_tr_b16 a[140:141], v4 offset:27776
 ds_read_b64_tr_b16 a[142:143], v4 offset:32384
 v_mfma_f32_16x16x32_bf16 a[52:55], a[156:159], a[172:175], a[52:55]
 v_mfma_f32_16x16x32_bf16 a[56:59], a[152:155], a[176:179], 0
 v_mfma_f32_16x16x32_bf16 a[56:59], a[156:159], a[180:183], a[56:59]
 v_mfma_f32_16x16x32_bf16 a[60:63], a[152:155], a[184:187], 0
 buffer_load_dwordx4 v11, s[16:19], s87 offen offset:3072 lds
 v_mfma_f32_16x16x32_bf16 a[60:63], a[156:159], a[188:191], a[60:63]
 s_waitcnt lgkmcnt(4)
 v_mfma_f32_16x16x32_bf16 v[104:107], a[128:131], a[160:163], 0
 s_add_u32 m0, s60, 77824
 ds_read_b64_tr_b16 a[144:145], v4 offset:160
 ds_read_b64_tr_b16 a[146:147], v4 offset:4768
 v_mfma_f32_16x16x32_bf16 v[104:107], a[132:135], a[164:167], v[104:107]
 v_mfma_f32_16x16x32_bf16 v[108:111], a[128:131], a[168:171], 0
 ds_read_b64_tr_b16 a[148:149], v4 offset:9376
 ds_read_b64_tr_b16 a[150:151], v4 offset:13984
 v_mfma_f32_16x16x32_bf16 v[108:111], a[132:135], a[172:175], v[108:111]
 buffer_load_dwordx4 v12, s[16:19], s87 offen offset:0 lds
 v_mfma_f32_16x16x32_bf16 v[112:115], a[128:131], a[176:179], 0
 v_mfma_f32_16x16x32_bf16 v[112:115], a[132:135], a[180:183], v[112:115]
 v_mfma_f32_16x16x32_bf16 v[116:119], a[128:131], a[184:187], 0
 v_mfma_f32_16x16x32_bf16 v[116:119], a[132:135], a[188:191], v[116:119]
 s_waitcnt lgkmcnt(4)
 v_mfma_f32_16x16x32_bf16 a[64:67], a[136:139], a[160:163], 0
 ds_read_b64_tr_b16 a[152:153], v4 offset:18592
 ds_read_b64_tr_b16 a[154:155], v4 offset:23200
 v_mfma_f32_16x16x32_bf16 a[64:67], a[140:143], a[164:167], a[64:67]
 buffer_load_dwordx4 v13, s[16:19], s87 offen offset:1024 lds
 v_mfma_f32_16x16x32_bf16 a[68:71], a[136:139], a[168:171], 0
 ds_read_b64_tr_b16 a[156:157], v4 offset:27808
 ds_read_b64_tr_b16 a[158:159], v4 offset:32416
 v_mfma_f32_16x16x32_bf16 a[68:71], a[140:143], a[172:175], a[68:71]
 v_mfma_f32_16x16x32_bf16 v[120:123], a[136:139], a[176:179], 0
 v_mfma_f32_16x16x32_bf16 v[120:123], a[140:143], a[180:183], v[120:123]
 v_mfma_f32_16x16x32_bf16 v[124:127], a[136:139], a[184:187], 0
 buffer_load_dwordx4 v14, s[16:19], s87 offen offset:2048 lds
 v_mfma_f32_16x16x32_bf16 v[124:127], a[140:143], a[188:191], v[124:127]
 s_waitcnt lgkmcnt(4)
 v_mfma_f32_16x16x32_bf16 v[128:131], a[144:147], a[160:163], 0
 ds_read_b64_tr_b16 a[128:129], v4 offset:192
 ds_read_b64_tr_b16 a[130:131], v4 offset:4800
 v_mfma_f32_16x16x32_bf16 v[128:131], a[148:151], a[164:167], v[128:131]
 v_mfma_f32_16x16x32_bf16 v[132:135], a[144:147], a[168:171], 0
 ds_read_b64_tr_b16 a[132:133], v4 offset:9408
 ds_read_b64_tr_b16 a[134:135], v4 offset:14016
 v_mfma_f32_16x16x32_bf16 v[132:135], a[148:151], a[172:175], v[132:135]
 buffer_load_dwordx4 v15, s[16:19], s87 offen offset:3072 lds
 v_mfma_f32_16x16x32_bf16 v[136:139], a[144:147], a[176:179], 0
 s_add_u32 m0, s60, 81920
 v_mfma_f32_16x16x32_bf16 v[136:139], a[148:151], a[180:183], v[136:139]
 v_mfma_f32_16x16x32_bf16 v[140:143], a[144:147], a[184:187], 0
 v_mfma_f32_16x16x32_bf16 v[140:143], a[148:151], a[188:191], v[140:143]
 s_waitcnt lgkmcnt(4)
 v_mfma_f32_16x16x32_bf16 v[144:147], a[152:155], a[160:163], 0
 ds_read_b64_tr_b16 a[136:137], v4 offset:18624
 ds_read_b64_tr_b16 a[138:139], v4 offset:23232
 v_mfma_f32_16x16x32_bf16 v[144:147], a[156:159], a[164:167], v[144:147]
 buffer_load_dwordx4 v16, s[16:19], s87 offen offset:0 lds
 v_mfma_f32_16x16x32_bf16 v[148:151], a[152:155], a[168:171], 0
 s_mov_b32 s86, 3538944
 ds_read_b64_tr_b16 a[140:141], v4 offset:27840
 ds_read_b64_tr_b16 a[142:143], v4 offset:32448
 v_mfma_f32_16x16x32_bf16 v[148:151], a[156:159], a[172:175], v[148:151]
 v_mfma_f32_16x16x32_bf16 v[152:155], a[152:155], a[176:179], 0
 v_mfma_f32_16x16x32_bf16 v[152:155], a[156:159], a[180:183], v[152:155]
 v_mfma_f32_16x16x32_bf16 v[156:159], a[152:155], a[184:187], 0
 buffer_load_dword v30, v28, s[36:39], s86 offen sc0
 v_mfma_f32_16x16x32_bf16 v[156:159], a[156:159], a[188:191], v[156:159]
 s_waitcnt lgkmcnt(4)
 v_mfma_f32_16x16x32_bf16 v[160:163], a[128:131], a[160:163], 0
 s_mov_b32 s86, 4194304
 ds_read_b64_tr_b16 a[144:145], v4 offset:224
 ds_read_b64_tr_b16 a[146:147], v4 offset:4832
 v_mfma_f32_16x16x32_bf16 v[160:163], a[132:135], a[164:167], v[160:163]
 v_mfma_f32_16x16x32_bf16 v[164:167], a[128:131], a[168:171], 0
 ds_read_b64_tr_b16 a[148:149], v4 offset:9440
 ds_read_b64_tr_b16 a[150:151], v4 offset:14048
 v_mfma_f32_16x16x32_bf16 v[164:167], a[132:135], a[172:175], v[164:167]
 buffer_load_dword v31, v29, s[40:43], s86 offen sc0
 v_mfma_f32_16x16x32_bf16 v[168:171], a[128:131], a[176:179], 0
 s_mov_b32 s79, 4096
 v_mfma_f32_16x16x32_bf16 v[168:171], a[132:135], a[180:183], v[168:171]
 v_mfma_f32_16x16x32_bf16 v[172:175], a[128:131], a[184:187], 0
 v_mfma_f32_16x16x32_bf16 v[172:175], a[132:135], a[188:191], v[172:175]
 s_waitcnt lgkmcnt(4)
 v_mfma_f32_16x16x32_bf16 v[176:179], a[136:139], a[160:163], 0
 ds_read_b64_tr_b16 a[152:153], v4 offset:18656
 ds_read_b64_tr_b16 a[154:155], v4 offset:23264
 v_mfma_f32_16x16x32_bf16 v[176:179], a[140:143], a[164:167], v[176:179]
 buffer_load_dwordx4 a[224:227], v2, s[12:15], s79 offen offset:0 sc1
 v_mfma_f32_16x16x32_bf16 v[180:183], a[136:139], a[168:171], 0
 ds_read_b64_tr_b16 a[156:157], v4 offset:27872
 ds_read_b64_tr_b16 a[158:159], v4 offset:32480
 v_mfma_f32_16x16x32_bf16 v[180:183], a[140:143], a[172:175], v[180:183]
 v_mfma_f32_16x16x32_bf16 v[184:187], a[136:139], a[176:179], 0
 v_mfma_f32_16x16x32_bf16 v[184:187], a[140:143], a[180:183], v[184:187]
 v_mfma_f32_16x16x32_bf16 v[188:191], a[136:139], a[184:187], 0
 buffer_load_dwordx4 a[228:231], v2, s[12:15], s79 offen offset:1024 sc1
 v_mfma_f32_16x16x32_bf16 v[188:191], a[140:143], a[188:191], v[188:191]
 s_waitcnt lgkmcnt(4)
 v_mfma_f32_16x16x32_bf16 v[192:195], a[144:147], a[160:163], 0
 s_mov_b32 s80, 22528
 ds_read_b64_tr_b16 a[128:129], v4 offset:256
 ds_read_b64_tr_b16 a[130:131], v4 offset:4864
 v_mfma_f32_16x16x32_bf16 v[192:195], a[148:151], a[164:167], v[192:195]
 v_mfma_f32_16x16x32_bf16 v[196:199], a[144:147], a[168:171], 0
 ds_read_b64_tr_b16 a[132:133], v4 offset:9472
 ds_read_b64_tr_b16 a[134:135], v4 offset:14080
 v_mfma_f32_16x16x32_bf16 v[196:199], a[148:151], a[172:175], v[196:199]
 buffer_load_dwordx4 a[232:235], v2, s[12:15], s80 offen offset:0 sc1
 v_mfma_f32_16x16x32_bf16 v[200:203], a[144:147], a[176:179], 0
 v_mfma_f32_16x16x32_bf16 v[200:203], a[148:151], a[180:183], v[200:203]
 v_mfma_f32_16x16x32_bf16 v[204:207], a[144:147], a[184:187], 0
 v_mfma_f32_16x16x32_bf16 v[204:207], a[148:151], a[188:191], v[204:207]
 s_waitcnt lgkmcnt(4)
 v_mfma_f32_16x16x32_bf16 v[208:211], a[152:155], a[160:163], 0
 ds_read_b64_tr_b16 a[136:137], v4 offset:18688
 ds_read_b64_tr_b16 a[138:139], v4 offset:23296
 v_mfma_f32_16x16x32_bf16 v[208:211], a[156:159], a[164:167], v[208:211]
 buffer_load_dwordx4 a[236:239], v2, s[12:15], s80 offen offset:1024 sc1
 v_mfma_f32_16x16x32_bf16 v[212:215], a[152:155], a[168:171], 0
 s_mov_b32 s81, 40960
 ds_read_b64_tr_b16 a[140:141], v4 offset:27904
 ds_read_b64_tr_b16 a[142:143], v4 offset:32512
 v_mfma_f32_16x16x32_bf16 v[212:215], a[156:159], a[172:175], v[212:215]
 v_mfma_f32_16x16x32_bf16 v[216:219], a[152:155], a[176:179], 0
 v_mfma_f32_16x16x32_bf16 v[216:219], a[156:159], a[180:183], v[216:219]
 v_mfma_f32_16x16x32_bf16 v[220:223], a[152:155], a[184:187], 0
 buffer_load_dwordx4 a[240:243], v2, s[12:15], s81 offen offset:0 sc1
 v_mfma_f32_16x16x32_bf16 v[220:223], a[156:159], a[188:191], v[220:223]
 s_waitcnt lgkmcnt(4)
 v_mfma_f32_16x16x32_bf16 v[224:227], a[128:131], a[160:163], 0
 v_mfma_f32_16x16x32_bf16 v[224:227], a[132:135], a[164:167], v[224:227]
 s_waitcnt vmcnt(24) lgkmcnt(0)
 v_mfma_f32_16x16x32_bf16 v[228:231], a[128:131], a[168:171], 0
 s_barrier
 v_mfma_f32_16x16x32_bf16 v[228:231], a[132:135], a[172:175], v[228:231]
 ds_read_b64_tr_b16 a[144:145], v5 offset:0
 ds_read_b64_tr_b16 a[146:147], v5 offset:4608
 v_mfma_f32_16x16x32_bf16 v[232:235], a[128:131], a[176:179], 0
 buffer_load_dwordx4 a[244:247], v2, s[12:15], s81 offen offset:1024 sc1
 v_mfma_f32_16x16x32_bf16 v[232:235], a[132:135], a[180:183], v[232:235]
 s_mov_b32 s82, 59392
 ds_read_b64_tr_b16 a[148:149], v5 offset:9216
 ds_read_b64_tr_b16 a[150:151], v5 offset:13824
 v_mfma_f32_16x16x32_bf16 v[236:239], a[128:131], a[184:187], 0
 v_mfma_f32_16x16x32_bf16 v[236:239], a[132:135], a[188:191], v[236:239]
 v_mfma_f32_16x16x32_bf16 v[240:243], a[136:139], a[160:163], 0
 ds_read_b64_tr_b16 a[152:153], v5 offset:18432
 ds_read_b64_tr_b16 a[154:155], v5 offset:23040
 v_mfma_f32_16x16x32_bf16 v[240:243], a[140:143], a[164:167], v[240:243]
 buffer_load_dwordx4 a[248:251], v2, s[12:15], s82 offen offset:0 sc1
 v_mfma_f32_16x16x32_bf16 v[244:247], a[136:139], a[168:171], 0
 ds_read_b64_tr_b16 a[156:157], v5 offset:27648
 ds_read_b64_tr_b16 a[158:159], v5 offset:32256
 v_mfma_f32_16x16x32_bf16 v[244:247], a[140:143], a[172:175], v[244:247]
 v_mfma_f32_16x16x32_bf16 v[248:251], a[136:139], a[176:179], 0
 v_mfma_f32_16x16x32_bf16 v[248:251], a[140:143], a[180:183], v[248:251]
 v_mfma_f32_16x16x32_bf16 v[252:255], a[136:139], a[184:187], 0
 buffer_load_dwordx4 a[252:255], v2, s[12:15], s82 offen offset:1024 sc1
 v_mfma_f32_16x16x32_bf16 v[252:255], a[140:143], a[188:191], v[252:255]
 s_waitcnt vmcnt(19) lgkmcnt(4)
 v_mfma_f32_16x16x32_bf16 v[40:43], a[144:147], a[192:195], v[40:43]
 s_add_u32 s87, s61, 1769472
 ds_read_b64_tr_b16 a[128:129], v5 offset:32
 ds_read_b64_tr_b16 a[130:131], v5 offset:4640
 v_mfma_f32_16x16x32_bf16 v[40:43], a[148:151], a[196:199], v[40:43]
 s_add_u32 m0, s60, 110592
 v_mfma_f32_16x16x32_bf16 v[44:47], a[144:147], a[200:203], v[44:47]
 ds_read_b64_tr_b16 a[132:133], v5 offset:9248
 ds_read_b64_tr_b16 a[134:135], v5 offset:13856
 v_mfma_f32_16x16x32_bf16 v[44:47], a[148:151], a[204:207], v[44:47]
 buffer_load_dwordx4 v8, s[16:19], s87 offen offset:0 lds
 v_mfma_f32_16x16x32_bf16 v[48:51], a[144:147], a[208:211], v[48:51]
 v_mfma_f32_16x16x32_bf16 v[48:51], a[148:151], a[212:215], v[48:51]
 v_mfma_f32_16x16x32_bf16 v[52:55], a[144:147], a[216:219], v[52:55]
 v_mfma_f32_16x16x32_bf16 v[52:55], a[148:151], a[220:223], v[52:55]
 s_waitcnt lgkmcnt(4)
 v_mfma_f32_16x16x32_bf16 a[0:3], a[152:155], a[192:195], a[0:3]
 ds_read_b64_tr_b16 a[136:137], v5 offset:18464
 ds_read_b64_tr_b16 a[138:139], v5 offset:23072
 v_mfma_f32_16x16x32_bf16 a[0:3], a[156:159], a[196:199], a[0:3]
 buffer_load_dwordx4 v9, s[16:19], s87 offen offset:1024 lds
 v_mfma_f32_16x16x32_bf16 a[4:7], a[152:155], a[200:203], a[4:7]
 ds_read_b64_tr_b16 a[140:141], v5 offset:27680
 ds_read_b64_tr_b16 a[142:143], v5 offset:32288
 v_mfma_f32_16x16x32_bf16 a[4:7], a[156:159], a[204:207], a[4:7]
 v_mfma_f32_16x16x32_bf16 a[8:11], a[152:155], a[208:211], a[8:11]
 v_mfma_f32_16x16x32_bf16 a[8:11], a[156:159], a[212:215], a[8:11]
 v_mfma_f32_16x16x32_bf16 a[12:15], a[152:155], a[216:219], a[12:15]
 buffer_load_dwordx4 v10, s[16:19], s87 offen offset:2048 lds
 v_mfma_f32_16x16x32_bf16 a[12:15], a[156:159], a[220:223], a[12:15]
 s_waitcnt lgkmcnt(4)
 v_mfma_f32_16x16x32_bf16 v[56:59], a[128:131], a[192:195], v[56:59]
 ds_read_b64_tr_b16 a[144:145], v5 offset:64
 ds_read_b64_tr_b16 a[146:147], v5 offset:4672
 v_mfma_f32_16x16x32_bf16 v[56:59], a[132:135], a[196:199], v[56:59]
 v_mfma_f32_16x16x32_bf16 v[60:63], a[128:131], a[200:203], v[60:63]
 ds_read_b64_tr_b16 a[148:149], v5 offset:9280
 ds_read_b64_tr_b16 a[150:151], v5 offset:13888
 v_mfma_f32_16x16x32_bf16 v[60:63], a[132:135], a[204:207], v[60:63]
 buffer_load_dwordx4 v11, s[16:19], s87 offen offset:3072 lds
 v_mfma_f32_16x16x32_bf16 v[64:67], a[128:131], a[208:211], v[64:67]
 s_add_u32 m0, s60, 114688
 v_mfma_f32_16x16x32_bf16 v[64:67], a[132:135], a[212:215], v[64:67]
 v_mfma_f32_16x16x32_bf16 v[68:71], a[128:131], a[216:219], v[68:71]
 v_mfma_f32_16x16x32_bf16 v[68:71], a[132:135], a[220:223], v[68:71]
 s_waitcnt lgkmcnt(4)
 v_mfma_f32_16x16x32_bf16 a[16:19], a[136:139], a[192:195], a[16:19]
 ds_read_b64_tr_b16 a[152:153], v5 offset:18496
 ds_read_b64_tr_b16 a[154:155], v5 offset:23104
 v_mfma_f32_16x16x32_bf16 a[16:19], a[140:143], a[196:199], a[16:19]
 buffer_load_dwordx4 v12, s[16:19], s87 offen offset:0 lds
 v_mfma_f32_16x16x32_bf16 a[20:23], a[136:139], a[200:203], a[20:23]
 ds_read_b64_tr_b16 a[156:157], v5 offset:27712
 ds_read_b64_tr_b16 a[158:159], v5 offset:32320
 v_mfma_f32_16x16x32_bf16 a[20:23], a[140:143], a[204:207], a[20:23]
 v_mfma_f32_16x16x32_bf16 a[24:27], a[136:139], a[208:211], a[24:27]
 v_mfma_f32_16x16x32_bf16 a[24:27], a[140:143], a[212:215], a[24:27]
 v_mfma_f32_16x16x32_bf16 a[28:31], a[136:139], a[216:219], a[28:31]
 buffer_load_dwordx4 v13, s[16:19], s87 offen offset:1024 lds
 v_mfma_f32_16x16x32_bf16 a[28:31], a[140:143], a[220:223], a[28:31]
 s_waitcnt lgkmcnt(4)
 v_mfma_f32_16x16x32_bf16 v[72:75], a[144:147], a[192:195], v[72:75]
 ds_read_b64_tr_b16 a[128:129], v5 offset:96
 ds_read_b64_tr_b16 a[130:131], v5 offset:4704
 v_mfma_f32_16x16x32_bf16 v[72:75], a[148:151], a[196:199], v[72:75]
 v_mfma_f32_16x16x32_bf16 v[76:79], a[144:147], a[200:203], v[76:79]
 ds_read_b64_tr_b16 a[132:133], v5 offset:9312
 ds_read_b64_tr_b16 a[134:135], v5 offset:13920
 v_mfma_f32_16x16x32_bf16 v[76:79], a[148:151], a[204:207], v[76:79]
 buffer_load_dwordx4 v14, s[16:19], s87 offen offset:2048 lds
 v_mfma_f32_16x16x32_bf16 v[80:83], a[144:147], a[208:211], v[80:83]
 v_mfma_f32_16x16x32_bf16 v[80:83], a[148:151], a[212:215], v[80:83]
 v_mfma_f32_16x16x32_bf16 v[84:87], a[144:147], a[216:219], v[84:87]
 v_mfma_f32_16x16x32_bf16 v[84:87], a[148:151], a[220:223], v[84:87]
 s_waitcnt lgkmcnt(4)
 v_mfma_f32_16x16x32_bf16 a[32:35], a[152:155], a[192:195], a[32:35]
 ds_read_b64_tr_b16 a[136:137], v5 offset:18528
 ds_read_b64_tr_b16 a[138:139], v5 offset:23136
 v_mfma_f32_16x16x32_bf16 a[32:35], a[156:159], a[196:199], a[32:35]
 buffer_load_dwordx4 v15, s[16:19], s87 offen offset:3072 lds
 v_mfma_f32_16x16x32_bf16 a[36:39], a[152:155], a[200:203], a[36:39]
 s_add_u32 m0, s60, 118784
 ds_read_b64_tr_b16 a[140:141], v5 offset:27744
 ds_read_b64_tr_b16 a[142:143], v5 offset:32352
 v_mfma_f32_16x16x32_bf16 a[36:39], a[156:159], a[204:207], a[36:39]
 v_mfma_f32_16x16x32_bf16 a[40:43], a[152:155], a[208:211], a[40:43]
 v_mfma_f32_16x16x32_bf16 a[40:43], a[156:159], a[212:215], a[40:43]
 v_mfma_f32_16x16x32_bf16 a[44:47], a[152:155], a[216:219], a[44:47]
 buffer_load_dwordx4 v16, s[16:19], s87 offen offset:0 lds
 v_mfma_f32_16x16x32_bf16 a[44:47], a[156:159], a[220:223], a[44:47]
 s_waitcnt lgkmcnt(4)
 v_mfma_f32_16x16x32_bf16 v[88:91], a[128:131], a[192:195], v[88:91]
 s_add_u32 s87, s61, 2359296
 ds_read_b64_tr_b16 a[144:145], v5 offset:128
 ds_read_b64_tr_b16 a[146:147], v5 offset:4736
 v_mfma_f32_16x16x32_bf16 v[88:91], a[132:135], a[196:199], v[88:91]
 s_add_u32 m0, s60, 0
 v_mfma_f32_16x16x32_bf16 v[92:95], a[128:131], a[200:203], v[92:95]
 ds_read_b64_tr_b16 a[148:149], v5 offset:9344
 ds_read_b64_tr_b16 a[150:151], v5 offset:13952
 v_mfma_f32_16x16x32_bf16 v[92:95], a[132:135], a[204:207], v[92:95]
 buffer_load_dwordx4 v8, s[16:19], s87 offen offset:0 lds
 v_mfma_f32_16x16x32_bf16 v[96:99], a[128:131], a[208:211], v[96:99]
 v_mfma_f32_16x16x32_bf16 v[96:99], a[132:135], a[212:215], v[96:99]
 v_mfma_f32_16x16x32_bf16 v[100:103], a[128:131], a[216:219], v[100:103]
 v_mfma_f32_16x16x32_bf16 v[100:103], a[132:135], a[220:223], v[100:103]
 s_waitcnt lgkmcnt(4)
 v_mfma_f32_16x16x32_bf16 a[48:51], a[136:139], a[192:195], a[48:51]
 ds_read_b64_tr_b16 a[152:153], v5 offset:18560
 ds_read_b64_tr_b16 a[154:155], v5 offset:23168
 v_mfma_f32_16x16x32_bf16 a[48:51], a[140:143], a[196:199], a[48:51]
 buffer_load_dwordx4 v9, s[16:19], s87 offen offset:1024 lds
 v_mfma_f32_16x16x32_bf16 a[52:55], a[136:139], a[200:203], a[52:55]
 ds_read_b64_tr_b16 a[156:157], v5 offset:27776
 ds_read_b64_tr_b16 a[158:159], v5 offset:32384
 v_mfma_f32_16x16x32_bf16 a[52:55], a[140:143], a[204:207], a[52:55]
 v_mfma_f32_16x16x32_bf16 a[56:59], a[136:139], a[208:211], a[56:59]
 v_mfma_f32_16x16x32_bf16 a[56:59], a[140:143], a[212:215], a[56:59]
 v_mfma_f32_16x16x32_bf16 a[60:63], a[136:139], a[216:219], a[60:63]
 buffer_load_dwordx4 v10, s[16:19], s87 offen offset:2048 lds
 v_mfma_f32_16x16x32_bf16 a[60:63], a[140:143], a[220:223], a[60:63]
 s_waitcnt lgkmcnt(4)
 v_mfma_f32_16x16x32_bf16 v[104:107], a[144:147], a[192:195], v[104:107]
 ds_read_b64_tr_b16 a[128:129], v5 offset:160
 ds_read_b64_tr_b16 a[130:131], v5 offset:4768
 v_mfma_f32_16x16x32_bf16 v[104:107], a[148:151], a[196:199], v[104:107]
 v_mfma_f32_16x16x32_bf16 v[108:111], a[144:147], a[200:203], v[108:111]
 ds_read_b64_tr_b16 a[132:133], v5 offset:9376
 ds_read_b64_tr_b16 a[134:135], v5 offset:13984
 v_mfma_f32_16x16x32_bf16 v[108:111], a[148:151], a[204:207], v[108:111]
 buffer_load_dwordx4 v11, s[16:19], s87 offen offset:3072 lds
 v_mfma_f32_16x16x32_bf16 v[112:115], a[144:147], a[208:211], v[112:115]
 s_add_u32 m0, s60, 4096
 v_mfma_f32_16x16x32_bf16 v[112:115], a[148:151], a[212:215], v[112:115]
 v_mfma_f32_16x16x32_bf16 v[116:119], a[144:147], a[216:219], v[116:119]
 v_mfma_f32_16x16x32_bf16 v[116:119], a[148:151], a[220:223], v[116:119]
 s_waitcnt lgkmcnt(4)
 v_mfma_f32_16x16x32_bf16 a[64:67], a[152:155], a[192:195], a[64:67]
 ds_read_b64_tr_b16 a[136:137], v5 offset:18592
 ds_read_b64_tr_b16 a[138:139], v5 offset:23200
 v_mfma_f32_16x16x32_bf16 a[64:67], a[156:159], a[196:199], a[64:67]
 buffer_load_dwordx4 v12, s[16:19], s87 offen offset:0 lds
 v_mfma_f32_16x16x32_bf16 a[68:71], a[152:155], a[200:203], a[68:71]
 ds_read_b64_tr_b16 a[140:141], v5 offset:27808
 ds_read_b64_tr_b16 a[142:143], v5 offset:32416
 v_mfma_f32_16x16x32_bf16 a[68:71], a[156:159], a[204:207], a[68:71]
 v_mfma_f32_16x16x32_bf16 v[120:123], a[152:155], a[208:211], v[120:123]
 v_mfma_f32_16x16x32_bf16 v[120:123], a[156:159], a[212:215], v[120:123]
 v_mfma_f32_16x16x32_bf16 v[124:127], a[152:155], a[216:219], v[124:127]
 buffer_load_dwordx4 v13, s[16:19], s87 offen offset:1024 lds
 v_mfma_f32_16x16x32_bf16 v[124:127], a[156:159], a[220:223], v[124:127]
 s_waitcnt lgkmcnt(4)
 v_mfma_f32_16x16x32_bf16 v[128:131], a[128:131], a[192:195], v[128:131]
 ds_read_b64_tr_b16 a[144:145], v5 offset:192
 ds_read_b64_tr_b16 a[146:147], v5 offset:4800
 v_mfma_f32_16x16x32_bf16 v[128:131], a[132:135], a[196:199], v[128:131]
 v_mfma_f32_16x16x32_bf16 v[132:135], a[128:131], a[200:203], v[132:135]
 ds_read_b64_tr_b16 a[148:149], v5 offset:9408
 ds_read_b64_tr_b16 a[150:151], v5 offset:14016
 v_mfma_f32_16x16x32_bf16 v[132:135], a[132:135], a[204:207], v[132:135]
 buffer_load_dwordx4 v14, s[16:19], s87 offen offset:2048 lds
 v_mfma_f32_16x16x32_bf16 v[136:139], a[128:131], a[208:211], v[136:139]
 v_mfma_f32_16x16x32_bf16 v[136:139], a[132:135], a[212:215], v[136:139]
 v_mfma_f32_16x16x32_bf16 v[140:143], a[128:131], a[216:219], v[140:143]
 v_mfma_f32_16x16x32_bf16 v[140:143], a[132:135], a[220:223], v[140:143]
 s_waitcnt lgkmcnt(4)
 v_mfma_f32_16x16x32_bf16 v[144:147], a[136:139], a[192:195], v[144:147]
 ds_read_b64_tr_b16 a[152:153], v5 offset:18624
 ds_read_b64_tr_b16 a[154:155], v5 offset:23232
 v_mfma_f32_16x16x32_bf16 v[144:147], a[140:143], a[196:199], v[144:147]
 buffer_load_dwordx4 v15, s[16:19], s87 offen offset:3072 lds
 v_mfma_f32_16x16x32_bf16 v[148:151], a[136:139], a[200:203], v[148:151]
 s_add_u32 m0, s60, 8192
 ds_read_b64_tr_b16 a[156:157], v5 offset:27840
 ds_read_b64_tr_b16 a[158:159], v5 offset:32448
 v_mfma_f32_16x16x32_bf16 v[148:151], a[140:143], a[204:207], v[148:151]
 v_mfma_f32_16x16x32_bf16 v[152:155], a[136:139], a[208:211], v[152:155]
 v_mfma_f32_16x16x32_bf16 v[152:155], a[140:143], a[212:215], v[152:155]
 v_mfma_f32_16x16x32_bf16 v[156:159], a[136:139], a[216:219], v[156:159]
 buffer_load_dwordx4 v16, s[16:19], s87 offen offset:0 lds
 v_mfma_f32_16x16x32_bf16 v[156:159], a[140:143], a[220:223], v[156:159]
 s_waitcnt lgkmcnt(4)
 v_mfma_f32_16x16x32_bf16 v[160:163], a[144:147], a[192:195], v[160:163]
 s_mov_b32 s86, 4128768
 ds_read_b64_tr_b16 a[128:129], v5 offset:224
 ds_read_b64_tr_b16 a[130:131], v5 offset:4832
 v_mfma_f32_16x16x32_bf16 v[160:163], a[148:151], a[196:199], v[160:163]
 v_mfma_f32_16x16x32_bf16 v[164:167], a[144:147], a[200:203], v[164:167]
 ds_read_b64_tr_b16 a[132:133], v5 offset:9440
 ds_read_b64_tr_b16 a[134:135], v5 offset:14048
 v_mfma_f32_16x16x32_bf16 v[164:167], a[148:151], a[204:207], v[164:167]
 buffer_load_dword v30, v28, s[36:39], s86 offen sc0
 v_mfma_f32_16x16x32_bf16 v[168:171], a[144:147], a[208:211], v[168:171]
 s_mov_b32 s86, 3145728
 v_mfma_f32_16x16x32_bf16 v[168:171], a[148:151], a[212:215], v[168:171]
 v_mfma_f32_16x16x32_bf16 v[172:175], a[144:147], a[216:219], v[172:175]
 v_mfma_f32_16x16x32_bf16 v[172:175], a[148:151], a[220:223], v[172:175]
 s_waitcnt lgkmcnt(4)
 v_mfma_f32_16x16x32_bf16 v[176:179], a[152:155], a[192:195], v[176:179]
 ds_read_b64_tr_b16 a[136:137], v5 offset:18656
 ds_read_b64_tr_b16 a[138:139], v5 offset:23264
 v_mfma_f32_16x16x32_bf16 v[176:179], a[156:159], a[196:199], v[176:179]
 buffer_load_dword v31, v29, s[40:43], s86 offen sc0
 v_mfma_f32_16x16x32_bf16 v[180:183], a[152:155], a[200:203], v[180:183]
 s_mov_b32 s79, 6144
 ds_read_b64_tr_b16 a[140:141], v5 offset:27872
 ds_read_b64_tr_b16 a[142:143], v5 offset:32480
 v_mfma_f32_16x16x32_bf16 v[180:183], a[156:159], a[204:207], v[180:183]
 v_mfma_f32_16x16x32_bf16 v[184:187], a[152:155], a[208:211], v[184:187]
 v_mfma_f32_16x16x32_bf16 v[184:187], a[156:159], a[212:215], v[184:187]
 v_mfma_f32_16x16x32_bf16 v[188:191], a[152:155], a[216:219], v[188:191]
 buffer_load_dwordx4 a[160:163], v2, s[12:15], s79 offen offset:0 sc1
 v_mfma_f32_16x16x32_bf16 v[188:191], a[156:159], a[220:223], v[188:191]
 s_waitcnt lgkmcnt(4)
 v_mfma_f32_16x16x32_bf16 v[192:195], a[128:131], a[192:195], v[192:195]
 ds_read_b64_tr_b16 a[144:145], v5 offset:256
 ds_read_b64_tr_b16 a[146:147], v5 offset:4864
 v_mfma_f32_16x16x32_bf16 v[192:195], a[132:135], a[196:199], v[192:195]
 v_mfma_f32_16x16x32_bf16 v[196:199], a[128:131], a[200:203], v[196:199]
 ds_read_b64_tr_b16 a[148:149], v5 offset:9472
 ds_read_b64_tr_b16 a[150:151], v5 offset:14080
 v_mfma_f32_16x16x32_bf16 v[196:199], a[132:135], a[204:207], v[196:199]
 buffer_load_dwordx4 a[164:167], v2, s[12:15], s79 offen offset:1024 sc1
 v_mfma_f32_16x16x32_bf16 v[200:203], a[128:131], a[208:211], v[200:203]
 s_mov_b32 s80, 24576
 v_mfma_f32_16x16x32_bf16 v[200:203], a[132:135], a[212:215], v[200:203]
 v_mfma_f32_16x16x32_bf16 v[204:207], a[128:131], a[216:219], v[204:207]
 v_mfma_f32_16x16x32_bf16 v[204:207], a[132:135], a[220:223], v[204:207]
 s_waitcnt lgkmcnt(4)
 v_mfma_f32_16x16x32_bf16 v[208:211], a[136:139], a[192:195], v[208:211]
 ds_read_b64_tr_b16 a[152:153], v5 offset:18688
 ds_read_b64_tr_b16 a[154:155], v5 offset:23296
 v_mfma_f32_16x16x32_bf16 v[208:211], a[140:143], a[196:199], v[208:211]
 buffer_load_dwordx4 a[168:171], v2, s[12:15], s80 offen offset:0 sc1
 v_mfma_f32_16x16x32_bf16 v[212:215], a[136:139], a[200:203], v[212:215]
 ds_read_b64_tr_b16 a[156:157], v5 offset:27904
 ds_read_b64_tr_b16 a[158:159], v5 offset:32512
 v_mfma_f32_16x16x32_bf16 v[212:215], a[140:143], a[204:207], v[212:215]
 v_mfma_f32_16x16x32_bf16 v[216:219], a[136:139], a[208:211], v[216:219]
 v_mfma_f32_16x16x32_bf16 v[216:219], a[140:143], a[212:215], v[216:219]
 v_mfma_f32_16x16x32_bf16 v[220:223], a[136:139], a[216:219], v[220:223]
 buffer_load_dwordx4 a[172:175], v2, s[12:15], s80 offen offset:1024 sc1
 v_mfma_f32_16x16x32_bf16 v[220:223], a[140:143], a[220:223], v[220:223]
 s_waitcnt lgkmcnt(4)
 v_mfma_f32_16x16x32_bf16 v[224:227], a[144:147], a[192:195], v[224:227]
 s_mov_b32 s81, 43008
 v_mfma_f32_16x16x32_bf16 v[224:227], a[148:151], a[196:199], v[224:227]
 s_waitcnt vmcnt(34) lgkmcnt(0)
 v_mfma_f32_16x16x32_bf16 v[228:231], a[144:147], a[200:203], v[228:231]
 s_barrier
 v_mfma_f32_16x16x32_bf16 v[228:231], a[148:151], a[204:207], v[228:231]
 ds_read_b64_tr_b16 a[128:129], v6 offset:0
 ds_read_b64_tr_b16 a[130:131], v6 offset:4608
 v_mfma_f32_16x16x32_bf16 v[232:235], a[144:147], a[208:211], v[232:235]
 buffer_load_dwordx4 a[176:179], v2, s[12:15], s81 offen offset:0 sc1
 v_mfma_f32_16x16x32_bf16 v[232:235], a[148:151], a[212:215], v[232:235]
 ds_read_b64_tr_b16 a[132:133], v6 offset:9216
 ds_read_b64_tr_b16 a[134:135], v6 offset:13824
 v_mfma_f32_16x16x32_bf16 v[236:239], a[144:147], a[216:219], v[236:239]
 v_mfma_f32_16x16x32_bf16 v[236:239], a[148:151], a[220:223], v[236:239]
 v_mfma_f32_16x16x32_bf16 v[240:243], a[152:155], a[192:195], v[240:243]
 ds_read_b64_tr_b16 a[136:137], v6 offset:18432
 ds_read_b64_tr_b16 a[138:139], v6 offset:23040
 v_mfma_f32_16x16x32_bf16 v[240:243], a[156:159], a[196:199], v[240:243]
 buffer_load_dwordx4 a[180:183], v2, s[12:15], s81 offen offset:1024 sc1
 v_mfma_f32_16x16x32_bf16 v[244:247], a[152:155], a[200:203], v[244:247]
 s_mov_b32 s82, 61440
 ds_read_b64_tr_b16 a[140:141], v6 offset:27648
 ds_read_b64_tr_b16 a[142:143], v6 offset:32256
 v_mfma_f32_16x16x32_bf16 v[244:247], a[156:159], a[204:207], v[244:247]
 v_mfma_f32_16x16x32_bf16 v[248:251], a[152:155], a[208:211], v[248:251]
 v_mfma_f32_16x16x32_bf16 v[248:251], a[156:159], a[212:215], v[248:251]
 v_mfma_f32_16x16x32_bf16 v[252:255], a[152:155], a[216:219], v[252:255]
 buffer_load_dwordx4 a[184:187], v2, s[12:15], s82 offen offset:0 sc1
 v_mfma_f32_16x16x32_bf16 v[252:255], a[156:159], a[220:223], v[252:255]
 s_waitcnt vmcnt(27) lgkmcnt(4)
 v_mfma_f32_16x16x32_bf16 v[40:43], a[128:131], a[224:227], v[40:43]
 ds_read_b64_tr_b16 a[144:145], v6 offset:32
 ds_read_b64_tr_b16 a[146:147], v6 offset:4640
 v_mfma_f32_16x16x32_bf16 v[40:43], a[132:135], a[228:231], v[40:43]
 v_mfma_f32_16x16x32_bf16 v[44:47], a[128:131], a[232:235], v[44:47]
 ds_read_b64_tr_b16 a[148:149], v6 offset:9248
 ds_read_b64_tr_b16 a[150:151], v6 offset:13856
 v_mfma_f32_16x16x32_bf16 v[44:47], a[132:135], a[236:239], v[44:47]
 buffer_load_dwordx4 a[188:191], v2, s[12:15], s82 offen offset:1024 sc1
 v_mfma_f32_16x16x32_bf16 v[48:51], a[128:131], a[240:243], v[48:51]
 s_add_u32 s87, s61, 2949120
 v_mfma_f32_16x16x32_bf16 v[48:51], a[132:135], a[244:247], v[48:51]
 s_add_u32 m0, s60, 36864
 v_mfma_f32_16x16x32_bf16 v[52:55], a[128:131], a[248:251], v[52:55]
 v_mfma_f32_16x16x32_bf16 v[52:55], a[132:135], a[252:255], v[52:55]
 s_waitcnt lgkmcnt(4)
 v_mfma_f32_16x16x32_bf16 a[0:3], a[136:139], a[224:227], a[0:3]
 ds_read_b64_tr_b16 a[152:153], v6 offset:18464
 ds_read_b64_tr_b16 a[154:155], v6 offset:23072
 v_mfma_f32_16x16x32_bf16 a[0:3], a[140:143], a[228:231], a[0:3]
 buffer_load_dwordx4 v8, s[16:19], s87 offen offset:0 lds
 v_mfma_f32_16x16x32_bf16 a[4:7], a[136:139], a[232:235], a[4:7]
 ds_read_b64_tr_b16 a[156:157], v6 offset:27680
 ds_read_b64_tr_b16 a[158:159], v6 offset:32288
 v_mfma_f32_16x16x32_bf16 a[4:7], a[140:143], a[236:239], a[4:7]
 v_mfma_f32_16x16x32_bf16 a[8:11], a[136:139], a[240:243], a[8:11]
 v_mfma_f32_16x16x32_bf16 a[8:11], a[140:143], a[244:247], a[8:11]
 v_mfma_f32_16x16x32_bf16 a[12:15], a[136:139], a[248:251], a[12:15]
 buffer_load_dwordx4 v9, s[16:19], s87 offen offset:1024 lds
 v_mfma_f32_16x16x32_bf16 a[12:15], a[140:143], a[252:255], a[12:15]
 s_waitcnt lgkmcnt(4)
 v_mfma_f32_16x16x32_bf16 v[56:59], a[144:147], a[224:227], v[56:59]
 ds_read_b64_tr_b16 a[128:129], v6 offset:64
 ds_read_b64_tr_b16 a[130:131], v6 offset:4672
 v_mfma_f32_16x16x32_bf16 v[56:59], a[148:151], a[228:231], v[56:59]
 v_mfma_f32_16x16x32_bf16 v[60:63], a[144:147], a[232:235], v[60:63]
 ds_read_b64_tr_b16 a[132:133], v6 offset:9280
 ds_read_b64_tr_b16 a[134:135], v6 offset:13888
 v_mfma_f32_16x16x32_bf16 v[60:63], a[148:151], a[236:239], v[60:63]
 buffer_load_dwordx4 v10, s[16:19], s87 offen offset:2048 lds
 v_mfma_f32_16x16x32_bf16 v[64:67], a[144:147], a[240:243], v[64:67]
 v_mfma_f32_16x16x32_bf16 v[64:67], a[148:151], a[244:247], v[64:67]
 v_mfma_f32_16x16x32_bf16 v[68:71], a[144:147], a[248:251], v[68:71]
 v_mfma_f32_16x16x32_bf16 v[68:71], a[148:151], a[252:255], v[68:71]
 s_waitcnt lgkmcnt(4)
 v_mfma_f32_16x16x32_bf16 a[16:19], a[152:155], a[224:227], a[16:19]
 ds_read_b64_tr_b16 a[136:137], v6 offset:18496
 ds_read_b64_tr_b16 a[138:139], v6 offset:23104
 v_mfma_f32_16x16x32_bf16 a[16:19], a[156:159], a[228:231], a[16:19]
 buffer_load_dwordx4 v11, s[16:19], s87 offen offset:3072 lds
 v_mfma_f32_16x16x32_bf16 a[20:23], a[152:155], a[232:235], a[20:23]
 s_add_u32 m0, s60, 40960
 ds_read_b64_tr_b16 a[140:141], v6 offset:27712
 ds_read_b64_tr_b16 a[142:143], v6 offset:32320
 v_mfma_f32_16x16x32_bf16 a[20:23], a[156:159], a[236:239], a[20:23]
 v_mfma_f32_16x16x32_bf16 a[24:27], a[152:155], a[240:243], a[24:27]
 v_mfma_f32_16x16x32_bf16 a[24:27], a[156:159], a[244:247], a[24:27]
 v_mfma_f32_16x16x32_bf16 a[28:31], a[152:155], a[248:251], a[28:31]
 buffer_load_dwordx4 v12, s[16:19], s87 offen offset:0 lds
 v_mfma_f32_16x16x32_bf16 a[28:31], a[156:159], a[252:255], a[28:31]
 s_waitcnt lgkmcnt(4)
 v_mfma_f32_16x16x32_bf16 v[72:75], a[128:131], a[224:227], v[72:75]
 ds_read_b64_tr_b16 a[144:145], v6 offset:96
 ds_read_b64_tr_b16 a[146:147], v6 offset:4704
 v_mfma_f32_16x16x32_bf16 v[72:75], a[132:135], a[228:231], v[72:75]
 v_mfma_f32_16x16x32_bf16 v[76:79], a[128:131], a[232:235], v[76:79]
 ds_read_b64_tr_b16 a[148:149], v6 offset:9312
 ds_read_b64_tr_b16 a[150:151], v6 offset:13920
 v_mfma_f32_16x16x32_bf16 v[76:79], a[132:135], a[236:239], v[76:79]
 buffer_load_dwordx4 v13, s[16:19], s87 offen offset:1024 lds
 v_mfma_f32_16x16x32_bf16 v[80:83], a[128:131], a[240:243], v[80:83]
 v_mfma_f32_16x16x32_bf16 v[80:83], a[132:135], a[244:247], v[80:83]
 v_mfma_f32_16x16x32_bf16 v[84:87], a[128:131], a[248:251], v[84:87]
 v_mfma_f32_16x16x32_bf16 v[84:87], a[132:135], a[252:255], v[84:87]
 s_waitcnt lgkmcnt(4)
 v_mfma_f32_16x16x32_bf16 a[32:35], a[136:139], a[224:227], a[32:35]
 ds_read_b64_tr_b16 a[152:153], v6 offset:18528
 ds_read_b64_tr_b16 a[154:155], v6 offset:23136
 v_mfma_f32_16x16x32_bf16 a[32:35], a[140:143], a[228:231], a[32:35]
 buffer_load_dwordx4 v14, s[16:19], s87 offen offset:2048 lds
 v_mfma_f32_16x16x32_bf16 a[36:39], a[136:139], a[232:235], a[36:39]
 ds_read_b64_tr_b16 a[156:157], v6 offset:27744
 ds_read_b64_tr_b16 a[158:159], v6 offset:32352
 v_mfma_f32_16x16x32_bf16 a[36:39], a[140:143], a[236:239], a[36:39]
 v_mfma_f32_16x16x32_bf16 a[40:43], a[136:139], a[240:243], a[40:43]
 v_mfma_f32_16x16x32_bf16 a[40:43], a[140:143], a[244:247], a[40:43]
 v_mfma_f32_16x16x32_bf16 a[44:47], a[136:139], a[248:251], a[44:47]
 buffer_load_dwordx4 v15, s[16:19], s87 offen offset:3072 lds
 v_mfma_f32_16x16x32_bf16 a[44:47], a[140:143], a[252:255], a[44:47]
 s_waitcnt lgkmcnt(4)
 v_mfma_f32_16x16x32_bf16 v[88:91], a[144:147], a[224:227], v[88:91]
 s_add_u32 m0, s60, 45056
 ds_read_b64_tr_b16 a[128:129], v6 offset:128
 ds_read_b64_tr_b16 a[130:131], v6 offset:4736
 v_mfma_f32_16x16x32_bf16 v[88:91], a[148:151], a[228:231], v[88:91]
 v_mfma_f32_16x16x32_bf16 v[92:95], a[144:147], a[232:235], v[92:95]
 ds_read_b64_tr_b16 a[132:133], v6 offset:9344
 ds_read_b64_tr_b16 a[134:135], v6 offset:13952
 v_mfma_f32_16x16x32_bf16 v[92:95], a[148:151], a[236:239], v[92:95]
 buffer_load_dwordx4 v16, s[16:19], s87 offen offset:0 lds
 v_mfma_f32_16x16x32_bf16 v[96:99], a[144:147], a[240:243], v[96:99]
 s_mov_b32 s86, 4718592
 v_mfma_f32_16x16x32_bf16 v[96:99], a[148:151], a[244:247], v[96:99]
 v_mfma_f32_16x16x32_bf16 v[100:103], a[144:147], a[248:251], v[100:103]
 v_mfma_f32_16x16x32_bf16 v[100:103], a[148:151], a[252:255], v[100:103]
 s_waitcnt lgkmcnt(4)
 v_mfma_f32_16x16x32_bf16 a[48:51], a[152:155], a[224:227], a[48:51]
 ds_read_b64_tr_b16 a[136:137], v6 offset:18560
 ds_read_b64_tr_b16 a[138:139], v6 offset:23168
 v_mfma_f32_16x16x32_bf16 a[48:51], a[156:159], a[228:231], a[48:51]
 buffer_load_dword v30, v28, s[36:39], s86 offen sc0
 v_mfma_f32_16x16x32_bf16 a[52:55], a[152:155], a[232:235], a[52:55]
 s_mov_b32 s86, 2097152
 ds_read_b64_tr_b16 a[140:141], v6 offset:27776
 ds_read_b64_tr_b16 a[142:143], v6 offset:32384
 v_mfma_f32_16x16x32_bf16 a[52:55], a[156:159], a[236:239], a[52:55]
 v_mfma_f32_16x16x32_bf16 a[56:59], a[152:155], a[240:243], a[56:59]
 v_mfma_f32_16x16x32_bf16 a[56:59], a[156:159], a[244:247], a[56:59]
 v_mfma_f32_16x16x32_bf16 a[60:63], a[152:155], a[248:251], a[60:63]
 buffer_load_dword v31, v29, s[40:43], s86 offen sc0
 v_mfma_f32_16x16x32_bf16 a[60:63], a[156:159], a[252:255], a[60:63]
 s_waitcnt lgkmcnt(4)
 v_mfma_f32_16x16x32_bf16 v[104:107], a[128:131], a[224:227], v[104:107]
 s_mov_b32 s79, 8192
 ds_read_b64_tr_b16 a[144:145], v6 offset:160
 ds_read_b64_tr_b16 a[146:147], v6 offset:4768
 v_mfma_f32_16x16x32_bf16 v[104:107], a[132:135], a[228:231], v[104:107]
 v_mfma_f32_16x16x32_bf16 v[108:111], a[128:131], a[232:235], v[108:111]
 ds_read_b64_tr_b16 a[148:149], v6 offset:9376
 ds_read_b64_tr_b16 a[150:151], v6 offset:13984
 v_mfma_f32_16x16x32_bf16 v[108:111], a[132:135], a[236:239], v[108:111]
 buffer_load_dwordx4 a[192:195], v2, s[12:15], s79 offen offset:0 sc1
 v_mfma_f32_16x16x32_bf16 v[112:115], a[128:131], a[240:243], v[112:115]
 v_mfma_f32_16x16x32_bf16 v[112:115], a[132:135], a[244:247], v[112:115]
 v_mfma_f32_16x16x32_bf16 v[116:119], a[128:131], a[248:251], v[116:119]
 v_mfma_f32_16x16x32_bf16 v[116:119], a[132:135], a[252:255], v[116:119]
 s_waitcnt lgkmcnt(4)
 v_mfma_f32_16x16x32_bf16 a[64:67], a[136:139], a[224:227], a[64:67]
 ds_read_b64_tr_b16 a[152:153], v6 offset:18592
 ds_read_b64_tr_b16 a[154:155], v6 offset:23200
 v_mfma_f32_16x16x32_bf16 a[64:67], a[140:143], a[228:231], a[64:67]
 buffer_load_dwordx4 a[196:199], v2, s[12:15], s79 offen offset:1024 sc1
 v_mfma_f32_16x16x32_bf16 a[68:71], a[136:139], a[232:235], a[68:71]
 s_mov_b32 s80, 26624
 ds_read_b64_tr_b16 a[156:157], v6 offset:27808
 ds_read_b64_tr_b16 a[158:159], v6 offset:32416
 v_mfma_f32_16x16x32_bf16 a[68:71], a[140:143], a[236:239], a[68:71]
 v_mfma_f32_16x16x32_bf16 v[120:123], a[136:139], a[240:243], v[120:123]
 v_mfma_f32_16x16x32_bf16 v[120:123], a[140:143], a[244:247], v[120:123]
 v_mfma_f32_16x16x32_bf16 v[124:127], a[136:139], a[248:251], v[124:127]
 buffer_load_dwordx4 a[200:203], v2, s[12:15], s80 offen offset:0 sc1
 v_mfma_f32_16x16x32_bf16 v[124:127], a[140:143], a[252:255], v[124:127]
 s_waitcnt lgkmcnt(4)
 v_mfma_f32_16x16x32_bf16 v[128:131], a[144:147], a[224:227], v[128:131]
 ds_read_b64_tr_b16 a[128:129], v6 offset:192
 ds_read_b64_tr_b16 a[130:131], v6 offset:4800
 v_mfma_f32_16x16x32_bf16 v[128:131], a[148:151], a[228:231], v[128:131]
 v_mfma_f32_16x16x32_bf16 v[132:135], a[144:147], a[232:235], v[132:135]
 ds_read_b64_tr_b16 a[132:133], v6 offset:9408
 ds_read_b64_tr_b16 a[134:135], v6 offset:14016
 v_mfma_f32_16x16x32_bf16 v[132:135], a[148:151], a[236:239], v[132:135]
 buffer_load_dwordx4 a[204:207], v2, s[12:15], s80 offen offset:1024 sc1
 v_mfma_f32_16x16x32_bf16 v[136:139], a[144:147], a[240:243], v[136:139]
 s_mov_b32 s81, 45056
 v_mfma_f32_16x16x32_bf16 v[136:139], a[148:151], a[244:247], v[136:139]
 v_mfma_f32_16x16x32_bf16 v[140:143], a[144:147], a[248:251], v[140:143]
 v_mfma_f32_16x16x32_bf16 v[140:143], a[148:151], a[252:255], v[140:143]
 s_waitcnt lgkmcnt(4)
 v_mfma_f32_16x16x32_bf16 v[144:147], a[152:155], a[224:227], v[144:147]
 ds_read_b64_tr_b16 a[136:137], v6 offset:18624
 ds_read_b64_tr_b16 a[138:139], v6 offset:23232
 v_mfma_f32_16x16x32_bf16 v[144:147], a[156:159], a[228:231], v[144:147]
 buffer_load_dwordx4 a[208:211], v2, s[12:15], s81 offen offset:0 sc1
 v_mfma_f32_16x16x32_bf16 v[148:151], a[152:155], a[232:235], v[148:151]
 ds_read_b64_tr_b16 a[140:141], v6 offset:27840
 ds_read_b64_tr_b16 a[142:143], v6 offset:32448
 v_mfma_f32_16x16x32_bf16 v[148:151], a[156:159], a[236:239], v[148:151]
 v_mfma_f32_16x16x32_bf16 v[152:155], a[152:155], a[240:243], v[152:155]
 v_mfma_f32_16x16x32_bf16 v[152:155], a[156:159], a[244:247], v[152:155]
 v_mfma_f32_16x16x32_bf16 v[156:159], a[152:155], a[248:251], v[156:159]
 buffer_load_dwordx4 a[212:215], v2, s[12:15], s81 offen offset:1024 sc1
 v_mfma_f32_16x16x32_bf16 v[156:159], a[156:159], a[252:255], v[156:159]
 s_waitcnt lgkmcnt(4)
 v_mfma_f32_16x16x32_bf16 v[160:163], a[128:131], a[224:227], v[160:163]
 s_mov_b32 s82, 63488
 ds_read_b64_tr_b16 a[144:145], v6 offset:224
 ds_read_b64_tr_b16 a[146:147], v6 offset:4832
 v_mfma_f32_16x16x32_bf16 v[160:163], a[132:135], a[228:231], v[160:163]
 v_mfma_f32_16x16x32_bf16 v[164:167], a[128:131], a[232:235], v[164:167]
 ds_read_b64_tr_b16 a[148:149], v6 offset:9440
 ds_read_b64_tr_b16 a[150:151], v6 offset:14048
 v_mfma_f32_16x16x32_bf16 v[164:167], a[132:135], a[236:239], v[164:167]
 buffer_load_dwordx4 a[216:219], v2, s[12:15], s82 offen offset:0 sc1
 v_mfma_f32_16x16x32_bf16 v[168:171], a[128:131], a[240:243], v[168:171]
 v_mfma_f32_16x16x32_bf16 v[168:171], a[132:135], a[244:247], v[168:171]
 v_mfma_f32_16x16x32_bf16 v[172:175], a[128:131], a[248:251], v[172:175]
 v_mfma_f32_16x16x32_bf16 v[172:175], a[132:135], a[252:255], v[172:175]
 s_waitcnt lgkmcnt(4)
 v_mfma_f32_16x16x32_bf16 v[176:179], a[136:139], a[224:227], v[176:179]
 ds_read_b64_tr_b16 a[152:153], v6 offset:18656
 ds_read_b64_tr_b16 a[154:155], v6 offset:23264
 v_mfma_f32_16x16x32_bf16 v[176:179], a[140:143], a[228:231], v[176:179]
 buffer_load_dwordx4 a[220:223], v2, s[12:15], s82 offen offset:1024 sc1
 v_mfma_f32_16x16x32_bf16 v[180:183], a[136:139], a[232:235], v[180:183]
 ds_read_b64_tr_b16 a[156:157], v6 offset:27872
 ds_read_b64_tr_b16 a[158:159], v6 offset:32480
 v_mfma_f32_16x16x32_bf16 v[180:183], a[140:143], a[236:239], v[180:183]
 v_mfma_f32_16x16x32_bf16 v[184:187], a[136:139], a[240:243], v[184:187]
 v_mfma_f32_16x16x32_bf16 v[184:187], a[140:143], a[244:247], v[184:187]
 v_mfma_f32_16x16x32_bf16 v[188:191], a[136:139], a[248:251], v[188:191]
 v_mfma_f32_16x16x32_bf16 v[188:191], a[140:143], a[252:255], v[188:191]
 s_waitcnt lgkmcnt(4)
 v_mfma_f32_16x16x32_bf16 v[192:195], a[144:147], a[224:227], v[192:195]
 ds_read_b64_tr_b16 a[128:129], v6 offset:256
 ds_read_b64_tr_b16 a[130:131], v6 offset:4864
 v_mfma_f32_16x16x32_bf16 v[192:195], a[148:151], a[228:231], v[192:195]
 v_mfma_f32_16x16x32_bf16 v[196:199], a[144:147], a[232:235], v[196:199]
 ds_read_b64_tr_b16 a[132:133], v6 offset:9472
 ds_read_b64_tr_b16 a[134:135], v6 offset:14080
 v_mfma_f32_16x16x32_bf16 v[196:199], a[148:151], a[236:239], v[196:199]
 v_mfma_f32_16x16x32_bf16 v[200:203], a[144:147], a[240:243], v[200:203]
 v_mfma_f32_16x16x32_bf16 v[200:203], a[148:151], a[244:247], v[200:203]
 v_mfma_f32_16x16x32_bf16 v[204:207], a[144:147], a[248:251], v[204:207]
 v_mfma_f32_16x16x32_bf16 v[204:207], a[148:151], a[252:255], v[204:207]
 s_waitcnt lgkmcnt(4)
 v_mfma_f32_16x16x32_bf16 v[208:211], a[152:155], a[224:227], v[208:211]
 ds_read_b64_tr_b16 a[136:137], v6 offset:18688
 ds_read_b64_tr_b16 a[138:139], v6 offset:23296
 v_mfma_f32_16x16x32_bf16 v[208:211], a[156:159], a[228:231], v[208:211]
 v_mfma_f32_16x16x32_bf16 v[212:215], a[152:155], a[232:235], v[212:215]
 ds_read_b64_tr_b16 a[140:141], v6 offset:27904
 ds_read_b64_tr_b16 a[142:143], v6 offset:32512
 v_mfma_f32_16x16x32_bf16 v[212:215], a[156:159], a[236:239], v[212:215]
 v_mfma_f32_16x16x32_bf16 v[216:219], a[152:155], a[240:243], v[216:219]
 v_mfma_f32_16x16x32_bf16 v[216:219], a[156:159], a[244:247], v[216:219]
 v_mfma_f32_16x16x32_bf16 v[220:223], a[152:155], a[248:251], v[220:223]
 v_mfma_f32_16x16x32_bf16 v[220:223], a[156:159], a[252:255], v[220:223]
 s_waitcnt lgkmcnt(4)
 v_mfma_f32_16x16x32_bf16 v[224:227], a[128:131], a[224:227], v[224:227]
 v_mfma_f32_16x16x32_bf16 v[224:227], a[132:135], a[228:231], v[224:227]
 s_waitcnt vmcnt(38) lgkmcnt(0)
 v_mfma_f32_16x16x32_bf16 v[228:231], a[128:131], a[232:235], v[228:231]
 s_barrier
 v_mfma_f32_16x16x32_bf16 v[228:231], a[132:135], a[236:239], v[228:231]
 s_add_u32 s87, s61, 3538944
 ds_read_b64_tr_b16 a[144:145], v7 offset:0
 ds_read_b64_tr_b16 a[146:147], v7 offset:4608
 v_mfma_f32_16x16x32_bf16 v[232:235], a[128:131], a[240:243], v[232:235]
 s_add_u32 m0, s60, 73728
 v_mfma_f32_16x16x32_bf16 v[232:235], a[132:135], a[244:247], v[232:235]
 ds_read_b64_tr_b16 a[148:149], v7 offset:9216
 ds_read_b64_tr_b16 a[150:151], v7 offset:13824
 v_mfma_f32_16x16x32_bf16 v[236:239], a[128:131], a[248:251], v[236:239]
 buffer_load_dwordx4 v8, s[16:19], s87 offen offset:0 lds
 v_mfma_f32_16x16x32_bf16 v[236:239], a[132:135], a[252:255], v[236:239]
 v_mfma_f32_16x16x32_bf16 v[240:243], a[136:139], a[224:227], v[240:243]
 ds_read_b64_tr_b16 a[152:153], v7 offset:18432
 ds_read_b64_tr_b16 a[154:155], v7 offset:23040
 v_mfma_f32_16x16x32_bf16 v[240:243], a[140:143], a[228:231], v[240:243]
 v_mfma_f32_16x16x32_bf16 v[244:247], a[136:139], a[232:235], v[244:247]
 ds_read_b64_tr_b16 a[156:157], v7 offset:27648
 ds_read_b64_tr_b16 a[158:159], v7 offset:32256
 v_mfma_f32_16x16x32_bf16 v[244:247], a[140:143], a[236:239], v[244:247]
 buffer_load_dwordx4 v9, s[16:19], s87 offen offset:1024 lds
 v_mfma_f32_16x16x32_bf16 v[248:251], a[136:139], a[240:243], v[248:251]
 v_mfma_f32_16x16x32_bf16 v[248:251], a[140:143], a[244:247], v[248:251]
 v_mfma_f32_16x16x32_bf16 v[252:255], a[136:139], a[248:251], v[252:255]
 v_mfma_f32_16x16x32_bf16 v[252:255], a[140:143], a[252:255], v[252:255]
 s_waitcnt vmcnt(21) lgkmcnt(4)
 v_mfma_f32_16x16x32_bf16 v[40:43], a[144:147], a[160:163], v[40:43]
 ds_read_b64_tr_b16 a[128:129], v7 offset:32
 ds_read_b64_tr_b16 a[130:131], v7 offset:4640
 v_mfma_f32_16x16x32_bf16 v[40:43], a[148:151], a[164:167], v[40:43]
 buffer_load_dwordx4 v10, s[16:19], s87 offen offset:2048 lds
 v_mfma_f32_16x16x32_bf16 v[44:47], a[144:147], a[168:171], v[44:47]
 ds_read_b64_tr_b16 a[132:133], v7 offset:9248
 ds_read_b64_tr_b16 a[134:135], v7 offset:13856
 v_mfma_f32_16x16x32_bf16 v[44:47], a[148:151], a[172:175], v[44:47]
 v_mfma_f32_16x16x32_bf16 v[48:51], a[144:147], a[176:179], v[48:51]
 v_mfma_f32_16x16x32_bf16 v[48:51], a[148:151], a[180:183], v[48:51]
 v_mfma_f32_16x16x32_bf16 v[52:55], a[144:147], a[184:187], v[52:55]
 buffer_load_dwordx4 v11, s[16:19], s87 offen offset:3072 lds
 v_mfma_f32_16x16x32_bf16 v[52:55], a[148:151], a[188:191], v[52:55]
 s_waitcnt lgkmcnt(4)
 v_mfma_f32_16x16x32_bf16 a[0:3], a[152:155], a[160:163], a[0:3]
 s_add_u32 m0, s60, 77824
 ds_read_b64_tr_b16 a[136:137], v7 offset:18464
 ds_read_b64_tr_b16 a[138:139], v7 offset:23072
 v_mfma_f32_16x16x32_bf16 a[0:3], a[156:159], a[164:167], a[0:3]
 v_mfma_f32_16x16x32_bf16 a[4:7], a[152:155], a[168:171], a[4:7]
 ds_read_b64_tr_b16 a[140:141], v7 offset:27680
 ds_read_b64_tr_b16 a[142:143], v7 offset:32288
 v_mfma_f32_16x16x32_bf16 a[4:7], a[156:159], a[172:175], a[4:7]
 buffer_load_dwordx4 v12, s[16:19], s87 offen offset:0 lds
 v_mfma_f32_16x16x32_bf16 a[8:11], a[152:155], a[176:179], a[8:11]
 v_mfma_f32_16x16x32_bf16 a[8:11], a[156:159], a[180:183], a[8:11]
 v_mfma_f32_16x16x32_bf16 a[12:15], a[152:155], a[184:187], a[12:15]
 v_mfma_f32_16x16x32_bf16 a[12:15], a[156:159], a[188:191], a[12:15]
 s_waitcnt lgkmcnt(4)
 v_mfma_f32_16x16x32_bf16 v[56:59], a[128:131], a[160:163], v[56:59]
 ds_read_b64_tr_b16 a[144:145], v7 offset:64
 ds_read_b64_tr_b16 a[146:147], v7 offset:4672
 v_mfma_f32_16x16x32_bf16 v[56:59], a[132:135], a[164:167], v[56:59]
 buffer_load_dwordx4 v13, s[16:19], s87 offen offset:1024 lds
 v_mfma_f32_16x16x32_bf16 v[60:63], a[128:131], a[168:171], v[60:63]
 ds_read_b64_tr_b16 a[148:149], v7 offset:9280
 ds_read_b64_tr_b16 a[150:151], v7 offset:13888
 v_mfma_f32_16x16x32_bf16 v[60:63], a[132:135], a[172:175], v[60:63]
 v_mfma_f32_16x16x32_bf16 v[64:67], a[128:131], a[176:179], v[64:67]
 v_mfma_f32_16x16x32_bf16 v[64:67], a[132:135], a[180:183], v[64:67]
 v_mfma_f32_16x16x32_bf16 v[68:71], a[128:131], a[184:187], v[68:71]
 buffer_load_dwordx4 v14, s[16:19], s87 offen offset:2048 lds
 v_mfma_f32_16x16x32_bf16 v[68:71], a[132:135], a[188:191], v[68:71]
 s_waitcnt lgkmcnt(4)
 v_mfma_f32_16x16x32_bf16 a[16:19], a[136:139], a[160:163], a[16:19]
 ds_read_b64_tr_b16 a[152:153], v7 offset:18496
 ds_read_b64_tr_b16 a[154:155], v7 offset:23104
 v_mfma_f32_16x16x32_bf16 a[16:19], a[140:143], a[164:167], a[16:19]
 v_mfma_f32_16x16x32_bf16 a[20:23], a[136:139], a[168:171], a[20:23]
 ds_read_b64_tr_b16 a[156:157], v7 offset:27712
 ds_read_b64_tr_b16 a[158:159], v7 offset:32320
 v_mfma_f32_16x16x32_bf16 a[20:23], a[140:143], a[172:175], a[20:23]
 buffer_load_dwordx4 v15, s[16:19], s87 offen offset:3072 lds
 v_mfma_f32_16x16x32_bf16 a[24:27], a[136:139], a[176:179], a[24:27]
 s_add_u32 m0, s60, 81920
 v_mfma_f32_16x16x32_bf16 a[24:27], a[140:143], a[180:183], a[24:27]
 v_mfma_f32_16x16x32_bf16 a[28:31], a[136:139], a[184:187], a[28:31]
 v_mfma_f32_16x16x32_bf16 a[28:31], a[140:143], a[188:191], a[28:31]
 s_waitcnt lgkmcnt(4)
 v_mfma_f32_16x16x32_bf16 v[72:75], a[144:147], a[160:163], v[72:75]
 ds_read_b64_tr_b16 a[128:129], v7 offset:96
 ds_read_b64_tr_b16 a[130:131], v7 offset:4704
 v_mfma_f32_16x16x32_bf16 v[72:75], a[148:151], a[164:167], v[72:75]
 buffer_load_dwordx4 v16, s[16:19], s87 offen offset:0 lds
 v_mfma_f32_16x16x32_bf16 v[76:79], a[144:147], a[168:171], v[76:79]
 s_mov_b32 s86, 1048576
 ds_read_b64_tr_b16 a[132:133], v7 offset:9312
 ds_read_b64_tr_b16 a[134:135], v7 offset:13920
 v_mfma_f32_16x16x32_bf16 v[76:79], a[148:151], a[172:175], v[76:79]
 v_mfma_f32_16x16x32_bf16 v[80:83], a[144:147], a[176:179], v[80:83]
 v_mfma_f32_16x16x32_bf16 v[80:83], a[148:151], a[180:183], v[80:83]
 v_mfma_f32_16x16x32_bf16 v[84:87], a[144:147], a[184:187], v[84:87]
 buffer_load_dword v31, v29, s[40:43], s86 offen sc0
 v_mfma_f32_16x16x32_bf16 v[84:87], a[148:151], a[188:191], v[84:87]
 s_waitcnt lgkmcnt(4)
 v_mfma_f32_16x16x32_bf16 a[32:35], a[152:155], a[160:163], a[32:35]
 s_mov_b32 s79, 10240
 ds_read_b64_tr_b16 a[136:137], v7 offset:18528
 ds_read_b64_tr_b16 a[138:139], v7 offset:23136
 v_mfma_f32_16x16x32_bf16 a[32:35], a[156:159], a[164:167], a[32:35]
 v_mfma_f32_16x16x32_bf16 a[36:39], a[152:155], a[168:171], a[36:39]
 ds_read_b64_tr_b16 a[140:141], v7 offset:27744
 ds_read_b64_tr_b16 a[142:143], v7 offset:32352
 v_mfma_f32_16x16x32_bf16 a[36:39], a[156:159], a[172:175], a[36:39]
 buffer_load_dwordx4 a[224:227], v2, s[12:15], s79 offen offset:0 sc1
 v_mfma_f32_16x16x32_bf16 a[40:43], a[152:155], a[176:179], a[40:43]
 v_mfma_f32_16x16x32_bf16 a[40:43], a[156:159], a[180:183], a[40:43]
 v_mfma_f32_16x16x32_bf16 a[44:47], a[152:155], a[184:187], a[44:47]
 v_mfma_f32_16x16x32_bf16 a[44:47], a[156:159], a[188:191], a[44:47]
 s_waitcnt lgkmcnt(4)
 v_mfma_f32_16x16x32_bf16 v[88:91], a[128:131], a[160:163], v[88:91]
 ds_read_b64_tr_b16 a[144:145], v7 offset:128
 ds_read_b64_tr_b16 a[146:147], v7 offset:4736
 v_mfma_f32_16x16x32_bf16 v[88:91], a[132:135], a[164:167], v[88:91]
 buffer_load_dwordx4 a[228:231], v2, s[12:15], s79 offen offset:1024 sc1
 v_mfma_f32_16x16x32_bf16 v[92:95], a[128:131], a[168:171], v[92:95]
 s_mov_b32 s80, 28672
 ds_read_b64_tr_b16 a[148:149], v7 offset:9344
 ds_read_b64_tr_b16 a[150:151], v7 offset:13952
 v_mfma_f32_16x16x32_bf16 v[92:95], a[132:135], a[172:175], v[92:95]
 v_mfma_f32_16x16x32_bf16 v[96:99], a[128:131], a[176:179], v[96:99]
 v_mfma_f32_16x16x32_bf16 v[96:99], a[132:135], a[180:183], v[96:99]
 v_mfma_f32_16x16x32_bf16 v[100:103], a[128:131], a[184:187], v[100:103]
 buffer_load_dwordx4 a[232:235], v2, s[12:15], s80 offen offset:0 sc1
 v_mfma_f32_16x16x32_bf16 v[100:103], a[132:135], a[188:191], v[100:103]
 s_waitcnt lgkmcnt(4)
 v_mfma_f32_16x16x32_bf16 a[48:51], a[136:139], a[160:163], a[48:51]
 ds_read_b64_tr_b16 a[152:153], v7 offset:18560
 ds_read_b64_tr_b16 a[154:155], v7 offset:23168
 v_mfma_f32_16x16x32_bf16 a[48:51], a[140:143], a[164:167], a[48:51]
 v_mfma_f32_16x16x32_bf16 a[52:55], a[136:139], a[168:171], a[52:55]
 ds_read_b64_tr_b16 a[156:157], v7 offset:27776
 ds_read_b64_tr_b16 a[158:159], v7 offset:32384
 v_mfma_f32_16x16x32_bf16 a[52:55], a[140:143], a[172:175], a[52:55]
 buffer_load_dwordx4 a[236:239], v2, s[12:15], s80 offen offset:1024 sc1
 v_mfma_f32_16x16x32_bf16 a[56:59], a[136:139], a[176:179], a[56:59]
 s_mov_b32 s81, 47104
 v_mfma_f32_16x16x32_bf16 a[56:59], a[140:143], a[180:183], a[56:59]
 v_mfma_f32_16x16x32_bf16 a[60:63], a[136:139], a[184:187], a[60:63]
 v_mfma_f32_16x16x32_bf16 a[60:63], a[140:143], a[188:191], a[60:63]
 s_waitcnt lgkmcnt(4)
 v_mfma_f32_16x16x32_bf16 v[104:107], a[144:147], a[160:163], v[104:107]
 ds_read_b64_tr_b16 a[128:129], v7 offset:160
 ds_read_b64_tr_b16 a[130:131], v7 offset:4768
 v_mfma_f32_16x16x32_bf16 v[104:107], a[148:151], a[164:167], v[104:107]
 buffer_load_dwordx4 a[240:243], v2, s[12:15], s81 offen offset:0 sc1
 v_mfma_f32_16x16x32_bf16 v[108:111], a[144:147], a[168:171], v[108:111]
 ds_read_b64_tr_b16 a[132:133], v7 offset:9376
 ds_read_b64_tr_b16 a[134:135], v7 offset:13984
 v_mfma_f32_16x16x32_bf16 v[108:111], a[148:151], a[172:175], v[108:111]
 v_mfma_f32_16x16x32_bf16 v[112:115], a[144:147], a[176:179], v[112:115]
 v_mfma_f32_16x16x32_bf16 v[112:115], a[148:151], a[180:183], v[112:115]
 v_mfma_f32_16x16x32_bf16 v[116:119], a[144:147], a[184:187], v[116:119]
 buffer_load_dwordx4 a[244:247], v2, s[12:15], s81 offen offset:1024 sc1
 v_mfma_f32_16x16x32_bf16 v[116:119], a[148:151], a[188:191], v[116:119]
 s_waitcnt lgkmcnt(4)
 v_mfma_f32_16x16x32_bf16 a[64:67], a[152:155], a[160:163], a[64:67]
 s_mov_b32 s82, 65536
 ds_read_b64_tr_b16 a[136:137], v7 offset:18592
 ds_read_b64_tr_b16 a[138:139], v7 offset:23200
 v_mfma_f32_16x16x32_bf16 a[64:67], a[156:159], a[164:167], a[64:67]
 v_mfma_f32_16x16x32_bf16 a[68:71], a[152:155], a[168:171], a[68:71]
 ds_read_b64_tr_b16 a[140:141], v7 offset:27808
 ds_read_b64_tr_b16 a[142:143], v7 offset:32416
 v_mfma_f32_16x16x32_bf16 a[68:71], a[156:159], a[172:175], a[68:71]
 buffer_load_dwordx4 a[248:251], v2, s[12:15], s82 offen offset:0 sc1
 v_mfma_f32_16x16x32_bf16 v[120:123], a[152:155], a[176:179], v[120:123]
 v_mfma_f32_16x16x32_bf16 v[120:123], a[156:159], a[180:183], v[120:123]
 v_mfma_f32_16x16x32_bf16 v[124:127], a[152:155], a[184:187], v[124:127]
 v_mfma_f32_16x16x32_bf16 v[124:127], a[156:159], a[188:191], v[124:127]
 s_waitcnt lgkmcnt(4)
 v_mfma_f32_16x16x32_bf16 v[128:131], a[128:131], a[160:163], v[128:131]
 ds_read_b64_tr_b16 a[144:145], v7 offset:192
 ds_read_b64_tr_b16 a[146:147], v7 offset:4800
 v_mfma_f32_16x16x32_bf16 v[128:131], a[132:135], a[164:167], v[128:131]
 buffer_load_dwordx4 a[252:255], v2, s[12:15], s82 offen offset:1024 sc1
 v_mfma_f32_16x16x32_bf16 v[132:135], a[128:131], a[168:171], v[132:135]
 ds_read_b64_tr_b16 a[148:149], v7 offset:9408
 ds_read_b64_tr_b16 a[150:151], v7 offset:14016
 v_mfma_f32_16x16x32_bf16 v[132:135], a[132:135], a[172:175], v[132:135]
 v_mfma_f32_16x16x32_bf16 v[136:139], a[128:131], a[176:179], v[136:139]
 v_mfma_f32_16x16x32_bf16 v[136:139], a[132:135], a[180:183], v[136:139]
 v_mfma_f32_16x16x32_bf16 v[140:143], a[128:131], a[184:187], v[140:143]
 v_mfma_f32_16x16x32_bf16 v[140:143], a[132:135], a[188:191], v[140:143]
 s_waitcnt lgkmcnt(4)
 v_mfma_f32_16x16x32_bf16 v[144:147], a[136:139], a[160:163], v[144:147]
 ds_read_b64_tr_b16 a[152:153], v7 offset:18624
 ds_read_b64_tr_b16 a[154:155], v7 offset:23232
 v_mfma_f32_16x16x32_bf16 v[144:147], a[140:143], a[164:167], v[144:147]
 v_mfma_f32_16x16x32_bf16 v[148:151], a[136:139], a[168:171], v[148:151]
 ds_read_b64_tr_b16 a[156:157], v7 offset:27840
 ds_read_b64_tr_b16 a[158:159], v7 offset:32448
 v_mfma_f32_16x16x32_bf16 v[148:151], a[140:143], a[172:175], v[148:151]
 v_mfma_f32_16x16x32_bf16 v[152:155], a[136:139], a[176:179], v[152:155]
 v_mfma_f32_16x16x32_bf16 v[152:155], a[140:143], a[180:183], v[152:155]
 v_mfma_f32_16x16x32_bf16 v[156:159], a[136:139], a[184:187], v[156:159]
 v_mfma_f32_16x16x32_bf16 v[156:159], a[140:143], a[188:191], v[156:159]
 s_waitcnt lgkmcnt(4)
 v_mfma_f32_16x16x32_bf16 v[160:163], a[144:147], a[160:163], v[160:163]
 ds_read_b64_tr_b16 a[128:129], v7 offset:224
 ds_read_b64_tr_b16 a[130:131], v7 offset:4832
 v_mfma_f32_16x16x32_bf16 v[160:163], a[148:151], a[164:167], v[160:163]
 v_mfma_f32_16x16x32_bf16 v[164:167], a[144:147], a[168:171], v[164:167]
 ds_read_b64_tr_b16 a[132:133], v7 offset:9440
 ds_read_b64_tr_b16 a[134:135], v7 offset:14048
 v_mfma_f32_16x16x32_bf16 v[164:167], a[148:151], a[172:175], v[164:167]
 v_mfma_f32_16x16x32_bf16 v[168:171], a[144:147], a[176:179], v[168:171]
 v_mfma_f32_16x16x32_bf16 v[168:171], a[148:151], a[180:183], v[168:171]
 v_mfma_f32_16x16x32_bf16 v[172:175], a[144:147], a[184:187], v[172:175]
 v_mfma_f32_16x16x32_bf16 v[172:175], a[148:151], a[188:191], v[172:175]
 s_waitcnt lgkmcnt(4)
 v_mfma_f32_16x16x32_bf16 v[176:179], a[152:155], a[160:163], v[176:179]
 ds_read_b64_tr_b16 a[136:137], v7 offset:18656
 ds_read_b64_tr_b16 a[138:139], v7 offset:23264
 v_mfma_f32_16x16x32_bf16 v[176:179], a[156:159], a[164:167], v[176:179]
 v_mfma_f32_16x16x32_bf16 v[180:183], a[152:155], a[168:171], v[180:183]
 ds_read_b64_tr_b16 a[140:141], v7 offset:27872
 ds_read_b64_tr_b16 a[142:143], v7 offset:32480
 v_mfma_f32_16x16x32_bf16 v[180:183], a[156:159], a[172:175], v[180:183]
 v_mfma_f32_16x16x32_bf16 v[184:187], a[152:155], a[176:179], v[184:187]
 v_mfma_f32_16x16x32_bf16 v[184:187], a[156:159], a[180:183], v[184:187]
 v_mfma_f32_16x16x32_bf16 v[188:191], a[152:155], a[184:187], v[188:191]
 v_mfma_f32_16x16x32_bf16 v[188:191], a[156:159], a[188:191], v[188:191]
 s_waitcnt lgkmcnt(4)
 v_mfma_f32_16x16x32_bf16 v[192:195], a[128:131], a[160:163], v[192:195]
 ds_read_b64_tr_b16 a[144:145], v7 offset:256
 ds_read_b64_tr_b16 a[146:147], v7 offset:4864
 v_mfma_f32_16x16x32_bf16 v[192:195], a[132:135], a[164:167], v[192:195]
 v_mfma_f32_16x16x32_bf16 v[196:199], a[128:131], a[168:171], v[196:199]
 ds_read_b64_tr_b16 a[148:149], v7 offset:9472
 ds_read_b64_tr_b16 a[150:151], v7 offset:14080
 v_mfma_f32_16x16x32_bf16 v[196:199], a[132:135], a[172:175], v[196:199]
 v_mfma_f32_16x16x32_bf16 v[200:203], a[128:131], a[176:179], v[200:203]
 v_mfma_f32_16x16x32_bf16 v[200:203], a[132:135], a[180:183], v[200:203]
 v_mfma_f32_16x16x32_bf16 v[204:207], a[128:131], a[184:187], v[204:207]
 v_mfma_f32_16x16x32_bf16 v[204:207], a[132:135], a[188:191], v[204:207]
 s_waitcnt lgkmcnt(4)
 v_mfma_f32_16x16x32_bf16 v[208:211], a[136:139], a[160:163], v[208:211]
 ds_read_b64_tr_b16 a[152:153], v7 offset:18688
 ds_read_b64_tr_b16 a[154:155], v7 offset:23296
 v_mfma_f32_16x16x32_bf16 v[208:211], a[140:143], a[164:167], v[208:211]
 v_mfma_f32_16x16x32_bf16 v[212:215], a[136:139], a[168:171], v[212:215]
 ds_read_b64_tr_b16 a[156:157], v7 offset:27904
 ds_read_b64_tr_b16 a[158:159], v7 offset:32512
 v_mfma_f32_16x16x32_bf16 v[212:215], a[140:143], a[172:175], v[212:215]
 v_mfma_f32_16x16x32_bf16 v[216:219], a[136:139], a[176:179], v[216:219]
 v_mfma_f32_16x16x32_bf16 v[216:219], a[140:143], a[180:183], v[216:219]
 v_mfma_f32_16x16x32_bf16 v[220:223], a[136:139], a[184:187], v[220:223]
 v_mfma_f32_16x16x32_bf16 v[220:223], a[140:143], a[188:191], v[220:223]
 s_waitcnt lgkmcnt(4)
 v_mfma_f32_16x16x32_bf16 v[224:227], a[144:147], a[160:163], v[224:227]
 v_mfma_f32_16x16x32_bf16 v[224:227], a[148:151], a[164:167], v[224:227]
 s_waitcnt lgkmcnt(0)
 v_mfma_f32_16x16x32_bf16 v[228:231], a[144:147], a[168:171], v[228:231]
 s_barrier
 v_mfma_f32_16x16x32_bf16 v[228:231], a[148:151], a[172:175], v[228:231]
 s_add_u32 s87, s61, 4128768
 ds_read_b64_tr_b16 a[128:129], v4 offset:0
 ds_read_b64_tr_b16 a[130:131], v4 offset:4608
 v_mfma_f32_16x16x32_bf16 v[232:235], a[144:147], a[176:179], v[232:235]
 s_add_u32 m0, s60, 110592
 v_mfma_f32_16x16x32_bf16 v[232:235], a[148:151], a[180:183], v[232:235]
 ds_read_b64_tr_b16 a[132:133], v4 offset:9216
 ds_read_b64_tr_b16 a[134:135], v4 offset:13824
 v_mfma_f32_16x16x32_bf16 v[236:239], a[144:147], a[184:187], v[236:239]
 buffer_load_dwordx4 v8, s[16:19], s87 offen offset:0 lds
 v_mfma_f32_16x16x32_bf16 v[236:239], a[148:151], a[188:191], v[236:239]
 v_mfma_f32_16x16x32_bf16 v[240:243], a[152:155], a[160:163], v[240:243]
 ds_read_b64_tr_b16 a[136:137], v4 offset:18432
 ds_read_b64_tr_b16 a[138:139], v4 offset:23040
 v_mfma_f32_16x16x32_bf16 v[240:243], a[156:159], a[164:167], v[240:243]
 v_mfma_f32_16x16x32_bf16 v[244:247], a[152:155], a[168:171], v[244:247]
 ds_read_b64_tr_b16 a[140:141], v4 offset:27648
 ds_read_b64_tr_b16 a[142:143], v4 offset:32256
 v_mfma_f32_16x16x32_bf16 v[244:247], a[156:159], a[172:175], v[244:247]
 buffer_load_dwordx4 v9, s[16:19], s87 offen offset:1024 lds
 v_mfma_f32_16x16x32_bf16 v[248:251], a[152:155], a[176:179], v[248:251]
 v_mfma_f32_16x16x32_bf16 v[248:251], a[156:159], a[180:183], v[248:251]
 v_mfma_f32_16x16x32_bf16 v[252:255], a[152:155], a[184:187], v[252:255]
 v_mfma_f32_16x16x32_bf16 v[252:255], a[156:159], a[188:191], v[252:255]
 s_waitcnt vmcnt(20) lgkmcnt(4)
 v_mfma_f32_16x16x32_bf16 v[40:43], a[128:131], a[192:195], v[40:43]
 ds_read_b64_tr_b16 a[144:145], v4 offset:32
 ds_read_b64_tr_b16 a[146:147], v4 offset:4640
 v_mfma_f32_16x16x32_bf16 v[40:43], a[132:135], a[196:199], v[40:43]
 buffer_load_dwordx4 v10, s[16:19], s87 offen offset:2048 lds
 v_mfma_f32_16x16x32_bf16 v[44:47], a[128:131], a[200:203], v[44:47]
 ds_read_b64_tr_b16 a[148:149], v4 offset:9248
 ds_read_b64_tr_b16 a[150:151], v4 offset:13856
 v_mfma_f32_16x16x32_bf16 v[44:47], a[132:135], a[204:207], v[44:47]
 v_mfma_f32_16x16x32_bf16 v[48:51], a[128:131], a[208:211], v[48:51]
 v_mfma_f32_16x16x32_bf16 v[48:51], a[132:135], a[212:215], v[48:51]
 v_mfma_f32_16x16x32_bf16 v[52:55], a[128:131], a[216:219], v[52:55]
 buffer_load_dwordx4 v11, s[16:19], s87 offen offset:3072 lds
 v_mfma_f32_16x16x32_bf16 v[52:55], a[132:135], a[220:223], v[52:55]
 s_waitcnt lgkmcnt(4)
 v_mfma_f32_16x16x32_bf16 a[0:3], a[136:139], a[192:195], a[0:3]
 s_add_u32 m0, s60, 114688
 ds_read_b64_tr_b16 a[152:153], v4 offset:18464
 ds_read_b64_tr_b16 a[154:155], v4 offset:23072
 v_mfma_f32_16x16x32_bf16 a[0:3], a[140:143], a[196:199], a[0:3]
 v_mfma_f32_16x16x32_bf16 a[4:7], a[136:139], a[200:203], a[4:7]
 ds_read_b64_tr_b16 a[156:157], v4 offset:27680
 ds_read_b64_tr_b16 a[158:159], v4 offset:32288
 v_mfma_f32_16x16x32_bf16 a[4:7], a[140:143], a[204:207], a[4:7]
 buffer_load_dwordx4 v12, s[16:19], s87 offen offset:0 lds
 v_mfma_f32_16x16x32_bf16 a[8:11], a[136:139], a[208:211], a[8:11]
 v_mfma_f32_16x16x32_bf16 a[8:11], a[140:143], a[212:215], a[8:11]
 v_mfma_f32_16x16x32_bf16 a[12:15], a[136:139], a[216:219], a[12:15]
 v_mfma_f32_16x16x32_bf16 a[12:15], a[140:143], a[220:223], a[12:15]
 s_waitcnt lgkmcnt(4)
 v_mfma_f32_16x16x32_bf16 v[56:59], a[144:147], a[192:195], v[56:59]
 ds_read_b64_tr_b16 a[128:129], v4 offset:64
 ds_read_b64_tr_b16 a[130:131], v4 offset:4672
 v_mfma_f32_16x16x32_bf16 v[56:59], a[148:151], a[196:199], v[56:59]
 buffer_load_dwordx4 v13, s[16:19], s87 offen offset:1024 lds
 v_mfma_f32_16x16x32_bf16 v[60:63], a[144:147], a[200:203], v[60:63]
 ds_read_b64_tr_b16 a[132:133], v4 offset:9280
 ds_read_b64_tr_b16 a[134:135], v4 offset:13888
 v_mfma_f32_16x16x32_bf16 v[60:63], a[148:151], a[204:207], v[60:63]
 v_mfma_f32_16x16x32_bf16 v[64:67], a[144:147], a[208:211], v[64:67]
 v_mfma_f32_16x16x32_bf16 v[64:67], a[148:151], a[212:215], v[64:67]
 v_mfma_f32_16x16x32_bf16 v[68:71], a[144:147], a[216:219], v[68:71]
 buffer_load_dwordx4 v14, s[16:19], s87 offen offset:2048 lds
 v_mfma_f32_16x16x32_bf16 v[68:71], a[148:151], a[220:223], v[68:71]
 s_waitcnt lgkmcnt(4)
 v_mfma_f32_16x16x32_bf16 a[16:19], a[152:155], a[192:195], a[16:19]
 ds_read_b64_tr_b16 a[136:137], v4 offset:18496
 ds_read_b64_tr_b16 a[138:139], v4 offset:23104
 v_mfma_f32_16x16x32_bf16 a[16:19], a[156:159], a[196:199], a[16:19]
 v_mfma_f32_16x16x32_bf16 a[20:23], a[152:155], a[200:203], a[20:23]
 ds_read_b64_tr_b16 a[140:141], v4 offset:27712
 ds_read_b64_tr_b16 a[142:143], v4 offset:32320
 v_mfma_f32_16x16x32_bf16 a[20:23], a[156:159], a[204:207], a[20:23]
 buffer_load_dwordx4 v15, s[16:19], s87 offen offset:3072 lds
 v_mfma_f32_16x16x32_bf16 a[24:27], a[152:155], a[208:211], a[24:27]
 s_add_u32 m0, s60, 118784
 v_mfma_f32_16x16x32_bf16 a[24:27], a[156:159], a[212:215], a[24:27]
 v_mfma_f32_16x16x32_bf16 a[28:31], a[152:155], a[216:219], a[28:31]
 v_mfma_f32_16x16x32_bf16 a[28:31], a[156:159], a[220:223], a[28:31]
 s_waitcnt lgkmcnt(4)
 v_mfma_f32_16x16x32_bf16 v[72:75], a[128:131], a[192:195], v[72:75]
 ds_read_b64_tr_b16 a[144:145], v4 offset:96
 ds_read_b64_tr_b16 a[146:147], v4 offset:4704
 v_mfma_f32_16x16x32_bf16 v[72:75], a[132:135], a[196:199], v[72:75]
 buffer_load_dwordx4 v16, s[16:19], s87 offen offset:0 lds
 v_mfma_f32_16x16x32_bf16 v[76:79], a[128:131], a[200:203], v[76:79]
 s_mov_b32 s86, 0
 ds_read_b64_tr_b16 a[148:149], v4 offset:9312
 ds_read_b64_tr_b16 a[150:151], v4 offset:13920
 v_mfma_f32_16x16x32_bf16 v[76:79], a[132:135], a[204:207], v[76:79]
 v_mfma_f32_16x16x32_bf16 v[80:83], a[128:131], a[208:211], v[80:83]
 v_mfma_f32_16x16x32_bf16 v[80:83], a[132:135], a[212:215], v[80:83]
 v_mfma_f32_16x16x32_bf16 v[84:87], a[128:131], a[216:219], v[84:87]
 buffer_load_dword v31, v29, s[40:43], s86 offen sc0
 v_mfma_f32_16x16x32_bf16 v[84:87], a[132:135], a[220:223], v[84:87]
 s_waitcnt lgkmcnt(4)
 v_mfma_f32_16x16x32_bf16 a[32:35], a[136:139], a[192:195], a[32:35]
 s_mov_b32 s79, 12288
 ds_read_b64_tr_b16 a[152:153], v4 offset:18528
 ds_read_b64_tr_b16 a[154:155], v4 offset:23136
 v_mfma_f32_16x16x32_bf16 a[32:35], a[140:143], a[196:199], a[32:35]
 v_mfma_f32_16x16x32_bf16 a[36:39], a[136:139], a[200:203], a[36:39]
 ds_read_b64_tr_b16 a[156:157], v4 offset:27744
 ds_read_b64_tr_b16 a[158:159], v4 offset:32352
 v_mfma_f32_16x16x32_bf16 a[36:39], a[140:143], a[204:207], a[36:39]
 buffer_load_dwordx4 a[160:163], v2, s[12:15], s79 offen offset:0 sc1
 v_mfma_f32_16x16x32_bf16 a[40:43], a[136:139], a[208:211], a[40:43]
 v_mfma_f32_16x16x32_bf16 a[40:43], a[140:143], a[212:215], a[40:43]
 v_mfma_f32_16x16x32_bf16 a[44:47], a[136:139], a[216:219], a[44:47]
 v_mfma_f32_16x16x32_bf16 a[44:47], a[140:143], a[220:223], a[44:47]
 s_waitcnt lgkmcnt(4)
 v_mfma_f32_16x16x32_bf16 v[88:91], a[144:147], a[192:195], v[88:91]
 ds_read_b64_tr_b16 a[128:129], v4 offset:128
 ds_read_b64_tr_b16 a[130:131], v4 offset:4736
 v_mfma_f32_16x16x32_bf16 v[88:91], a[148:151], a[196:199], v[88:91]
 buffer_load_dwordx4 a[164:167], v2, s[12:15], s79 offen offset:1024 sc1
 v_mfma_f32_16x16x32_bf16 v[92:95], a[144:147], a[200:203], v[92:95]
 s_mov_b32 s80, 30720
 ds_read_b64_tr_b16 a[132:133], v4 offset:9344
 ds_read_b64_tr_b16 a[134:135], v4 offset:13952
 v_mfma_f32_16x16x32_bf16 v[92:95], a[148:151], a[204:207], v[92:95]
 v_mfma_f32_16x16x32_bf16 v[96:99], a[144:147], a[208:211], v[96:99]
 v_mfma_f32_16x16x32_bf16 v[96:99], a[148:151], a[212:215], v[96:99]
 v_mfma_f32_16x16x32_bf16 v[100:103], a[144:147], a[216:219], v[100:103]
 buffer_load_dwordx4 a[168:171], v2, s[12:15], s80 offen offset:0 sc1
 v_mfma_f32_16x16x32_bf16 v[100:103], a[148:151], a[220:223], v[100:103]
 s_waitcnt lgkmcnt(4)
 v_mfma_f32_16x16x32_bf16 a[48:51], a[152:155], a[192:195], a[48:51]
 ds_read_b64_tr_b16 a[136:137], v4 offset:18560
 ds_read_b64_tr_b16 a[138:139], v4 offset:23168
 v_mfma_f32_16x16x32_bf16 a[48:51], a[156:159], a[196:199], a[48:51]
 v_mfma_f32_16x16x32_bf16 a[52:55], a[152:155], a[200:203], a[52:55]
 ds_read_b64_tr_b16 a[140:141], v4 offset:27776
 ds_read_b64_tr_b16 a[142:143], v4 offset:32384
 v_mfma_f32_16x16x32_bf16 a[52:55], a[156:159], a[204:207], a[52:55]
 buffer_load_dwordx4 a[172:175], v2, s[12:15], s80 offen offset:1024 sc1
 v_mfma_f32_16x16x32_bf16 a[56:59], a[152:155], a[208:211], a[56:59]
 s_mov_b32 s81, 49152
 v_mfma_f32_16x16x32_bf16 a[56:59], a[156:159], a[212:215], a[56:59]
 v_mfma_f32_16x16x32_bf16 a[60:63], a[152:155], a[216:219], a[60:63]
 v_mfma_f32_16x16x32_bf16 a[60:63], a[156:159], a[220:223], a[60:63]
 s_waitcnt lgkmcnt(4)
 v_mfma_f32_16x16x32_bf16 v[104:107], a[128:131], a[192:195], v[104:107]
 ds_read_b64_tr_b16 a[144:145], v4 offset:160
 ds_read_b64_tr_b16 a[146:147], v4 offset:4768
 v_mfma_f32_16x16x32_bf16 v[104:107], a[132:135], a[196:199], v[104:107]
 buffer_load_dwordx4 a[176:179], v2, s[12:15], s81 offen offset:0 sc1
 v_mfma_f32_16x16x32_bf16 v[108:111], a[128:131], a[200:203], v[108:111]
 ds_read_b64_tr_b16 a[148:149], v4 offset:9376
 ds_read_b64_tr_b16 a[150:151], v4 offset:13984
 v_mfma_f32_16x16x32_bf16 v[108:111], a[132:135], a[204:207], v[108:111]
 v_mfma_f32_16x16x32_bf16 v[112:115], a[128:131], a[208:211], v[112:115]
 v_mfma_f32_16x16x32_bf16 v[112:115], a[132:135], a[212:215], v[112:115]
 v_mfma_f32_16x16x32_bf16 v[116:119], a[128:131], a[216:219], v[116:119]
 buffer_load_dwordx4 a[180:183], v2, s[12:15], s81 offen offset:1024 sc1
 v_mfma_f32_16x16x32_bf16 v[116:119], a[132:135], a[220:223], v[116:119]
 s_waitcnt lgkmcnt(4)
 v_mfma_f32_16x16x32_bf16 a[64:67], a[136:139], a[192:195], a[64:67]
 s_mov_b32 s82, 67584
 ds_read_b64_tr_b16 a[152:153], v4 offset:18592
 ds_read_b64_tr_b16 a[154:155], v4 offset:23200
 v_mfma_f32_16x16x32_bf16 a[64:67], a[140:143], a[196:199], a[64:67]
 v_mfma_f32_16x16x32_bf16 a[68:71], a[136:139], a[200:203], a[68:71]
 ds_read_b64_tr_b16 a[156:157], v4 offset:27808
 ds_read_b64_tr_b16 a[158:159], v4 offset:32416
 v_mfma_f32_16x16x32_bf16 a[68:71], a[140:143], a[204:207], a[68:71]
 buffer_load_dwordx4 a[184:187], v2, s[12:15], s82 offen offset:0 sc1
 v_mfma_f32_16x16x32_bf16 v[120:123], a[136:139], a[208:211], v[120:123]
 v_mfma_f32_16x16x32_bf16 v[120:123], a[140:143], a[212:215], v[120:123]
 v_mfma_f32_16x16x32_bf16 v[124:127], a[136:139], a[216:219], v[124:127]
 v_mfma_f32_16x16x32_bf16 v[124:127], a[140:143], a[220:223], v[124:127]
 s_waitcnt lgkmcnt(4)
 v_mfma_f32_16x16x32_bf16 v[128:131], a[144:147], a[192:195], v[128:131]
 ds_read_b64_tr_b16 a[128:129], v4 offset:192
 ds_read_b64_tr_b16 a[130:131], v4 offset:4800
 v_mfma_f32_16x16x32_bf16 v[128:131], a[148:151], a[196:199], v[128:131]
 buffer_load_dwordx4 a[188:191], v2, s[12:15], s82 offen offset:1024 sc1
 v_mfma_f32_16x16x32_bf16 v[132:135], a[144:147], a[200:203], v[132:135]
 s_add_u32 s83, s62, 4194304
 ds_read_b64_tr_b16 a[132:133], v4 offset:9408
 ds_read_b64_tr_b16 a[134:135], v4 offset:14016
 v_mfma_f32_16x16x32_bf16 v[132:135], a[148:151], a[204:207], v[132:135]
 s_add_u32 m0, s53, 147456
 v_mfma_f32_16x16x32_bf16 v[136:139], a[144:147], a[208:211], v[136:139]
 v_mfma_f32_16x16x32_bf16 v[136:139], a[148:151], a[212:215], v[136:139]
 v_mfma_f32_16x16x32_bf16 v[140:143], a[144:147], a[216:219], v[140:143]
 buffer_load_dwordx4 v20, s[20:23], s83 offen lds
 v_mfma_f32_16x16x32_bf16 v[140:143], a[148:151], a[220:223], v[140:143]
 s_waitcnt lgkmcnt(4)
 v_mfma_f32_16x16x32_bf16 v[144:147], a[152:155], a[192:195], v[144:147]
 s_add_u32 s84, s62, 4227072
 ds_read_b64_tr_b16 a[136:137], v4 offset:18624
 ds_read_b64_tr_b16 a[138:139], v4 offset:23232
 v_mfma_f32_16x16x32_bf16 v[144:147], a[156:159], a[196:199], v[144:147]
 s_add_u32 m0, s53, 148480
 v_mfma_f32_16x16x32_bf16 v[148:151], a[152:155], a[200:203], v[148:151]
 ds_read_b64_tr_b16 a[140:141], v4 offset:27840
 ds_read_b64_tr_b16 a[142:143], v4 offset:32448
 v_mfma_f32_16x16x32_bf16 v[148:151], a[156:159], a[204:207], v[148:151]
 buffer_load_dwordx4 v21, s[20:23], s84 offen lds
 v_mfma_f32_16x16x32_bf16 v[152:155], a[152:155], a[208:211], v[152:155]
 s_add_u32 s83, s62, 4259840
 v_mfma_f32_16x16x32_bf16 v[152:155], a[156:159], a[212:215], v[152:155]
 s_add_u32 m0, s53, 149504
 v_mfma_f32_16x16x32_bf16 v[156:159], a[152:155], a[216:219], v[156:159]
 v_mfma_f32_16x16x32_bf16 v[156:159], a[156:159], a[220:223], v[156:159]
 s_waitcnt lgkmcnt(4)
 v_mfma_f32_16x16x32_bf16 v[160:163], a[128:131], a[192:195], v[160:163]
 ds_read_b64_tr_b16 a[144:145], v4 offset:224
 ds_read_b64_tr_b16 a[146:147], v4 offset:4832
 v_mfma_f32_16x16x32_bf16 v[160:163], a[132:135], a[196:199], v[160:163]
 buffer_load_dwordx4 v20, s[20:23], s83 offen lds
 v_mfma_f32_16x16x32_bf16 v[164:167], a[128:131], a[200:203], v[164:167]
 s_add_u32 s84, s62, 4292608
 ds_read_b64_tr_b16 a[148:149], v4 offset:9440
 ds_read_b64_tr_b16 a[150:151], v4 offset:14048
 v_mfma_f32_16x16x32_bf16 v[164:167], a[132:135], a[204:207], v[164:167]
 s_add_u32 m0, s53, 150528
 v_mfma_f32_16x16x32_bf16 v[168:171], a[128:131], a[208:211], v[168:171]
 v_mfma_f32_16x16x32_bf16 v[168:171], a[132:135], a[212:215], v[168:171]
 v_mfma_f32_16x16x32_bf16 v[172:175], a[128:131], a[216:219], v[172:175]
 buffer_load_dwordx4 v21, s[20:23], s84 offen lds
 v_mfma_f32_16x16x32_bf16 v[172:175], a[132:135], a[220:223], v[172:175]
 s_waitcnt lgkmcnt(4)
 v_mfma_f32_16x16x32_bf16 v[176:179], a[136:139], a[192:195], v[176:179]
 s_getpc_b64 s[44:45]
L_ct2:
 s_add_u32 s44, s44, L_c1-L_ct2
 s_addc_u32 s45, s45, 0
 ds_read_b64_tr_b16 a[152:153], v4 offset:18656
 ds_read_b64_tr_b16 a[154:155], v4 offset:23264
 v_mfma_f32_16x16x32_bf16 v[176:179], a[140:143], a[196:199], v[176:179]
 s_lshr_b32 s3, s2, 3
 v_mfma_f32_16x16x32_bf16 v[180:183], a[136:139], a[200:203], v[180:183]
 s_lshl_b32 s3, s3, 11
 ds_read_b64_tr_b16 a[156:157], v4 offset:27872
 ds_read_b64_tr_b16 a[158:159], v4 offset:32480
 v_mfma_f32_16x16x32_bf16 v[180:183], a[140:143], a[204:207], v[180:183]
 v_and_b32 v32, 15, v3
 v_lshlrev_b32 v32, 7, v32
 v_mfma_f32_16x16x32_bf16 v[184:187], a[136:139], a[208:211], v[184:187]
 v_add_u32 v32, s3, v32
 v_min_u32 v32, L_code_end-L_c1-4, v32
 v_mfma_f32_16x16x32_bf16 v[184:187], a[140:143], a[212:215], v[184:187]
 v_mov_b32 v33, s45
 v_add_co_u32 v32, vcc, s44, v32
 v_mfma_f32_16x16x32_bf16 v[188:191], a[136:139], a[216:219], v[188:191]
 s_nop 0
 v_addc_co_u32 v33, vcc, 0, v33, vcc
 v_mfma_f32_16x16x32_bf16 v[188:191], a[140:143], a[220:223], v[188:191]
 s_waitcnt lgkmcnt(4)
 global_load_dword v39, v[32:33], off
 v_mfma_f32_16x16x32_bf16 v[192:195], a[144:147], a[192:195], v[192:195]
 ds_read_b64_tr_b16 a[128:129], v4 offset:256
 ds_read_b64_tr_b16 a[130:131], v4 offset:4864
 v_mfma_f32_16x16x32_bf16 v[192:195], a[148:151], a[196:199], v[192:195]
 v_mfma_f32_16x16x32_bf16 v[196:199], a[144:147], a[200:203], v[196:199]
 ds_read_b64_tr_b16 a[132:133], v4 offset:9472
 ds_read_b64_tr_b16 a[134:135], v4 offset:14080
 v_mfma_f32_16x16x32_bf16 v[196:199], a[148:151], a[204:207], v[196:199]
 v_mfma_f32_16x16x32_bf16 v[200:203], a[144:147], a[208:211], v[200:203]
 v_mfma_f32_16x16x32_bf16 v[200:203], a[148:151], a[212:215], v[200:203]
 v_mfma_f32_16x16x32_bf16 v[204:207], a[144:147], a[216:219], v[204:207]
 v_mfma_f32_16x16x32_bf16 v[204:207], a[148:151], a[220:223], v[204:207]
 s_waitcnt lgkmcnt(4)
 v_mfma_f32_16x16x32_bf16 v[208:211], a[152:155], a[192:195], v[208:211]
 ds_read_b64_tr_b16 a[136:137], v4 offset:18688
 ds_read_b64_tr_b16 a[138:139], v4 offset:23296
 v_mfma_f32_16x16x32_bf16 v[208:211], a[156:159], a[196:199], v[208:211]
 v_mfma_f32_16x16x32_bf16 v[212:215], a[152:155], a[200:203], v[212:215]
 ds_read_b64_tr_b16 a[140:141], v4 offset:27904
 ds_read_b64_tr_b16 a[142:143], v4 offset:32512
 v_mfma_f32_16x16x32_bf16 v[212:215], a[156:159], a[204:207], v[212:215]
 v_mfma_f32_16x16x32_bf16 v[216:219], a[152:155], a[208:211], v[216:219]
 v_mfma_f32_16x16x32_bf16 v[216:219], a[156:159], a[212:215], v[216:219]
 v_mfma_f32_16x16x32_bf16 v[220:223], a[152:155], a[216:219], v[220:223]
 v_mfma_f32_16x16x32_bf16 v[220:223], a[156:159], a[220:223], v[220:223]
 s_waitcnt lgkmcnt(4)
 v_mfma_f32_16x16x32_bf16 v[224:227], a[128:131], a[192:195], v[224:227]
 v_mfma_f32_16x16x32_bf16 v[224:227], a[132:135], a[196:199], v[224:227]
 s_waitcnt lgkmcnt(0)
 v_mfma_f32_16x16x32_bf16 v[228:231], a[128:131], a[200:203], v[228:231]
 s_barrier
 v_mfma_f32_16x16x32_bf16 v[228:231], a[132:135], a[204:207], v[228:231]
 s_add_u32 s87, s61, 4718592
 ds_read_b64_tr_b16 a[144:145], v5 offset:0
 ds_read_b64_tr_b16 a[146:147], v5 offset:4608
 v_mfma_f32_16x16x32_bf16 v[232:235], a[128:131], a[208:211], v[232:235]
 s_add_u32 m0, s60, 0
 v_mfma_f32_16x16x32_bf16 v[232:235], a[132:135], a[212:215], v[232:235]
 ds_read_b64_tr_b16 a[148:149], v5 offset:9216
 ds_read_b64_tr_b16 a[150:151], v5 offset:13824
 v_mfma_f32_16x16x32_bf16 v[236:239], a[128:131], a[216:219], v[236:239]
 buffer_load_dwordx4 v8, s[16:19], s87 offen offset:0 lds
 v_mfma_f32_16x16x32_bf16 v[236:239], a[132:135], a[220:223], v[236:239]
 v_mfma_f32_16x16x32_bf16 v[240:243], a[136:139], a[192:195], v[240:243]
 ds_read_b64_tr_b16 a[152:153], v5 offset:18432
 ds_read_b64_tr_b16 a[154:155], v5 offset:23040
 v_mfma_f32_16x16x32_bf16 v[240:243], a[140:143], a[196:199], v[240:243]
 v_mfma_f32_16x16x32_bf16 v[244:247], a[136:139], a[200:203], v[244:247]
 ds_read_b64_tr_b16 a[156:157], v5 offset:27648
 ds_read_b64_tr_b16 a[158:159], v5 offset:32256
 v_mfma_f32_16x16x32_bf16 v[244:247], a[140:143], a[204:207], v[244:247]
 buffer_load_dwordx4 v9, s[16:19], s87 offen offset:1024 lds
 v_mfma_f32_16x16x32_bf16 v[248:251], a[136:139], a[208:211], v[248:251]
 v_mfma_f32_16x16x32_bf16 v[248:251], a[140:143], a[212:215], v[248:251]
 v_mfma_f32_16x16x32_bf16 v[252:255], a[136:139], a[216:219], v[252:255]
 v_mfma_f32_16x16x32_bf16 v[252:255], a[140:143], a[220:223], v[252:255]
 s_waitcnt vmcnt(25) lgkmcnt(4)
 v_mfma_f32_16x16x32_bf16 v[40:43], a[144:147], a[224:227], v[40:43]
 ds_read_b64_tr_b16 a[128:129], v5 offset:32
 ds_read_b64_tr_b16 a[130:131], v5 offset:4640
 v_mfma_f32_16x16x32_bf16 v[40:43], a[148:151], a[228:231], v[40:43]
 buffer_load_dwordx4 v10, s[16:19], s87 offen offset:2048 lds
 v_mfma_f32_16x16x32_bf16 v[44:47], a[144:147], a[232:235], v[44:47]
 ds_read_b64_tr_b16 a[132:133], v5 offset:9248
 ds_read_b64_tr_b16 a[134:135], v5 offset:13856
 v_mfma_f32_16x16x32_bf16 v[44:47], a[148:151], a[236:239], v[44:47]
 v_mfma_f32_16x16x32_bf16 v[48:51], a[144:147], a[240:243], v[48:51]
 v_mfma_f32_16x16x32_bf16 v[48:51], a[148:151], a[244:247], v[48:51]
 v_mfma_f32_16x16x32_bf16 v[52:55], a[144:147], a[248:251], v[52:55]
 buffer_load_dwordx4 v11, s[16:19], s87 offen offset:3072 lds
 v_mfma_f32_16x16x32_bf16 v[52:55], a[148:151], a[252:255], v[52:55]
 s_waitcnt lgkmcnt(4)
 v_mfma_f32_16x16x32_bf16 a[0:3], a[152:155], a[224:227], a[0:3]
 s_add_u32 m0, s60, 4096
 ds_read_b64_tr_b16 a[136:137], v5 offset:18464
 ds_read_b64_tr_b16 a[138:139], v5 offset:23072
 v_mfma_f32_16x16x32_bf16 a[0:3], a[156:159], a[228:231], a[0:3]
 v_mfma_f32_16x16x32_bf16 a[4:7], a[152:155], a[232:235], a[4:7]
 ds_read_b64_tr_b16 a[140:141], v5 offset:27680
 ds_read_b64_tr_b16 a[142:143], v5 offset:32288
 v_mfma_f32_16x16x32_bf16 a[4:7], a[156:159], a[236:239], a[4:7]
 buffer_load_dwordx4 v12, s[16:19], s87 offen offset:0 lds
 v_mfma_f32_16x16x32_bf16 a[8:11], a[152:155], a[240:243], a[8:11]
 v_mfma_f32_16x16x32_bf16 a[8:11], a[156:159], a[244:247], a[8:11]
 v_mfma_f32_16x16x32_bf16 a[12:15], a[152:155], a[248:251], a[12:15]
 v_mfma_f32_16x16x32_bf16 a[12:15], a[156:159], a[252:255], a[12:15]
 s_waitcnt lgkmcnt(4)
 v_mfma_f32_16x16x32_bf16 v[56:59], a[128:131], a[224:227], v[56:59]
 ds_read_b64_tr_b16 a[144:145], v5 offset:64
 ds_read_b64_tr_b16 a[146:147], v5 offset:4672
 v_mfma_f32_16x16x32_bf16 v[56:59], a[132:135], a[228:231], v[56:59]
 buffer_load_dwordx4 v13, s[16:19], s87 offen offset:1024 lds
 v_mfma_f32_16x16x32_bf16 v[60:63], a[128:131], a[232:235], v[60:63]
 ds_read_b64_tr_b16 a[148:149], v5 offset:9280
 ds_read_b64_tr_b16 a[150:151], v5 offset:13888
 v_mfma_f32_16x16x32_bf16 v[60:63], a[132:135], a[236:239], v[60:63]
 v_mfma_f32_16x16x32_bf16 v[64:67], a[128:131], a[240:243], v[64:67]
 v_mfma_f32_16x16x32_bf16 v[64:67], a[132:135], a[244:247], v[64:67]
 v_mfma_f32_16x16x32_bf16 v[68:71], a[128:131], a[248:251], v[68:71]
 buffer_load_dwordx4 v14, s[16:19], s87 offen offset:2048 lds
 v_mfma_f32_16x16x32_bf16 v[68:71], a[132:135], a[252:255], v[68:71]
 s_waitcnt lgkmcnt(4)
 v_mfma_f32_16x16x32_bf16 a[16:19], a[136:139], a[224:227], a[16:19]
 ds_read_b64_tr_b16 a[152:153], v5 offset:18496
 ds_read_b64_tr_b16 a[154:155], v5 offset:23104
 v_mfma_f32_16x16x32_bf16 a[16:19], a[140:143], a[228:231], a[16:19]
 v_mfma_f32_16x16x32_bf16 a[20:23], a[136:139], a[232:235], a[20:23]
 ds_read_b64_tr_b16 a[156:157], v5 offset:27712
 ds_read_b64_tr_b16 a[158:159], v5 offset:32320
 v_mfma_f32_16x16x32_bf16 a[20:23], a[140:143], a[236:239], a[20:23]
 buffer_load_dwordx4 v15, s[16:19], s87 offen offset:3072 lds
 v_mfma_f32_16x16x32_bf16 a[24:27], a[136:139], a[240:243], a[24:27]
 s_add_u32 m0, s60, 8192
 v_mfma_f32_16x16x32_bf16 a[24:27], a[140:143], a[244:247], a[24:27]
 v_mfma_f32_16x16x32_bf16 a[28:31], a[136:139], a[248:251], a[28:31]
 v_mfma_f32_16x16x32_bf16 a[28:31], a[140:143], a[252:255], a[28:31]
 s_waitcnt lgkmcnt(4)
 v_mfma_f32_16x16x32_bf16 v[72:75], a[144:147], a[224:227], v[72:75]
 ds_read_b64_tr_b16 a[128:129], v5 offset:96
 ds_read_b64_tr_b16 a[130:131], v5 offset:4704
 v_mfma_f32_16x16x32_bf16 v[72:75], a[148:151], a[228:231], v[72:75]
 buffer_load_dwordx4 v16, s[16:19], s87 offen offset:0 lds
 v_mfma_f32_16x16x32_bf16 v[76:79], a[144:147], a[232:235], v[76:79]
 s_mov_b32 s79, 14336
 ds_read_b64_tr_b16 a[132:133], v5 offset:9312
 ds_read_b64_tr_b16 a[134:135], v5 offset:13920
 v_mfma_f32_16x16x32_bf16 v[76:79], a[148:151], a[236:239], v[76:79]
 v_mfma_f32_16x16x32_bf16 v[80:83], a[144:147], a[240:243], v[80:83]
 v_mfma_f32_16x16x32_bf16 v[80:83], a[148:151], a[244:247], v[80:83]
 v_mfma_f32_16x16x32_bf16 v[84:87], a[144:147], a[248:251], v[84:87]
 buffer_load_dwordx4 a[192:195], v2, s[12:15], s79 offen offset:0 sc1
 v_mfma_f32_16x16x32_bf16 v[84:87], a[148:151], a[252:255], v[84:87]
 s_waitcnt lgkmcnt(4)
 v_mfma_f32_16x16x32_bf16 a[32:35], a[152:155], a[224:227], a[32:35]
 ds_read_b64_tr_b16 a[136:137], v5 offset:18528
 ds_read_b64_tr_b16 a[138:139], v5 offset:23136
 v_mfma_f32_16x16x32_bf16 a[32:35], a[156:159], a[228:231], a[32:35]
 v_mfma_f32_16x16x32_bf16 a[36:39], a[152:155], a[232:235], a[36:39]
 ds_read_b64_tr_b16 a[140:141], v5 offset:27744
 ds_read_b64_tr_b16 a[142:143], v5 offset:32352
 v_mfma_f32_16x16x32_bf16 a[36:39], a[156:159], a[236:239], a[36:39]
 buffer_load_dwordx4 a[196:199], v2, s[12:15], s79 offen offset:1024 sc1
 v_mfma_f32_16x16x32_bf16 a[40:43], a[152:155], a[240:243], a[40:43]
 s_mov_b32 s80, 32768
 v_mfma_f32_16x16x32_bf16 a[40:43], a[156:159], a[244:247], a[40:43]
 v_mfma_f32_16x16x32_bf16 a[44:47], a[152:155], a[248:251], a[44:47]
 v_mfma_f32_16x16x32_bf16 a[44:47], a[156:159], a[252:255], a[44:47]
 s_waitcnt lgkmcnt(4)
 v_mfma_f32_16x16x32_bf16 v[88:91], a[128:131], a[224:227], v[88:91]
 ds_read_b64_tr_b16 a[144:145], v5 offset:128
 ds_read_b64_tr_b16 a[146:147], v5 offset:4736
 v_mfma_f32_16x16x32_bf16 v[88:91], a[132:135], a[228:231], v[88:91]
 buffer_load_dwordx4 a[200:203], v2, s[12:15], s80 offen offset:0 sc1
 v_mfma_f32_16x16x32_bf16 v[92:95], a[128:131], a[232:235], v[92:95]
 ds_read_b64_tr_b16 a[148:149], v5 offset:9344
 ds_read_b64_tr_b16 a[150:151], v5 offset:13952
 v_mfma_f32_16x16x32_bf16 v[92:95], a[132:135], a[236:239], v[92:95]
 v_mfma_f32_16x16x32_bf16 v[96:99], a[128:131], a[240:243], v[96:99]
 v_mfma_f32_16x16x32_bf16 v[96:99], a[132:135], a[244:247], v[96:99]
 v_mfma_f32_16x16x32_bf16 v[100:103], a[128:131], a[248:251], v[100:103]
 buffer_load_dwordx4 a[204:207], v2, s[12:15], s80 offen offset:1024 sc1
 v_mfma_f32_16x16x32_bf16 v[100:103], a[132:135], a[252:255], v[100:103]
 s_waitcnt lgkmcnt(4)
 v_mfma_f32_16x16x32_bf16 a[48:51], a[136:139], a[224:227], a[48:51]
 s_mov_b32 s81, 51200
 ds_read_b64_tr_b16 a[152:153], v5 offset:18560
 ds_read_b64_tr_b16 a[154:155], v5 offset:23168
 v_mfma_f32_16x16x32_bf16 a[48:51], a[140:143], a[228:231], a[48:51]
 v_mfma_f32_16x16x32_bf16 a[52:55], a[136:139], a[232:235], a[52:55]
 ds_read_b64_tr_b16 a[156:157], v5 offset:27776
 ds_read_b64_tr_b16 a[158:159], v5 offset:32384
 v_mfma_f32_16x16x32_bf16 a[52:55], a[140:143], a[236:239], a[52:55]
 buffer_load_dwordx4 a[208:211], v2, s[12:15], s81 offen offset:0 sc1
 v_mfma_f32_16x16x32_bf16 a[56:59], a[136:139], a[240:243], a[56:59]
 v_mfma_f32_16x16x32_bf16 a[56:59], a[140:143], a[244:247], a[56:59]
 v_mfma_f32_16x16x32_bf16 a[60:63], a[136:139], a[248:251], a[60:63]
 v_mfma_f32_16x16x32_bf16 a[60:63], a[140:143], a[252:255], a[60:63]
 s_waitcnt lgkmcnt(4)
 v_mfma_f32_16x16x32_bf16 v[104:107], a[144:147], a[224:227], v[104:107]
 ds_read_b64_tr_b16 a[128:129], v5 offset:160
 ds_read_b64_tr_b16 a[130:131], v5 offset:4768
 v_mfma_f32_16x16x32_bf16 v[104:107], a[148:151], a[228:231], v[104:107]
 buffer_load_dwordx4 a[212:215], v2, s[12:15], s81 offen offset:1024 sc1
 v_mfma_f32_16x16x32_bf16 v[108:111], a[144:147], a[232:235], v[108:111]
 s_mov_b32 s82, 69632
 ds_read_b64_tr_b16 a[132:133], v5 offset:9376
 ds_read_b64_tr_b16 a[134:135], v5 offset:13984
 v_mfma_f32_16x16x32_bf16 v[108:111], a[148:151], a[236:239], v[108:111]
 v_mfma_f32_16x16x32_bf16 v[112:115], a[144:147], a[240:243], v[112:115]
 v_mfma_f32_16x16x32_bf16 v[112:115], a[148:151], a[244:247], v[112:115]
 v_mfma_f32_16x16x32_bf16 v[116:119], a[144:147], a[248:251], v[116:119]
 buffer_load_dwordx4 a[216:219], v2, s[12:15], s82 offen offset:0 sc1
 v_mfma_f32_16x16x32_bf16 v[116:119], a[148:151], a[252:255], v[116:119]
 s_waitcnt lgkmcnt(4)
 v_mfma_f32_16x16x32_bf16 a[64:67], a[152:155], a[224:227], a[64:67]
 ds_read_b64_tr_b16 a[136:137], v5 offset:18592
 ds_read_b64_tr_b16 a[138:139], v5 offset:23200
 v_mfma_f32_16x16x32_bf16 a[64:67], a[156:159], a[228:231], a[64:67]
 v_mfma_f32_16x16x32_bf16 a[68:71], a[152:155], a[232:235], a[68:71]
 ds_read_b64_tr_b16 a[140:141], v5 offset:27808
 ds_read_b64_tr_b16 a[142:143], v5 offset:32416
 v_mfma_f32_16x16x32_bf16 a[68:71], a[156:159], a[236:239], a[68:71]
 buffer_load_dwordx4 a[220:223], v2, s[12:15], s82 offen offset:1024 sc1
 v_mfma_f32_16x16x32_bf16 v[120:123], a[152:155], a[240:243], v[120:123]
 v_mfma_f32_16x16x32_bf16 v[120:123], a[156:159], a[244:247], v[120:123]
 v_mfma_f32_16x16x32_bf16 v[124:127], a[152:155], a[248:251], v[124:127]
 v_mfma_f32_16x16x32_bf16 v[124:127], a[156:159], a[252:255], v[124:127]
 s_waitcnt lgkmcnt(4)
 v_mfma_f32_16x16x32_bf16 v[128:131], a[128:131], a[224:227], v[128:131]
 ds_read_b64_tr_b16 a[144:145], v5 offset:192
 ds_read_b64_tr_b16 a[146:147], v5 offset:4800
 v_mfma_f32_16x16x32_bf16 v[128:131], a[132:135], a[228:231], v[128:131]
 v_mfma_f32_16x16x32_bf16 v[132:135], a[128:131], a[232:235], v[132:135]
 ds_read_b64_tr_b16 a[148:149], v5 offset:9408
 ds_read_b64_tr_b16 a[150:151], v5 offset:14016
 v_mfma_f32_16x16x32_bf16 v[132:135], a[132:135], a[236:239], v[132:135]
 v_mfma_f32_16x16x32_bf16 v[136:139], a[128:131], a[240:243], v[136:139]
 v_mfma_f32_16x16x32_bf16 v[136:139], a[132:135], a[244:247], v[136:139]
 v_mfma_f32_16x16x32_bf16 v[140:143], a[128:131], a[248:251], v[140:143]
 v_mfma_f32_16x16x32_bf16 v[140:143], a[132:135], a[252:255], v[140:143]
 s_waitcnt lgkmcnt(4)
 v_mfma_f32_16x16x32_bf16 v[144:147], a[136:139], a[224:227], v[144:147]
 ds_read_b64_tr_b16 a[152:153], v5 offset:18624
 ds_read_b64_tr_b16 a[154:155], v5 offset:23232
 v_mfma_f32_16x16x32_bf16 v[144:147], a[140:143], a[228:231], v[144:147]
 v_mfma_f32_16x16x32_bf16 v[148:151], a[136:139], a[232:235], v[148:151]
 ds_read_b64_tr_b16 a[156:157], v5 offset:27840
 ds_read_b64_tr_b16 a[158:159], v5 offset:32448
 v_mfma_f32_16x16x32_bf16 v[148:151], a[140:143], a[236:239], v[148:151]
 v_mfma_f32_16x16x32_bf16 v[152:155], a[136:139], a[240:243], v[152:155]
 v_mfma_f32_16x16x32_bf16 v[152:155], a[140:143], a[244:247], v[152:155]
 v_mfma_f32_16x16x32_bf16 v[156:159], a[136:139], a[248:251], v[156:159]
 v_mfma_f32_16x16x32_bf16 v[156:159], a[140:143], a[252:255], v[156:159]
 s_waitcnt lgkmcnt(4)
 v_mfma_f32_16x16x32_bf16 v[160:163], a[144:147], a[224:227], v[160:163]
 ds_read_b64_tr_b16 a[128:129], v5 offset:224
 ds_read_b64_tr_b16 a[130:131], v5 offset:4832
 v_mfma_f32_16x16x32_bf16 v[160:163], a[148:151], a[228:231], v[160:163]
 v_mfma_f32_16x16x32_bf16 v[164:167], a[144:147], a[232:235], v[164:167]
 ds_read_b64_tr_b16 a[132:133], v5 offset:9440
 ds_read_b64_tr_b16 a[134:135], v5 offset:14048
 v_mfma_f32_16x16x32_bf16 v[164:167], a[148:151], a[236:239], v[164:167]
 v_mfma_f32_16x16x32_bf16 v[168:171], a[144:147], a[240:243], v[168:171]
 v_mfma_f32_16x16x32_bf16 v[168:171], a[148:151], a[244:247], v[168:171]
 v_mfma_f32_16x16x32_bf16 v[172:175], a[144:147], a[248:251], v[172:175]
 v_mfma_f32_16x16x32_bf16 v[172:175], a[148:151], a[252:255], v[172:175]
 s_waitcnt lgkmcnt(4)
 v_mfma_f32_16x16x32_bf16 v[176:179], a[152:155], a[224:227], v[176:179]
 ds_read_b64_tr_b16 a[136:137], v5 offset:18656
 ds_read_b64_tr_b16 a[138:139], v5 offset:23264
 v_mfma_f32_16x16x32_bf16 v[176:179], a[156:159], a[228:231], v[176:179]
 v_mfma_f32_16x16x32_bf16 v[180:183], a[152:155], a[232:235], v[180:183]
 ds_read_b64_tr_b16 a[140:141], v5 offset:27872
 ds_read_b64_tr_b16 a[142:143], v5 offset:32480
 v_mfma_f32_16x16x32_bf16 v[180:183], a[156:159], a[236:239], v[180:183]
 v_mfma_f32_16x16x32_bf16 v[184:187], a[152:155], a[240:243], v[184:187]
 v_mfma_f32_16x16x32_bf16 v[184:187], a[156:159], a[244:247], v[184:187]
 v_mfma_f32_16x16x32_bf16 v[188:191], a[152:155], a[248:251], v[188:191]
 v_mfma_f32_16x16x32_bf16 v[188:191], a[156:159], a[252:255], v[188:191]
 s_waitcnt lgkmcnt(4)
 v_mfma_f32_16x16x32_bf16 v[192:195], a[128:131], a[224:227], v[192:195]
 ds_read_b64_tr_b16 a[144:145], v5 offset:256
 ds_read_b64_tr_b16 a[146:147], v5 offset:4864
 v_mfma_f32_16x16x32_bf16 v[192:195], a[132:135], a[228:231], v[192:195]
 v_mfma_f32_16x16x32_bf16 v[196:199], a[128:131], a[232:235], v[196:199]
 ds_read_b64_tr_b16 a[148:149], v5 offset:9472
 ds_read_b64_tr_b16 a[150:151], v5 offset:14080
 v_mfma_f32_16x16x32_bf16 v[196:199], a[132:135], a[236:239], v[196:199]
 v_mfma_f32_16x16x32_bf16 v[200:203], a[128:131], a[240:243], v[200:203]
 v_mfma_f32_16x16x32_bf16 v[200:203], a[132:135], a[244:247], v[200:203]
 v_mfma_f32_16x16x32_bf16 v[204:207], a[128:131], a[248:251], v[204:207]
 v_mfma_f32_16x16x32_bf16 v[204:207], a[132:135], a[252:255], v[204:207]
 s_waitcnt lgkmcnt(4)
 v_mfma_f32_16x16x32_bf16 v[208:211], a[136:139], a[224:227], v[208:211]
 ds_read_b64_tr_b16 a[152:153], v5 offset:18688
 ds_read_b64_tr_b16 a[154:155], v5 offset:23296
 v_mfma_f32_16x16x32_bf16 v[208:211], a[140:143], a[228:231], v[208:211]
 v_mfma_f32_16x16x32_bf16 v[212:215], a[136:139], a[232:235], v[212:215]
 ds_read_b64_tr_b16 a[156:157], v5 offset:27904
 ds_read_b64_tr_b16 a[158:159], v5 offset:32512
 v_mfma_f32_16x16x32_bf16 v[212:215], a[140:143], a[236:239], v[212:215]
 v_mfma_f32_16x16x32_bf16 v[216:219], a[136:139], a[240:243], v[216:219]
 v_mfma_f32_16x16x32_bf16 v[216:219], a[140:143], a[244:247], v[216:219]
 v_mfma_f32_16x16x32_bf16 v[220:223], a[136:139], a[248:251], v[220:223]
 v_mfma_f32_16x16x32_bf16 v[220:223], a[140:143], a[252:255], v[220:223]
 s_waitcnt lgkmcnt(4)
 v_mfma_f32_16x16x32_bf16 v[224:227], a[144:147], a[224:227], v[224:227]
 v_mfma_f32_16x16x32_bf16 v[224:227], a[148:151], a[228:231], v[224:227]
 s_waitcnt lgkmcnt(0)
 v_mfma_f32_16x16x32_bf16 v[228:231], a[144:147], a[232:235], v[228:231]
 s_barrier
 v_mfma_f32_16x16x32_bf16 v[228:231], a[148:151], a[236:239], v[228:231]
 s_add_u32 s83, s62, 3670016
 ds_read_b64_tr_b16 a[128:129], v6 offset:0
 ds_read_b64_tr_b16 a[130:131], v6 offset:4608
 v_mfma_f32_16x16x32_bf16 v[232:235], a[144:147], a[240:243], v[232:235]
 s_add_u32 m0, s53, 49152
 v_mfma_f32_16x16x32_bf16 v[232:235], a[148:151], a[244:247], v[232:235]
 ds_read_b64_tr_b16 a[132:133], v6 offset:9216
 ds_read_b64_tr_b16 a[134:135], v6 offset:13824
 v_mfma_f32_16x16x32_bf16 v[236:239], a[144:147], a[248:251], v[236:239]
 buffer_load_dwordx4 v20, s[20:23], s83 offen lds
 v_mfma_f32_16x16x32_bf16 v[236:239], a[148:151], a[252:255], v[236:239]
 v_mfma_f32_16x16x32_bf16 v[240:243], a[152:155], a[224:227], v[240:243]
 s_add_u32 s84, s62, 3702784
 ds_read_b64_tr_b16 a[136:137], v6 offset:18432
 ds_read_b64_tr_b16 a[138:139], v6 offset:23040
 v_mfma_f32_16x16x32_bf16 v[240:243], a[156:159], a[228:231], v[240:243]
 s_add_u32 m0, s53, 50176
 v_mfma_f32_16x16x32_bf16 v[244:247], a[152:155], a[232:235], v[244:247]
 ds_read_b64_tr_b16 a[140:141], v6 offset:27648
 ds_read_b64_tr_b16 a[142:143], v6 offset:32256
 v_mfma_f32_16x16x32_bf16 v[244:247], a[156:159], a[236:239], v[244:247]
 buffer_load_dwordx4 v21, s[20:23], s84 offen lds
 v_mfma_f32_16x16x32_bf16 v[248:251], a[152:155], a[240:243], v[248:251]
 s_add_u32 s83, s62, 3735552
 v_mfma_f32_16x16x32_bf16 v[248:251], a[156:159], a[244:247], v[248:251]
 s_add_u32 m0, s53, 51200
 v_mfma_f32_16x16x32_bf16 v[252:255], a[152:155], a[248:251], v[252:255]
 v_mfma_f32_16x16x32_bf16 v[252:255], a[156:159], a[252:255], v[252:255]
 s_waitcnt vmcnt(24) lgkmcnt(4)
 v_mfma_f32_16x16x32_bf16 v[40:43], a[128:131], a[160:163], v[40:43]
 ds_read_b64_tr_b16 a[144:145], v6 offset:32
 ds_read_b64_tr_b16 a[146:147], v6 offset:4640
 v_mfma_f32_16x16x32_bf16 v[40:43], a[132:135], a[164:167], v[40:43]
 buffer_load_dwordx4 v20, s[20:23], s83 offen lds
 v_mfma_f32_16x16x32_bf16 v[44:47], a[128:131], a[168:171], v[44:47]
 s_add_u32 s84, s62, 3768320
 ds_read_b64_tr_b16 a[148:149], v6 offset:9248
 ds_read_b64_tr_b16 a[150:151], v6 offset:13856
 v_mfma_f32_16x16x32_bf16 v[44:47], a[132:135], a[172:175], v[44:47]
 s_add_u32 m0, s53, 52224
 v_lshrrev_b32 v34, 2, v3
 v_and_b32 v35, 7, v34
 v_mfma_f32_16x16x32_bf16 v[48:51], a[128:131], a[176:179], v[48:51]
 v_lshlrev_b32 v35, 1, v35
 v_and_b32 v36, 3, v3
 v_mfma_f32_16x16x32_bf16 v[48:51], a[132:135], a[180:183], v[48:51]
 v_xor_b32 v35, v35, v36
 v_lshlrev_b32 v35, 4, v35
 v_mfma_f32_16x16x32_bf16 v[52:55], a[128:131], a[184:187], v[52:55]
 buffer_load_dwordx4 v21, s[20:23], s84 offen lds
 v_mfma_f32_16x16x32_bf16 v[52:55], a[132:135], a[188:191], v[52:55]
 s_waitcnt lgkmcnt(4)
 v_lshl_add_u32 v8, v34, 8, v35
 v_xor_b32 v9, 64, v8
 v_mfma_f32_16x16x32_bf16 a[0:3], a[136:139], a[160:163], a[0:3]
 s_mov_b32 s79, 16384
 ds_read_b64_tr_b16 a[152:153], v6 offset:18464
 ds_read_b64_tr_b16 a[154:155], v6 offset:23072
 v_mfma_f32_16x16x32_bf16 a[0:3], a[140:143], a[164:167], a[0:3]
 v_xor_b32 v10, 128, v8
 v_xor_b32 v11, 192, v8
 v_mfma_f32_16x16x32_bf16 a[4:7], a[136:139], a[168:171], a[4:7]
 ds_read_b64_tr_b16 a[156:157], v6 offset:27680
 ds_read_b64_tr_b16 a[158:159], v6 offset:32288
 v_mfma_f32_16x16x32_bf16 a[4:7], a[140:143], a[172:175], a[4:7]
 buffer_load_dwordx4 a[224:227], v2, s[12:15], s79 offen offset:0 sc1
 v_mfma_f32_16x16x32_bf16 a[8:11], a[136:139], a[176:179], a[8:11]
 v_add_u32 v12, 0x10000, v8
 v_add_u32 v13, 0x10000, v9
 v_mfma_f32_16x16x32_bf16 a[8:11], a[140:143], a[180:183], a[8:11]
 v_add_u32 v14, 0x10000, v10
 v_add_u32 v15, 0x10000, v11
 v_mfma_f32_16x16x32_bf16 a[12:15], a[136:139], a[184:187], a[12:15]
 v_add_u32 v16, 0x20000, v8
 v_add_u32 v17, 0x20000, v9
 v_mfma_f32_16x16x32_bf16 a[12:15], a[140:143], a[188:191], a[12:15]
 s_waitcnt lgkmcnt(4)
 v_add_u32 v18, 0x20000, v10
 v_add_u32 v19, 0x20000, v11
 v_mfma_f32_16x16x32_bf16 v[56:59], a[144:147], a[160:163], v[56:59]
 ds_read_b64_tr_b16 a[128:129], v6 offset:64
 ds_read_b64_tr_b16 a[130:131], v6 offset:4672
 v_mfma_f32_16x16x32_bf16 v[56:59], a[148:151], a[164:167], v[56:59]
 buffer_load_dwordx4 a[228:231], v2, s[12:15], s79 offen offset:1024 sc1
 v_mfma_f32_16x16x32_bf16 v[60:63], a[144:147], a[168:171], v[60:63]
 s_mov_b32 s80, 34816
 ds_read_b64_tr_b16 a[132:133], v6 offset:9280
 ds_read_b64_tr_b16 a[134:135], v6 offset:13888
 v_mfma_f32_16x16x32_bf16 v[60:63], a[148:151], a[172:175], v[60:63]
 v_mfma_f32_16x16x32_bf16 v[64:67], a[144:147], a[176:179], v[64:67]
 v_mfma_f32_16x16x32_bf16 v[64:67], a[148:151], a[180:183], v[64:67]
 v_mfma_f32_16x16x32_bf16 v[68:71], a[144:147], a[184:187], v[68:71]
 buffer_load_dwordx4 a[232:235], v2, s[12:15], s80 offen offset:0 sc1
 v_mfma_f32_16x16x32_bf16 v[68:71], a[148:151], a[188:191], v[68:71]
 s_waitcnt lgkmcnt(4)
 v_mfma_f32_16x16x32_bf16 a[16:19], a[152:155], a[160:163], a[16:19]
 ds_read_b64_tr_b16 a[136:137], v6 offset:18496
 ds_read_b64_tr_b16 a[138:139], v6 offset:23104
 v_mfma_f32_16x16x32_bf16 a[16:19], a[156:159], a[164:167], a[16:19]
 v_mfma_f32_16x16x32_bf16 a[20:23], a[152:155], a[168:171], a[20:23]
 ds_read_b64_tr_b16 a[140:141], v6 offset:27712
 ds_read_b64_tr_b16 a[142:143], v6 offset:32320
 v_mfma_f32_16x16x32_bf16 a[20:23], a[156:159], a[172:175], a[20:23]
 buffer_load_dwordx4 a[236:239], v2, s[12:15], s80 offen offset:1024 sc1
 v_mfma_f32_16x16x32_bf16 a[24:27], a[152:155], a[176:179], a[24:27]
 s_mov_b32 s81, 53248
 v_mfma_f32_16x16x32_bf16 a[24:27], a[156:159], a[180:183], a[24:27]
 v_mfma_f32_16x16x32_bf16 a[28:31], a[152:155], a[184:187], a[28:31]
 v_mfma_f32_16x16x32_bf16 a[28:31], a[156:159], a[188:191], a[28:31]
 s_waitcnt lgkmcnt(4)
 v_mfma_f32_16x16x32_bf16 v[72:75], a[128:131], a[160:163], v[72:75]
 ds_read_b64_tr_b16 a[144:145], v6 offset:96
 ds_read_b64_tr_b16 a[146:147], v6 offset:4704
 v_mfma_f32_16x16x32_bf16 v[72:75], a[132:135], a[164:167], v[72:75]
 buffer_load_dwordx4 a[240:243], v2, s[12:15], s81 offen offset:0 sc1
 v_mfma_f32_16x16x32_bf16 v[76:79], a[128:131], a[168:171], v[76:79]
 ds_read_b64_tr_b16 a[148:149], v6 offset:9312
 ds_read_b64_tr_b16 a[150:151], v6 offset:13920
 v_mfma_f32_16x16x32_bf16 v[76:79], a[132:135], a[172:175], v[76:79]
 v_mfma_f32_16x16x32_bf16 v[80:83], a[128:131], a[176:179], v[80:83]
 v_mfma_f32_16x16x32_bf16 v[80:83], a[132:135], a[180:183], v[80:83]
 v_mfma_f32_16x16x32_bf16 v[84:87], a[128:131], a[184:187], v[84:87]
 buffer_load_dwordx4 a[244:247], v2, s[12:15], s81 offen offset:1024 sc1
 v_mfma_f32_16x16x32_bf16 v[84:87], a[132:135], a[188:191], v[84:87]
 s_waitcnt lgkmcnt(4)
 v_mfma_f32_16x16x32_bf16 a[32:35], a[136:139], a[160:163], a[32:35]
 s_mov_b32 s82, 71680
 ds_read_b64_tr_b16 a[152:153], v6 offset:18528
 ds_read_b64_tr_b16 a[154:155], v6 offset:23136
 v_mfma_f32_16x16x32_bf16 a[32:35], a[140:143], a[164:167], a[32:35]
 v_mfma_f32_16x16x32_bf16 a[36:39], a[136:139], a[168:171], a[36:39]
 ds_read_b64_tr_b16 a[156:157], v6 offset:27744
 ds_read_b64_tr_b16 a[158:159], v6 offset:32352
 v_mfma_f32_16x16x32_bf16 a[36:39], a[140:143], a[172:175], a[36:39]
 buffer_load_dwordx4 a[248:251], v2, s[12:15], s82 offen offset:0 sc1
 v_mfma_f32_16x16x32_bf16 a[40:43], a[136:139], a[176:179], a[40:43]
 v_mfma_f32_16x16x32_bf16 a[40:43], a[140:143], a[180:183], a[40:43]
 v_mfma_f32_16x16x32_bf16 a[44:47], a[136:139], a[184:187], a[44:47]
 v_mfma_f32_16x16x32_bf16 a[44:47], a[140:143], a[188:191], a[44:47]
 s_waitcnt lgkmcnt(4)
 v_mfma_f32_16x16x32_bf16 v[88:91], a[144:147], a[160:163], v[88:91]
 ds_read_b64_tr_b16 a[128:129], v6 offset:128
 ds_read_b64_tr_b16 a[130:131], v6 offset:4736
 v_mfma_f32_16x16x32_bf16 v[88:91], a[148:151], a[164:167], v[88:91]
 buffer_load_dwordx4 a[252:255], v2, s[12:15], s82 offen offset:1024 sc1
 v_mfma_f32_16x16x32_bf16 v[92:95], a[144:147], a[168:171], v[92:95]
 ds_read_b64_tr_b16 a[132:133], v6 offset:9344
 ds_read_b64_tr_b16 a[134:135], v6 offset:13952
 v_mfma_f32_16x16x32_bf16 v[92:95], a[148:151], a[172:175], v[92:95]
 v_mfma_f32_16x16x32_bf16 v[96:99], a[144:147], a[176:179], v[96:99]
 v_mfma_f32_16x16x32_bf16 v[96:99], a[148:151], a[180:183], v[96:99]
 v_mfma_f32_16x16x32_bf16 v[100:103], a[144:147], a[184:187], v[100:103]
 v_mfma_f32_16x16x32_bf16 v[100:103], a[148:151], a[188:191], v[100:103]
 s_waitcnt lgkmcnt(4)
 v_mfma_f32_16x16x32_bf16 a[48:51], a[152:155], a[160:163], a[48:51]
 ds_read_b64_tr_b16 a[136:137], v6 offset:18560
 ds_read_b64_tr_b16 a[138:139], v6 offset:23168
 v_mfma_f32_16x16x32_bf16 a[48:51], a[156:159], a[164:167], a[48:51]
 v_mfma_f32_16x16x32_bf16 a[52:55], a[152:155], a[168:171], a[52:55]
 ds_read_b64_tr_b16 a[140:141], v6 offset:27776
 ds_read_b64_tr_b16 a[142:143], v6 offset:32384
 v_mfma_f32_16x16x32_bf16 a[52:55], a[156:159], a[172:175], a[52:55]
 v_mfma_f32_16x16x32_bf16 a[56:59], a[152:155], a[176:179], a[56:59]
 v_mfma_f32_16x16x32_bf16 a[56:59], a[156:159], a[180:183], a[56:59]
 v_mfma_f32_16x16x32_bf16 a[60:63], a[152:155], a[184:187], a[60:63]
 v_mfma_f32_16x16x32_bf16 a[60:63], a[156:159], a[188:191], a[60:63]
 s_waitcnt lgkmcnt(4)
 v_mfma_f32_16x16x32_bf16 v[104:107], a[128:131], a[160:163], v[104:107]
 ds_read_b64_tr_b16 a[144:145], v6 offset:160
 ds_read_b64_tr_b16 a[146:147], v6 offset:4768
 v_mfma_f32_16x16x32_bf16 v[104:107], a[132:135], a[164:167], v[104:107]
 v_mfma_f32_16x16x32_bf16 v[108:111], a[128:131], a[168:171], v[108:111]
 ds_read_b64_tr_b16 a[148:149], v6 offset:9376
 ds_read_b64_tr_b16 a[150:151], v6 offset:13984
 v_mfma_f32_16x16x32_bf16 v[108:111], a[132:135], a[172:175], v[108:111]
 v_mfma_f32_16x16x32_bf16 v[112:115], a[128:131], a[176:179], v[112:115]
 v_mfma_f32_16x16x32_bf16 v[112:115], a[132:135], a[180:183], v[112:115]
 v_mfma_f32_16x16x32_bf16 v[116:119], a[128:131], a[184:187], v[116:119]
 v_mfma_f32_16x16x32_bf16 v[116:119], a[132:135], a[188:191], v[116:119]
 s_waitcnt lgkmcnt(4)
 v_mfma_f32_16x16x32_bf16 a[64:67], a[136:139], a[160:163], a[64:67]
 ds_read_b64_tr_b16 a[152:153], v6 offset:18592
 ds_read_b64_tr_b16 a[154:155], v6 offset:23200
 v_mfma_f32_16x16x32_bf16 a[64:67], a[140:143], a[164:167], a[64:67]
 v_mfma_f32_16x16x32_bf16 a[68:71], a[136:139], a[168:171], a[68:71]
 ds_read_b64_tr_b16 a[156:157], v6 offset:27808
 ds_read_b64_tr_b16 a[158:159], v6 offset:32416
 v_mfma_f32_16x16x32_bf16 a[68:71], a[140:143], a[172:175], a[68:71]
 v_mfma_f32_16x16x32_bf16 v[120:123], a[136:139], a[176:179], v[120:123]
 v_mfma_f32_16x16x32_bf16 v[120:123], a[140:143], a[180:183], v[120:123]
 v_mfma_f32_16x16x32_bf16 v[124:127], a[136:139], a[184:187], v[124:127]
 v_mfma_f32_16x16x32_bf16 v[124:127], a[140:143], a[188:191], v[124:127]
 s_waitcnt lgkmcnt(4)
 v_mfma_f32_16x16x32_bf16 v[128:131], a[144:147], a[160:163], v[128:131]
 ds_read_b64_tr_b16 a[128:129], v6 offset:192
 ds_read_b64_tr_b16 a[130:131], v6 offset:4800
 v_mfma_f32_16x16x32_bf16 v[128:131], a[148:151], a[164:167], v[128:131]
 v_mfma_f32_16x16x32_bf16 v[132:135], a[144:147], a[168:171], v[132:135]
 ds_read_b64_tr_b16 a[132:133], v6 offset:9408
 ds_read_b64_tr_b16 a[134:135], v6 offset:14016
 v_mfma_f32_16x16x32_bf16 v[132:135], a[148:151], a[172:175], v[132:135]
 v_mfma_f32_16x16x32_bf16 v[136:139], a[144:147], a[176:179], v[136:139]
 v_mfma_f32_16x16x32_bf16 v[136:139], a[148:151], a[180:183], v[136:139]
 v_mfma_f32_16x16x32_bf16 v[140:143], a[144:147], a[184:187], v[140:143]
 v_mfma_f32_16x16x32_bf16 v[140:143], a[148:151], a[188:191], v[140:143]
 s_waitcnt lgkmcnt(4)
 v_mfma_f32_16x16x32_bf16 v[144:147], a[152:155], a[160:163], v[144:147]
 ds_read_b64_tr_b16 a[136:137], v6 offset:18624
 ds_read_b64_tr_b16 a[138:139], v6 offset:23232
 v_mfma_f32_16x16x32_bf16 v[144:147], a[156:159], a[164:167], v[144:147]
 v_mfma_f32_16x16x32_bf16 v[148:151], a[152:155], a[168:171], v[148:151]
 ds_read_b64_tr_b16 a[140:141], v6 offset:27840
 ds_read_b64_tr_b16 a[142:143], v6 offset:32448
 v_mfma_f32_16x16x32_bf16 v[148:151], a[156:159], a[172:175], v[148:151]
 v_mfma_f32_16x16x32_bf16 v[152:155], a[152:155], a[176:179], v[152:155]
 v_mfma_f32_16x16x32_bf16 v[152:155], a[156:159], a[180:183], v[152:155]
 v_mfma_f32_16x16x32_bf16 v[156:159], a[152:155], a[184:187], v[156:159]
 v_mfma_f32_16x16x32_bf16 v[156:159], a[156:159], a[188:191], v[156:159]
 s_waitcnt lgkmcnt(4)
 v_mfma_f32_16x16x32_bf16 v[160:163], a[128:131], a[160:163], v[160:163]
 ds_read_b64_tr_b16 a[144:145], v6 offset:224
 ds_read_b64_tr_b16 a[146:147], v6 offset:4832
 v_mfma_f32_16x16x32_bf16 v[160:163], a[132:135], a[164:167], v[160:163]
 v_mfma_f32_16x16x32_bf16 v[164:167], a[128:131], a[168:171], v[164:167]
 ds_read_b64_tr_b16 a[148:149], v6 offset:9440
 ds_read_b64_tr_b16 a[150:151], v6 offset:14048
 v_mfma_f32_16x16x32_bf16 v[164:167], a[132:135], a[172:175], v[164:167]
 v_mfma_f32_16x16x32_bf16 v[168:171], a[128:131], a[176:179], v[168:171]
 v_mfma_f32_16x16x32_bf16 v[168:171], a[132:135], a[180:183], v[168:171]
 v_mfma_f32_16x16x32_bf16 v[172:175], a[128:131], a[184:187], v[172:175]
 v_mfma_f32_16x16x32_bf16 v[172:175], a[132:135], a[188:191], v[172:175]
 s_waitcnt lgkmcnt(4)
 v_mfma_f32_16x16x32_bf16 v[176:179], a[136:139], a[160:163], v[176:179]
 ds_read_b64_tr_b16 a[152:153], v6 offset:18656
 ds_read_b64_tr_b16 a[154:155], v6 offset:23264
 v_mfma_f32_16x16x32_bf16 v[176:179], a[140:143], a[164:167], v[176:179]
 v_mfma_f32_16x16x32_bf16 v[180:183], a[136:139], a[168:171], v[180:183]
 ds_read_b64_tr_b16 a[156:157], v6 offset:27872
 ds_read_b64_tr_b16 a[158:159], v6 offset:32480
 v_mfma_f32_16x16x32_bf16 v[180:183], a[140:143], a[172:175], v[180:183]
 v_mfma_f32_16x16x32_bf16 v[184:187], a[136:139], a[176:179], v[184:187]
 v_mfma_f32_16x16x32_bf16 v[184:187], a[140:143], a[180:183], v[184:187]
 v_mfma_f32_16x16x32_bf16 v[188:191], a[136:139], a[184:187], v[188:191]
 v_mfma_f32_16x16x32_bf16 v[188:191], a[140:143], a[188:191], v[188:191]
 s_waitcnt lgkmcnt(4)
 v_mfma_f32_16x16x32_bf16 v[192:195], a[144:147], a[160:163], v[192:195]
 ds_read_b64_tr_b16 a[128:129], v6 offset:256
 ds_read_b64_tr_b16 a[130:131], v6 offset:4864
 v_mfma_f32_16x16x32_bf16 v[192:195], a[148:151], a[164:167], v[192:195]
 v_mfma_f32_16x16x32_bf16 v[196:199], a[144:147], a[168:171], v[196:199]
 ds_read_b64_tr_b16 a[132:133], v6 offset:9472
 ds_read_b64_tr_b16 a[134:135], v6 offset:14080
 v_mfma_f32_16x16x32_bf16 v[196:199], a[148:151], a[172:175], v[196:199]
 v_mfma_f32_16x16x32_bf16 v[200:203], a[144:147], a[176:179], v[200:203]
 v_mfma_f32_16x16x32_bf16 v[200:203], a[148:151], a[180:183], v[200:203]
 v_mfma_f32_16x16x32_bf16 v[204:207], a[144:147], a[184:187], v[204:207]
 v_mfma_f32_16x16x32_bf16 v[204:207], a[148:151], a[188:191], v[204:207]
 s_waitcnt lgkmcnt(4)
 v_mfma_f32_16x16x32_bf16 v[208:211], a[152:155], a[160:163], v[208:211]
 ds_read_b64_tr_b16 a[136:137], v6 offset:18688
 ds_read_b64_tr_b16 a[138:139], v6 offset:23296
 v_mfma_f32_16x16x32_bf16 v[208:211], a[156:159], a[164:167], v[208:211]
 v_mfma_f32_16x16x32_bf16 v[212:215], a[152:155], a[168:171], v[212:215]
 ds_read_b64_tr_b16 a[140:141], v6 offset:27904
 ds_read_b64_tr_b16 a[142:143], v6 offset:32512
 v_mfma_f32_16x16x32_bf16 v[212:215], a[156:159], a[172:175], v[212:215]
 v_mfma_f32_16x16x32_bf16 v[216:219], a[152:155], a[176:179], v[216:219]
 v_mfma_f32_16x16x32_bf16 v[216:219], a[156:159], a[180:183], v[216:219]
 v_mfma_f32_16x16x32_bf16 v[220:223], a[152:155], a[184:187], v[220:223]
 v_mfma_f32_16x16x32_bf16 v[220:223], a[156:159], a[188:191], v[220:223]
 s_waitcnt lgkmcnt(4)
 v_mfma_f32_16x16x32_bf16 v[224:227], a[128:131], a[160:163], v[224:227]
 v_mfma_f32_16x16x32_bf16 v[224:227], a[132:135], a[164:167], v[224:227]
 s_waitcnt vmcnt(20) lgkmcnt(0)
 v_mfma_f32_16x16x32_bf16 v[228:231], a[128:131], a[168:171], v[228:231]
 s_barrier
 v_mfma_f32_16x16x32_bf16 v[228:231], a[132:135], a[172:175], v[228:231]
 s_add_u32 s83, s62, 3145728
 ds_read_b64_tr_b16 a[144:145], v7 offset:0
 ds_read_b64_tr_b16 a[146:147], v7 offset:4608
 v_mfma_f32_16x16x32_bf16 v[232:235], a[128:131], a[176:179], v[232:235]
 s_add_u32 m0, s53, 65536
 ds_read_b64_tr_b16 a[148:149], v7 offset:9216
 ds_read_b64_tr_b16 a[150:151], v7 offset:13824
 v_mfma_f32_16x16x32_bf16 v[232:235], a[132:135], a[180:183], v[232:235]
 ds_read_b64_tr_b16 a[152:153], v4 offset:0
 ds_read_b64_tr_b16 a[154:155], v4 offset:4608
 v_mfma_f32_16x16x32_bf16 v[236:239], a[128:131], a[184:187], v[236:239]
 ds_read_b64_tr_b16 a[156:157], v4 offset:9216
 ds_read_b64_tr_b16 a[158:159], v4 offset:13824
 v_mfma_f32_16x16x32_bf16 v[236:239], a[132:135], a[188:191], v[236:239]
 buffer_load_dwordx4 v20, s[20:23], s83 offen lds
 v_mfma_f32_16x16x32_bf16 v[240:243], a[136:139], a[160:163], v[240:243]
 s_add_u32 s84, s62, 3178496
 v_mfma_f32_16x16x32_bf16 v[240:243], a[140:143], a[164:167], v[240:243]
 s_add_u32 m0, s53, 66560
 v_mfma_f32_16x16x32_bf16 v[244:247], a[136:139], a[168:171], v[244:247]
 v_mfma_f32_16x16x32_bf16 v[244:247], a[140:143], a[172:175], v[244:247]
 v_mfma_f32_16x16x32_bf16 v[248:251], a[136:139], a[176:179], v[248:251]
 buffer_load_dwordx4 v21, s[20:23], s84 offen lds
 v_mfma_f32_16x16x32_bf16 v[248:251], a[140:143], a[180:183], v[248:251]
 s_add_u32 s83, s62, 3211264
 v_mfma_f32_16x16x32_bf16 v[252:255], a[136:139], a[184:187], v[252:255]
 s_add_u32 m0, s53, 67584
 v_mfma_f32_16x16x32_bf16 v[252:255], a[140:143], a[188:191], v[252:255]
 s_waitcnt vmcnt(2) lgkmcnt(0)
L_c1:
 v_mfma_f32_16x16x32_bf16 v[40:43], a[144:147], a[192:195], v[40:43]
 ds_read_b64_tr_b16 a[128:129], v7 offset:18432
 ds_read_b64_tr_b16 a[130:131], v7 offset:23040
 v_mfma_f32_16x16x32_bf16 v[40:43], a[148:151], a[196:199], v[40:43]
 buffer_load_dwordx4 v20, s[20:23], s83 offen lds
 v_mfma_f32_16x16x32_bf16 v[40:43], a[152:155], a[224:227], v[40:43]
 s_add_u32 s84, s62, 3244032
 ds_read_b64_tr_b16 a[132:133], v7 offset:27648
 ds_read_b64_tr_b16 a[134:135], v7 offset:32256
 v_mfma_f32_16x16x32_bf16 v[40:43], a[156:159], a[228:231], v[40:43]
 s_add_u32 m0, s53, 68608
 v_mfma_f32_16x16x32_bf16 v[44:47], a[144:147], a[200:203], v[44:47]
 ds_read_b64_tr_b16 a[136:137], v4 offset:18432
 ds_read_b64_tr_b16 a[138:139], v4 offset:23040
 v_mfma_f32_16x16x32_bf16 v[44:47], a[148:151], a[204:207], v[44:47]
 v_mfma_f32_16x16x32_bf16 v[44:47], a[152:155], a[232:235], v[44:47]
 ds_read_b64_tr_b16 a[140:141], v4 offset:27648
 ds_read_b64_tr_b16 a[142:143], v4 offset:32256
 v_mfma_f32_16x16x32_bf16 v[44:47], a[156:159], a[236:239], v[44:47]
 buffer_load_dwordx4 v21, s[20:23], s84 offen lds
 v_mfma_f32_16x16x32_bf16 v[48:51], a[144:147], a[208:211], v[48:51]
 s_add_u32 s83, s62, 2621440
 v_mfma_f32_16x16x32_bf16 v[48:51], a[148:151], a[212:215], v[48:51]
 s_add_u32 m0, s53, 81920
 v_mfma_f32_16x16x32_bf16 v[48:51], a[152:155], a[240:243], v[48:51]
 v_mfma_f32_16x16x32_bf16 v[48:51], a[156:159], a[244:247], v[48:51]
 v_mfma_f32_16x16x32_bf16 v[52:55], a[144:147], a[216:219], v[52:55]
 buffer_load_dwordx4 v20, s[20:23], s83 offen lds
 v_mfma_f32_16x16x32_bf16 v[52:55], a[148:151], a[220:223], v[52:55]
 s_add_u32 s84, s62, 2654208
 v_mfma_f32_16x16x32_bf16 v[52:55], a[152:155], a[248:251], v[52:55]
 s_add_u32 m0, s53, 82944
 v_mfma_f32_16x16x32_bf16 v[52:55], a[156:159], a[252:255], v[52:55]
 s_waitcnt lgkmcnt(0)
 v_mfma_f32_16x16x32_bf16 a[0:3], a[128:131], a[192:195], a[0:3]
 ds_read_b64_tr_b16 a[144:145], v7 offset:32
 ds_read_b64_tr_b16 a[146:147], v7 offset:4640
 v_mfma_f32_16x16x32_bf16 a[0:3], a[132:135], a[196:199], a[0:3]
 buffer_load_dwordx4 v21, s[20:23], s84 offen lds
 v_mfma_f32_16x16x32_bf16 a[0:3], a[136:139], a[224:227], a[0:3]
 s_add_u32 s83, s62, 2686976
 ds_read_b64_tr_b16 a[148:149], v7 offset:9248
 ds_read_b64_tr_b16 a[150:151], v7 offset:13856
 v_mfma_f32_16x16x32_bf16 a[0:3], a[140:143], a[228:231], a[0:3]
 s_add_u32 m0, s53, 83968
 v_mfma_f32_16x16x32_bf16 a[4:7], a[128:131], a[200:203], a[4:7]
 ds_read_b64_tr_b16 a[152:153], v4 offset:32
 ds_read_b64_tr_b16 a[154:155], v4 offset:4640
 v_mfma_f32_16x16x32_bf16 a[4:7], a[132:135], a[204:207], a[4:7]
 v_mfma_f32_16x16x32_bf16 a[4:7], a[136:139], a[232:235], a[4:7]
 ds_read_b64_tr_b16 a[156:157], v4 offset:9248
 ds_read_b64_tr_b16 a[158:159], v4 offset:13856
 v_mfma_f32_16x16x32_bf16 a[4:7], a[140:143], a[236:239], a[4:7]
 buffer_load_dwordx4 v20, s[20:23], s83 offen lds
 v_mfma_f32_16x16x32_bf16 a[8:11], a[128:131], a[208:211], a[8:11]
 s_add_u32 s84, s62, 2719744
 v_mfma_f32_16x16x32_bf16 a[8:11], a[132:135], a[212:215], a[8:11]
 s_add_u32 m0, s53, 84992
 v_mfma_f32_16x16x32_bf16 a[8:11], a[136:139], a[240:243], a[8:11]
 v_mfma_f32_16x16x32_bf16 a[8:11], a[140:143], a[244:247], a[8:11]
 v_mfma_f32_16x16x32_bf16 a[12:15], a[128:131], a[216:219], a[12:15]
 buffer_load_dwordx4 v21, s[20:23], s84 offen lds
 v_mfma_f32_16x16x32_bf16 a[12:15], a[132:135], a[220:223], a[12:15]
 v_mfma_f32_16x16x32_bf16 a[12:15], a[136:139], a[248:251], a[12:15]
 v_mfma_f32_16x16x32_bf16 a[12:15], a[140:143], a[252:255], a[12:15]
 s_waitcnt lgkmcnt(0)
 v_mfma_f32_16x16x32_bf16 v[56:59], a[144:147], a[192:195], v[56:59]
 ds_read_b64_tr_b16 a[128:129], v7 offset:18464
 ds_read_b64_tr_b16 a[130:131], v7 offset:23072
 v_mfma_f32_16x16x32_bf16 v[56:59], a[148:151], a[196:199], v[56:59]
 v_mfma_f32_16x16x32_bf16 v[56:59], a[152:155], a[224:227], v[56:59]
 ds_read_b64_tr_b16 a[132:133], v7 offset:27680
 ds_read_b64_tr_b16 a[134:135], v7 offset:32288
 v_mfma_f32_16x16x32_bf16 v[56:59], a[156:159], a[228:231], v[56:59]
 v_accvgpr_read_b32 v30, a0
 v_accvgpr_read_b32 v31, a1
 v_mul_f32 v28, s64, v40
 v_mfma_f32_16x16x32_bf16 v[60:63], a[144:147], a[200:203], v[60:63]
 ds_read_b64_tr_b16 a[136:137], v4 offset:18464
 ds_read_b64_tr_b16 a[138:139], v4 offset:23072
 v_mul_f32 v29, s64, v41
 v_mfma_f32_16x16x32_bf16 v[60:63], a[148:151], a[204:207], v[60:63]
 v_exp_f32 v28, v28
 v_mfma_f32_16x16x32_bf16 v[60:63], a[152:155], a[232:235], v[60:63]
 ds_read_b64_tr_b16 a[140:141], v4 offset:27680
 ds_read_b64_tr_b16 a[142:143], v4 offset:32288
 v_mfma_f32_16x16x32_bf16 v[60:63], a[156:159], a[236:239], v[60:63]
 v_exp_f32 v29, v29
 v_mul_f32 v30, v40, v30
 v_mfma_f32_16x16x32_bf16 v[64:67], a[144:147], a[208:211], v[64:67]
 v_mul_f32 v31, v41, v31
 v_add_f32 v28, 1.0, v28
 v_add_f32 v29, 1.0, v29
 v_mfma_f32_16x16x32_bf16 v[64:67], a[148:151], a[212:215], v[64:67]
 v_rcp_f32 v28, v28
 v_mfma_f32_16x16x32_bf16 v[64:67], a[152:155], a[240:243], v[64:67]
 v_rcp_f32 v29, v29
 v_mul_f32 v30, v30, v28
 v_mfma_f32_16x16x32_bf16 v[64:67], a[156:159], a[244:247], v[64:67]
 v_mul_f32 v31, v31, v29
 v_accvgpr_read_b32 v32, a2
 v_accvgpr_read_b32 v33, a3
 v_mfma_f32_16x16x32_bf16 v[68:71], a[144:147], a[216:219], v[68:71]
 v_mul_f32 v28, s64, v42
 v_mul_f32 v29, s64, v43
 v_mfma_f32_16x16x32_bf16 v[68:71], a[148:151], a[220:223], v[68:71]
 v_exp_f32 v28, v28
 v_mfma_f32_16x16x32_bf16 v[68:71], a[152:155], a[248:251], v[68:71]
 v_exp_f32 v29, v29
 v_mul_f32 v32, v42, v32
 v_mfma_f32_16x16x32_bf16 v[68:71], a[156:159], a[252:255], v[68:71]
 s_waitcnt lgkmcnt(0)
 v_mul_f32 v33, v43, v33
 v_add_f32 v28, 1.0, v28
 v_add_f32 v29, 1.0, v29
 v_mfma_f32_16x16x32_bf16 a[16:19], a[128:131], a[192:195], a[16:19]
 ds_read_b64_tr_b16 a[144:145], v7 offset:64
 ds_read_b64_tr_b16 a[146:147], v7 offset:4672
 v_mfma_f32_16x16x32_bf16 a[16:19], a[132:135], a[196:199], a[16:19]
 v_rcp_f32 v28, v28
 v_mfma_f32_16x16x32_bf16 a[16:19], a[136:139], a[224:227], a[16:19]
 ds_read_b64_tr_b16 a[148:149], v7 offset:9280
 ds_read_b64_tr_b16 a[150:151], v7 offset:13888
 v_mfma_f32_16x16x32_bf16 a[16:19], a[140:143], a[228:231], a[16:19]
 v_rcp_f32 v29, v29
 v_mul_f32 v32, v32, v28
 v_mfma_f32_16x16x32_bf16 a[20:23], a[128:131], a[200:203], a[20:23]
 ds_read_b64_tr_b16 a[152:153], v4 offset:64
 ds_read_b64_tr_b16 a[154:155], v4 offset:4672
 v_mul_f32 v33, v33, v29
 v_mfma_f32_16x16x32_bf16 a[20:23], a[132:135], a[204:207], a[20:23]
 v_cvt_pk_bf16_f32 v40, v30, v31
 v_cvt_pk_bf16_f32 v41, v32, v33
 v_accvgpr_read_b32 v30, a4
 v_mfma_f32_16x16x32_bf16 a[20:23], a[136:139], a[232:235], a[20:23]
 ds_read_b64_tr_b16 a[156:157], v4 offset:9280
 ds_read_b64_tr_b16 a[158:159], v4 offset:13888
 v_accvgpr_read_b32 v31, a5
 v_mfma_f32_16x16x32_bf16 a[20:23], a[140:143], a[236:239], a[20:23]
 v_mul_f32 v28, s64, v44
 v_mul_f32 v29, s64, v45
 v_mfma_f32_16x16x32_bf16 a[24:27], a[128:131], a[208:211], a[24:27]
 v_exp_f32 v28, v28
 v_mfma_f32_16x16x32_bf16 a[24:27], a[132:135], a[212:215], a[24:27]
 v_exp_f32 v29, v29
 v_mul_f32 v30, v44, v30
 v_mfma_f32_16x16x32_bf16 a[24:27], a[136:139], a[240:243], a[24:27]
 v_mul_f32 v31, v45, v31
 v_add_f32 v28, 1.0, v28
 v_add_f32 v29, 1.0, v29
 v_mfma_f32_16x16x32_bf16 a[24:27], a[140:143], a[244:247], a[24:27]
 v_rcp_f32 v28, v28
 v_mfma_f32_16x16x32_bf16 a[28:31], a[128:131], a[216:219], a[28:31]
 v_rcp_f32 v29, v29
 v_mul_f32 v30, v30, v28
 v_mfma_f32_16x16x32_bf16 a[28:31], a[132:135], a[220:223], a[28:31]
 v_mul_f32 v31, v31, v29
 v_accvgpr_read_b32 v32, a6
 v_accvgpr_read_b32 v33, a7
 v_mfma_f32_16x16x32_bf16 a[28:31], a[136:139], a[248:251], a[28:31]
 v_mul_f32 v28, s64, v46
 v_mul_f32 v29, s64, v47
 v_mfma_f32_16x16x32_bf16 a[28:31], a[140:143], a[252:255], a[28:31]
 s_waitcnt lgkmcnt(0)
 v_exp_f32 v28, v28
 v_mfma_f32_16x16x32_bf16 v[72:75], a[144:147], a[192:195], v[72:75]
 ds_read_b64_tr_b16 a[128:129], v7 offset:18496
 ds_read_b64_tr_b16 a[130:131], v7 offset:23104
 v_mfma_f32_16x16x32_bf16 v[72:75], a[148:151], a[196:199], v[72:75]
 v_exp_f32 v29, v29
 v_mul_f32 v32, v46, v32
 v_mfma_f32_16x16x32_bf16 v[72:75], a[152:155], a[224:227], v[72:75]
 ds_read_b64_tr_b16 a[132:133], v7 offset:27712
 ds_read_b64_tr_b16 a[134:135], v7 offset:32320
 v_mul_f32 v33, v47, v33
 v_mfma_f32_16x16x32_bf16 v[72:75], a[156:159], a[228:231], v[72:75]
 v_add_f32 v28, 1.0, v28
 v_add_f32 v29, 1.0, v29
 v_mfma_f32_16x16x32_bf16 v[76:79], a[144:147], a[200:203], v[76:79]
 ds_read_b64_tr_b16 a[136:137], v4 offset:18496
 ds_read_b64_tr_b16 a[138:139], v4 offset:23104
 v_mfma_f32_16x16x32_bf16 v[76:79], a[148:151], a[204:207], v[76:79]
 v_rcp_f32 v28, v28
 v_mfma_f32_16x16x32_bf16 v[76:79], a[152:155], a[232:235], v[76:79]
 ds_read_b64_tr_b16 a[140:141], v4 offset:27712
 ds_read_b64_tr_b16 a[142:143], v4 offset:32320
 v_mfma_f32_16x16x32_bf16 v[76:79], a[156:159], a[236:239], v[76:79]
 v_rcp_f32 v29, v29
 v_mul_f32 v32, v32, v28
 v_mfma_f32_16x16x32_bf16 v[80:83], a[144:147], a[208:211], v[80:83]
 v_mul_f32 v33, v33, v29
 v_cvt_pk_bf16_f32 v44, v30, v31
 v_cvt_pk_bf16_f32 v45, v32, v33
 v_mfma_f32_16x16x32_bf16 v[80:83], a[148:151], a[212:215], v[80:83]
 v_accvgpr_read_b32 v30, a8
 v_accvgpr_read_b32 v31, a9
 v_mul_f32 v28, s64, v48
 v_mfma_f32_16x16x32_bf16 v[80:83], a[152:155], a[240:243], v[80:83]
 v_mul_f32 v29, s64, v49
 v_exp_f32 v28, v28
 v_mfma_f32_16x16x32_bf16 v[80:83], a[156:159], a[244:247], v[80:83]
 v_exp_f32 v29, v29
 v_mul_f32 v30, v48, v30
 v_mfma_f32_16x16x32_bf16 v[84:87], a[144:147], a[216:219], v[84:87]
 v_mul_f32 v31, v49, v31
 v_add_f32 v28, 1.0, v28
 v_add_f32 v29, 1.0, v29
 v_mfma_f32_16x16x32_bf16 v[84:87], a[148:151], a[220:223], v[84:87]
 v_rcp_f32 v28, v28
 v_mfma_f32_16x16x32_bf16 v[84:87], a[152:155], a[248:251], v[84:87]
 v_rcp_f32 v29, v29
 v_mul_f32 v30, v30, v28
 v_mfma_f32_16x16x32_bf16 v[84:87], a[156:159], a[252:255], v[84:87]
 s_waitcnt lgkmcnt(0)
 v_mul_f32 v31, v31, v29
 v_accvgpr_read_b32 v32, a10
 v_accvgpr_read_b32 v33, a11
 v_mfma_f32_16x16x32_bf16 a[32:35], a[128:131], a[192:195], a[32:35]
 ds_read_b64_tr_b16 a[144:145], v7 offset:96
 ds_read_b64_tr_b16 a[146:147], v7 offset:4704
 v_mul_f32 v28, s64, v50
 v_mfma_f32_16x16x32_bf16 a[32:35], a[132:135], a[196:199], a[32:35]
 v_mul_f32 v29, s64, v51
 v_exp_f32 v28, v28
 v_mfma_f32_16x16x32_bf16 a[32:35], a[136:139], a[224:227], a[32:35]
 ds_read_b64_tr_b16 a[148:149], v7 offset:9312
 ds_read_b64_tr_b16 a[150:151], v7 offset:13920
 v_mfma_f32_16x16x32_bf16 a[32:35], a[140:143], a[228:231], a[32:35]
 v_exp_f32 v29, v29
 v_mul_f32 v32, v50, v32
 v_mfma_f32_16x16x32_bf16 a[36:39], a[128:131], a[200:203], a[36:39]
 ds_read_b64_tr_b16 a[152:153], v4 offset:96
 ds_read_b64_tr_b16 a[154:155], v4 offset:4704
 v_mul_f32 v33, v51, v33
 v_mfma_f32_16x16x32_bf16 a[36:39], a[132:135], a[204:207], a[36:39]
 v_add_f32 v28, 1.0, v28
 v_add_f32 v29, 1.0, v29
 v_mfma_f32_16x16x32_bf16 a[36:39], a[136:139], a[232:235], a[36:39]
 ds_read_b64_tr_b16 a[156:157], v4 offset:9312
 ds_read_b64_tr_b16 a[158:159], v4 offset:13920
 v_mfma_f32_16x16x32_bf16 a[36:39], a[140:143], a[236:239], a[36:39]
 v_rcp_f32 v28, v28
 v_mfma_f32_16x16x32_bf16 a[40:43], a[128:131], a[208:211], a[40:43]
 v_rcp_f32 v29, v29
 v_mul_f32 v32, v32, v28
 v_mfma_f32_16x16x32_bf16 a[40:43], a[132:135], a[212:215], a[40:43]
 v_mul_f32 v33, v33, v29
 v_cvt_pk_bf16_f32 v48, v30, v31
 v_cvt_pk_bf16_f32 v49, v32, v33
 v_mfma_f32_16x16x32_bf16 a[40:43], a[136:139], a[240:243], a[40:43]
 v_accvgpr_read_b32 v30, a12
 v_accvgpr_read_b32 v31, a13
 v_mul_f32 v28, s64, v52
 v_mfma_f32_16x16x32_bf16 a[40:43], a[140:143], a[244:247], a[40:43]
 v_mul_f32 v29, s64, v53
 v_exp_f32 v28, v28
 v_mfma_f32_16x16x32_bf16 a[44:47], a[128:131], a[216:219], a[44:47]
 v_exp_f32 v29, v29
 v_mul_f32 v30, v52, v30
 v_mfma_f32_16x16x32_bf16 a[44:47], a[132:135], a[220:223], a[44:47]
 v_mul_f32 v31, v53, v31
 v_add_f32 v28, 1.0, v28
 v_add_f32 v29, 1.0, v29
 v_mfma_f32_16x16x32_bf16 a[44:47], a[136:139], a[248:251], a[44:47]
 v_rcp_f32 v28, v28
 v_mfma_f32_16x16x32_bf16 a[44:47], a[140:143], a[252:255], a[44:47]
 s_waitcnt lgkmcnt(0)
 v_rcp_f32 v29, v29
 v_mul_f32 v30, v30, v28
 v_mfma_f32_16x16x32_bf16 v[88:91], a[144:147], a[192:195], v[88:91]
 ds_read_b64_tr_b16 a[128:129], v7 offset:18528
 ds_read_b64_tr_b16 a[130:131], v7 offset:23136
 v_mul_f32 v31, v31, v29
 v_mfma_f32_16x16x32_bf16 v[88:91], a[148:151], a[196:199], v[88:91]
 v_accvgpr_read_b32 v32, a14
 v_accvgpr_read_b32 v33, a15
 v_mul_f32 v28, s64, v54
 v_mfma_f32_16x16x32_bf16 v[88:91], a[152:155], a[224:227], v[88:91]
 ds_read_b64_tr_b16 a[132:133], v7 offset:27744
 ds_read_b64_tr_b16 a[134:135], v7 offset:32352
 v_mul_f32 v29, s64, v55
 v_mfma_f32_16x16x32_bf16 v[88:91], a[156:159], a[228:231], v[88:91]
 v_exp_f32 v28, v28
 v_mfma_f32_16x16x32_bf16 v[92:95], a[144:147], a[200:203], v[92:95]
 ds_read_b64_tr_b16 a[136:137], v4 offset:18528
 ds_read_b64_tr_b16 a[138:139], v4 offset:23136
 v_mfma_f32_16x16x32_bf16 v[92:95], a[148:151], a[204:207], v[92:95]
 v_exp_f32 v29, v29
 v_mul_f32 v32, v54, v32
 v_mfma_f32_16x16x32_bf16 v[92:95], a[152:155], a[232:235], v[92:95]
 ds_read_b64_tr_b16 a[140:141], v4 offset:27744
 ds_read_b64_tr_b16 a[142:143], v4 offset:32352
 v_mul_f32 v33, v55, v33
 v_mfma_f32_16x16x32_bf16 v[92:95], a[156:159], a[236:239], v[92:95]
 v_add_f32 v28, 1.0, v28
 v_add_f32 v29, 1.0, v29
 v_mfma_f32_16x16x32_bf16 v[96:99], a[144:147], a[208:211], v[96:99]
 v_rcp_f32 v28, v28
 v_mfma_f32_16x16x32_bf16 v[96:99], a[148:151], a[212:215], v[96:99]
 v_rcp_f32 v29, v29
 v_mul_f32 v32, v32, v28
 v_mfma_f32_16x16x32_bf16 v[96:99], a[152:155], a[240:243], v[96:99]
 v_mul_f32 v33, v33, v29
 v_cvt_pk_bf16_f32 v52, v30, v31
 v_cvt_pk_bf16_f32 v53, v32, v33
 v_mfma_f32_16x16x32_bf16 v[96:99], a[156:159], a[244:247], v[96:99]
 v_accvgpr_read_b32 v30, a16
 v_accvgpr_read_b32 v31, a17
 v_mul_f32 v28, s64, v56
 v_mfma_f32_16x16x32_bf16 v[100:103], a[144:147], a[216:219], v[100:103]
 v_mul_f32 v29, s64, v57
 v_exp_f32 v28, v28
 v_mfma_f32_16x16x32_bf16 v[100:103], a[148:151], a[220:223], v[100:103]
 v_exp_f32 v29, v29
 v_mul_f32 v30, v56, v30
 v_mfma_f32_16x16x32_bf16 v[100:103], a[152:155], a[248:251], v[100:103]
 v_mul_f32 v31, v57, v31
 v_add_f32 v28, 1.0, v28
 v_add_f32 v29, 1.0, v29
 v_mfma_f32_16x16x32_bf16 v[100:103], a[156:159], a[252:255], v[100:103]
 s_waitcnt lgkmcnt(0)
 v_rcp_f32 v28, v28
 v_mfma_f32_16x16x32_bf16 a[48:51], a[128:131], a[192:195], a[48:51]
 ds_read_b64_tr_b16 a[144:145], v7 offset:128
 ds_read_b64_tr_b16 a[146:147], v7 offset:4736
 v_mfma_f32_16x16x32_bf16 a[48:51], a[132:135], a[196:199], a[48:51]
 v_rcp_f32 v29, v29
 v_mul_f32 v30, v30, v28
 v_mfma_f32_16x16x32_bf16 a[48:51], a[136:139], a[224:227], a[48:51]
 ds_read_b64_tr_b16 a[148:149], v7 offset:9344
 ds_read_b64_tr_b16 a[150:151], v7 offset:13952
 v_mul_f32 v31, v31, v29
 v_mfma_f32_16x16x32_bf16 a[48:51], a[140:143], a[228:231], a[48:51]
 v_accvgpr_read_b32 v32, a18
 v_accvgpr_read_b32 v33, a19
 v_mul_f32 v28, s64, v58
 v_mfma_f32_16x16x32_bf16 a[52:55], a[128:131], a[200:203], a[52:55]
 ds_read_b64_tr_b16 a[152:153], v4 offset:128
 ds_read_b64_tr_b16 a[154:155], v4 offset:4736
 v_mul_f32 v29, s64, v59
 v_mfma_f32_16x16x32_bf16 a[52:55], a[132:135], a[204:207], a[52:55]
 v_exp_f32 v28, v28
 v_mfma_f32_16x16x32_bf16 a[52:55], a[136:139], a[232:235], a[52:55]
 ds_read_b64_tr_b16 a[156:157], v4 offset:9344
 ds_read_b64_tr_b16 a[158:159], v4 offset:13952
 v_mfma_f32_16x16x32_bf16 a[52:55], a[140:143], a[236:239], a[52:55]
 v_exp_f32 v29, v29
 v_mul_f32 v32, v58, v32
 v_mfma_f32_16x16x32_bf16 a[56:59], a[128:131], a[208:211], a[56:59]
 v_mul_f32 v33, v59, v33
 v_add_f32 v28, 1.0, v28
 v_add_f32 v29, 1.0, v29
 v_mfma_f32_16x16x32_bf16 a[56:59], a[132:135], a[212:215], a[56:59]
 v_rcp_f32 v28, v28
 v_mfma_f32_16x16x32_bf16 a[56:59], a[136:139], a[240:243], a[56:59]
 v_rcp_f32 v29, v29
 v_mul_f32 v32, v32, v28
 v_mfma_f32_16x16x32_bf16 a[56:59], a[140:143], a[244:247], a[56:59]
 v_mul_f32 v33, v33, v29
 v_cvt_pk_bf16_f32 v42, v30, v31
 v_cvt_pk_bf16_f32 v43, v32, v33
 v_mfma_f32_16x16x32_bf16 a[60:63], a[128:131], a[216:219], a[60:63]
 buffer_store_dwordx4 v[40:43], v2, s[24:27], s71 offen offset:0 sc1
 v_accvgpr_read_b32 v30, a20
 v_mfma_f32_16x16x32_bf16 a[60:63], a[132:135], a[220:223], a[60:63]
 v_accvgpr_read_b32 v31, a21
 v_mul_f32 v28, s64, v60
 v_mul_f32 v29, s64, v61
 v_mfma_f32_16x16x32_bf16 a[60:63], a[136:139], a[248:251], a[60:63]
 v_exp_f32 v28, v28
 v_mfma_f32_16x16x32_bf16 a[60:63], a[140:143], a[252:255], a[60:63]
 s_waitcnt lgkmcnt(0)
 v_exp_f32 v29, v29
 v_mul_f32 v30, v60, v30
 v_mfma_f32_16x16x32_bf16 v[104:107], a[144:147], a[192:195], v[104:107]
 ds_read_b64_tr_b16 a[128:129], v7 offset:18560
 ds_read_b64_tr_b16 a[130:131], v7 offset:23168
 v_mul_f32 v31, v61, v31
 v_mfma_f32_16x16x32_bf16 v[104:107], a[148:151], a[196:199], v[104:107]
 v_add_f32 v28, 1.0, v28
 v_add_f32 v29, 1.0, v29
 v_mfma_f32_16x16x32_bf16 v[104:107], a[152:155], a[224:227], v[104:107]
 ds_read_b64_tr_b16 a[132:133], v7 offset:27776
 ds_read_b64_tr_b16 a[134:135], v7 offset:32384
 v_mfma_f32_16x16x32_bf16 v[104:107], a[156:159], a[228:231], v[104:107]
 v_rcp_f32 v28, v28
 v_mfma_f32_16x16x32_bf16 v[108:111], a[144:147], a[200:203], v[108:111]
 ds_read_b64_tr_b16 a[136:137], v4 offset:18560
 ds_read_b64_tr_b16 a[138:139], v4 offset:23168
 v_mfma_f32_16x16x32_bf16 v[108:111], a[148:151], a[204:207], v[108:111]
 v_rcp_f32 v29, v29
 v_mul_f32 v30, v30, v28
 v_mfma_f32_16x16x32_bf16 v[108:111], a[152:155], a[232:235], v[108:111]
 ds_read_b64_tr_b16 a[140:141], v4 offset:27776
 ds_read_b64_tr_b16 a[142:143], v4 offset:32384
 v_mul_f32 v31, v31, v29
 v_mfma_f32_16x16x32_bf16 v[108:111], a[156:159], a[236:239], v[108:111]
 v_accvgpr_read_b32 v32, a22
 v_accvgpr_read_b32 v33, a23
 v_mul_f32 v28, s64, v62
 v_mfma_f32_16x16x32_bf16 v[112:115], a[144:147], a[208:211], v[112:115]
 v_mul_f32 v29, s64, v63
 v_exp_f32 v28, v28
 v_mfma_f32_16x16x32_bf16 v[112:115], a[148:151], a[212:215], v[112:115]
 v_exp_f32 v29, v29
 v_mul_f32 v32, v62, v32
 v_mfma_f32_16x16x32_bf16 v[112:115], a[152:155], a[240:243], v[112:115]
 v_mul_f32 v33, v63, v33
 v_add_f32 v28, 1.0, v28
 v_add_f32 v29, 1.0, v29
 v_mfma_f32_16x16x32_bf16 v[112:115], a[156:159], a[244:247], v[112:115]
 v_rcp_f32 v28, v28
 v_mfma_f32_16x16x32_bf16 v[116:119], a[144:147], a[216:219], v[116:119]
 v_rcp_f32 v29, v29
 v_mul_f32 v32, v32, v28
 v_mfma_f32_16x16x32_bf16 v[116:119], a[148:151], a[220:223], v[116:119]
 v_mul_f32 v33, v33, v29
 v_cvt_pk_bf16_f32 v46, v30, v31
 v_cvt_pk_bf16_f32 v47, v32, v33
 v_mfma_f32_16x16x32_bf16 v[116:119], a[152:155], a[248:251], v[116:119]
 buffer_store_dwordx4 v[44:47], v2, s[24:27], s72 offen offset:0 sc1
 v_accvgpr_read_b32 v30, a24
 v_mfma_f32_16x16x32_bf16 v[116:119], a[156:159], a[252:255], v[116:119]
 s_waitcnt lgkmcnt(0)
 v_accvgpr_read_b32 v31, a25
 v_mul_f32 v28, s64, v64
 v_mul_f32 v29, s64, v65
 v_mfma_f32_16x16x32_bf16 a[64:67], a[128:131], a[192:195], a[64:67]
 ds_read_b64_tr_b16 a[144:145], v7 offset:160
 ds_read_b64_tr_b16 a[146:147], v7 offset:4768
 v_mfma_f32_16x16x32_bf16 a[64:67], a[132:135], a[196:199], a[64:67]
 v_exp_f32 v28, v28
 v_mfma_f32_16x16x32_bf16 a[64:67], a[136:139], a[224:227], a[64:67]
 ds_read_b64_tr_b16 a[148:149], v7 offset:9376
 ds_read_b64_tr_b16 a[150:151], v7 offset:13984
 v_mfma_f32_16x16x32_bf16 a[64:67], a[140:143], a[228:231], a[64:67]
 v_exp_f32 v29, v29
 v_mul_f32 v30, v64, v30
 v_mfma_f32_16x16x32_bf16 a[68:71], a[128:131], a[200:203], a[68:71]
 ds_read_b64_tr_b16 a[152:153], v4 offset:160
 ds_read_b64_tr_b16 a[154:155], v4 offset:4768
 v_mul_f32 v31, v65, v31
 v_mfma_f32_16x16x32_bf16 a[68:71], a[132:135], a[204:207], a[68:71]
 v_add_f32 v28, 1.0, v28
 v_add_f32 v29, 1.0, v29
 v_mfma_f32_16x16x32_bf16 a[68:71], a[136:139], a[232:235], a[68:71]
 ds_read_b64_tr_b16 a[156:157], v4 offset:9376
 ds_read_b64_tr_b16 a[158:159], v4 offset:13984
 v_mfma_f32_16x16x32_bf16 a[68:71], a[140:143], a[236:239], a[68:71]
 v_rcp_f32 v28, v28
 v_mfma_f32_16x16x32_bf16 v[120:123], a[128:131], a[208:211], v[120:123]
 v_rcp_f32 v29, v29
 v_mul_f32 v30, v30, v28
 v_mfma_f32_16x16x32_bf16 v[120:123], a[132:135], a[212:215], v[120:123]
 v_mul_f32 v31, v31, v29
 v_accvgpr_read_b32 v32, a26
 v_accvgpr_read_b32 v33, a27
 v_mfma_f32_16x16x32_bf16 v[120:123], a[136:139], a[240:243], v[120:123]
 v_mul_f32 v28, s64, v66
 v_mul_f32 v29, s64, v67
 v_mfma_f32_16x16x32_bf16 v[120:123], a[140:143], a[244:247], v[120:123]
 v_exp_f32 v28, v28
 v_mfma_f32_16x16x32_bf16 v[124:127], a[128:131], a[216:219], v[124:127]
 v_exp_f32 v29, v29
 v_mul_f32 v32, v66, v32
 v_mfma_f32_16x16x32_bf16 v[124:127], a[132:135], a[220:223], v[124:127]
 v_mul_f32 v33, v67, v33
 v_add_f32 v28, 1.0, v28
 v_add_f32 v29, 1.0, v29
 v_mfma_f32_16x16x32_bf16 v[124:127], a[136:139], a[248:251], v[124:127]
 v_rcp_f32 v28, v28
 v_mfma_f32_16x16x32_bf16 v[124:127], a[140:143], a[252:255], v[124:127]
 s_waitcnt lgkmcnt(0)
 v_rcp_f32 v29, v29
 v_mul_f32 v32, v32, v28
 v_mfma_f32_16x16x32_bf16 v[128:131], a[144:147], a[192:195], v[128:131]
 ds_read_b64_tr_b16 a[128:129], v7 offset:18592
 ds_read_b64_tr_b16 a[130:131], v7 offset:23200
 v_mul_f32 v33, v33, v29
 v_mfma_f32_16x16x32_bf16 v[128:131], a[148:151], a[196:199], v[128:131]
 v_cvt_pk_bf16_f32 v50, v30, v31
 v_cvt_pk_bf16_f32 v51, v32, v33
 v_accvgpr_read_b32 v30, a28
 v_mfma_f32_16x16x32_bf16 v[128:131], a[152:155], a[224:227], v[128:131]
 ds_read_b64_tr_b16 a[132:133], v7 offset:27808
 ds_read_b64_tr_b16 a[134:135], v7 offset:32416
 v_accvgpr_read_b32 v31, a29
 v_mfma_f32_16x16x32_bf16 v[128:131], a[156:159], a[228:231], v[128:131]
 buffer_store_dwordx4 v[48:51], v2, s[24:27], s73 offen offset:0 sc1
 v_mul_f32 v28, s64, v68
 v_mfma_f32_16x16x32_bf16 v[132:135], a[144:147], a[200:203], v[132:135]
 ds_read_b64_tr_b16 a[136:137], v4 offset:18592
 ds_read_b64_tr_b16 a[138:139], v4 offset:23200
 v_mul_f32 v29, s64, v69
 v_mfma_f32_16x16x32_bf16 v[132:135], a[148:151], a[204:207], v[132:135]
 v_exp_f32 v28, v28
 v_mfma_f32_16x16x32_bf16 v[132:135], a[152:155], a[232:235], v[132:135]
 ds_read_b64_tr_b16 a[140:141], v4 offset:27808
 ds_read_b64_tr_b16 a[142:143], v4 offset:32416
 v_mfma_f32_16x16x32_bf16 v[132:135], a[156:159], a[236:239], v[132:135]
 v_exp_f32 v29, v29
 v_mul_f32 v30, v68, v30
 v_mfma_f32_16x16x32_bf16 v[136:139], a[144:147], a[208:211], v[136:139]
 v_mul_f32 v31, v69, v31
 v_add_f32 v28, 1.0, v28
 v_add_f32 v29, 1.0, v29
 v_mfma_f32_16x16x32_bf16 v[136:139], a[148:151], a[212:215], v[136:139]
 v_rcp_f32 v28, v28
 v_mfma_f32_16x16x32_bf16 v[136:139], a[152:155], a[240:243], v[136:139]
 v_rcp_f32 v29, v29
 v_mul_f32 v30, v30, v28
 v_mfma_f32_16x16x32_bf16 v[136:139], a[156:159], a[244:247], v[136:139]
 v_mul_f32 v31, v31, v29
 v_accvgpr_read_b32 v32, a30
 v_accvgpr_read_b32 v33, a31
 v_mfma_f32_16x16x32_bf16 v[140:143], a[144:147], a[216:219], v[140:143]
 v_mul_f32 v28, s64, v70
 v_mul_f32 v29, s64, v71
 v_mfma_f32_16x16x32_bf16 v[140:143], a[148:151], a[220:223], v[140:143]
 v_exp_f32 v28, v28
 v_mfma_f32_16x16x32_bf16 v[140:143], a[152:155], a[248:251], v[140:143]
 v_exp_f32 v29, v29
 v_mul_f32 v32, v70, v32
 v_mfma_f32_16x16x32_bf16 v[140:143], a[156:159], a[252:255], v[140:143]
 s_waitcnt lgkmcnt(0)
 v_mul_f32 v33, v71, v33
 v_add_f32 v28, 1.0, v28
 v_add_f32 v29, 1.0, v29
 v_mfma_f32_16x16x32_bf16 v[144:147], a[128:131], a[192:195], v[144:147]
 ds_read_b64_tr_b16 a[144:145], v7 offset:192
 ds_read_b64_tr_b16 a[146:147], v7 offset:4800
 v_mfma_f32_16x16x32_bf16 v[144:147], a[132:135], a[196:199], v[144:147]
 v_rcp_f32 v28, v28
 v_mfma_f32_16x16x32_bf16 v[144:147], a[136:139], a[224:227], v[144:147]
 ds_read_b64_tr_b16 a[148:149], v7 offset:9408
 ds_read_b64_tr_b16 a[150:151], v7 offset:14016
 v_mfma_f32_16x16x32_bf16 v[144:147], a[140:143], a[228:231], v[144:147]
 v_rcp_f32 v29, v29
 v_mul_f32 v32, v32, v28
 v_mfma_f32_16x16x32_bf16 v[148:151], a[128:131], a[200:203], v[148:151]
 ds_read_b64_tr_b16 a[152:153], v4 offset:192
 ds_read_b64_tr_b16 a[154:155], v4 offset:4800
 v_mul_f32 v33, v33, v29
 v_mfma_f32_16x16x32_bf16 v[148:151], a[132:135], a[204:207], v[148:151]
 v_cvt_pk_bf16_f32 v54, v30, v31
 v_cvt_pk_bf16_f32 v55, v32, v33
 v_accvgpr_read_b32 v30, a32
 v_mfma_f32_16x16x32_bf16 v[148:151], a[136:139], a[232:235], v[148:151]
 ds_read_b64_tr_b16 a[156:157], v4 offset:9408
 ds_read_b64_tr_b16 a[158:159], v4 offset:14016
 v_accvgpr_read_b32 v31, a33
 v_mfma_f32_16x16x32_bf16 v[148:151], a[140:143], a[236:239], v[148:151]
 buffer_store_dwordx4 v[52:55], v2, s[24:27], s74 offen offset:0 sc1
 v_mul_f32 v28, s64, v72
 v_mfma_f32_16x16x32_bf16 v[152:155], a[128:131], a[208:211], v[152:155]
 v_mul_f32 v29, s64, v73
 v_exp_f32 v28, v28
 v_mfma_f32_16x16x32_bf16 v[152:155], a[132:135], a[212:215], v[152:155]
 v_exp_f32 v29, v29
 v_mul_f32 v30, v72, v30
 v_mfma_f32_16x16x32_bf16 v[152:155], a[136:139], a[240:243], v[152:155]
 v_mul_f32 v31, v73, v31
 v_add_f32 v28, 1.0, v28
 v_add_f32 v29, 1.0, v29
 v_mfma_f32_16x16x32_bf16 v[152:155], a[140:143], a[244:247], v[152:155]
 v_rcp_f32 v28, v28
 v_mfma_f32_16x16x32_bf16 v[156:159], a[128:131], a[216:219], v[156:159]
 v_rcp_f32 v29, v29
 v_mul_f32 v30, v30, v28
 v_mfma_f32_16x16x32_bf16 v[156:159], a[132:135], a[220:223], v[156:159]
 v_mul_f32 v31, v31, v29
 v_accvgpr_read_b32 v32, a34
 v_accvgpr_read_b32 v33, a35
 v_mfma_f32_16x16x32_bf16 v[156:159], a[136:139], a[248:251], v[156:159]
 v_mul_f32 v28, s64, v74
 v_mul_f32 v29, s64, v75
 v_mfma_f32_16x16x32_bf16 v[156:159], a[140:143], a[252:255], v[156:159]
 s_waitcnt lgkmcnt(0)
 v_exp_f32 v28, v28
 v_mfma_f32_16x16x32_bf16 v[160:163], a[144:147], a[192:195], v[160:163]
 ds_read_b64_tr_b16 a[128:129], v7 offset:18624
 ds_read_b64_tr_b16 a[130:131], v7 offset:23232
 v_mfma_f32_16x16x32_bf16 v[160:163], a[148:151], a[196:199], v[160:163]
 v_exp_f32 v29, v29
 v_mul_f32 v32, v74, v32
 v_mfma_f32_16x16x32_bf16 v[160:163], a[152:155], a[224:227], v[160:163]
 ds_read_b64_tr_b16 a[132:133], v7 offset:27840
 ds_read_b64_tr_b16 a[134:135], v7 offset:32448
 v_mul_f32 v33, v75, v33
 v_mfma_f32_16x16x32_bf16 v[160:163], a[156:159], a[228:231], v[160:163]
 v_add_f32 v28, 1.0, v28
 v_add_f32 v29, 1.0, v29
 v_mfma_f32_16x16x32_bf16 v[164:167], a[144:147], a[200:203], v[164:167]
 ds_read_b64_tr_b16 a[136:137], v4 offset:18624
 ds_read_b64_tr_b16 a[138:139], v4 offset:23232
 v_mfma_f32_16x16x32_bf16 v[164:167], a[148:151], a[204:207], v[164:167]
 v_rcp_f32 v28, v28
 v_mfma_f32_16x16x32_bf16 v[164:167], a[152:155], a[232:235], v[164:167]
 ds_read_b64_tr_b16 a[140:141], v4 offset:27840
 ds_read_b64_tr_b16 a[142:143], v4 offset:32448
 v_mfma_f32_16x16x32_bf16 v[164:167], a[156:159], a[236:239], v[164:167]
 v_rcp_f32 v29, v29
 v_mul_f32 v32, v32, v28
 v_mfma_f32_16x16x32_bf16 v[168:171], a[144:147], a[208:211], v[168:171]
 v_mul_f32 v33, v33, v29
 v_cvt_pk_bf16_f32 v72, v30, v31
 v_cvt_pk_bf16_f32 v73, v32, v33
 v_mfma_f32_16x16x32_bf16 v[168:171], a[148:151], a[212:215], v[168:171]
 v_accvgpr_read_b32 v30, a36
 v_accvgpr_read_b32 v31, a37
 v_mul_f32 v28, s64, v76
 v_mfma_f32_16x16x32_bf16 v[168:171], a[152:155], a[240:243], v[168:171]
 v_mul_f32 v29, s64, v77
 v_exp_f32 v28, v28
 v_mfma_f32_16x16x32_bf16 v[168:171], a[156:159], a[244:247], v[168:171]
 v_exp_f32 v29, v29
 v_mul_f32 v30, v76, v30
 v_mfma_f32_16x16x32_bf16 v[172:175], a[144:147], a[216:219], v[172:175]
 v_mul_f32 v31, v77, v31
 v_add_f32 v28, 1.0, v28
 v_add_f32 v29, 1.0, v29
 v_mfma_f32_16x16x32_bf16 v[172:175], a[148:151], a[220:223], v[172:175]
 v_rcp_f32 v28, v28
 v_mfma_f32_16x16x32_bf16 v[172:175], a[152:155], a[248:251], v[172:175]
 v_rcp_f32 v29, v29
 v_mul_f32 v30, v30, v28
 v_mfma_f32_16x16x32_bf16 v[172:175], a[156:159], a[252:255], v[172:175]
 s_waitcnt lgkmcnt(0)
 v_mul_f32 v31, v31, v29
 v_accvgpr_read_b32 v32, a38
 v_accvgpr_read_b32 v33, a39
 v_mfma_f32_16x16x32_bf16 v[176:179], a[128:131], a[192:195], v[176:179]
 ds_read_b64_tr_b16 a[144:145], v7 offset:224
 ds_read_b64_tr_b16 a[146:147], v7 offset:4832
 v_mul_f32 v28, s64, v78
 v_mfma_f32_16x16x32_bf16 v[176:179], a[132:135], a[196:199], v[176:179]
 v_mul_f32 v29, s64, v79
 v_exp_f32 v28, v28
 v_mfma_f32_16x16x32_bf16 v[176:179], a[136:139], a[224:227], v[176:179]
 ds_read_b64_tr_b16 a[148:149], v7 offset:9440
 ds_read_b64_tr_b16 a[150:151], v7 offset:14048
 v_mfma_f32_16x16x32_bf16 v[176:179], a[140:143], a[228:231], v[176:179]
 v_exp_f32 v29, v29
 v_mul_f32 v32, v78, v32
 v_mfma_f32_16x16x32_bf16 v[180:183], a[128:131], a[200:203], v[180:183]
 ds_read_b64_tr_b16 a[152:153], v4 offset:224
 ds_read_b64_tr_b16 a[154:155], v4 offset:4832
 v_mul_f32 v33, v79, v33
 v_mfma_f32_16x16x32_bf16 v[180:183], a[132:135], a[204:207], v[180:183]
 v_add_f32 v28, 1.0, v28
 v_add_f32 v29, 1.0, v29
 v_mfma_f32_16x16x32_bf16 v[180:183], a[136:139], a[232:235], v[180:183]
 ds_read_b64_tr_b16 a[156:157], v4 offset:9440
 ds_read_b64_tr_b16 a[158:159], v4 offset:14048
 v_mfma_f32_16x16x32_bf16 v[180:183], a[140:143], a[236:239], v[180:183]
 v_rcp_f32 v28, v28
 v_mfma_f32_16x16x32_bf16 v[184:187], a[128:131], a[208:211], v[184:187]
 v_rcp_f32 v29, v29
 v_mul_f32 v32, v32, v28
 v_mfma_f32_16x16x32_bf16 v[184:187], a[132:135], a[212:215], v[184:187]
 v_mul_f32 v33, v33, v29
 v_cvt_pk_bf16_f32 v76, v30, v31
 v_cvt_pk_bf16_f32 v77, v32, v33
 v_mfma_f32_16x16x32_bf16 v[184:187], a[136:139], a[240:243], v[184:187]
 v_accvgpr_read_b32 v30, a40
 v_accvgpr_read_b32 v31, a41
 v_mul_f32 v28, s64, v80
 v_mfma_f32_16x16x32_bf16 v[184:187], a[140:143], a[244:247], v[184:187]
 v_mul_f32 v29, s64, v81
 v_exp_f32 v28, v28
 v_mfma_f32_16x16x32_bf16 v[188:191], a[128:131], a[216:219], v[188:191]
 v_exp_f32 v29, v29
 v_mul_f32 v30, v80, v30
 v_mfma_f32_16x16x32_bf16 v[188:191], a[132:135], a[220:223], v[188:191]
 v_mul_f32 v31, v81, v31
 v_add_f32 v28, 1.0, v28
 v_add_f32 v29, 1.0, v29
 v_mfma_f32_16x16x32_bf16 v[188:191], a[136:139], a[248:251], v[188:191]
 v_rcp_f32 v28, v28
 v_mfma_f32_16x16x32_bf16 v[188:191], a[140:143], a[252:255], v[188:191]
 s_waitcnt lgkmcnt(0)
 v_rcp_f32 v29, v29
 v_mul_f32 v30, v30, v28
 v_mfma_f32_16x16x32_bf16 v[192:195], a[144:147], a[192:195], v[192:195]
 ds_read_b64_tr_b16 a[128:129], v7 offset:18656
 ds_read_b64_tr_b16 a[130:131], v7 offset:23264
 v_mul_f32 v31, v31, v29
 v_mfma_f32_16x16x32_bf16 v[192:195], a[148:151], a[196:199], v[192:195]
 v_accvgpr_read_b32 v32, a42
 v_accvgpr_read_b32 v33, a43
 v_mul_f32 v28, s64, v82
 v_mfma_f32_16x16x32_bf16 v[192:195], a[152:155], a[224:227], v[192:195]
 ds_read_b64_tr_b16 a[132:133], v7 offset:27872
 ds_read_b64_tr_b16 a[134:135], v7 offset:32480
 v_mul_f32 v29, s64, v83
 v_mfma_f32_16x16x32_bf16 v[192:195], a[156:159], a[228:231], v[192:195]
 v_exp_f32 v28, v28
 v_mfma_f32_16x16x32_bf16 v[196:199], a[144:147], a[200:203], v[196:199]
 ds_read_b64_tr_b16 a[136:137], v4 offset:18656
 ds_read_b64_tr_b16 a[138:139], v4 offset:23264
 v_mfma_f32_16x16x32_bf16 v[196:199], a[148:151], a[204:207], v[196:199]
 v_exp_f32 v29, v29
 v_mul_f32 v32, v82, v32
 v_mfma_f32_16x16x32_bf16 v[196:199], a[152:155], a[232:235], v[196:199]
 ds_read_b64_tr_b16 a[140:141], v4 offset:27872
 ds_read_b64_tr_b16 a[142:143], v4 offset:32480
 v_mul_f32 v33, v83, v33
 v_mfma_f32_16x16x32_bf16 v[196:199], a[156:159], a[236:239], v[196:199]
 v_add_f32 v28, 1.0, v28
 v_add_f32 v29, 1.0, v29
 v_mfma_f32_16x16x32_bf16 v[200:203], a[144:147], a[208:211], v[200:203]
 v_rcp_f32 v28, v28
 v_mfma_f32_16x16x32_bf16 v[200:203], a[148:151], a[212:215], v[200:203]
 v_rcp_f32 v29, v29
 v_mul_f32 v32, v32, v28
 v_mfma_f32_16x16x32_bf16 v[200:203], a[152:155], a[240:243], v[200:203]
 v_mul_f32 v33, v33, v29
 v_cvt_pk_bf16_f32 v80, v30, v31
 v_cvt_pk_bf16_f32 v81, v32, v33
 v_mfma_f32_16x16x32_bf16 v[200:203], a[156:159], a[244:247], v[200:203]
 v_accvgpr_read_b32 v30, a44
 v_accvgpr_read_b32 v31, a45
 v_mul_f32 v28, s64, v84
 v_mfma_f32_16x16x32_bf16 v[204:207], a[144:147], a[216:219], v[204:207]
 v_mul_f32 v29, s64, v85
 v_exp_f32 v28, v28
 v_mfma_f32_16x16x32_bf16 v[204:207], a[148:151], a[220:223], v[204:207]
 v_exp_f32 v29, v29
 v_mul_f32 v30, v84, v30
 v_mfma_f32_16x16x32_bf16 v[204:207], a[152:155], a[248:251], v[204:207]
 v_mul_f32 v31, v85, v31
 v_add_f32 v28, 1.0, v28
 v_add_f32 v29, 1.0, v29
 v_mfma_f32_16x16x32_bf16 v[204:207], a[156:159], a[252:255], v[204:207]
 s_waitcnt lgkmcnt(0)
 v_rcp_f32 v28, v28
 v_mfma_f32_16x16x32_bf16 v[208:211], a[128:131], a[192:195], v[208:211]
 ds_read_b64_tr_b16 a[144:145], v7 offset:256
 ds_read_b64_tr_b16 a[146:147], v7 offset:4864
 v_mfma_f32_16x16x32_bf16 v[208:211], a[132:135], a[196:199], v[208:211]
 v_rcp_f32 v29, v29
 v_mul_f32 v30, v30, v28
 v_mfma_f32_16x16x32_bf16 v[208:211], a[136:139], a[224:227], v[208:211]
 ds_read_b64_tr_b16 a[148:149], v7 offset:9472
 ds_read_b64_tr_b16 a[150:151], v7 offset:14080
 v_mul_f32 v31, v31, v29
 v_mfma_f32_16x16x32_bf16 v[208:211], a[140:143], a[228:231], v[208:211]
 v_accvgpr_read_b32 v32, a46
 v_accvgpr_read_b32 v33, a47
 v_mul_f32 v28, s64, v86
 v_mfma_f32_16x16x32_bf16 v[212:215], a[128:131], a[200:203], v[212:215]
 ds_read_b64_tr_b16 a[152:153], v4 offset:256
 ds_read_b64_tr_b16 a[154:155], v4 offset:4864
 v_mul_f32 v29, s64, v87
 v_mfma_f32_16x16x32_bf16 v[212:215], a[132:135], a[204:207], v[212:215]
 v_exp_f32 v28, v28
 v_mfma_f32_16x16x32_bf16 v[212:215], a[136:139], a[232:235], v[212:215]
 ds_read_b64_tr_b16 a[156:157], v4 offset:9472
 ds_read_b64_tr_b16 a[158:159], v4 offset:14080
 v_mfma_f32_16x16x32_bf16 v[212:215], a[140:143], a[236:239], v[212:215]
 v_exp_f32 v29, v29
 v_mul_f32 v32, v86, v32
 v_mfma_f32_16x16x32_bf16 v[216:219], a[128:131], a[208:211], v[216:219]
 v_mul_f32 v33, v87, v33
 v_add_f32 v28, 1.0, v28
 v_add_f32 v29, 1.0, v29
 v_mfma_f32_16x16x32_bf16 v[216:219], a[132:135], a[212:215], v[216:219]
 v_rcp_f32 v28, v28
 v_mfma_f32_16x16x32_bf16 v[216:219], a[136:139], a[240:243], v[216:219]
 v_rcp_f32 v29, v29
 v_mul_f32 v32, v32, v28
 v_mfma_f32_16x16x32_bf16 v[216:219], a[140:143], a[244:247], v[216:219]
 v_mul_f32 v33, v33, v29
 v_cvt_pk_bf16_f32 v84, v30, v31
 v_cvt_pk_bf16_f32 v85, v32, v33
 v_mfma_f32_16x16x32_bf16 v[220:223], a[128:131], a[216:219], v[220:223]
 v_accvgpr_read_b32 v30, a48
 v_accvgpr_read_b32 v31, a49
 v_mul_f32 v28, s64, v88
 v_mfma_f32_16x16x32_bf16 v[220:223], a[132:135], a[220:223], v[220:223]
 v_mul_f32 v29, s64, v89
 v_exp_f32 v28, v28
 v_mfma_f32_16x16x32_bf16 v[220:223], a[136:139], a[248:251], v[220:223]
 v_exp_f32 v29, v29
 v_mul_f32 v30, v88, v30
 v_mfma_f32_16x16x32_bf16 v[220:223], a[140:143], a[252:255], v[220:223]
 s_waitcnt lgkmcnt(0)
 v_mul_f32 v31, v89, v31
 v_add_f32 v28, 1.0, v28
 v_add_f32 v29, 1.0, v29
 v_mfma_f32_16x16x32_bf16 v[224:227], a[144:147], a[192:195], v[224:227]
 ds_read_b64_tr_b16 a[128:129], v7 offset:18688
 ds_read_b64_tr_b16 a[130:131], v7 offset:23296
 v_mfma_f32_16x16x32_bf16 v[224:227], a[148:151], a[196:199], v[224:227]
 v_rcp_f32 v28, v28
 v_mfma_f32_16x16x32_bf16 v[224:227], a[152:155], a[224:227], v[224:227]
 ds_read_b64_tr_b16 a[132:133], v7 offset:27904
 ds_read_b64_tr_b16 a[134:135], v7 offset:32512
 v_mfma_f32_16x16x32_bf16 v[224:227], a[156:159], a[228:231], v[224:227]
 v_rcp_f32 v29, v29
 v_mul_f32 v30, v30, v28
 v_mfma_f32_16x16x32_bf16 v[228:231], a[144:147], a[200:203], v[228:231]
 ds_read_b64_tr_b16 a[136:137], v4 offset:18688
 ds_read_b64_tr_b16 a[138:139], v4 offset:23296
 v_mul_f32 v31, v31, v29
 v_mfma_f32_16x16x32_bf16 v[228:231], a[148:151], a[204:207], v[228:231]
 v_accvgpr_read_b32 v32, a50
 v_accvgpr_read_b32 v33, a51
 v_mul_f32 v28, s64, v90
 v_mfma_f32_16x16x32_bf16 v[228:231], a[152:155], a[232:235], v[228:231]
 ds_read_b64_tr_b16 a[140:141], v4 offset:27904
 ds_read_b64_tr_b16 a[142:143], v4 offset:32512
 v_mul_f32 v29, s64, v91
 v_mfma_f32_16x16x32_bf16 v[228:231], a[156:159], a[236:239], v[228:231]
 v_exp_f32 v28, v28
 v_mfma_f32_16x16x32_bf16 v[232:235], a[144:147], a[208:211], v[232:235]
 v_exp_f32 v29, v29
 v_mul_f32 v32, v90, v32
 v_mfma_f32_16x16x32_bf16 v[232:235], a[148:151], a[212:215], v[232:235]
 v_mul_f32 v33, v91, v33
 v_add_f32 v28, 1.0, v28
 v_add_f32 v29, 1.0, v29
 v_mfma_f32_16x16x32_bf16 v[232:235], a[152:155], a[240:243], v[232:235]
 v_rcp_f32 v28, v28
 v_mfma_f32_16x16x32_bf16 v[232:235], a[156:159], a[244:247], v[232:235]
 v_rcp_f32 v29, v29
 v_mul_f32 v32, v32, v28
 v_mfma_f32_16x16x32_bf16 v[236:239], a[144:147], a[216:219], v[236:239]
 v_mul_f32 v33, v33, v29
 v_cvt_pk_bf16_f32 v74, v30, v31
 v_cvt_pk_bf16_f32 v75, v32, v33
 v_mfma_f32_16x16x32_bf16 v[236:239], a[148:151], a[220:223], v[236:239]
 buffer_store_dwordx4 v[72:75], v2, s[24:27], s71 offen offset:1024 sc1
 v_accvgpr_read_b32 v30, a52
 v_mfma_f32_16x16x32_bf16 v[236:239], a[152:155], a[248:251], v[236:239]
 v_accvgpr_read_b32 v31, a53
 v_mul_f32 v28, s64, v92
 v_mul_f32 v29, s64, v93
 v_mfma_f32_16x16x32_bf16 v[236:239], a[156:159], a[252:255], v[236:239]
 s_waitcnt lgkmcnt(0)
 v_exp_f32 v28, v28
 v_mfma_f32_16x16x32_bf16 v[240:243], a[128:131], a[192:195], v[240:243]
 v_exp_f32 v29, v29
 v_mul_f32 v30, v92, v30
 v_mfma_f32_16x16x32_bf16 v[240:243], a[132:135], a[196:199], v[240:243]
 v_mul_f32 v31, v93, v31
 v_add_f32 v28, 1.0, v28
 v_add_f32 v29, 1.0, v29
 v_mfma_f32_16x16x32_bf16 v[240:243], a[136:139], a[224:227], v[240:243]
 s_barrier
 v_rcp_f32 v28, v28
 v_mfma_f32_16x16x32_bf16 v[240:243], a[140:143], a[228:231], v[240:243]
 s_add_u32 s83, s62, 2097152
 ds_read_b64_tr_b16 a[144:145], v16 offset:16384
 ds_read_b64_tr_b16 a[146:147], v16 offset:20480
 v_mfma_f32_16x16x32_bf16 v[244:247], a[128:131], a[200:203], v[244:247]
 s_add_u32 m0, s53, 98304
 v_rcp_f32 v29, v29
 v_mul_f32 v30, v30, v28
 v_mfma_f32_16x16x32_bf16 v[244:247], a[132:135], a[204:207], v[244:247]
 ds_read_b64_tr_b16 a[148:149], v16 offset:24576
 ds_read_b64_tr_b16 a[150:151], v16 offset:28672
 v_mul_f32 v31, v31, v29
 v_mfma_f32_16x16x32_bf16 v[244:247], a[136:139], a[232:235], v[244:247]
 v_accvgpr_read_b32 v32, a54
 v_accvgpr_read_b32 v33, a55
 v_mul_f32 v28, s64, v94
 v_mfma_f32_16x16x32_bf16 v[244:247], a[140:143], a[236:239], v[244:247]
 ds_read_b64_tr_b16 a[152:153], v8 offset:49152
 ds_read_b64_tr_b16 a[154:155], v8 offset:53248
 v_mul_f32 v29, s64, v95
 v_mfma_f32_16x16x32_bf16 v[248:251], a[128:131], a[208:211], v[248:251]
 v_exp_f32 v28, v28
 v_mfma_f32_16x16x32_bf16 v[248:251], a[132:135], a[212:215], v[248:251]
 ds_read_b64_tr_b16 a[156:157], v8 offset:57344
 ds_read_b64_tr_b16 a[158:159], v8 offset:61440
 v_mfma_f32_16x16x32_bf16 v[248:251], a[136:139], a[240:243], v[248:251]
 v_exp_f32 v29, v29
 v_mul_f32 v32, v94, v32
 v_mfma_f32_16x16x32_bf16 v[248:251], a[140:143], a[244:247], v[248:251]
 v_mul_f32 v33, v95, v33
 v_add_f32 v28, 1.0, v28
 v_add_f32 v29, 1.0, v29
 v_mfma_f32_16x16x32_bf16 v[252:255], a[128:131], a[216:219], v[252:255]
 buffer_load_dwordx4 v20, s[20:23], s83 offen lds
 v_mfma_f32_16x16x32_bf16 v[252:255], a[132:135], a[220:223], v[252:255]
 s_add_u32 s84, s62, 2129920
 v_rcp_f32 v28, v28
 v_mfma_f32_16x16x32_bf16 v[252:255], a[136:139], a[248:251], v[252:255]
 s_add_u32 m0, s53, 99328
 v_rcp_f32 v29, v29
 v_mul_f32 v32, v32, v28
 v_mfma_f32_16x16x32_bf16 v[252:255], a[140:143], a[252:255], v[252:255]
 s_waitcnt lgkmcnt(0)
 v_mul_f32 v33, v33, v29
 v_cvt_pk_bf16_f32 v78, v30, v31
 v_cvt_pk_bf16_f32 v79, v32, v33
 v_mfma_f32_16x16x32_bf16 v[56:59], a[144:147], a[224:227], 0
 ds_read_b64_tr_b16 a[128:129], v16 offset:16392
 ds_read_b64_tr_b16 a[130:131], v16 offset:20488
 v_mfma_f32_16x16x32_bf16 v[56:59], a[148:151], a[228:231], v[56:59]
 buffer_store_dwordx4 v[76:79], v2, s[24:27], s72 offen offset:1024 sc1
 v_mfma_f32_16x16x32_bf16 v[56:59], a[152:155], a[192:195], v[56:59]
 ds_read_b64_tr_b16 a[132:133], v16 offset:24584
 ds_read_b64_tr_b16 a[134:135], v16 offset:28680
 v_mfma_f32_16x16x32_bf16 v[56:59], a[156:159], a[196:199], v[56:59]
 v_accvgpr_read_b32 v30, a56
 v_accvgpr_read_b32 v31, a57
 v_mfma_f32_16x16x32_bf16 v[40:43], a[144:147], a[232:235], 0
 ds_read_b64_tr_b16 a[136:137], v8 offset:49160
 ds_read_b64_tr_b16 a[138:139], v8 offset:53256
 v_mfma_f32_16x16x32_bf16 v[40:43], a[148:151], a[236:239], v[40:43]
 buffer_load_dwordx4 v21, s[20:23], s84 offen lds
 v_mfma_f32_16x16x32_bf16 v[40:43], a[152:155], a[200:203], v[40:43]
 s_add_u32 s83, s62, 2162688
 ds_read_b64_tr_b16 a[140:141], v8 offset:57352
 ds_read_b64_tr_b16 a[142:143], v8 offset:61448
 v_mfma_f32_16x16x32_bf16 v[40:43], a[156:159], a[204:207], v[40:43]
 s_add_u32 m0, s53, 100352
 v_mul_f32 v28, s64, v96
 v_mul_f32 v29, s64, v97
 v_mfma_f32_16x16x32_bf16 v[60:63], a[144:147], a[240:243], 0
 v_exp_f32 v28, v28
 v_mfma_f32_16x16x32_bf16 v[60:63], a[148:151], a[244:247], v[60:63]
 buffer_load_dwordx4 v20, s[20:23], s83 offen lds
 v_mfma_f32_16x16x32_bf16 v[60:63], a[152:155], a[208:211], v[60:63]
 s_add_u32 s84, s62, 2195456
 v_exp_f32 v29, v29
 v_mfma_f32_16x16x32_bf16 v[60:63], a[156:159], a[212:215], v[60:63]
 s_add_u32 m0, s53, 101376
 v_mul_f32 v30, v96, v30
 v_mul_f32 v31, v97, v31
 v_mfma_f32_16x16x32_bf16 v[44:47], a[144:147], a[248:251], 0
 v_add_f32 v28, 1.0, v28
 v_add_f32 v29, 1.0, v29
 v_mfma_f32_16x16x32_bf16 v[44:47], a[148:151], a[252:255], v[44:47]
 buffer_load_dwordx4 v21, s[20:23], s84 offen lds
 v_mfma_f32_16x16x32_bf16 v[44:47], a[152:155], a[216:219], v[44:47]
 s_add_u32 s83, s62, 1572864
 v_rcp_f32 v28, v28
 v_mfma_f32_16x16x32_bf16 v[44:47], a[156:159], a[220:223], v[44:47]
 s_waitcnt lgkmcnt(0)
 v_rcp_f32 v29, v29
 v_mfma_f32_16x16x32_bf16 v[64:67], a[128:131], a[224:227], 0
 s_add_u32 m0, s53, 114688
 ds_read_b64_tr_b16 a[144:145], v17 offset:16384
 ds_read_b64_tr_b16 a[146:147], v17 offset:20480
 v_mfma_f32_16x16x32_bf16 v[64:67], a[132:135], a[228:231], v[64:67]
 buffer_load_dwordx4 v20, s[20:23], s83 offen lds
 v_mfma_f32_16x16x32_bf16 v[64:67], a[136:139], a[192:195], v[64:67]
 s_add_u32 s84, s62, 1605632
 ds_read_b64_tr_b16 a[148:149], v17 offset:24576
 ds_read_b64_tr_b16 a[150:151], v17 offset:28672
 v_mfma_f32_16x16x32_bf16 v[64:67], a[140:143], a[196:199], v[64:67]
 s_add_u32 m0, s53, 115712
 v_mul_f32 v30, v30, v28
 v_mul_f32 v31, v31, v29
 v_mfma_f32_16x16x32_bf16 v[48:51], a[128:131], a[232:235], 0
 ds_read_b64_tr_b16 a[152:153], v9 offset:49152
 ds_read_b64_tr_b16 a[154:155], v9 offset:53248
 v_mfma_f32_16x16x32_bf16 v[48:51], a[132:135], a[236:239], v[48:51]
 buffer_load_dwordx4 v21, s[20:23], s84 offen lds
 v_mfma_f32_16x16x32_bf16 v[48:51], a[136:139], a[200:203], v[48:51]
 s_add_u32 s83, s62, 1638400
 ds_read_b64_tr_b16 a[156:157], v9 offset:57344
 ds_read_b64_tr_b16 a[158:159], v9 offset:61440
 v_mfma_f32_16x16x32_bf16 v[48:51], a[140:143], a[204:207], v[48:51]
 s_add_u32 m0, s53, 116736
 v_accvgpr_read_b32 v32, a58
 v_accvgpr_read_b32 v33, a59
 v_mfma_f32_16x16x32_bf16 v[68:71], a[128:131], a[240:243], 0
 v_mul_f32 v28, s64, v98
 v_mul_f32 v29, s64, v99
 v_mfma_f32_16x16x32_bf16 v[68:71], a[132:135], a[244:247], v[68:71]
 buffer_load_dwordx4 v20, s[20:23], s83 offen lds
 v_mfma_f32_16x16x32_bf16 v[68:71], a[136:139], a[208:211], v[68:71]
 s_add_u32 s84, s62, 1671168
 v_exp_f32 v28, v28
 v_mfma_f32_16x16x32_bf16 v[68:71], a[140:143], a[212:215], v[68:71]
 s_add_u32 m0, s53, 117760
 v_exp_f32 v29, v29
 v_mfma_f32_16x16x32_bf16 v[52:55], a[128:131], a[248:251], 0
 v_mul_f32 v32, v98, v32
 v_mul_f32 v33, v99, v33
 v_mfma_f32_16x16x32_bf16 v[52:55], a[132:135], a[252:255], v[52:55]
 buffer_load_dwordx4 v21, s[20:23], s84 offen lds
 v_mfma_f32_16x16x32_bf16 v[52:55], a[136:139], a[216:219], v[52:55]
 s_add_u32 s83, s62, 1048576
 v_add_f32 v28, 1.0, v28
 v_add_f32 v29, 1.0, v29
 v_mfma_f32_16x16x32_bf16 v[52:55], a[140:143], a[220:223], v[52:55]
 s_waitcnt lgkmcnt(0)
 v_rcp_f32 v28, v28
 v_mfma_f32_16x16x32_bf16 v[88:91], a[144:147], a[224:227], 0
 s_add_u32 m0, s53, 131072
 ds_read_b64_tr_b16 a[128:129], v17 offset:16392
 ds_read_b64_tr_b16 a[130:131], v17 offset:20488
 v_mfma_f32_16x16x32_bf16 v[88:91], a[148:151], a[228:231], v[88:91]
 buffer_load_dwordx4 v20, s[20:23], s83 offen lds
 v_mfma_f32_16x16x32_bf16 v[88:91], a[152:155], a[192:195], v[88:91]
 s_add_u32 s84, s62, 1081344
 ds_read_b64_tr_b16 a[132:133], v17 offset:24584
 ds_read_b64_tr_b16 a[134:135], v17 offset:28680
 v_mfma_f32_16x16x32_bf16 v[88:91], a[156:159], a[196:199], v[88:91]
 s_add_u32 m0, s53, 132096
 v_rcp_f32 v29, v29
 v_mfma_f32_16x16x32_bf16 v[72:75], a[144:147], a[232:235], 0
 ds_read_b64_tr_b16 a[136:137], v9 offset:49160
 ds_read_b64_tr_b16 a[138:139], v9 offset:53256
 v_mfma_f32_16x16x32_bf16 v[72:75], a[148:151], a[236:239], v[72:75]
 buffer_load_dwordx4 v21, s[20:23], s84 offen lds
 v_mfma_f32_16x16x32_bf16 v[72:75], a[152:155], a[200:203], v[72:75]
 s_add_u32 s83, s62, 1114112
 ds_read_b64_tr_b16 a[140:141], v9 offset:57352
 ds_read_b64_tr_b16 a[142:143], v9 offset:61448
 v_mfma_f32_16x16x32_bf16 v[72:75], a[156:159], a[204:207], v[72:75]
 s_add_u32 m0, s53, 133120
 v_mul_f32 v32, v32, v28
 v_mul_f32 v33, v33, v29
 v_mfma_f32_16x16x32_bf16 v[92:95], a[144:147], a[240:243], 0
 v_cvt_pk_bf16_f32 v82, v30, v31
 v_cvt_pk_bf16_f32 v83, v32, v33
 v_mfma_f32_16x16x32_bf16 v[92:95], a[148:151], a[244:247], v[92:95]
 buffer_store_dwordx4 v[80:83], v2, s[24:27], s73 offen offset:1024 sc1
 v_mfma_f32_16x16x32_bf16 v[92:95], a[152:155], a[208:211], v[92:95]
 v_accvgpr_read_b32 v30, a60
 v_accvgpr_read_b32 v31, a61
 v_mfma_f32_16x16x32_bf16 v[92:95], a[156:159], a[212:215], v[92:95]
 v_mul_f32 v28, s64, v100
 v_mul_f32 v29, s64, v101
 v_mfma_f32_16x16x32_bf16 v[76:79], a[144:147], a[248:251], 0
 v_exp_f32 v28, v28
 v_mfma_f32_16x16x32_bf16 v[76:79], a[148:151], a[252:255], v[76:79]
 buffer_load_dwordx4 v20, s[20:23], s83 offen lds
 v_mfma_f32_16x16x32_bf16 v[76:79], a[152:155], a[216:219], v[76:79]
 s_add_u32 s84, s62, 1146880
 v_exp_f32 v29, v29
 v_mfma_f32_16x16x32_bf16 v[76:79], a[156:159], a[220:223], v[76:79]
 s_waitcnt lgkmcnt(0)
 v_mul_f32 v30, v100, v30
 v_mul_f32 v31, v101, v31
 v_mfma_f32_16x16x32_bf16 a[96:99], a[128:131], a[224:227], 0
 s_add_u32 m0, s53, 134144
 ds_read_b64_tr_b16 a[144:145], v18 offset:16384
 ds_read_b64_tr_b16 a[146:147], v18 offset:20480
 v_mfma_f32_16x16x32_bf16 a[96:99], a[132:135], a[228:231], a[96:99]
 buffer_load_dwordx4 v21, s[20:23], s84 offen lds
 v_mfma_f32_16x16x32_bf16 a[96:99], a[136:139], a[192:195], a[96:99]
 s_mov_b32 s79, 10240
 ds_read_b64_tr_b16 a[148:149], v18 offset:24576
 ds_read_b64_tr_b16 a[150:151], v18 offset:28672
 v_mfma_f32_16x16x32_bf16 a[96:99], a[140:143], a[196:199], a[96:99]
 v_add_f32 v28, 1.0, v28
 v_add_f32 v29, 1.0, v29
 v_mfma_f32_16x16x32_bf16 a[100:103], a[128:131], a[232:235], 0
 ds_read_b64_tr_b16 a[152:153], v10 offset:49152
 ds_read_b64_tr_b16 a[154:155], v10 offset:53248
 v_mfma_f32_16x16x32_bf16 a[100:103], a[132:135], a[236:239], a[100:103]
 buffer_load_dwordx4 v[96:99], v2, s[12:15], s79 offen offset:0 sc1
 v_mfma_f32_16x16x32_bf16 a[100:103], a[136:139], a[200:203], a[100:103]
 ds_read_b64_tr_b16 a[156:157], v10 offset:57344
 ds_read_b64_tr_b16 a[158:159], v10 offset:61440
 v_mfma_f32_16x16x32_bf16 a[100:103], a[140:143], a[204:207], a[100:103]
 v_rcp_f32 v28, v28
 v_mfma_f32_16x16x32_bf16 a[104:107], a[128:131], a[240:243], 0
 v_rcp_f32 v29, v29
 v_mfma_f32_16x16x32_bf16 a[104:107], a[132:135], a[244:247], a[104:107]
 buffer_load_dwordx4 v[80:83], v2, s[12:15], s79 offen offset:1024 sc1
 v_mfma_f32_16x16x32_bf16 a[104:107], a[136:139], a[208:211], a[104:107]
 s_mov_b32 s80, 28672
 v_mul_f32 v30, v30, v28
 v_mul_f32 v31, v31, v29
 v_mfma_f32_16x16x32_bf16 a[104:107], a[140:143], a[212:215], a[104:107]
 v_accvgpr_read_b32 v32, a62
 v_accvgpr_read_b32 v33, a63
 v_mfma_f32_16x16x32_bf16 a[108:111], a[128:131], a[248:251], 0
 v_mul_f32 v28, s64, v102
 v_mul_f32 v29, s64, v103
 v_mfma_f32_16x16x32_bf16 a[108:111], a[132:135], a[252:255], a[108:111]
 buffer_load_dwordx4 a[72:75], v2, s[12:15], s80 offen offset:0 sc1
 v_mfma_f32_16x16x32_bf16 a[108:111], a[136:139], a[216:219], a[108:111]
 v_exp_f32 v28, v28
 v_mfma_f32_16x16x32_bf16 a[108:111], a[140:143], a[220:223], a[108:111]
 s_waitcnt lgkmcnt(0)
 v_exp_f32 v29, v29
 v_mfma_f32_16x16x32_bf16 a[112:115], a[144:147], a[224:227], 0
 ds_read_b64_tr_b16 a[128:129], v18 offset:16392
 ds_read_b64_tr_b16 a[130:131], v18 offset:20488
 v_mfma_f32_16x16x32_bf16 a[112:115], a[148:151], a[228:231], a[112:115]
 buffer_load_dwordx4 a[76:79], v2, s[12:15], s80 offen offset:1024 sc1
 v_mfma_f32_16x16x32_bf16 a[112:115], a[152:155], a[192:195], a[112:115]
 s_mov_b32 s81, 47104
 ds_read_b64_tr_b16 a[132:133], v18 offset:24584
 ds_read_b64_tr_b16 a[134:135], v18 offset:28680
 v_mfma_f32_16x16x32_bf16 a[112:115], a[156:159], a[196:199], a[112:115]
 v_mul_f32 v32, v102, v32
 v_mul_f32 v33, v103, v33
 v_mfma_f32_16x16x32_bf16 a[116:119], a[144:147], a[232:235], 0
 ds_read_b64_tr_b16 a[136:137], v10 offset:49160
 ds_read_b64_tr_b16 a[138:139], v10 offset:53256
 v_mfma_f32_16x16x32_bf16 a[116:119], a[148:151], a[236:239], a[116:119]
 buffer_load_dwordx4 a[80:83], v2, s[12:15], s81 offen offset:0 sc1
 v_mfma_f32_16x16x32_bf16 a[116:119], a[152:155], a[200:203], a[116:119]
 ds_read_b64_tr_b16 a[140:141], v10 offset:57352
 ds_read_b64_tr_b16 a[142:143], v10 offset:61448
 v_mfma_f32_16x16x32_bf16 a[116:119], a[156:159], a[204:207], a[116:119]
 v_add_f32 v28, 1.0, v28
 v_add_f32 v29, 1.0, v29
 v_mfma_f32_16x16x32_bf16 a[120:123], a[144:147], a[240:243], 0
 v_rcp_f32 v28, v28
 v_mfma_f32_16x16x32_bf16 a[120:123], a[148:151], a[244:247], a[120:123]
 buffer_load_dwordx4 a[84:87], v2, s[12:15], s81 offen offset:1024 sc1
 v_mfma_f32_16x16x32_bf16 a[120:123], a[152:155], a[208:211], a[120:123]
 s_mov_b32 s82, 65536
 v_rcp_f32 v29, v29
 v_mfma_f32_16x16x32_bf16 a[120:123], a[156:159], a[212:215], a[120:123]
 v_mul_f32 v32, v32, v28
 v_mul_f32 v33, v33, v29
 v_mfma_f32_16x16x32_bf16 a[124:127], a[144:147], a[248:251], 0
 v_cvt_pk_bf16_f32 v86, v30, v31
 v_cvt_pk_bf16_f32 v87, v32, v33
 v_mfma_f32_16x16x32_bf16 a[124:127], a[148:151], a[252:255], a[124:127]
 buffer_store_dwordx4 v[84:87], v2, s[24:27], s74 offen offset:1024 sc1
 v_mfma_f32_16x16x32_bf16 a[124:127], a[152:155], a[216:219], a[124:127]
 v_accvgpr_read_b32 v30, a64
 v_accvgpr_read_b32 v31, a65
 v_mfma_f32_16x16x32_bf16 a[124:127], a[156:159], a[220:223], a[124:127]
 s_waitcnt lgkmcnt(0)
 v_mul_f32 v28, s64, v104
 v_mul_f32 v29, s64, v105
 v_mfma_f32_16x16x32_bf16 v[100:103], a[128:131], a[224:227], 0
 ds_read_b64_tr_b16 a[144:145], v19 offset:16384
 ds_read_b64_tr_b16 a[146:147], v19 offset:20480
 v_mfma_f32_16x16x32_bf16 v[100:103], a[132:135], a[228:231], v[100:103]
 buffer_load_dwordx4 a[88:91], v2, s[12:15], s82 offen offset:0 sc1
 v_mfma_f32_16x16x32_bf16 v[100:103], a[136:139], a[192:195], v[100:103]
 ds_read_b64_tr_b16 a[148:149], v19 offset:24576
 ds_read_b64_tr_b16 a[150:151], v19 offset:28672
 v_mfma_f32_16x16x32_bf16 v[100:103], a[140:143], a[196:199], v[100:103]
 v_exp_f32 v28, v28
 v_mfma_f32_16x16x32_bf16 v[84:87], a[128:131], a[232:235], 0
 ds_read_b64_tr_b16 a[152:153], v11 offset:49152
 ds_read_b64_tr_b16 a[154:155], v11 offset:53248
 v_mfma_f32_16x16x32_bf16 v[84:87], a[132:135], a[236:239], v[84:87]
 buffer_load_dwordx4 a[92:95], v2, s[12:15], s82 offen offset:1024 sc1
 v_mfma_f32_16x16x32_bf16 v[84:87], a[136:139], a[200:203], v[84:87]
 ds_read_b64_tr_b16 a[156:157], v11 offset:57344
 ds_read_b64_tr_b16 a[158:159], v11 offset:61440
 v_mfma_f32_16x16x32_bf16 v[84:87], a[140:143], a[204:207], v[84:87]
 v_exp_f32 v29, v29
 v_mfma_f32_16x16x32_bf16 a[0:3], a[128:131], a[240:243], 0
 v_mul_f32 v30, v104, v30
 v_mul_f32 v31, v105, v31
 v_mfma_f32_16x16x32_bf16 a[0:3], a[132:135], a[244:247], a[0:3]
 v_add_f32 v28, 1.0, v28
 v_add_f32 v29, 1.0, v29
 v_mfma_f32_16x16x32_bf16 a[0:3], a[136:139], a[208:211], a[0:3]
 v_rcp_f32 v28, v28
 v_mfma_f32_16x16x32_bf16 a[0:3], a[140:143], a[212:215], a[0:3]
 v_rcp_f32 v29, v29
 v_mfma_f32_16x16x32_bf16 a[4:7], a[128:131], a[248:251], 0
 v_mul_f32 v30, v30, v28
 v_mul_f32 v31, v31, v29
 v_mfma_f32_16x16x32_bf16 a[4:7], a[132:135], a[252:255], a[4:7]
 v_accvgpr_read_b32 v32, a66
 v_accvgpr_read_b32 v33, a67
 v_mfma_f32_16x16x32_bf16 a[4:7], a[136:139], a[216:219], a[4:7]
 v_mul_f32 v28, s64, v106
 v_mul_f32 v29, s64, v107
 v_mfma_f32_16x16x32_bf16 a[4:7], a[140:143], a[220:223], a[4:7]
 s_waitcnt lgkmcnt(0)
 v_exp_f32 v28, v28
 v_mfma_f32_16x16x32_bf16 a[8:11], a[144:147], a[224:227], 0
 ds_read_b64_tr_b16 a[128:129], v19 offset:16392
 ds_read_b64_tr_b16 a[130:131], v19 offset:20488
 v_mfma_f32_16x16x32_bf16 a[8:11], a[148:151], a[228:231], a[8:11]
 v_exp_f32 v29, v29
 v_mfma_f32_16x16x32_bf16 a[8:11], a[152:155], a[192:195], a[8:11]
 ds_read_b64_tr_b16 a[132:133], v19 offset:24584
 ds_read_b64_tr_b16 a[134:135], v19 offset:28680
 v_mfma_f32_16x16x32_bf16 a[8:11], a[156:159], a[196:199], a[8:11]
 v_mul_f32 v32, v106, v32
 v_mul_f32 v33, v107, v33
 v_mfma_f32_16x16x32_bf16 a[12:15], a[144:147], a[232:235], 0
 ds_read_b64_tr_b16 a[136:137], v11 offset:49160
 ds_read_b64_tr_b16 a[138:139], v11 offset:53256
 v_mfma_f32_16x16x32_bf16 a[12:15], a[148:151], a[236:239], a[12:15]
 v_add_f32 v28, 1.0, v28
 v_add_f32 v29, 1.0, v29
 v_mfma_f32_16x16x32_bf16 a[12:15], a[152:155], a[200:203], a[12:15]
 ds_read_b64_tr_b16 a[140:141], v11 offset:57352
 ds_read_b64_tr_b16 a[142:143], v11 offset:61448
 v_mfma_f32_16x16x32_bf16 a[12:15], a[156:159], a[204:207], a[12:15]
 v_rcp_f32 v28, v28
 v_mfma_f32_16x16x32_bf16 a[16:19], a[144:147], a[240:243], 0
 v_rcp_f32 v29, v29
 v_mfma_f32_16x16x32_bf16 a[16:19], a[148:151], a[244:247], a[16:19]
 v_mul_f32 v32, v32, v28
 v_mul_f32 v33, v33, v29
 v_mfma_f32_16x16x32_bf16 a[16:19], a[152:155], a[208:211], a[16:19]
 v_cvt_pk_bf16_f32 v104, v30, v31
 v_cvt_pk_bf16_f32 v105, v32, v33
 v_mfma_f32_16x16x32_bf16 a[16:19], a[156:159], a[212:215], a[16:19]
 v_accvgpr_read_b32 v30, a68
 v_accvgpr_read_b32 v31, a69
 v_mfma_f32_16x16x32_bf16 a[20:23], a[144:147], a[248:251], 0
 v_mul_f32 v28, s64, v108
 v_mul_f32 v29, s64, v109
 v_mfma_f32_16x16x32_bf16 a[20:23], a[148:151], a[252:255], a[20:23]
 v_exp_f32 v28, v28
 v_mfma_f32_16x16x32_bf16 a[20:23], a[152:155], a[216:219], a[20:23]
 v_exp_f32 v29, v29
 v_mfma_f32_16x16x32_bf16 a[20:23], a[156:159], a[220:223], a[20:23]
 s_waitcnt lgkmcnt(0)
 v_mul_f32 v30, v108, v30
 v_mul_f32 v31, v109, v31
 v_mfma_f32_16x16x32_bf16 a[24:27], a[128:131], a[224:227], 0
 v_add_f32 v28, 1.0, v28
 v_add_f32 v29, 1.0, v29
 v_mfma_f32_16x16x32_bf16 a[24:27], a[132:135], a[228:231], a[24:27]
 s_waitcnt vmcnt(32)
 v_rcp_f32 v28, v28
 v_mfma_f32_16x16x32_bf16 a[24:27], a[136:139], a[192:195], a[24:27]
 s_barrier
 v_rcp_f32 v29, v29
 v_mfma_f32_16x16x32_bf16 a[24:27], a[140:143], a[196:199], a[24:27]
 s_add_u32 s83, s62, 524288
 ds_read_b64_tr_b16 a[144:145], v12 offset:0
 ds_read_b64_tr_b16 a[146:147], v12 offset:4096
 v_mfma_f32_16x16x32_bf16 a[28:31], a[128:131], a[232:235], 0
 s_add_u32 m0, s53, 147456
 v_mul_f32 v30, v30, v28
 v_mul_f32 v31, v31, v29
 v_mfma_f32_16x16x32_bf16 a[28:31], a[132:135], a[236:239], a[28:31]
 ds_read_b64_tr_b16 a[148:149], v12 offset:8192
 ds_read_b64_tr_b16 a[150:151], v12 offset:12288
 v_mfma_f32_16x16x32_bf16 a[28:31], a[136:139], a[200:203], a[28:31]
 buffer_load_dwordx4 v20, s[20:23], s83 offen lds
 v_mfma_f32_16x16x32_bf16 a[28:31], a[140:143], a[204:207], a[28:31]
 s_add_u32 s84, s62, 557056
 ds_read_b64_tr_b16 a[152:153], v12 offset:8
 ds_read_b64_tr_b16 a[154:155], v12 offset:4104
 v_mfma_f32_16x16x32_bf16 a[32:35], a[128:131], a[240:243], 0
 s_add_u32 m0, s53, 148480
 v_accvgpr_read_b32 v32, a70
 v_accvgpr_read_b32 v33, a71
 v_mfma_f32_16x16x32_bf16 a[32:35], a[132:135], a[244:247], a[32:35]
 ds_read_b64_tr_b16 a[156:157], v12 offset:8200
 ds_read_b64_tr_b16 a[158:159], v12 offset:12296
 v_mfma_f32_16x16x32_bf16 a[32:35], a[136:139], a[208:211], a[32:35]
 buffer_load_dwordx4 v21, s[20:23], s84 offen lds
 v_mfma_f32_16x16x32_bf16 a[32:35], a[140:143], a[212:215], a[32:35]
 s_add_u32 s83, s62, 589824
 v_mul_f32 v28, s64, v110
 v_mul_f32 v29, s64, v111
 v_mfma_f32_16x16x32_bf16 a[36:39], a[128:131], a[248:251], 0
 s_add_u32 m0, s53, 149504
 v_exp_f32 v28, v28
 v_mfma_f32_16x16x32_bf16 a[36:39], a[132:135], a[252:255], a[36:39]
 v_exp_f32 v29, v29
 v_mfma_f32_16x16x32_bf16 a[36:39], a[136:139], a[216:219], a[36:39]
 buffer_load_dwordx4 v20, s[20:23], s83 offen lds
 v_mfma_f32_16x16x32_bf16 a[36:39], a[140:143], a[220:223], a[36:39]
 s_waitcnt lgkmcnt(4)
 v_mul_f32 v32, v110, v32
 v_mul_f32 v33, v111, v33
 v_mfma_f32_16x16x32_bf16 v[56:59], a[144:147], a[160:163], v[56:59]
 s_add_u32 s84, s62, 622592
 ds_read_b64_tr_b16 a[128:129], v13 offset:0
 ds_read_b64_tr_b16 a[130:131], v13 offset:4096
 v_mfma_f32_16x16x32_bf16 v[56:59], a[148:151], a[164:167], v[56:59]
 s_add_u32 m0, s53, 150528
 v_add_f32 v28, 1.0, v28
 v_add_f32 v29, 1.0, v29
 v_mfma_f32_16x16x32_bf16 v[40:43], a[144:147], a[168:171], v[40:43]
 ds_read_b64_tr_b16 a[132:133], v13 offset:8192
 ds_read_b64_tr_b16 a[134:135], v13 offset:12288
 v_mfma_f32_16x16x32_bf16 v[40:43], a[148:151], a[172:175], v[40:43]
 buffer_load_dwordx4 v21, s[20:23], s84 offen lds
 v_mfma_f32_16x16x32_bf16 v[60:63], a[144:147], a[176:179], v[60:63]
 s_add_u32 s83, s62, 0
 v_rcp_f32 v28, v28
 v_mfma_f32_16x16x32_bf16 v[60:63], a[148:151], a[180:183], v[60:63]
 s_add_u32 m0, s53, 49152
 v_rcp_f32 v29, v29
 v_mfma_f32_16x16x32_bf16 v[44:47], a[144:147], a[184:187], v[44:47]
 v_mul_f32 v32, v32, v28
 v_mul_f32 v33, v33, v29
 v_mfma_f32_16x16x32_bf16 v[44:47], a[148:151], a[188:191], v[44:47]
 s_waitcnt lgkmcnt(4)
 buffer_load_dwordx4 v20, s[20:23], s83 offen lds
 v_mfma_f32_16x16x32_bf16 v[64:67], a[152:155], a[160:163], v[64:67]
 s_add_u32 s84, s62, 32768
 ds_read_b64_tr_b16 a[136:137], v13 offset:8
 ds_read_b64_tr_b16 a[138:139], v13 offset:4104
 v_mfma_f32_16x16x32_bf16 v[64:67], a[156:159], a[164:167], v[64:67]
 s_add_u32 m0, s53, 50176
 v_cvt_pk_bf16_f32 v108, v30, v31
 v_cvt_pk_bf16_f32 v109, v32, v33
 v_mfma_f32_16x16x32_bf16 v[48:51], a[152:155], a[168:171], v[48:51]
 ds_read_b64_tr_b16 a[140:141], v13 offset:8200
 ds_read_b64_tr_b16 a[142:143], v13 offset:12296
 v_mfma_f32_16x16x32_bf16 v[48:51], a[156:159], a[172:175], v[48:51]
 buffer_load_dwordx4 v21, s[20:23], s84 offen lds
 v_mfma_f32_16x16x32_bf16 v[68:71], a[152:155], a[176:179], v[68:71]
 s_add_u32 s83, s62, 65536
 v_mul_f32 v28, s64, v112
 v_mul_f32 v29, s64, v113
 v_mfma_f32_16x16x32_bf16 v[68:71], a[156:159], a[180:183], v[68:71]
 s_add_u32 m0, s53, 51200
 v_exp_f32 v28, v28
 v_mfma_f32_16x16x32_bf16 v[52:55], a[152:155], a[184:187], v[52:55]
 v_exp_f32 v29, v29
 v_mfma_f32_16x16x32_bf16 v[52:55], a[156:159], a[188:191], v[52:55]
 s_waitcnt lgkmcnt(4)
 buffer_load_dwordx4 v20, s[20:23], s83 offen lds
 v_mfma_f32_16x16x32_bf16 v[88:91], a[128:131], a[160:163], v[88:91]
 s_add_u32 s84, s62, 98304
 ds_read_b64_tr_b16 a[144:145], v14 offset:0
 ds_read_b64_tr_b16 a[146:147], v14 offset:4096
 v_mfma_f32_16x16x32_bf16 v[88:91], a[132:135], a[164:167], v[88:91]
 s_add_u32 m0, s53, 52224
 v_mul_f32 v30, v112, v120
 v_mul_f32 v31, v113, v121
 v_mfma_f32_16x16x32_bf16 v[72:75], a[128:131], a[168:171], v[72:75]
 ds_read_b64_tr_b16 a[148:149], v14 offset:8192
 ds_read_b64_tr_b16 a[150:151], v14 offset:12288
 v_mfma_f32_16x16x32_bf16 v[72:75], a[132:135], a[172:175], v[72:75]
 buffer_load_dwordx4 v21, s[20:23], s84 offen lds
 v_mfma_f32_16x16x32_bf16 v[92:95], a[128:131], a[176:179], v[92:95]
 s_mov_b32 s79, 8192
 v_add_f32 v28, 1.0, v28
 v_add_f32 v29, 1.0, v29
 v_mfma_f32_16x16x32_bf16 v[92:95], a[132:135], a[180:183], v[92:95]
 v_rcp_f32 v28, v28
 v_mfma_f32_16x16x32_bf16 v[76:79], a[128:131], a[184:187], v[76:79]
 v_rcp_f32 v29, v29
 v_mfma_f32_16x16x32_bf16 v[76:79], a[132:135], a[188:191], v[76:79]
 s_waitcnt lgkmcnt(4)
 buffer_load_dwordx4 a[192:195], v2, s[12:15], s79 offen offset:0 sc1
 v_mfma_f32_16x16x32_bf16 a[96:99], a[136:139], a[160:163], a[96:99]
 ds_read_b64_tr_b16 a[152:153], v14 offset:8
 ds_read_b64_tr_b16 a[154:155], v14 offset:4104
 v_mfma_f32_16x16x32_bf16 a[96:99], a[140:143], a[164:167], a[96:99]
 v_mul_f32 v30, v30, v28
 v_mul_f32 v31, v31, v29
 v_mfma_f32_16x16x32_bf16 a[100:103], a[136:139], a[168:171], a[100:103]
 ds_read_b64_tr_b16 a[156:157], v14 offset:8200
 ds_read_b64_tr_b16 a[158:159], v14 offset:12296
 v_mfma_f32_16x16x32_bf16 a[100:103], a[140:143], a[172:175], a[100:103]
 buffer_load_dwordx4 a[196:199], v2, s[12:15], s79 offen offset:1024 sc1
 v_mfma_f32_16x16x32_bf16 a[104:107], a[136:139], a[176:179], a[104:107]
 s_mov_b32 s80, 26624
 v_mul_f32 v28, s64, v114
 v_mul_f32 v29, s64, v115
 v_mfma_f32_16x16x32_bf16 a[104:107], a[140:143], a[180:183], a[104:107]
 v_exp_f32 v28, v28
 v_mfma_f32_16x16x32_bf16 a[108:111], a[136:139], a[184:187], a[108:111]
 v_exp_f32 v29, v29
 v_mfma_f32_16x16x32_bf16 a[108:111], a[140:143], a[188:191], a[108:111]
 s_waitcnt lgkmcnt(4)
 buffer_load_dwordx4 a[200:203], v2, s[12:15], s80 offen offset:0 sc1
 v_mfma_f32_16x16x32_bf16 a[112:115], a[144:147], a[160:163], a[112:115]
 ds_read_b64_tr_b16 a[128:129], v15 offset:0
 ds_read_b64_tr_b16 a[130:131], v15 offset:4096
 v_mfma_f32_16x16x32_bf16 a[112:115], a[148:151], a[164:167], a[112:115]
 v_mul_f32 v32, v114, v122
 v_mul_f32 v33, v115, v123
 v_mfma_f32_16x16x32_bf16 a[116:119], a[144:147], a[168:171], a[116:119]
 ds_read_b64_tr_b16 a[132:133], v15 offset:8192
 ds_read_b64_tr_b16 a[134:135], v15 offset:12288
 v_mfma_f32_16x16x32_bf16 a[116:119], a[148:151], a[172:175], a[116:119]
 buffer_load_dwordx4 a[204:207], v2, s[12:15], s80 offen offset:1024 sc1
 v_mfma_f32_16x16x32_bf16 a[120:123], a[144:147], a[176:179], a[120:123]
 s_mov_b32 s81, 45056
 v_add_f32 v28, 1.0, v28
 v_add_f32 v29, 1.0, v29
 v_mfma_f32_16x16x32_bf16 a[120:123], a[148:151], a[180:183], a[120:123]
 v_rcp_f32 v28, v28
 v_mfma_f32_16x16x32_bf16 a[124:127], a[144:147], a[184:187], a[124:127]
 v_rcp_f32 v29, v29
 v_mfma_f32_16x16x32_bf16 a[124:127], a[148:151], a[188:191], a[124:127]
 s_waitcnt lgkmcnt(4)
 buffer_load_dwordx4 a[208:211], v2, s[12:15], s81 offen offset:0 sc1
 v_mfma_f32_16x16x32_bf16 v[100:103], a[152:155], a[160:163], v[100:103]
 ds_read_b64_tr_b16 a[136:137], v15 offset:8
 ds_read_b64_tr_b16 a[138:139], v15 offset:4104
 v_mfma_f32_16x16x32_bf16 v[100:103], a[156:159], a[164:167], v[100:103]
 v_mul_f32 v32, v32, v28
 v_mul_f32 v33, v33, v29
 v_mfma_f32_16x16x32_bf16 v[84:87], a[152:155], a[168:171], v[84:87]
 ds_read_b64_tr_b16 a[140:141], v15 offset:8200
 ds_read_b64_tr_b16 a[142:143], v15 offset:12296
 v_mfma_f32_16x16x32_bf16 v[84:87], a[156:159], a[172:175], v[84:87]
 buffer_load_dwordx4 a[212:215], v2, s[12:15], s81 offen offset:1024 sc1
 v_mfma_f32_16x16x32_bf16 a[0:3], a[152:155], a[176:179], a[0:3]
 s_mov_b32 s82, 63488
 v_cvt_pk_bf16_f32 v112, v30, v31
 v_cvt_pk_bf16_f32 v113, v32, v33
 v_mfma_f32_16x16x32_bf16 a[0:3], a[156:159], a[180:183], a[0:3]
 v_mul_f32 v28, s64, v116
 v_mul_f32 v29, s64, v117
 v_mfma_f32_16x16x32_bf16 a[4:7], a[152:155], a[184:187], a[4:7]
 v_exp_f32 v28, v28
 v_mfma_f32_16x16x32_bf16 a[4:7], a[156:159], a[188:191], a[4:7]
 s_waitcnt lgkmcnt(4)
 buffer_load_dwordx4 a[216:219], v2, s[12:15], s82 offen offset:0 sc1
 v_mfma_f32_16x16x32_bf16 a[8:11], a[128:131], a[160:163], a[8:11]
 v_exp_f32 v29, v29
 v_mfma_f32_16x16x32_bf16 a[8:11], a[132:135], a[164:167], a[8:11]
 s_waitcnt vmcnt(43) lgkmcnt(0)
 v_mul_f32 v30, v116, v124
 v_mul_f32 v31, v117, v125
 v_mfma_f32_16x16x32_bf16 a[12:15], a[128:131], a[168:171], a[12:15]
 s_barrier
 v_add_f32 v28, 1.0, v28
 v_add_f32 v29, 1.0, v29
 v_mfma_f32_16x16x32_bf16 a[12:15], a[132:135], a[172:175], a[12:15]
 ds_read_b64_tr_b16 a[144:145], v12 offset:16384
 ds_read_b64_tr_b16 a[146:147], v12 offset:20480
 v_mfma_f32_16x16x32_bf16 a[16:19], a[128:131], a[176:179], a[16:19]
 buffer_load_dwordx4 a[220:223], v2, s[12:15], s82 offen offset:1024 sc1
 v_mfma_f32_16x16x32_bf16 a[16:19], a[132:135], a[180:183], a[16:19]
 s_mov_b32 s79, 6144
 ds_read_b64_tr_b16 a[148:149], v12 offset:24576
 ds_read_b64_tr_b16 a[150:151], v12 offset:28672
 v_mfma_f32_16x16x32_bf16 a[20:23], a[128:131], a[184:187], a[20:23]
 v_rcp_f32 v28, v28
 v_mfma_f32_16x16x32_bf16 a[20:23], a[132:135], a[188:191], a[20:23]
 v_rcp_f32 v29, v29
 v_mfma_f32_16x16x32_bf16 a[24:27], a[136:139], a[160:163], a[24:27]
 ds_read_b64_tr_b16 a[152:153], v12 offset:16392
 ds_read_b64_tr_b16 a[154:155], v12 offset:20488
 v_mfma_f32_16x16x32_bf16 a[24:27], a[140:143], a[164:167], a[24:27]
 buffer_load_dwordx4 a[224:227], v2, s[12:15], s79 offen offset:0 sc1
 v_mfma_f32_16x16x32_bf16 a[28:31], a[136:139], a[168:171], a[28:31]
 ds_read_b64_tr_b16 a[156:157], v12 offset:24584
 ds_read_b64_tr_b16 a[158:159], v12 offset:28680
 v_mfma_f32_16x16x32_bf16 a[28:31], a[140:143], a[172:175], a[28:31]
 v_mul_f32 v30, v30, v28
 v_mul_f32 v31, v31, v29
 v_mfma_f32_16x16x32_bf16 a[32:35], a[136:139], a[176:179], a[32:35]
 v_mul_f32 v28, s64, v118
 v_mul_f32 v29, s64, v119
 v_mfma_f32_16x16x32_bf16 a[32:35], a[140:143], a[180:183], a[32:35]
 buffer_load_dwordx4 a[228:231], v2, s[12:15], s79 offen offset:1024 sc1
 v_mfma_f32_16x16x32_bf16 a[36:39], a[136:139], a[184:187], a[36:39]
 s_mov_b32 s80, 24576
 v_exp_f32 v28, v28
 v_mfma_f32_16x16x32_bf16 a[36:39], a[140:143], a[188:191], a[36:39]
 s_waitcnt vmcnt(18) lgkmcnt(4)
 v_exp_f32 v29, v29
 v_mfma_f32_16x16x32_bf16 v[56:59], a[144:147], v[96:99], v[56:59]
 ds_read_b64_tr_b16 a[128:129], v13 offset:16384
 ds_read_b64_tr_b16 a[130:131], v13 offset:20480
 v_mfma_f32_16x16x32_bf16 v[56:59], a[148:151], v[80:83], v[56:59]
 buffer_load_dwordx4 a[232:235], v2, s[12:15], s80 offen offset:0 sc1
 v_mfma_f32_16x16x32_bf16 v[40:43], a[144:147], a[72:75], v[40:43]
 ds_read_b64_tr_b16 a[132:133], v13 offset:24576
 ds_read_b64_tr_b16 a[134:135], v13 offset:28672
 v_mfma_f32_16x16x32_bf16 v[40:43], a[148:151], a[76:79], v[40:43]
 v_mul_f32 v32, v118, v126
 v_mul_f32 v33, v119, v127
 v_mfma_f32_16x16x32_bf16 v[60:63], a[144:147], a[80:83], v[60:63]
 v_add_f32 v28, 1.0, v28
 v_add_f32 v29, 1.0, v29
 v_mfma_f32_16x16x32_bf16 v[60:63], a[148:151], a[84:87], v[60:63]
 buffer_load_dwordx4 a[236:239], v2, s[12:15], s80 offen offset:1024 sc1
 v_mfma_f32_16x16x32_bf16 v[44:47], a[144:147], a[88:91], v[44:47]
 s_mov_b32 s81, 43008
 v_rcp_f32 v28, v28
 v_mfma_f32_16x16x32_bf16 v[44:47], a[148:151], a[92:95], v[44:47]
 s_waitcnt lgkmcnt(4)
 v_rcp_f32 v29, v29
 v_mfma_f32_16x16x32_bf16 v[64:67], a[152:155], v[96:99], v[64:67]
 ds_read_b64_tr_b16 a[136:137], v13 offset:16392
 ds_read_b64_tr_b16 a[138:139], v13 offset:20488
 v_mfma_f32_16x16x32_bf16 v[64:67], a[156:159], v[80:83], v[64:67]
 buffer_load_dwordx4 a[240:243], v2, s[12:15], s81 offen offset:0 sc1
 v_mfma_f32_16x16x32_bf16 v[48:51], a[152:155], a[72:75], v[48:51]
 ds_read_b64_tr_b16 a[140:141], v13 offset:24584
 ds_read_b64_tr_b16 a[142:143], v13 offset:28680
 v_mfma_f32_16x16x32_bf16 v[48:51], a[156:159], a[76:79], v[48:51]
 v_mul_f32 v32, v32, v28
 v_mul_f32 v33, v33, v29
 v_mfma_f32_16x16x32_bf16 v[68:71], a[152:155], a[80:83], v[68:71]
 v_cvt_pk_bf16_f32 v116, v30, v31
 v_cvt_pk_bf16_f32 v117, v32, v33
 v_mfma_f32_16x16x32_bf16 v[68:71], a[156:159], a[84:87], v[68:71]
 buffer_load_dwordx4 a[244:247], v2, s[12:15], s81 offen offset:1024 sc1
 v_mfma_f32_16x16x32_bf16 v[52:55], a[152:155], a[88:91], v[52:55]
 s_mov_b32 s82, 61440
 v_mul_f32 v28, s64, v128
 v_mul_f32 v29, s64, v129
 v_mfma_f32_16x16x32_bf16 v[52:55], a[156:159], a[92:95], v[52:55]
 s_waitcnt lgkmcnt(4)
 v_exp_f32 v28, v28
 v_mfma_f32_16x16x32_bf16 v[88:91], a[128:131], v[96:99], v[88:91]
 ds_read_b64_tr_b16 a[144:145], v14 offset:16384
 ds_read_b64_tr_b16 a[146:147], v14 offset:20480
 v_mfma_f32_16x16x32_bf16 v[88:91], a[132:135], v[80:83], v[88:91]
 buffer_load_dwordx4 a[248:251], v2, s[12:15], s82 offen offset:0 sc1
 v_mfma_f32_16x16x32_bf16 v[72:75], a[128:131], a[72:75], v[72:75]
 ds_read_b64_tr_b16 a[148:149], v14 offset:24576
 ds_read_b64_tr_b16 a[150:151], v14 offset:28672
 v_mfma_f32_16x16x32_bf16 v[72:75], a[132:135], a[76:79], v[72:75]
 v_exp_f32 v29, v29
 v_mfma_f32_16x16x32_bf16 v[92:95], a[128:131], a[80:83], v[92:95]
 v_mul_f32 v30, v128, v144
 v_mul_f32 v31, v129, v145
 v_mfma_f32_16x16x32_bf16 v[92:95], a[132:135], a[84:87], v[92:95]
 buffer_load_dwordx4 a[252:255], v2, s[12:15], s82 offen offset:1024 sc1
 v_mfma_f32_16x16x32_bf16 v[76:79], a[128:131], a[88:91], v[76:79]
 s_mov_b32 s79, 4096
 v_add_f32 v28, 1.0, v28
 v_add_f32 v29, 1.0, v29
 v_mfma_f32_16x16x32_bf16 v[76:79], a[132:135], a[92:95], v[76:79]
 s_waitcnt lgkmcnt(4)
 v_rcp_f32 v28, v28
 v_mfma_f32_16x16x32_bf16 a[96:99], a[136:139], v[96:99], a[96:99]
 ds_read_b64_tr_b16 a[152:153], v14 offset:16392
 ds_read_b64_tr_b16 a[154:155], v14 offset:20488
 v_mfma_f32_16x16x32_bf16 a[96:99], a[140:143], v[80:83], a[96:99]
 buffer_load_dwordx4 a[160:163], v2, s[12:15], s79 offen offset:0 sc1
 v_mfma_f32_16x16x32_bf16 a[100:103], a[136:139], a[72:75], a[100:103]
 ds_read_b64_tr_b16 a[156:157], v14 offset:24584
 ds_read_b64_tr_b16 a[158:159], v14 offset:28680
 v_mfma_f32_16x16x32_bf16 a[100:103], a[140:143], a[76:79], a[100:103]
 v_rcp_f32 v29, v29
 v_mfma_f32_16x16x32_bf16 a[104:107], a[136:139], a[80:83], a[104:107]
 v_mul_f32 v30, v30, v28
 v_mul_f32 v31, v31, v29
 v_mfma_f32_16x16x32_bf16 a[104:107], a[140:143], a[84:87], a[104:107]
 buffer_load_dwordx4 a[164:167], v2, s[12:15], s79 offen offset:1024 sc1
 v_mfma_f32_16x16x32_bf16 a[108:111], a[136:139], a[88:91], a[108:111]
 s_mov_b32 s80, 22528
 v_mul_f32 v28, s64, v130
 v_mul_f32 v29, s64, v131
 v_mfma_f32_16x16x32_bf16 a[108:111], a[140:143], a[92:95], a[108:111]
 s_waitcnt lgkmcnt(4)
 v_exp_f32 v28, v28
 v_mfma_f32_16x16x32_bf16 a[112:115], a[144:147], v[96:99], a[112:115]
 ds_read_b64_tr_b16 a[128:129], v15 offset:16384
 ds_read_b64_tr_b16 a[130:131], v15 offset:20480
 v_mfma_f32_16x16x32_bf16 a[112:115], a[148:151], v[80:83], a[112:115]
 buffer_load_dwordx4 a[168:171], v2, s[12:15], s80 offen offset:0 sc1
 v_mfma_f32_16x16x32_bf16 a[116:119], a[144:147], a[72:75], a[116:119]
 ds_read_b64_tr_b16 a[132:133], v15 offset:24576
 ds_read_b64_tr_b16 a[134:135], v15 offset:28672
 v_mfma_f32_16x16x32_bf16 a[116:119], a[148:151], a[76:79], a[116:119]
 v_exp_f32 v29, v29
 v_mfma_f32_16x16x32_bf16 a[120:123], a[144:147], a[80:83], a[120:123]
 v_mul_f32 v32, v130, v146
 v_mul_f32 v33, v131, v147
 v_mfma_f32_16x16x32_bf16 a[120:123], a[148:151], a[84:87], a[120:123]
 buffer_load_dwordx4 a[172:175], v2, s[12:15], s80 offen offset:1024 sc1
 v_mfma_f32_16x16x32_bf16 a[124:127], a[144:147], a[88:91], a[124:127]
 s_mov_b32 s81, 40960
 v_add_f32 v28, 1.0, v28
 v_add_f32 v29, 1.0, v29
 v_mfma_f32_16x16x32_bf16 a[124:127], a[148:151], a[92:95], a[124:127]
 s_waitcnt lgkmcnt(4)
 v_rcp_f32 v28, v28
 v_mfma_f32_16x16x32_bf16 v[100:103], a[152:155], v[96:99], v[100:103]
 ds_read_b64_tr_b16 a[136:137], v15 offset:16392
 ds_read_b64_tr_b16 a[138:139], v15 offset:20488
 v_mfma_f32_16x16x32_bf16 v[100:103], a[156:159], v[80:83], v[100:103]
 buffer_load_dwordx4 a[176:179], v2, s[12:15], s81 offen offset:0 sc1
 v_mfma_f32_16x16x32_bf16 v[84:87], a[152:155], a[72:75], v[84:87]
 ds_read_b64_tr_b16 a[140:141], v15 offset:24584
 ds_read_b64_tr_b16 a[142:143], v15 offset:28680
 v_mfma_f32_16x16x32_bf16 v[84:87], a[156:159], a[76:79], v[84:87]
 v_rcp_f32 v29, v29
 v_mfma_f32_16x16x32_bf16 a[0:3], a[152:155], a[80:83], a[0:3]
 v_mul_f32 v32, v32, v28
 v_mul_f32 v33, v33, v29
 v_mfma_f32_16x16x32_bf16 a[0:3], a[156:159], a[84:87], a[0:3]
 buffer_load_dwordx4 a[180:183], v2, s[12:15], s81 offen offset:1024 sc1
 v_mfma_f32_16x16x32_bf16 a[4:7], a[152:155], a[88:91], a[4:7]
 s_mov_b32 s82, 59392
 v_cvt_pk_bf16_f32 v106, v30, v31
 v_cvt_pk_bf16_f32 v107, v32, v33
 v_mfma_f32_16x16x32_bf16 a[4:7], a[156:159], a[92:95], a[4:7]
 s_waitcnt lgkmcnt(4)
 v_mul_f32 v28, s64, v132
 v_mul_f32 v29, s64, v133
 v_mfma_f32_16x16x32_bf16 a[8:11], a[128:131], v[96:99], a[8:11]
 v_exp_f32 v28, v28
 v_mfma_f32_16x16x32_bf16 a[8:11], a[132:135], v[80:83], a[8:11]
 s_waitcnt lgkmcnt(0)
 buffer_store_dwordx4 v[104:107], v2, s[24:27], s71 offen offset:2048 sc1
 v_mfma_f32_16x16x32_bf16 a[12:15], a[128:131], a[72:75], a[12:15]
 s_barrier
 v_exp_f32 v29, v29
 v_mfma_f32_16x16x32_bf16 a[12:15], a[132:135], a[76:79], a[12:15]
 ds_read_b64_tr_b16 a[144:145], v12 offset:32768
 ds_read_b64_tr_b16 a[146:147], v12 offset:36864
 v_mfma_f32_16x16x32_bf16 a[16:19], a[128:131], a[80:83], a[16:19]
 v_mul_f32 v30, v132, v148
 v_mul_f32 v31, v133, v149
 v_mfma_f32_16x16x32_bf16 a[16:19], a[132:135], a[84:87], a[16:19]
 ds_read_b64_tr_b16 a[148:149], v12 offset:40960
 ds_read_b64_tr_b16 a[150:151], v12 offset:45056
 v_mfma_f32_16x16x32_bf16 a[20:23], a[128:131], a[88:91], a[20:23]
 buffer_load_dwordx4 a[184:187], v2, s[12:15], s82 offen offset:0 sc1
 v_mfma_f32_16x16x32_bf16 a[20:23], a[132:135], a[92:95], a[20:23]
 v_add_f32 v28, 1.0, v28
 v_add_f32 v29, 1.0, v29
 v_mfma_f32_16x16x32_bf16 a[24:27], a[136:139], v[96:99], a[24:27]
 ds_read_b64_tr_b16 a[152:153], v12 offset:32776
 ds_read_b64_tr_b16 a[154:155], v12 offset:36872
 v_mfma_f32_16x16x32_bf16 a[24:27], a[140:143], v[80:83], a[24:27]
 v_rcp_f32 v28, v28
 v_mfma_f32_16x16x32_bf16 a[28:31], a[136:139], a[72:75], a[28:31]
 ds_read_b64_tr_b16 a[156:157], v12 offset:40968
 ds_read_b64_tr_b16 a[158:159], v12 offset:45064
 v_mfma_f32_16x16x32_bf16 a[28:31], a[140:143], a[76:79], a[28:31]
 buffer_load_dwordx4 a[188:191], v2, s[12:15], s82 offen offset:1024 sc1
 v_mfma_f32_16x16x32_bf16 a[32:35], a[136:139], a[80:83], a[32:35]
 v_rcp_f32 v29, v29
 v_mfma_f32_16x16x32_bf16 a[32:35], a[140:143], a[84:87], a[32:35]
 v_mul_f32 v30, v30, v28
 v_mul_f32 v31, v31, v29
 v_mfma_f32_16x16x32_bf16 a[36:39], a[136:139], a[88:91], a[36:39]
 v_mul_f32 v28, s64, v134
 v_mul_f32 v29, s64, v135
 v_mfma_f32_16x16x32_bf16 a[36:39], a[140:143], a[92:95], a[36:39]
 s_waitcnt vmcnt(17) lgkmcnt(4)
 v_exp_f32 v28, v28
 v_mfma_f32_16x16x32_bf16 v[56:59], a[144:147], a[192:195], v[56:59]
 s_mov_b32 s79, 2048
 ds_read_b64_tr_b16 a[128:129], v13 offset:32768
 ds_read_b64_tr_b16 a[130:131], v13 offset:36864
 v_mfma_f32_16x16x32_bf16 v[56:59], a[148:151], a[196:199], v[56:59]
 buffer_load_dwordx4 v[96:99], v2, s[12:15], s79 offen offset:0 sc1
 v_mfma_f32_16x16x32_bf16 v[40:43], a[144:147], a[200:203], v[40:43]
 ds_read_b64_tr_b16 a[132:133], v13 offset:40960
 ds_read_b64_tr_b16 a[134:135], v13 offset:45056
 v_mfma_f32_16x16x32_bf16 v[40:43], a[148:151], a[204:207], v[40:43]
 v_exp_f32 v29, v29
 v_mfma_f32_16x16x32_bf16 v[60:63], a[144:147], a[208:211], v[60:63]
 v_mul_f32 v32, v134, v150
 v_mul_f32 v33, v135, v151
 v_mfma_f32_16x16x32_bf16 v[60:63], a[148:151], a[212:215], v[60:63]
 buffer_load_dwordx4 v[80:83], v2, s[12:15], s79 offen offset:1024 sc1
 v_mfma_f32_16x16x32_bf16 v[44:47], a[144:147], a[216:219], v[44:47]
 s_mov_b32 s80, 20480
 v_add_f32 v28, 1.0, v28
 v_add_f32 v29, 1.0, v29
 v_mfma_f32_16x16x32_bf16 v[44:47], a[148:151], a[220:223], v[44:47]
 s_waitcnt lgkmcnt(4)
 v_rcp_f32 v28, v28
 v_mfma_f32_16x16x32_bf16 v[64:67], a[152:155], a[192:195], v[64:67]
 ds_read_b64_tr_b16 a[136:137], v13 offset:32776
 ds_read_b64_tr_b16 a[138:139], v13 offset:36872
 v_mfma_f32_16x16x32_bf16 v[64:67], a[156:159], a[196:199], v[64:67]
 buffer_load_dwordx4 a[72:75], v2, s[12:15], s80 offen offset:0 sc1
 v_mfma_f32_16x16x32_bf16 v[48:51], a[152:155], a[200:203], v[48:51]
 ds_read_b64_tr_b16 a[140:141], v13 offset:40968
 ds_read_b64_tr_b16 a[142:143], v13 offset:45064
 v_mfma_f32_16x16x32_bf16 v[48:51], a[156:159], a[204:207], v[48:51]
 v_rcp_f32 v29, v29
 v_mfma_f32_16x16x32_bf16 v[68:71], a[152:155], a[208:211], v[68:71]
 v_mul_f32 v32, v32, v28
 v_mul_f32 v33, v33, v29
 v_mfma_f32_16x16x32_bf16 v[68:71], a[156:159], a[212:215], v[68:71]
 buffer_load_dwordx4 a[76:79], v2, s[12:15], s80 offen offset:1024 sc1
 v_mfma_f32_16x16x32_bf16 v[52:55], a[152:155], a[216:219], v[52:55]
 s_mov_b32 s81, 38912
 v_cvt_pk_bf16_f32 v110, v30, v31
 v_cvt_pk_bf16_f32 v111, v32, v33
 v_mfma_f32_16x16x32_bf16 v[52:55], a[156:159], a[220:223], v[52:55]
 s_waitcnt lgkmcnt(4)
 v_mul_f32 v28, s64, v136
 v_mul_f32 v29, s64, v137
 v_mfma_f32_16x16x32_bf16 v[88:91], a[128:131], a[192:195], v[88:91]
 ds_read_b64_tr_b16 a[144:145], v14 offset:32768
 ds_read_b64_tr_b16 a[146:147], v14 offset:36864
 v_mfma_f32_16x16x32_bf16 v[88:91], a[132:135], a[196:199], v[88:91]
 buffer_store_dwordx4 v[108:111], v2, s[24:27], s72 offen offset:2048 sc1
 v_mfma_f32_16x16x32_bf16 v[72:75], a[128:131], a[200:203], v[72:75]
 ds_read_b64_tr_b16 a[148:149], v14 offset:40960
 ds_read_b64_tr_b16 a[150:151], v14 offset:45056
 v_mfma_f32_16x16x32_bf16 v[72:75], a[132:135], a[204:207], v[72:75]
 v_exp_f32 v28, v28
 v_mfma_f32_16x16x32_bf16 v[92:95], a[128:131], a[208:211], v[92:95]
 v_exp_f32 v29, v29
 v_mfma_f32_16x16x32_bf16 v[92:95], a[132:135], a[212:215], v[92:95]
 buffer_load_dwordx4 a[80:83], v2, s[12:15], s81 offen offset:0 sc1
 v_mfma_f32_16x16x32_bf16 v[76:79], a[128:131], a[216:219], v[76:79]
 v_mul_f32 v30, v136, v152
 v_mul_f32 v31, v137, v153
 v_mfma_f32_16x16x32_bf16 v[76:79], a[132:135], a[220:223], v[76:79]
 s_waitcnt lgkmcnt(4)
 v_add_f32 v28, 1.0, v28
 v_add_f32 v29, 1.0, v29
 v_mfma_f32_16x16x32_bf16 a[96:99], a[136:139], a[192:195], a[96:99]
 ds_read_b64_tr_b16 a[152:153], v14 offset:32776
 ds_read_b64_tr_b16 a[154:155], v14 offset:36872
 v_mfma_f32_16x16x32_bf16 a[96:99], a[140:143], a[196:199], a[96:99]
 buffer_load_dwordx4 a[84:87], v2, s[12:15], s81 offen offset:1024 sc1
 v_mfma_f32_16x16x32_bf16 a[100:103], a[136:139], a[200:203], a[100:103]
 s_mov_b32 s82, 57344
 ds_read_b64_tr_b16 a[156:157], v14 offset:40968
 ds_read_b64_tr_b16 a[158:159], v14 offset:45064
 v_mfma_f32_16x16x32_bf16 a[100:103], a[140:143], a[204:207], a[100:103]
 v_rcp_f32 v28, v28
 v_mfma_f32_16x16x32_bf16 a[104:107], a[136:139], a[208:211], a[104:107]
 v_rcp_f32 v29, v29
 v_mfma_f32_16x16x32_bf16 a[104:107], a[140:143], a[212:215], a[104:107]
 buffer_load_dwordx4 a[88:91], v2, s[12:15], s82 offen offset:0 sc1
 v_mfma_f32_16x16x32_bf16 a[108:111], a[136:139], a[216:219], a[108:111]
 v_mul_f32 v30, v30, v28
 v_mul_f32 v31, v31, v29
 v_mfma_f32_16x16x32_bf16 a[108:111], a[140:143], a[220:223], a[108:111]
 s_waitcnt lgkmcnt(4)
 v_mul_f32 v28, s64, v138
 v_mul_f32 v29, s64, v139
 v_mfma_f32_16x16x32_bf16 a[112:115], a[144:147], a[192:195], a[112:115]
 ds_read_b64_tr_b16 a[128:129], v15 offset:32768
 ds_read_b64_tr_b16 a[130:131], v15 offset:36864
 v_mfma_f32_16x16x32_bf16 a[112:115], a[148:151], a[196:199], a[112:115]
 buffer_load_dwordx4 a[92:95], v2, s[12:15], s82 offen offset:1024 sc1
 v_mfma_f32_16x16x32_bf16 a[116:119], a[144:147], a[200:203], a[116:119]
 ds_read_b64_tr_b16 a[132:133], v15 offset:40960
 ds_read_b64_tr_b16 a[134:135], v15 offset:45056
 v_mfma_f32_16x16x32_bf16 a[116:119], a[148:151], a[204:207], a[116:119]
 v_exp_f32 v28, v28
 v_mfma_f32_16x16x32_bf16 a[120:123], a[144:147], a[208:211], a[120:123]
 v_exp_f32 v29, v29
 v_mfma_f32_16x16x32_bf16 a[120:123], a[148:151], a[212:215], a[120:123]
 v_mul_f32 v32, v138, v154
 v_mul_f32 v33, v139, v155
 v_mfma_f32_16x16x32_bf16 a[124:127], a[144:147], a[216:219], a[124:127]
 v_add_f32 v28, 1.0, v28
 v_add_f32 v29, 1.0, v29
 v_mfma_f32_16x16x32_bf16 a[124:127], a[148:151], a[220:223], a[124:127]
 s_waitcnt lgkmcnt(4)
 v_rcp_f32 v28, v28
 v_mfma_f32_16x16x32_bf16 v[100:103], a[152:155], a[192:195], v[100:103]
 ds_read_b64_tr_b16 a[136:137], v15 offset:32776
 ds_read_b64_tr_b16 a[138:139], v15 offset:36872
 v_mfma_f32_16x16x32_bf16 v[100:103], a[156:159], a[196:199], v[100:103]
 v_rcp_f32 v29, v29
 v_mfma_f32_16x16x32_bf16 v[84:87], a[152:155], a[200:203], v[84:87]
 ds_read_b64_tr_b16 a[140:141], v15 offset:40968
 ds_read_b64_tr_b16 a[142:143], v15 offset:45064
 v_mfma_f32_16x16x32_bf16 v[84:87], a[156:159], a[204:207], v[84:87]
 v_mul_f32 v32, v32, v28
 v_mul_f32 v33, v33, v29
 v_mfma_f32_16x16x32_bf16 a[0:3], a[152:155], a[208:211], a[0:3]
 v_cvt_pk_bf16_f32 v114, v30, v31
 v_cvt_pk_bf16_f32 v115, v32, v33
 v_mfma_f32_16x16x32_bf16 a[0:3], a[156:159], a[212:215], a[0:3]
 buffer_store_dwordx4 v[112:115], v2, s[24:27], s73 offen offset:2048 sc1
 v_mfma_f32_16x16x32_bf16 a[4:7], a[152:155], a[216:219], a[4:7]
 v_mul_f32 v28, s64, v140
 v_mul_f32 v29, s64, v141
 v_mfma_f32_16x16x32_bf16 a[4:7], a[156:159], a[220:223], a[4:7]
 s_waitcnt lgkmcnt(4)
 v_exp_f32 v28, v28
 v_mfma_f32_16x16x32_bf16 a[8:11], a[128:131], a[192:195], a[8:11]
 v_exp_f32 v29, v29
 v_mfma_f32_16x16x32_bf16 a[8:11], a[132:135], a[196:199], a[8:11]
 s_waitcnt lgkmcnt(0)
 v_mul_f32 v30, v140, v156
 v_mul_f32 v31, v141, v157
 v_mfma_f32_16x16x32_bf16 a[12:15], a[128:131], a[200:203], a[12:15]
 s_barrier
 v_add_f32 v28, 1.0, v28
 v_add_f32 v29, 1.0, v29
 v_mfma_f32_16x16x32_bf16 a[12:15], a[132:135], a[204:207], a[12:15]
 s_add_u32 m0, s53, 0
 ds_read_b64_tr_b16 a[144:145], v12 offset:49152
 ds_read_b64_tr_b16 a[146:147], v12 offset:53248
 v_mfma_f32_16x16x32_bf16 a[16:19], a[128:131], a[208:211], a[16:19]
 buffer_load_dwordx4 v22, s[4:7], s55 offen offset:0 nt lds
 v_mfma_f32_16x16x32_bf16 a[16:19], a[132:135], a[212:215], a[16:19]
 ds_read_b64_tr_b16 a[148:149], v12 offset:57344
 ds_read_b64_tr_b16 a[150:151], v12 offset:61440
 v_mfma_f32_16x16x32_bf16 a[20:23], a[128:131], a[216:219], a[20:23]
 v_rcp_f32 v28, v28
 v_mfma_f32_16x16x32_bf16 a[20:23], a[132:135], a[220:223], a[20:23]
 v_rcp_f32 v29, v29
 v_mfma_f32_16x16x32_bf16 a[24:27], a[136:139], a[192:195], a[24:27]
 ds_read_b64_tr_b16 a[152:153], v12 offset:49160
 ds_read_b64_tr_b16 a[154:155], v12 offset:53256
 v_mfma_f32_16x16x32_bf16 a[24:27], a[140:143], a[196:199], a[24:27]
 buffer_load_dwordx4 v23, s[4:7], s55 offen offset:1024 nt lds
 v_mfma_f32_16x16x32_bf16 a[28:31], a[136:139], a[200:203], a[28:31]
 ds_read_b64_tr_b16 a[156:157], v12 offset:57352
 ds_read_b64_tr_b16 a[158:159], v12 offset:61448
 v_mfma_f32_16x16x32_bf16 a[28:31], a[140:143], a[204:207], a[28:31]
 v_mul_f32 v30, v30, v28
 v_mul_f32 v31, v31, v29
 v_mfma_f32_16x16x32_bf16 a[32:35], a[136:139], a[208:211], a[32:35]
 v_mul_f32 v28, s64, v142
 v_mul_f32 v29, s64, v143
 v_mfma_f32_16x16x32_bf16 a[32:35], a[140:143], a[212:215], a[32:35]
 buffer_load_dwordx4 v24, s[4:7], s55 offen offset:2048 nt lds
 v_mfma_f32_16x16x32_bf16 a[36:39], a[136:139], a[216:219], a[36:39]
 v_exp_f32 v28, v28
 v_mfma_f32_16x16x32_bf16 a[36:39], a[140:143], a[220:223], a[36:39]
 s_waitcnt vmcnt(22) lgkmcnt(4)
 v_exp_f32 v29, v29
 v_mfma_f32_16x16x32_bf16 v[56:59], a[144:147], a[224:227], v[56:59]
 ds_read_b64_tr_b16 a[128:129], v13 offset:49152
 ds_read_b64_tr_b16 a[130:131], v13 offset:53248
 v_mfma_f32_16x16x32_bf16 v[56:59], a[148:151], a[228:231], v[56:59]
 buffer_load_dwordx4 v25, s[4:7], s55 offen offset:3072 nt lds
 v_mfma_f32_16x16x32_bf16 v[40:43], a[144:147], a[232:235], v[40:43]
 s_add_u32 s55, s55, 16384
 ds_read_b64_tr_b16 a[132:133], v13 offset:57344
 ds_read_b64_tr_b16 a[134:135], v13 offset:61440
 v_mfma_f32_16x16x32_bf16 v[40:43], a[148:151], a[236:239], v[40:43]
 s_mov_b32 s79, 0
 v_mul_f32 v32, v142, v158
 v_mul_f32 v33, v143, v159
 v_mfma_f32_16x16x32_bf16 v[60:63], a[144:147], a[240:243], v[60:63]
 v_add_f32 v28, 1.0, v28
 v_add_f32 v29, 1.0, v29
 v_mfma_f32_16x16x32_bf16 v[60:63], a[148:151], a[244:247], v[60:63]
 buffer_load_dwordx4 a[192:195], v2, s[12:15], s79 offen offset:0 sc1
 v_mfma_f32_16x16x32_bf16 v[44:47], a[144:147], a[248:251], v[44:47]
 v_rcp_f32 v28, v28
 v_mfma_f32_16x16x32_bf16 v[44:47], a[148:151], a[252:255], v[44:47]
 s_waitcnt lgkmcnt(4)
 v_rcp_f32 v29, v29
 v_mfma_f32_16x16x32_bf16 v[64:67], a[152:155], a[224:227], v[64:67]
 ds_read_b64_tr_b16 a[136:137], v13 offset:49160
 ds_read_b64_tr_b16 a[138:139], v13 offset:53256
 v_mfma_f32_16x16x32_bf16 v[64:67], a[156:159], a[228:231], v[64:67]
 buffer_load_dwordx4 a[196:199], v2, s[12:15], s79 offen offset:1024 sc1
 v_mfma_f32_16x16x32_bf16 v[48:51], a[152:155], a[232:235], v[48:51]
 s_mov_b32 s80, 18432
 ds_read_b64_tr_b16 a[140:141], v13 offset:57352
 ds_read_b64_tr_b16 a[142:143], v13 offset:61448
 v_mfma_f32_16x16x32_bf16 v[48:51], a[156:159], a[236:239], v[48:51]
 v_mul_f32 v32, v32, v28
 v_mul_f32 v33, v33, v29
 v_mfma_f32_16x16x32_bf16 v[68:71], a[152:155], a[240:243], v[68:71]
 v_cvt_pk_bf16_f32 v118, v30, v31
 v_cvt_pk_bf16_f32 v119, v32, v33
 v_mfma_f32_16x16x32_bf16 v[68:71], a[156:159], a[244:247], v[68:71]
 buffer_store_dwordx4 v[116:119], v2, s[24:27], s74 offen offset:2048 sc1
 v_mfma_f32_16x16x32_bf16 v[52:55], a[152:155], a[248:251], v[52:55]
 v_mul_f32 v28, s64, v160
 v_mul_f32 v29, s64, v161
 v_mfma_f32_16x16x32_bf16 v[52:55], a[156:159], a[252:255], v[52:55]
 s_waitcnt lgkmcnt(4)
 v_exp_f32 v28, v28
 v_mfma_f32_16x16x32_bf16 v[88:91], a[128:131], a[224:227], v[88:91]
 ds_read_b64_tr_b16 a[144:145], v14 offset:49152
 ds_read_b64_tr_b16 a[146:147], v14 offset:53248
 v_mfma_f32_16x16x32_bf16 v[88:91], a[132:135], a[228:231], v[88:91]
 buffer_load_dwordx4 a[200:203], v2, s[12:15], s80 offen offset:0 sc1
 v_mfma_f32_16x16x32_bf16 v[72:75], a[128:131], a[232:235], v[72:75]
 ds_read_b64_tr_b16 a[148:149], v14 offset:57344
 ds_read_b64_tr_b16 a[150:151], v14 offset:61440
 v_mfma_f32_16x16x32_bf16 v[72:75], a[132:135], a[236:239], v[72:75]
 v_exp_f32 v29, v29
 v_mfma_f32_16x16x32_bf16 v[92:95], a[128:131], a[240:243], v[92:95]
 v_mul_f32 v30, v160, v176
 v_mul_f32 v31, v161, v177
 v_mfma_f32_16x16x32_bf16 v[92:95], a[132:135], a[244:247], v[92:95]
 buffer_load_dwordx4 a[204:207], v2, s[12:15], s80 offen offset:1024 sc1
 v_mfma_f32_16x16x32_bf16 v[76:79], a[128:131], a[248:251], v[76:79]
 s_mov_b32 s81, 36864
 v_add_f32 v28, 1.0, v28
 v_add_f32 v29, 1.0, v29
 v_mfma_f32_16x16x32_bf16 v[76:79], a[132:135], a[252:255], v[76:79]
 s_waitcnt lgkmcnt(4)
 v_rcp_f32 v28, v28
 v_mfma_f32_16x16x32_bf16 a[96:99], a[136:139], a[224:227], a[96:99]
 ds_read_b64_tr_b16 a[152:153], v14 offset:49160
 ds_read_b64_tr_b16 a[154:155], v14 offset:53256
 v_mfma_f32_16x16x32_bf16 a[96:99], a[140:143], a[228:231], a[96:99]
 buffer_load_dwordx4 a[208:211], v2, s[12:15], s81 offen offset:0 sc1
 v_mfma_f32_16x16x32_bf16 a[100:103], a[136:139], a[232:235], a[100:103]
 ds_read_b64_tr_b16 a[156:157], v14 offset:57352
 ds_read_b64_tr_b16 a[158:159], v14 offset:61448
 v_mfma_f32_16x16x32_bf16 a[100:103], a[140:143], a[236:239], a[100:103]
 v_rcp_f32 v29, v29
 v_mfma_f32_16x16x32_bf16 a[104:107], a[136:139], a[240:243], a[104:107]
 v_mul_f32 v30, v30, v28
 v_mul_f32 v31, v31, v29
 v_mfma_f32_16x16x32_bf16 a[104:107], a[140:143], a[244:247], a[104:107]
 buffer_load_dwordx4 a[212:215], v2, s[12:15], s81 offen offset:1024 sc1
 v_mfma_f32_16x16x32_bf16 a[108:111], a[136:139], a[248:251], a[108:111]
 s_mov_b32 s82, 55296
 v_mul_f32 v28, s64, v162
 v_mul_f32 v29, s64, v163
 v_mfma_f32_16x16x32_bf16 a[108:111], a[140:143], a[252:255], a[108:111]
 s_waitcnt lgkmcnt(4)
 v_exp_f32 v28, v28
 v_mfma_f32_16x16x32_bf16 a[112:115], a[144:147], a[224:227], a[112:115]
 ds_read_b64_tr_b16 a[128:129], v15 offset:49152
 ds_read_b64_tr_b16 a[130:131], v15 offset:53248
 v_mfma_f32_16x16x32_bf16 a[112:115], a[148:151], a[228:231], a[112:115]
 buffer_load_dwordx4 a[216:219], v2, s[12:15], s82 offen offset:0 sc1
 v_mfma_f32_16x16x32_bf16 a[116:119], a[144:147], a[232:235], a[116:119]
 ds_read_b64_tr_b16 a[132:133], v15 offset:57344
 ds_read_b64_tr_b16 a[134:135], v15 offset:61440
 v_mfma_f32_16x16x32_bf16 a[116:119], a[148:151], a[236:239], a[116:119]
 v_exp_f32 v29, v29
 v_mfma_f32_16x16x32_bf16 a[120:123], a[144:147], a[240:243], a[120:123]
 v_mul_f32 v32, v162, v178
 v_mul_f32 v33, v163, v179
 v_mfma_f32_16x16x32_bf16 a[120:123], a[148:151], a[244:247], a[120:123]
 buffer_load_dwordx4 a[220:223], v2, s[12:15], s82 offen offset:1024 sc1
 v_mfma_f32_16x16x32_bf16 a[124:127], a[144:147], a[248:251], a[124:127]
 v_add_f32 v28, 1.0, v28
 v_add_f32 v29, 1.0, v29
 v_mfma_f32_16x16x32_bf16 a[124:127], a[148:151], a[252:255], a[124:127]
 s_waitcnt lgkmcnt(4)
 v_rcp_f32 v28, v28
 v_mfma_f32_16x16x32_bf16 v[100:103], a[152:155], a[224:227], v[100:103]
 ds_read_b64_tr_b16 a[136:137], v15 offset:49160
 ds_read_b64_tr_b16 a[138:139], v15 offset:53256
 v_mfma_f32_16x16x32_bf16 v[100:103], a[156:159], a[228:231], v[100:103]
 v_rcp_f32 v29, v29
 v_mfma_f32_16x16x32_bf16 v[84:87], a[152:155], a[232:235], v[84:87]
 ds_read_b64_tr_b16 a[140:141], v15 offset:57352
 ds_read_b64_tr_b16 a[142:143], v15 offset:61448
 v_mfma_f32_16x16x32_bf16 v[84:87], a[156:159], a[236:239], v[84:87]
 v_mul_f32 v32, v32, v28
 v_mul_f32 v33, v33, v29
 v_mfma_f32_16x16x32_bf16 a[0:3], a[152:155], a[240:243], a[0:3]
 v_cvt_pk_bf16_f32 v160, v30, v31
 v_cvt_pk_bf16_f32 v161, v32, v33
 v_mfma_f32_16x16x32_bf16 a[0:3], a[156:159], a[244:247], a[0:3]
 v_mul_f32 v28, s64, v164
 v_mul_f32 v29, s64, v165
 v_mfma_f32_16x16x32_bf16 a[4:7], a[152:155], a[248:251], a[4:7]
 v_exp_f32 v28, v28
 v_mfma_f32_16x16x32_bf16 a[4:7], a[156:159], a[252:255], a[4:7]
 s_waitcnt lgkmcnt(4)
 v_exp_f32 v29, v29
 v_mfma_f32_16x16x32_bf16 a[8:11], a[128:131], a[224:227], a[8:11]
 v_mul_f32 v30, v164, v180
 v_mul_f32 v31, v165, v181
 v_mfma_f32_16x16x32_bf16 a[8:11], a[132:135], a[228:231], a[8:11]
 s_waitcnt lgkmcnt(0)
 v_add_f32 v28, 1.0, v28
 v_add_f32 v29, 1.0, v29
 v_mfma_f32_16x16x32_bf16 a[12:15], a[128:131], a[232:235], a[12:15]
 s_barrier
 v_rcp_f32 v28, v28
 v_mfma_f32_16x16x32_bf16 a[12:15], a[132:135], a[236:239], a[12:15]
 s_add_u32 m0, s53, 16384
 ds_read_b64_tr_b16 a[144:145], v16 offset:0
 ds_read_b64_tr_b16 a[146:147], v16 offset:4096
 v_mfma_f32_16x16x32_bf16 a[16:19], a[128:131], a[240:243], a[16:19]
 buffer_load_dwordx4 v22, s[4:7], s55 offen offset:0 nt lds
 v_mfma_f32_16x16x32_bf16 a[16:19], a[132:135], a[244:247], a[16:19]
 ds_read_b64_tr_b16 a[148:149], v16 offset:8192
 ds_read_b64_tr_b16 a[150:151], v16 offset:12288
 v_mfma_f32_16x16x32_bf16 a[20:23], a[128:131], a[248:251], a[20:23]
 v_rcp_f32 v29, v29
 v_mfma_f32_16x16x32_bf16 a[20:23], a[132:135], a[252:255], a[20:23]
 v_mul_f32 v30, v30, v28
 v_mul_f32 v31, v31, v29
 v_mfma_f32_16x16x32_bf16 a[24:27], a[136:139], a[224:227], a[24:27]
 ds_read_b64_tr_b16 a[152:153], v16 offset:8
 ds_read_b64_tr_b16 a[154:155], v16 offset:4104
 v_mfma_f32_16x16x32_bf16 a[24:27], a[140:143], a[228:231], a[24:27]
 buffer_load_dwordx4 v23, s[4:7], s55 offen offset:1024 nt lds
 v_mfma_f32_16x16x32_bf16 a[28:31], a[136:139], a[232:235], a[28:31]
 ds_read_b64_tr_b16 a[156:157], v16 offset:8200
 ds_read_b64_tr_b16 a[158:159], v16 offset:12296
 v_mfma_f32_16x16x32_bf16 a[28:31], a[140:143], a[236:239], a[28:31]
 v_mul_f32 v28, s64, v166
 v_mul_f32 v29, s64, v167
 v_mfma_f32_16x16x32_bf16 a[32:35], a[136:139], a[240:243], a[32:35]
 v_exp_f32 v28, v28
 v_mfma_f32_16x16x32_bf16 a[32:35], a[140:143], a[244:247], a[32:35]
 buffer_load_dwordx4 v24, s[4:7], s55 offen offset:2048 nt lds
 v_mfma_f32_16x16x32_bf16 a[36:39], a[136:139], a[248:251], a[36:39]
 v_exp_f32 v29, v29
 v_mfma_f32_16x16x32_bf16 a[36:39], a[140:143], a[252:255], a[36:39]
 s_waitcnt vmcnt(26) lgkmcnt(4)
 v_mul_f32 v32, v166, v182
 v_mul_f32 v33, v167, v183
 v_mfma_f32_16x16x32_bf16 v[56:59], a[144:147], a[160:163], v[56:59]
 ds_read_b64_tr_b16 a[128:129], v17 offset:0
 ds_read_b64_tr_b16 a[130:131], v17 offset:4096
 v_mfma_f32_16x16x32_bf16 v[56:59], a[148:151], a[164:167], v[56:59]
 buffer_load_dwordx4 v25, s[4:7], s55 offen offset:3072 nt lds
 v_mfma_f32_16x16x32_bf16 v[40:43], a[144:147], a[168:171], v[40:43]
 s_add_u32 s55, s55, 16384
 ds_read_b64_tr_b16 a[132:133], v17 offset:8192
 ds_read_b64_tr_b16 a[134:135], v17 offset:12288
 v_mfma_f32_16x16x32_bf16 v[40:43], a[148:151], a[172:175], v[40:43]
 s_add_u32 m0, s53, 114688
 v_add_f32 v28, 1.0, v28
 v_add_f32 v29, 1.0, v29
 v_mfma_f32_16x16x32_bf16 v[60:63], a[144:147], a[176:179], v[60:63]
 v_rcp_f32 v28, v28
 v_mfma_f32_16x16x32_bf16 v[60:63], a[148:151], a[180:183], v[60:63]
 buffer_load_dwordx4 v26, s[8:11], s56 offen offset:0 nt lds
 v_mfma_f32_16x16x32_bf16 v[44:47], a[144:147], a[184:187], v[44:47]
 v_rcp_f32 v29, v29
 v_mfma_f32_16x16x32_bf16 v[44:47], a[148:151], a[188:191], v[44:47]
 s_waitcnt lgkmcnt(4)
 v_mul_f32 v32, v32, v28
 v_mul_f32 v33, v33, v29
 v_mfma_f32_16x16x32_bf16 v[64:67], a[152:155], a[160:163], v[64:67]
 ds_read_b64_tr_b16 a[136:137], v17 offset:8
 ds_read_b64_tr_b16 a[138:139], v17 offset:4104
 v_mfma_f32_16x16x32_bf16 v[64:67], a[156:159], a[164:167], v[64:67]
 buffer_load_dwordx4 v27, s[8:11], s56 offen offset:1024 nt lds
 v_mfma_f32_16x16x32_bf16 v[48:51], a[152:155], a[168:171], v[48:51]
 ds_read_b64_tr_b16 a[140:141], v17 offset:8200
 ds_read_b64_tr_b16 a[142:143], v17 offset:12296
 v_mfma_f32_16x16x32_bf16 v[48:51], a[156:159], a[172:175], v[48:51]
 v_cvt_pk_bf16_f32 v164, v30, v31
 v_cvt_pk_bf16_f32 v165, v32, v33
 v_mfma_f32_16x16x32_bf16 v[68:71], a[152:155], a[176:179], v[68:71]
 v_mul_f32 v28, s64, v168
 v_mul_f32 v29, s64, v169
 v_mfma_f32_16x16x32_bf16 v[68:71], a[156:159], a[180:183], v[68:71]
 buffer_load_dwordx4 v26, s[8:11], s56 offen offset:2048 nt lds
 v_mfma_f32_16x16x32_bf16 v[52:55], a[152:155], a[184:187], v[52:55]
 v_exp_f32 v28, v28
 v_mfma_f32_16x16x32_bf16 v[52:55], a[156:159], a[188:191], v[52:55]
 s_waitcnt lgkmcnt(4)
 v_exp_f32 v29, v29
 v_mfma_f32_16x16x32_bf16 v[88:91], a[128:131], a[160:163], v[88:91]
 ds_read_b64_tr_b16 a[144:145], v18 offset:0
 ds_read_b64_tr_b16 a[146:147], v18 offset:4096
 v_mfma_f32_16x16x32_bf16 v[88:91], a[132:135], a[164:167], v[88:91]
 buffer_load_dwordx4 v27, s[8:11], s56 offen offset:3072 nt lds
 v_mfma_f32_16x16x32_bf16 v[72:75], a[128:131], a[168:171], v[72:75]
 s_add_u32 s56, s56, 16384
 ds_read_b64_tr_b16 a[148:149], v18 offset:8192
 ds_read_b64_tr_b16 a[150:151], v18 offset:12288
 v_mfma_f32_16x16x32_bf16 v[72:75], a[132:135], a[172:175], v[72:75]
 v_mul_f32 v30, v168, v184
 v_mul_f32 v31, v169, v185
 v_mfma_f32_16x16x32_bf16 v[92:95], a[128:131], a[176:179], v[92:95]
 v_add_f32 v28, 1.0, v28
 v_add_f32 v29, 1.0, v29
 v_mfma_f32_16x16x32_bf16 v[92:95], a[132:135], a[180:183], v[92:95]
 v_rcp_f32 v28, v28
 v_mfma_f32_16x16x32_bf16 v[76:79], a[128:131], a[184:187], v[76:79]
 v_rcp_f32 v29, v29
 v_mfma_f32_16x16x32_bf16 v[76:79], a[132:135], a[188:191], v[76:79]
 s_waitcnt lgkmcnt(4)
 v_mul_f32 v30, v30, v28
 v_mul_f32 v31, v31, v29
 v_mfma_f32_16x16x32_bf16 a[96:99], a[136:139], a[160:163], a[96:99]
 ds_read_b64_tr_b16 a[152:153], v18 offset:8
 ds_read_b64_tr_b16 a[154:155], v18 offset:4104
 v_mfma_f32_16x16x32_bf16 a[96:99], a[140:143], a[164:167], a[96:99]
 v_mul_f32 v28, s64, v170
 v_mul_f32 v29, s64, v171
 v_mfma_f32_16x16x32_bf16 a[100:103], a[136:139], a[168:171], a[100:103]
 ds_read_b64_tr_b16 a[156:157], v18 offset:8200
 ds_read_b64_tr_b16 a[158:159], v18 offset:12296
 v_mfma_f32_16x16x32_bf16 a[100:103], a[140:143], a[172:175], a[100:103]
 v_exp_f32 v28, v28
 v_mfma_f32_16x16x32_bf16 a[104:107], a[136:139], a[176:179], a[104:107]
 v_exp_f32 v29, v29
 v_mfma_f32_16x16x32_bf16 a[104:107], a[140:143], a[180:183], a[104:107]
 v_mul_f32 v32, v170, v186
 v_mul_f32 v33, v171, v187
 v_mfma_f32_16x16x32_bf16 a[108:111], a[136:139], a[184:187], a[108:111]
 v_add_f32 v28, 1.0, v28
 v_add_f32 v29, 1.0, v29
 v_mfma_f32_16x16x32_bf16 a[108:111], a[140:143], a[188:191], a[108:111]
 s_waitcnt lgkmcnt(4)
 v_rcp_f32 v28, v28
 v_mfma_f32_16x16x32_bf16 a[112:115], a[144:147], a[160:163], a[112:115]
 ds_read_b64_tr_b16 a[128:129], v19 offset:0
 ds_read_b64_tr_b16 a[130:131], v19 offset:4096
 v_mfma_f32_16x16x32_bf16 a[112:115], a[148:151], a[164:167], a[112:115]
 v_rcp_f32 v29, v29
 v_mfma_f32_16x16x32_bf16 a[116:119], a[144:147], a[168:171], a[116:119]
 ds_read_b64_tr_b16 a[132:133], v19 offset:8192
 ds_read_b64_tr_b16 a[134:135], v19 offset:12288
 v_mfma_f32_16x16x32_bf16 a[116:119], a[148:151], a[172:175], a[116:119]
 v_mul_f32 v32, v32, v28
 v_mul_f32 v33, v33, v29
 v_mfma_f32_16x16x32_bf16 a[120:123], a[144:147], a[176:179], a[120:123]
 v_cvt_pk_bf16_f32 v168, v30, v31
 v_cvt_pk_bf16_f32 v169, v32, v33
 v_mfma_f32_16x16x32_bf16 a[120:123], a[148:151], a[180:183], a[120:123]
 v_mul_f32 v28, s64, v172
 v_mul_f32 v29, s64, v173
 v_mfma_f32_16x16x32_bf16 a[124:127], a[144:147], a[184:187], a[124:127]
 v_exp_f32 v28, v28
 v_mfma_f32_16x16x32_bf16 a[124:127], a[148:151], a[188:191], a[124:127]
 s_waitcnt lgkmcnt(4)
 v_exp_f32 v29, v29
 v_mfma_f32_16x16x32_bf16 v[100:103], a[152:155], a[160:163], v[100:103]
 ds_read_b64_tr_b16 a[136:137], v19 offset:8
 ds_read_b64_tr_b16 a[138:139], v19 offset:4104
 v_mfma_f32_16x16x32_bf16 v[100:103], a[156:159], a[164:167], v[100:103]
 v_mul_f32 v30, v172, v188
 v_mul_f32 v31, v173, v189
 v_mfma_f32_16x16x32_bf16 v[84:87], a[152:155], a[168:171], v[84:87]
 ds_read_b64_tr_b16 a[140:141], v19 offset:8200
 ds_read_b64_tr_b16 a[142:143], v19 offset:12296
 v_mfma_f32_16x16x32_bf16 v[84:87], a[156:159], a[172:175], v[84:87]
 v_add_f32 v28, 1.0, v28
 v_add_f32 v29, 1.0, v29
 v_mfma_f32_16x16x32_bf16 a[0:3], a[152:155], a[176:179], a[0:3]
 v_rcp_f32 v28, v28
 v_mfma_f32_16x16x32_bf16 a[0:3], a[156:159], a[180:183], a[0:3]
 v_rcp_f32 v29, v29
 v_mfma_f32_16x16x32_bf16 a[4:7], a[152:155], a[184:187], a[4:7]
 v_mul_f32 v30, v30, v28
 v_mul_f32 v31, v31, v29
 v_mfma_f32_16x16x32_bf16 a[4:7], a[156:159], a[188:191], a[4:7]
 s_waitcnt lgkmcnt(4)
 v_mul_f32 v28, s64, v174
 v_mul_f32 v29, s64, v175
 v_mfma_f32_16x16x32_bf16 a[8:11], a[128:131], a[160:163], a[8:11]
 v_exp_f32 v28, v28
 v_mfma_f32_16x16x32_bf16 a[8:11], a[132:135], a[164:167], a[8:11]
 s_waitcnt lgkmcnt(0)
 v_exp_f32 v29, v29
 v_mfma_f32_16x16x32_bf16 a[12:15], a[128:131], a[168:171], a[12:15]
 s_barrier
 v_mul_f32 v32, v174, v190
 v_mul_f32 v33, v175, v191
 v_mfma_f32_16x16x32_bf16 a[12:15], a[132:135], a[172:175], a[12:15]
 ds_read_b64_tr_b16 a[144:145], v16 offset:16384
 ds_read_b64_tr_b16 a[146:147], v16 offset:20480
 v_mfma_f32_16x16x32_bf16 a[16:19], a[128:131], a[176:179], a[16:19]
 ds_read_b64_tr_b16 a[148:149], v16 offset:24576
 ds_read_b64_tr_b16 a[150:151], v16 offset:28672
 v_mfma_f32_16x16x32_bf16 a[16:19], a[132:135], a[180:183], a[16:19]
 ds_read_b64_tr_b16 a[152:153], v8 offset:49152
 ds_read_b64_tr_b16 a[154:155], v8 offset:53248
 v_mfma_f32_16x16x32_bf16 a[20:23], a[128:131], a[184:187], a[20:23]
 ds_read_b64_tr_b16 a[156:157], v8 offset:57344
 ds_read_b64_tr_b16 a[158:159], v8 offset:61440
 v_mfma_f32_16x16x32_bf16 a[20:23], a[132:135], a[188:191], a[20:23]
 v_add_f32 v28, 1.0, v28
 v_add_f32 v29, 1.0, v29
 v_mfma_f32_16x16x32_bf16 a[24:27], a[136:139], a[160:163], a[24:27]
 v_rcp_f32 v28, v28
 v_mfma_f32_16x16x32_bf16 a[24:27], a[140:143], a[164:167], a[24:27]
 v_rcp_f32 v29, v29
 v_mfma_f32_16x16x32_bf16 a[28:31], a[136:139], a[168:171], a[28:31]
 v_mul_f32 v32, v32, v28
 v_mul_f32 v33, v33, v29
 v_mfma_f32_16x16x32_bf16 a[28:31], a[140:143], a[172:175], a[28:31]
 v_cvt_pk_bf16_f32 v172, v30, v31
 v_cvt_pk_bf16_f32 v173, v32, v33
 v_mfma_f32_16x16x32_bf16 a[32:35], a[136:139], a[176:179], a[32:35]
 v_mul_f32 v28, s64, v192
 v_mul_f32 v29, s64, v193
 v_mfma_f32_16x16x32_bf16 a[32:35], a[140:143], a[180:183], a[32:35]
 v_exp_f32 v28, v28
 v_mfma_f32_16x16x32_bf16 a[36:39], a[136:139], a[184:187], a[36:39]
 v_exp_f32 v29, v29
 v_mfma_f32_16x16x32_bf16 a[36:39], a[140:143], a[188:191], a[36:39]
 s_waitcnt vmcnt(8) lgkmcnt(0)
 v_mul_f32 v30, v192, v208
 v_mul_f32 v31, v193, v209
 v_mfma_f32_16x16x32_bf16 v[56:59], a[144:147], v[96:99], v[56:59]
 s_add_u32 m0, s53, 32768
 ds_read_b64_tr_b16 a[128:129], v16 offset:16392
 ds_read_b64_tr_b16 a[130:131], v16 offset:20488
 v_mfma_f32_16x16x32_bf16 v[56:59], a[148:151], v[80:83], v[56:59]
 buffer_load_dwordx4 v22, s[4:7], s55 offen offset:0 nt lds
 v_mfma_f32_16x16x32_bf16 v[56:59], a[152:155], a[192:195], v[56:59]
 ds_read_b64_tr_b16 a[132:133], v16 offset:24584
 ds_read_b64_tr_b16 a[134:135], v16 offset:28680
 v_mfma_f32_16x16x32_bf16 v[56:59], a[156:159], a[196:199], v[56:59]
 v_add_f32 v28, 1.0, v28
 v_add_f32 v29, 1.0, v29
 v_mfma_f32_16x16x32_bf16 v[40:43], a[144:147], a[72:75], v[40:43]
 ds_read_b64_tr_b16 a[136:137], v8 offset:49160
 ds_read_b64_tr_b16 a[138:139], v8 offset:53256
 v_mfma_f32_16x16x32_bf16 v[40:43], a[148:151], a[76:79], v[40:43]
 buffer_load_dwordx4 v23, s[4:7], s55 offen offset:1024 nt lds
 v_mfma_f32_16x16x32_bf16 v[40:43], a[152:155], a[200:203], v[40:43]
 ds_read_b64_tr_b16 a[140:141], v8 offset:57352
 ds_read_b64_tr_b16 a[142:143], v8 offset:61448
 v_mfma_f32_16x16x32_bf16 v[40:43], a[156:159], a[204:207], v[40:43]
 v_rcp_f32 v28, v28
 v_mfma_f32_16x16x32_bf16 v[60:63], a[144:147], a[80:83], v[60:63]
 v_rcp_f32 v29, v29
 v_mfma_f32_16x16x32_bf16 v[60:63], a[148:151], a[84:87], v[60:63]
 buffer_load_dwordx4 v24, s[4:7], s55 offen offset:2048 nt lds
 v_mfma_f32_16x16x32_bf16 v[60:63], a[152:155], a[208:211], v[60:63]
 v_mul_f32 v30, v30, v28
 v_mul_f32 v31, v31, v29
 v_mfma_f32_16x16x32_bf16 v[60:63], a[156:159], a[212:215], v[60:63]
 v_mul_f32 v28, s64, v194
 v_mul_f32 v29, s64, v195
 v_mfma_f32_16x16x32_bf16 v[44:47], a[144:147], a[88:91], v[44:47]
 v_exp_f32 v28, v28
 v_mfma_f32_16x16x32_bf16 v[44:47], a[148:151], a[92:95], v[44:47]
 buffer_load_dwordx4 v25, s[4:7], s55 offen offset:3072 nt lds
 v_mfma_f32_16x16x32_bf16 v[44:47], a[152:155], a[216:219], v[44:47]
 s_add_u32 s55, s55, 16384
 v_exp_f32 v29, v29
 v_mfma_f32_16x16x32_bf16 v[44:47], a[156:159], a[220:223], v[44:47]
 s_waitcnt lgkmcnt(0)
 v_mul_f32 v32, v194, v210
 v_mul_f32 v33, v195, v211
 v_mfma_f32_16x16x32_bf16 v[64:67], a[128:131], v[96:99], v[64:67]
 s_add_u32 m0, s53, 65536
 ds_read_b64_tr_b16 a[144:145], v17 offset:16384
 ds_read_b64_tr_b16 a[146:147], v17 offset:20480
 v_mfma_f32_16x16x32_bf16 v[64:67], a[132:135], v[80:83], v[64:67]
 buffer_load_dwordx4 v26, s[8:11], s56 offen offset:0 nt lds
 v_mfma_f32_16x16x32_bf16 v[64:67], a[136:139], a[192:195], v[64:67]
 ds_read_b64_tr_b16 a[148:149], v17 offset:24576
 ds_read_b64_tr_b16 a[150:151], v17 offset:28672
 v_mfma_f32_16x16x32_bf16 v[64:67], a[140:143], a[196:199], v[64:67]
 v_add_f32 v28, 1.0, v28
 v_add_f32 v29, 1.0, v29
 v_mfma_f32_16x16x32_bf16 v[48:51], a[128:131], a[72:75], v[48:51]
 ds_read_b64_tr_b16 a[152:153], v9 offset:49152
 ds_read_b64_tr_b16 a[154:155], v9 offset:53248
 v_mfma_f32_16x16x32_bf16 v[48:51], a[132:135], a[76:79], v[48:51]
 buffer_load_dwordx4 v27, s[8:11], s56 offen offset:1024 nt lds
 v_mfma_f32_16x16x32_bf16 v[48:51], a[136:139], a[200:203], v[48:51]
 ds_read_b64_tr_b16 a[156:157], v9 offset:57344
 ds_read_b64_tr_b16 a[158:159], v9 offset:61440
 v_mfma_f32_16x16x32_bf16 v[48:51], a[140:143], a[204:207], v[48:51]
 v_rcp_f32 v28, v28
 v_mfma_f32_16x16x32_bf16 v[68:71], a[128:131], a[80:83], v[68:71]
 v_rcp_f32 v29, v29
 v_mfma_f32_16x16x32_bf16 v[68:71], a[132:135], a[84:87], v[68:71]
 buffer_load_dwordx4 v26, s[8:11], s56 offen offset:2048 nt lds
 v_mfma_f32_16x16x32_bf16 v[68:71], a[136:139], a[208:211], v[68:71]
 v_mul_f32 v32, v32, v28
 v_mul_f32 v33, v33, v29
 v_mfma_f32_16x16x32_bf16 v[68:71], a[140:143], a[212:215], v[68:71]
 v_cvt_pk_bf16_f32 v162, v30, v31
 v_cvt_pk_bf16_f32 v163, v32, v33
 v_mfma_f32_16x16x32_bf16 v[52:55], a[128:131], a[88:91], v[52:55]
 v_mul_f32 v28, s64, v196
 v_mul_f32 v29, s64, v197
 v_mfma_f32_16x16x32_bf16 v[52:55], a[132:135], a[92:95], v[52:55]
 buffer_store_dwordx4 v[160:163], v2, s[24:27], s71 offen offset:3072 sc1
 v_mfma_f32_16x16x32_bf16 v[52:55], a[136:139], a[216:219], v[52:55]
 v_exp_f32 v28, v28
 v_mfma_f32_16x16x32_bf16 v[52:55], a[140:143], a[220:223], v[52:55]
 s_waitcnt lgkmcnt(0)
 v_exp_f32 v29, v29
 v_mfma_f32_16x16x32_bf16 v[88:91], a[144:147], v[96:99], v[88:91]
 ds_read_b64_tr_b16 a[128:129], v17 offset:16392
 ds_read_b64_tr_b16 a[130:131], v17 offset:20488
 v_mfma_f32_16x16x32_bf16 v[88:91], a[148:151], v[80:83], v[88:91]
 buffer_load_dwordx4 v27, s[8:11], s56 offen offset:3072 nt lds
 v_mfma_f32_16x16x32_bf16 v[88:91], a[152:155], a[192:195], v[88:91]
 s_add_u32 s56, s56, 16384
 ds_read_b64_tr_b16 a[132:133], v17 offset:24584
 ds_read_b64_tr_b16 a[134:135], v17 offset:28680
 v_mfma_f32_16x16x32_bf16 v[88:91], a[156:159], a[196:199], v[88:91]
 v_mul_f32 v30, v196, v212
 v_mul_f32 v31, v197, v213
 v_mfma_f32_16x16x32_bf16 v[72:75], a[144:147], a[72:75], v[72:75]
 ds_read_b64_tr_b16 a[136:137], v9 offset:49160
 ds_read_b64_tr_b16 a[138:139], v9 offset:53256
 v_mfma_f32_16x16x32_bf16 v[72:75], a[148:151], a[76:79], v[72:75]
 v_add_f32 v28, 1.0, v28
 v_add_f32 v29, 1.0, v29
 v_mfma_f32_16x16x32_bf16 v[72:75], a[152:155], a[200:203], v[72:75]
 ds_read_b64_tr_b16 a[140:141], v9 offset:57352
 ds_read_b64_tr_b16 a[142:143], v9 offset:61448
 v_mfma_f32_16x16x32_bf16 v[72:75], a[156:159], a[204:207], v[72:75]
 v_rcp_f32 v28, v28
 v_mfma_f32_16x16x32_bf16 v[92:95], a[144:147], a[80:83], v[92:95]
 v_rcp_f32 v29, v29
 v_mfma_f32_16x16x32_bf16 v[92:95], a[148:151], a[84:87], v[92:95]
 v_mul_f32 v30, v30, v28
 v_mul_f32 v31, v31, v29
 v_mfma_f32_16x16x32_bf16 v[92:95], a[152:155], a[208:211], v[92:95]
 v_mul_f32 v28, s64, v198
 v_mul_f32 v29, s64, v199
 v_mfma_f32_16x16x32_bf16 v[92:95], a[156:159], a[212:215], v[92:95]
 v_exp_f32 v28, v28
 v_mfma_f32_16x16x32_bf16 v[76:79], a[144:147], a[88:91], v[76:79]
 v_exp_f32 v29, v29
 v_mfma_f32_16x16x32_bf16 v[76:79], a[148:151], a[92:95], v[76:79]
 v_mul_f32 v32, v198, v214
 v_mul_f32 v33, v199, v215
 v_mfma_f32_16x16x32_bf16 v[76:79], a[152:155], a[216:219], v[76:79]
 v_add_f32 v28, 1.0, v28
 v_add_f32 v29, 1.0, v29
 v_mfma_f32_16x16x32_bf16 v[76:79], a[156:159], a[220:223], v[76:79]
 s_waitcnt lgkmcnt(0)
 v_rcp_f32 v28, v28
 v_mfma_f32_16x16x32_bf16 a[96:99], a[128:131], v[96:99], a[96:99]
 ds_read_b64_tr_b16 a[144:145], v18 offset:16384
 ds_read_b64_tr_b16 a[146:147], v18 offset:20480
 v_mfma_f32_16x16x32_bf16 a[96:99], a[132:135], v[80:83], a[96:99]
 v_rcp_f32 v29, v29
 v_mfma_f32_16x16x32_bf16 a[96:99], a[136:139], a[192:195], a[96:99]
 ds_read_b64_tr_b16 a[148:149], v18 offset:24576
 ds_read_b64_tr_b16 a[150:151], v18 offset:28672
 v_mfma_f32_16x16x32_bf16 a[96:99], a[140:143], a[196:199], a[96:99]
 v_mul_f32 v32, v32, v28
 v_mul_f32 v33, v33, v29
 v_mfma_f32_16x16x32_bf16 a[100:103], a[128:131], a[72:75], a[100:103]
 ds_read_b64_tr_b16 a[152:153], v10 offset:49152
 ds_read_b64_tr_b16 a[154:155], v10 offset:53248
 v_mfma_f32_16x16x32_bf16 a[100:103], a[132:135], a[76:79], a[100:103]
 v_cvt_pk_bf16_f32 v166, v30, v31
 v_cvt_pk_bf16_f32 v167, v32, v33
 v_mfma_f32_16x16x32_bf16 a[100:103], a[136:139], a[200:203], a[100:103]
 ds_read_b64_tr_b16 a[156:157], v10 offset:57344
 ds_read_b64_tr_b16 a[158:159], v10 offset:61440
 v_mfma_f32_16x16x32_bf16 a[100:103], a[140:143], a[204:207], a[100:103]
 buffer_store_dwordx4 v[164:167], v2, s[24:27], s72 offen offset:3072 sc1
 v_mfma_f32_16x16x32_bf16 a[104:107], a[128:131], a[80:83], a[104:107]
 v_mul_f32 v28, s64, v200
 v_mul_f32 v29, s64, v201
 v_mfma_f32_16x16x32_bf16 a[104:107], a[132:135], a[84:87], a[104:107]
 v_exp_f32 v28, v28
 v_mfma_f32_16x16x32_bf16 a[104:107], a[136:139], a[208:211], a[104:107]
 v_exp_f32 v29, v29
 v_mfma_f32_16x16x32_bf16 a[104:107], a[140:143], a[212:215], a[104:107]
 v_mul_f32 v30, v200, v216
 v_mul_f32 v31, v201, v217
 v_mfma_f32_16x16x32_bf16 a[108:111], a[128:131], a[88:91], a[108:111]
 v_add_f32 v28, 1.0, v28
 v_add_f32 v29, 1.0, v29
 v_mfma_f32_16x16x32_bf16 a[108:111], a[132:135], a[92:95], a[108:111]
 v_rcp_f32 v28, v28
 v_mfma_f32_16x16x32_bf16 a[108:111], a[136:139], a[216:219], a[108:111]
 v_rcp_f32 v29, v29
 v_mfma_f32_16x16x32_bf16 a[108:111], a[140:143], a[220:223], a[108:111]
 s_waitcnt lgkmcnt(0)
 v_mul_f32 v30, v30, v28
 v_mul_f32 v31, v31, v29
 v_mfma_f32_16x16x32_bf16 a[112:115], a[144:147], v[96:99], a[112:115]
 ds_read_b64_tr_b16 a[128:129], v18 offset:16392
 ds_read_b64_tr_b16 a[130:131], v18 offset:20488
 v_mfma_f32_16x16x32_bf16 a[112:115], a[148:151], v[80:83], a[112:115]
 v_mul_f32 v28, s64, v202
 v_mul_f32 v29, s64, v203
 v_mfma_f32_16x16x32_bf16 a[112:115], a[152:155], a[192:195], a[112:115]
 ds_read_b64_tr_b16 a[132:133], v18 offset:24584
 ds_read_b64_tr_b16 a[134:135], v18 offset:28680
 v_mfma_f32_16x16x32_bf16 a[112:115], a[156:159], a[196:199], a[112:115]
 v_exp_f32 v28, v28
 v_mfma_f32_16x16x32_bf16 a[116:119], a[144:147], a[72:75], a[116:119]
 ds_read_b64_tr_b16 a[136:137], v10 offset:49160
 ds_read_b64_tr_b16 a[138:139], v10 offset:53256
 v_mfma_f32_16x16x32_bf16 a[116:119], a[148:151], a[76:79], a[116:119]
 v_exp_f32 v29, v29
 v_mfma_f32_16x16x32_bf16 a[116:119], a[152:155], a[200:203], a[116:119]
 ds_read_b64_tr_b16 a[140:141], v10 offset:57352
 ds_read_b64_tr_b16 a[142:143], v10 offset:61448
 v_mfma_f32_16x16x32_bf16 a[116:119], a[156:159], a[204:207], a[116:119]
 v_mul_f32 v32, v202, v218
 v_mul_f32 v33, v203, v219
 v_mfma_f32_16x16x32_bf16 a[120:123], a[144:147], a[80:83], a[120:123]
 v_add_f32 v28, 1.0, v28
 v_add_f32 v29, 1.0, v29
 v_mfma_f32_16x16x32_bf16 a[120:123], a[148:151], a[84:87], a[120:123]
 v_rcp_f32 v28, v28
 v_mfma_f32_16x16x32_bf16 a[120:123], a[152:155], a[208:211], a[120:123]
 v_rcp_f32 v29, v29
 v_mfma_f32_16x16x32_bf16 a[120:123], a[156:159], a[212:215], a[120:123]
 v_mul_f32 v32, v32, v28
 v_mul_f32 v33, v33, v29
 v_mfma_f32_16x16x32_bf16 a[124:127], a[144:147], a[88:91], a[124:127]
 v_cvt_pk_bf16_f32 v170, v30, v31
 v_cvt_pk_bf16_f32 v171, v32, v33
 v_mfma_f32_16x16x32_bf16 a[124:127], a[148:151], a[92:95], a[124:127]
 buffer_store_dwordx4 v[168:171], v2, s[24:27], s73 offen offset:3072 sc1
 v_mfma_f32_16x16x32_bf16 a[124:127], a[152:155], a[216:219], a[124:127]
 v_mul_f32 v28, s64, v204
 v_mul_f32 v29, s64, v205
 v_mfma_f32_16x16x32_bf16 a[124:127], a[156:159], a[220:223], a[124:127]
 s_waitcnt lgkmcnt(0)
 v_exp_f32 v28, v28
 v_mfma_f32_16x16x32_bf16 v[100:103], a[128:131], v[96:99], v[100:103]
 ds_read_b64_tr_b16 a[144:145], v19 offset:16384
 ds_read_b64_tr_b16 a[146:147], v19 offset:20480
 v_mfma_f32_16x16x32_bf16 v[100:103], a[132:135], v[80:83], v[100:103]
 v_exp_f32 v29, v29
 v_mfma_f32_16x16x32_bf16 v[100:103], a[136:139], a[192:195], v[100:103]
 ds_read_b64_tr_b16 a[148:149], v19 offset:24576
 ds_read_b64_tr_b16 a[150:151], v19 offset:28672
 v_mfma_f32_16x16x32_bf16 v[100:103], a[140:143], a[196:199], v[100:103]
 v_mul_f32 v30, v204, v220
 v_mul_f32 v31, v205, v221
 v_mfma_f32_16x16x32_bf16 v[84:87], a[128:131], a[72:75], v[84:87]
 ds_read_b64_tr_b16 a[152:153], v11 offset:49152
 ds_read_b64_tr_b16 a[154:155], v11 offset:53248
 v_mfma_f32_16x16x32_bf16 v[84:87], a[132:135], a[76:79], v[84:87]
 v_add_f32 v28, 1.0, v28
 v_add_f32 v29, 1.0, v29
 v_mfma_f32_16x16x32_bf16 v[84:87], a[136:139], a[200:203], v[84:87]
 ds_read_b64_tr_b16 a[156:157], v11 offset:57344
 ds_read_b64_tr_b16 a[158:159], v11 offset:61440
 v_mfma_f32_16x16x32_bf16 v[84:87], a[140:143], a[204:207], v[84:87]
 v_rcp_f32 v28, v28
 v_mfma_f32_16x16x32_bf16 a[0:3], a[128:131], a[80:83], a[0:3]
 v_rcp_f32 v29, v29
 v_mfma_f32_16x16x32_bf16 a[0:3], a[132:135], a[84:87], a[0:3]
 v_mul_f32 v30, v30, v28
 v_mul_f32 v31, v31, v29
 v_mfma_f32_16x16x32_bf16 a[0:3], a[136:139], a[208:211], a[0:3]
 v_mul_f32 v28, s64, v206
 v_mul_f32 v29, s64, v207
 v_mfma_f32_16x16x32_bf16 a[0:3], a[140:143], a[212:215], a[0:3]
 v_exp_f32 v28, v28
 v_mfma_f32_16x16x32_bf16 a[4:7], a[128:131], a[88:91], a[4:7]
 v_exp_f32 v29, v29
 v_mfma_f32_16x16x32_bf16 a[4:7], a[132:135], a[92:95], a[4:7]
 v_mul_f32 v32, v206, v222
 v_mul_f32 v33, v207, v223
 v_mfma_f32_16x16x32_bf16 a[4:7], a[136:139], a[216:219], a[4:7]
 v_add_f32 v28, 1.0, v28
 v_add_f32 v29, 1.0, v29
 v_mfma_f32_16x16x32_bf16 a[4:7], a[140:143], a[220:223], a[4:7]
 s_waitcnt lgkmcnt(0)
 v_rcp_f32 v28, v28
 v_mfma_f32_16x16x32_bf16 a[8:11], a[144:147], v[96:99], a[8:11]
 ds_read_b64_tr_b16 a[128:129], v19 offset:16392
 ds_read_b64_tr_b16 a[130:131], v19 offset:20488
 v_mfma_f32_16x16x32_bf16 a[8:11], a[148:151], v[80:83], a[8:11]
 v_rcp_f32 v29, v29
 v_mfma_f32_16x16x32_bf16 a[8:11], a[152:155], a[192:195], a[8:11]
 ds_read_b64_tr_b16 a[132:133], v19 offset:24584
 ds_read_b64_tr_b16 a[134:135], v19 offset:28680
 v_mfma_f32_16x16x32_bf16 a[8:11], a[156:159], a[196:199], a[8:11]
 v_mul_f32 v32, v32, v28
 v_mul_f32 v33, v33, v29
 v_mfma_f32_16x16x32_bf16 a[12:15], a[144:147], a[72:75], a[12:15]
 ds_read_b64_tr_b16 a[136:137], v11 offset:49160
 ds_read_b64_tr_b16 a[138:139], v11 offset:53256
 v_mfma_f32_16x16x32_bf16 a[12:15], a[148:151], a[76:79], a[12:15]
 v_cvt_pk_bf16_f32 v174, v30, v31
 v_cvt_pk_bf16_f32 v175, v32, v33
 v_mfma_f32_16x16x32_bf16 a[12:15], a[152:155], a[200:203], a[12:15]
 ds_read_b64_tr_b16 a[140:141], v11 offset:57352
 ds_read_b64_tr_b16 a[142:143], v11 offset:61448
 v_mfma_f32_16x16x32_bf16 a[12:15], a[156:159], a[204:207], a[12:15]
 buffer_store_dwordx4 v[172:175], v2, s[24:27], s74 offen offset:3072 sc1
 v_mfma_f32_16x16x32_bf16 a[16:19], a[144:147], a[80:83], a[16:19]
 v_mul_f32 v28, s64, v224
 v_mul_f32 v29, s64, v225
 v_mfma_f32_16x16x32_bf16 a[16:19], a[148:151], a[84:87], a[16:19]
 v_exp_f32 v28, v28
 v_mfma_f32_16x16x32_bf16 a[16:19], a[152:155], a[208:211], a[16:19]
 v_exp_f32 v29, v29
 v_mfma_f32_16x16x32_bf16 a[16:19], a[156:159], a[212:215], a[16:19]
 v_mul_f32 v30, v224, v240
 v_mul_f32 v31, v225, v241
 v_mfma_f32_16x16x32_bf16 a[20:23], a[144:147], a[88:91], a[20:23]
 v_add_f32 v28, 1.0, v28
 v_add_f32 v29, 1.0, v29
 v_mfma_f32_16x16x32_bf16 a[20:23], a[148:151], a[92:95], a[20:23]
 v_rcp_f32 v28, v28
 v_mfma_f32_16x16x32_bf16 a[20:23], a[152:155], a[216:219], a[20:23]
 v_rcp_f32 v29, v29
 v_mfma_f32_16x16x32_bf16 a[20:23], a[156:159], a[220:223], a[20:23]
 s_waitcnt lgkmcnt(0)
 v_mul_f32 v30, v30, v28
 v_mul_f32 v31, v31, v29
 v_mfma_f32_16x16x32_bf16 a[24:27], a[128:131], v[96:99], a[24:27]
 v_mul_f32 v28, s64, v226
 v_mul_f32 v29, s64, v227
 v_mfma_f32_16x16x32_bf16 a[24:27], a[132:135], v[80:83], a[24:27]
 v_exp_f32 v28, v28
 v_mfma_f32_16x16x32_bf16 a[24:27], a[136:139], a[192:195], a[24:27]
 v_exp_f32 v29, v29
 v_mfma_f32_16x16x32_bf16 a[24:27], a[140:143], a[196:199], a[24:27]
 v_mul_f32 v32, v226, v242
 v_mul_f32 v33, v227, v243
 v_mfma_f32_16x16x32_bf16 a[28:31], a[128:131], a[72:75], a[28:31]
 v_add_f32 v28, 1.0, v28
 v_add_f32 v29, 1.0, v29
 v_mfma_f32_16x16x32_bf16 a[28:31], a[132:135], a[76:79], a[28:31]
 v_rcp_f32 v28, v28
 v_mfma_f32_16x16x32_bf16 a[28:31], a[136:139], a[200:203], a[28:31]
 v_rcp_f32 v29, v29
 v_mfma_f32_16x16x32_bf16 a[28:31], a[140:143], a[204:207], a[28:31]
 v_mul_f32 v32, v32, v28
 v_mul_f32 v33, v33, v29
 v_mfma_f32_16x16x32_bf16 a[32:35], a[128:131], a[80:83], a[32:35]
 v_cvt_pk_bf16_f32 v224, v30, v31
 v_cvt_pk_bf16_f32 v225, v32, v33
 v_mfma_f32_16x16x32_bf16 a[32:35], a[132:135], a[84:87], a[32:35]
 buffer_store_dwordx2 v[224:225], v2, s[24:27], s75 offen sc1
 v_mfma_f32_16x16x32_bf16 a[32:35], a[136:139], a[208:211], a[32:35]
 v_mul_f32 v28, s64, v228
 v_mul_f32 v29, s64, v229
 v_mfma_f32_16x16x32_bf16 a[32:35], a[140:143], a[212:215], a[32:35]
 v_exp_f32 v28, v28
 v_mfma_f32_16x16x32_bf16 a[36:39], a[128:131], a[88:91], a[36:39]
 v_exp_f32 v29, v29
 v_mfma_f32_16x16x32_bf16 a[36:39], a[132:135], a[92:95], a[36:39]
 v_mul_f32 v30, v228, v244
 v_mul_f32 v31, v229, v245
 v_mfma_f32_16x16x32_bf16 a[36:39], a[136:139], a[216:219], a[36:39]
 v_add_f32 v28, 1.0, v28
 v_add_f32 v29, 1.0, v29
 v_mfma_f32_16x16x32_bf16 a[36:39], a[140:143], a[220:223], a[36:39]
 v_rcp_f32 v28, v28
 v_and_b32 v34, 15, v3
 v_lshrrev_b32 v35, 4, v3
 v_xor_b32 v36, v34, v35
 v_lshlrev_b32 v36, 4, v36
 v_lshl_add_u32 v4, v34, 8, v36
 v_xor_b32 v5, 64, v4
 v_xor_b32 v6, 128, v4
 v_xor_b32 v7, 192, v4
 s_barrier
 ds_read_b128 a[128:131], v4 offset:0
 ds_read_b128 a[132:135], v5 offset:0
 ds_read_b128 a[136:139], v6 offset:0
 ds_read_b128 a[140:143], v7 offset:0
 ds_read_b128 a[144:147], v4 offset:4096
 ds_read_b128 a[148:151], v5 offset:4096
 ds_read_b128 a[152:155], v6 offset:4096
 ds_read_b128 a[156:159], v7 offset:4096
 ds_read_b128 a[160:163], v4 offset:8192
 ds_read_b128 a[164:167], v5 offset:8192
 ds_read_b128 a[168:171], v6 offset:8192
 ds_read_b128 a[172:175], v7 offset:8192
 ds_read_b128 a[176:179], v4 offset:12288
 ds_read_b128 a[180:183], v5 offset:12288
 ds_read_b128 a[184:187], v6 offset:12288
 ds_read_b128 a[188:191], v7 offset:12288
 v_rcp_f32 v29, v29
 v_mul_f32 v30, v30, v28
 v_mul_f32 v31, v31, v29
 v_mul_f32 v28, s64, v230
 v_mul_f32 v29, s64, v231
 v_exp_f32 v28, v28
 v_exp_f32 v29, v29
 v_mul_f32 v32, v230, v246
 v_mul_f32 v33, v231, v247
 v_add_f32 v28, 1.0, v28
 v_add_f32 v29, 1.0, v29
 v_rcp_f32 v28, v28
 v_rcp_f32 v29, v29
 v_mul_f32 v32, v32, v28
 v_mul_f32 v33, v33, v29
 v_cvt_pk_bf16_f32 v228, v30, v31
 v_cvt_pk_bf16_f32 v229, v32, v33
 buffer_store_dwordx2 v[228:229], v2, s[24:27], s76 offen sc1
 v_mul_f32 v28, s64, v232
 v_mul_f32 v29, s64, v233
 v_exp_f32 v28, v28
 v_exp_f32 v29, v29
 v_mul_f32 v30, v232, v248
 v_mul_f32 v31, v233, v249
 v_add_f32 v28, 1.0, v28
 v_add_f32 v29, 1.0, v29
 v_rcp_f32 v28, v28
 v_rcp_f32 v29, v29
 v_mul_f32 v30, v30, v28
 v_mul_f32 v31, v31, v29
 v_mul_f32 v28, s64, v234
 v_mul_f32 v29, s64, v235
 v_exp_f32 v28, v28
 v_exp_f32 v29, v29
 v_mul_f32 v32, v234, v250
 v_mul_f32 v33, v235, v251
 v_add_f32 v28, 1.0, v28
 v_add_f32 v29, 1.0, v29
 v_rcp_f32 v28, v28
 v_rcp_f32 v29, v29
 v_mul_f32 v32, v32, v28
 v_mul_f32 v33, v33, v29
 v_cvt_pk_bf16_f32 v232, v30, v31
 v_cvt_pk_bf16_f32 v233, v32, v33
 buffer_store_dwordx2 v[232:233], v2, s[24:27], s77 offen sc1
 v_mul_f32 v28, s64, v236
 v_mul_f32 v29, s64, v237
 v_exp_f32 v28, v28
 v_exp_f32 v29, v29
 v_mul_f32 v30, v236, v252
 v_mul_f32 v31, v237, v253
 v_add_f32 v28, 1.0, v28
 v_add_f32 v29, 1.0, v29
 v_rcp_f32 v28, v28
 v_rcp_f32 v29, v29
 v_mul_f32 v30, v30, v28
 v_mul_f32 v31, v31, v29
 v_mul_f32 v28, s64, v238
 v_mul_f32 v29, s64, v239
 v_exp_f32 v28, v28
 v_exp_f32 v29, v29
 v_mul_f32 v32, v238, v254
 v_mul_f32 v33, v239, v255
 v_add_f32 v28, 1.0, v28
 v_add_f32 v29, 1.0, v29
 v_rcp_f32 v28, v28
 v_rcp_f32 v29, v29
 v_mul_f32 v32, v32, v28
 v_mul_f32 v33, v33, v29
 v_cvt_pk_bf16_f32 v236, v30, v31
 v_cvt_pk_bf16_f32 v237, v32, v33
 buffer_store_dwordx2 v[236:237], v2, s[24:27], s78 offen sc1
 v_mul_f32 v28, s63, v56
 v_mul_f32 v29, s63, v57
 v_mul_f32 v30, s63, v58
 v_mul_f32 v31, s63, v59
 v_cvt_pk_bf16_f32 v184, v28, v29
 v_cvt_pk_bf16_f32 v185, v30, v31
 v_mul_f32 v28, s63, v64
 v_mul_f32 v29, s63, v65
 v_mul_f32 v30, s63, v66
 v_mul_f32 v31, s63, v67
 v_cvt_pk_bf16_f32 v186, v28, v29
 v_cvt_pk_bf16_f32 v187, v30, v31
 v_mul_f32 v28, s63, v40
 v_mul_f32 v29, s63, v41
 v_mul_f32 v30, s63, v42
 v_mul_f32 v31, s63, v43
 v_cvt_pk_bf16_f32 v200, v28, v29
 v_cvt_pk_bf16_f32 v201, v30, v31
 v_mul_f32 v28, s63, v48
 v_mul_f32 v29, s63, v49
 v_mul_f32 v30, s63, v50
 v_mul_f32 v31, s63, v51
 v_cvt_pk_bf16_f32 v202, v28, v29
 v_cvt_pk_bf16_f32 v203, v30, v31
 v_mul_f32 v28, s63, v60
 v_mul_f32 v29, s63, v61
 v_mul_f32 v30, s63, v62
 v_mul_f32 v31, s63, v63
 v_cvt_pk_bf16_f32 v216, v28, v29
 v_cvt_pk_bf16_f32 v217, v30, v31
 v_mul_f32 v28, s63, v68
 v_mul_f32 v29, s63, v69
 v_mul_f32 v30, s63, v70
 v_mul_f32 v31, s63, v71
 v_cvt_pk_bf16_f32 v218, v28, v29
 v_cvt_pk_bf16_f32 v219, v30, v31
 v_mul_f32 v28, s63, v44
 v_mul_f32 v29, s63, v45
 v_mul_f32 v30, s63, v46
 v_mul_f32 v31, s63, v47
 v_cvt_pk_bf16_f32 v232, v28, v29
 v_cvt_pk_bf16_f32 v233, v30, v31
 v_mul_f32 v28, s63, v52
 v_mul_f32 v29, s63, v53
 v_mul_f32 v30, s63, v54
 v_mul_f32 v31, s63, v55
 v_cvt_pk_bf16_f32 v234, v28, v29
 v_cvt_pk_bf16_f32 v235, v30, v31
 v_mul_f32 v28, s63, v88
 v_mul_f32 v29, s63, v89
 v_mul_f32 v30, s63, v90
 v_mul_f32 v31, s63, v91
 v_cvt_pk_bf16_f32 v188, v28, v29
 v_cvt_pk_bf16_f32 v189, v30, v31
 v_accvgpr_read_b32 v28, a96
 v_accvgpr_read_b32 v29, a97
 v_accvgpr_read_b32 v30, a98
 v_accvgpr_read_b32 v31, a99
 v_mul_f32 v28, s63, v28
 v_mul_f32 v29, s63, v29
 v_mul_f32 v30, s63, v30
 v_mul_f32 v31, s63, v31
 v_cvt_pk_bf16_f32 v190, v28, v29
 v_cvt_pk_bf16_f32 v191, v30, v31
 v_mul_f32 v28, s63, v72
 v_mul_f32 v29, s63, v73
 v_mul_f32 v30, s63, v74
 v_mul_f32 v31, s63, v75
 v_cvt_pk_bf16_f32 v204, v28, v29
 v_cvt_pk_bf16_f32 v205, v30, v31
 v_accvgpr_read_b32 v28, a100
 v_accvgpr_read_b32 v29, a101
 v_accvgpr_read_b32 v30, a102
 v_accvgpr_read_b32 v31, a103
 v_mul_f32 v28, s63, v28
 v_mul_f32 v29, s63, v29
 v_mul_f32 v30, s63, v30
 v_mul_f32 v31, s63, v31
 v_cvt_pk_bf16_f32 v206, v28, v29
 v_cvt_pk_bf16_f32 v207, v30, v31
 v_mul_f32 v28, s63, v92
 v_mul_f32 v29, s63, v93
 v_mul_f32 v30, s63, v94
 v_mul_f32 v31, s63, v95
 v_cvt_pk_bf16_f32 v220, v28, v29
 v_cvt_pk_bf16_f32 v221, v30, v31
 v_accvgpr_read_b32 v28, a104
 v_accvgpr_read_b32 v29, a105
 v_accvgpr_read_b32 v30, a106
 v_accvgpr_read_b32 v31, a107
 v_mul_f32 v28, s63, v28
 v_mul_f32 v29, s63, v29
 v_mul_f32 v30, s63, v30
 v_mul_f32 v31, s63, v31
 v_cvt_pk_bf16_f32 v222, v28, v29
 v_cvt_pk_bf16_f32 v223, v30, v31
 v_mul_f32 v28, s63, v76
 v_mul_f32 v29, s63, v77
 v_mul_f32 v30, s63, v78
 v_mul_f32 v31, s63, v79
 v_cvt_pk_bf16_f32 v236, v28, v29
 v_cvt_pk_bf16_f32 v237, v30, v31
 v_accvgpr_read_b32 v28, a108
 v_accvgpr_read_b32 v29, a109
 v_accvgpr_read_b32 v30, a110
 v_accvgpr_read_b32 v31, a111
 v_mul_f32 v28, s63, v28
 v_mul_f32 v29, s63, v29
 v_mul_f32 v30, s63, v30
 v_mul_f32 v31, s63, v31
 v_cvt_pk_bf16_f32 v238, v28, v29
 v_cvt_pk_bf16_f32 v239, v30, v31
 v_accvgpr_read_b32 v28, a112
 v_accvgpr_read_b32 v29, a113
 v_accvgpr_read_b32 v30, a114
 v_accvgpr_read_b32 v31, a115
 v_mul_f32 v28, s63, v28
 v_mul_f32 v29, s63, v29
 v_mul_f32 v30, s63, v30
 v_mul_f32 v31, s63, v31
 v_cvt_pk_bf16_f32 v192, v28, v29
 v_cvt_pk_bf16_f32 v193, v30, v31
 v_mul_f32 v28, s63, v100
 v_mul_f32 v29, s63, v101
 v_mul_f32 v30, s63, v102
 v_mul_f32 v31, s63, v103
 v_cvt_pk_bf16_f32 v194, v28, v29
 v_cvt_pk_bf16_f32 v195, v30, v31
 v_accvgpr_read_b32 v28, a116
 v_accvgpr_read_b32 v29, a117
 v_accvgpr_read_b32 v30, a118
 v_accvgpr_read_b32 v31, a119
 v_mul_f32 v28, s63, v28
 v_mul_f32 v29, s63, v29
 v_mul_f32 v30, s63, v30
 v_mul_f32 v31, s63, v31
 v_cvt_pk_bf16_f32 v208, v28, v29
 v_cvt_pk_bf16_f32 v209, v30, v31
 v_mul_f32 v28, s63, v84
 v_mul_f32 v29, s63, v85
 v_mul_f32 v30, s63, v86
 v_mul_f32 v31, s63, v87
 v_cvt_pk_bf16_f32 v210, v28, v29
 v_cvt_pk_bf16_f32 v211, v30, v31
 v_accvgpr_read_b32 v28, a120
 v_accvgpr_read_b32 v29, a121
 v_accvgpr_read_b32 v30, a122
 v_accvgpr_read_b32 v31, a123
 v_mul_f32 v28, s63, v28
 v_mul_f32 v29, s63, v29
 v_mul_f32 v30, s63, v30
 v_mul_f32 v31, s63, v31
 v_cvt_pk_bf16_f32 v224, v28, v29
 v_cvt_pk_bf16_f32 v225, v30, v31
 v_accvgpr_read_b32 v28, a0
 v_accvgpr_read_b32 v29, a1
 v_accvgpr_read_b32 v30, a2
 v_accvgpr_read_b32 v31, a3
 v_mul_f32 v28, s63, v28
 v_mul_f32 v29, s63, v29
 v_mul_f32 v30, s63, v30
 v_mul_f32 v31, s63, v31
 v_cvt_pk_bf16_f32 v226, v28, v29
 v_cvt_pk_bf16_f32 v227, v30, v31
 v_accvgpr_read_b32 v28, a124
 v_accvgpr_read_b32 v29, a125
 v_accvgpr_read_b32 v30, a126
 v_accvgpr_read_b32 v31, a127
 v_mul_f32 v28, s63, v28
 v_mul_f32 v29, s63, v29
 v_mul_f32 v30, s63, v30
 v_mul_f32 v31, s63, v31
 v_cvt_pk_bf16_f32 v240, v28, v29
 v_cvt_pk_bf16_f32 v241, v30, v31
 v_accvgpr_read_b32 v28, a4
 v_accvgpr_read_b32 v29, a5
 v_accvgpr_read_b32 v30, a6
 v_accvgpr_read_b32 v31, a7
 v_mul_f32 v28, s63, v28
 v_mul_f32 v29, s63, v29
 v_mul_f32 v30, s63, v30
 v_mul_f32 v31, s63, v31
 v_cvt_pk_bf16_f32 v242, v28, v29
 v_cvt_pk_bf16_f32 v243, v30, v31
 v_accvgpr_read_b32 v28, a8
 v_accvgpr_read_b32 v29, a9
 v_accvgpr_read_b32 v30, a10
 v_accvgpr_read_b32 v31, a11
 v_mul_f32 v28, s63, v28
 v_mul_f32 v29, s63, v29
 v_mul_f32 v30, s63, v30
 v_mul_f32 v31, s63, v31
 v_cvt_pk_bf16_f32 v196, v28, v29
 v_cvt_pk_bf16_f32 v197, v30, v31
 v_accvgpr_read_b32 v28, a24
 v_accvgpr_read_b32 v29, a25
 v_accvgpr_read_b32 v30, a26
 v_accvgpr_read_b32 v31, a27
 v_mul_f32 v28, s63, v28
 v_mul_f32 v29, s63, v29
 v_mul_f32 v30, s63, v30
 v_mul_f32 v31, s63, v31
 v_cvt_pk_bf16_f32 v198, v28, v29
 v_cvt_pk_bf16_f32 v199, v30, v31
 v_accvgpr_read_b32 v28, a12
 v_accvgpr_read_b32 v29, a13
 v_accvgpr_read_b32 v30, a14
 v_accvgpr_read_b32 v31, a15
 v_mul_f32 v28, s63, v28
 v_mul_f32 v29, s63, v29
 v_mul_f32 v30, s63, v30
 v_mul_f32 v31, s63, v31
 v_cvt_pk_bf16_f32 v212, v28, v29
 v_cvt_pk_bf16_f32 v213, v30, v31
 v_accvgpr_read_b32 v28, a28
 v_accvgpr_read_b32 v29, a29
 v_accvgpr_read_b32 v30, a30
 v_accvgpr_read_b32 v31, a31
 v_mul_f32 v28, s63, v28
 v_mul_f32 v29, s63, v29
 v_mul_f32 v30, s63, v30
 v_mul_f32 v31, s63, v31
 v_cvt_pk_bf16_f32 v214, v28, v29
 v_cvt_pk_bf16_f32 v215, v30, v31
 v_accvgpr_read_b32 v28, a16
 v_accvgpr_read_b32 v29, a17
 v_accvgpr_read_b32 v30, a18
 v_accvgpr_read_b32 v31, a19
 v_mul_f32 v28, s63, v28
 v_mul_f32 v29, s63, v29
 v_mul_f32 v30, s63, v30
 v_mul_f32 v31, s63, v31
 v_cvt_pk_bf16_f32 v228, v28, v29
 v_cvt_pk_bf16_f32 v229, v30, v31
 v_accvgpr_read_b32 v28, a32
 v_accvgpr_read_b32 v29, a33
 v_accvgpr_read_b32 v30, a34
 v_accvgpr_read_b32 v31, a35
 v_mul_f32 v28, s63, v28
 v_mul_f32 v29, s63, v29
 v_mul_f32 v30, s63, v30
 v_mul_f32 v31, s63, v31
 v_cvt_pk_bf16_f32 v230, v28, v29
 v_cvt_pk_bf16_f32 v231, v30, v31
 v_accvgpr_read_b32 v28, a20
 v_accvgpr_read_b32 v29, a21
 v_accvgpr_read_b32 v30, a22
 v_accvgpr_read_b32 v31, a23
 v_mul_f32 v28, s63, v28
 v_mul_f32 v29, s63, v29
 v_mul_f32 v30, s63, v30
 v_mul_f32 v31, s63, v31
 v_cvt_pk_bf16_f32 v244, v28, v29
 v_cvt_pk_bf16_f32 v245, v30, v31
 v_accvgpr_read_b32 v28, a36
 v_accvgpr_read_b32 v29, a37
 v_accvgpr_read_b32 v30, a38
 v_accvgpr_read_b32 v31, a39
 v_mul_f32 v28, s63, v28
 v_mul_f32 v29, s63, v29
 v_mul_f32 v30, s63, v30
 v_mul_f32 v31, s63, v31
 v_cvt_pk_bf16_f32 v246, v28, v29
 v_cvt_pk_bf16_f32 v247, v30, v31
 s_waitcnt lgkmcnt(15)
 v_mfma_f32_16x16x32_bf16 v[56:59], a[128:131], v[184:187], 0
 s_add_u32 m0, s53, 49152
 v_accvgpr_write_b32 a0, 0
 v_accvgpr_write_b32 a1, 0
 s_waitcnt lgkmcnt(14)
 v_mfma_f32_16x16x32_bf16 v[56:59], a[132:135], v[188:191], v[56:59]
 buffer_load_dwordx4 v22, s[4:7], s55 offen offset:0 nt lds
 s_waitcnt lgkmcnt(13)
 v_mfma_f32_16x16x32_bf16 v[56:59], a[136:139], v[192:195], v[56:59]
 v_accvgpr_write_b32 a2, 0
 v_accvgpr_write_b32 a3, 0
 s_waitcnt lgkmcnt(12)
 v_mfma_f32_16x16x32_bf16 v[56:59], a[140:143], v[196:199], v[56:59]
 v_accvgpr_write_b32 a4, 0
 v_accvgpr_write_b32 a5, 0
 v_mfma_f32_16x16x32_bf16 v[60:63], a[128:131], v[200:203], 0
 v_accvgpr_write_b32 a6, 0
 v_accvgpr_write_b32 a7, 0
 v_mfma_f32_16x16x32_bf16 v[60:63], a[132:135], v[204:207], v[60:63]
 buffer_load_dwordx4 v23, s[4:7], s55 offen offset:1024 nt lds
 v_mfma_f32_16x16x32_bf16 v[60:63], a[136:139], v[208:211], v[60:63]
 v_accvgpr_write_b32 a8, 0
 v_accvgpr_write_b32 a9, 0
 v_mfma_f32_16x16x32_bf16 v[60:63], a[140:143], v[212:215], v[60:63]
 v_accvgpr_write_b32 a10, 0
 v_accvgpr_write_b32 a11, 0
 v_mfma_f32_16x16x32_bf16 v[64:67], a[128:131], v[216:219], 0
 v_accvgpr_write_b32 a12, 0
 v_accvgpr_write_b32 a13, 0
 v_mfma_f32_16x16x32_bf16 v[64:67], a[132:135], v[220:223], v[64:67]
 buffer_load_dwordx4 v24, s[4:7], s55 offen offset:2048 nt lds
 v_mfma_f32_16x16x32_bf16 v[64:67], a[136:139], v[224:227], v[64:67]
 v_accvgpr_write_b32 a14, 0
 v_accvgpr_write_b32 a15, 0
 v_mfma_f32_16x16x32_bf16 v[64:67], a[140:143], v[228:231], v[64:67]
 v_accvgpr_write_b32 a16, 0
 v_accvgpr_write_b32 a17, 0
 v_mfma_f32_16x16x32_bf16 v[68:71], a[128:131], v[232:235], 0
 v_accvgpr_write_b32 a18, 0
 v_accvgpr_write_b32 a19, 0
 v_mfma_f32_16x16x32_bf16 v[68:71], a[132:135], v[236:239], v[68:71]
 buffer_load_dwordx4 v25, s[4:7], s55 offen offset:3072 nt lds
 v_mfma_f32_16x16x32_bf16 v[68:71], a[136:139], v[240:243], v[68:71]
 s_add_u32 s55, s55, 16384
 v_accvgpr_write_b32 a20, 0
 v_accvgpr_write_b32 a21, 0
 v_mfma_f32_16x16x32_bf16 v[68:71], a[140:143], v[244:247], v[68:71]
 s_mul_i32 s80, s52, 288
 v_accvgpr_write_b32 a22, 0
 v_accvgpr_write_b32 a23, 0
 s_waitcnt lgkmcnt(11)
 v_mfma_f32_16x16x32_bf16 v[72:75], a[144:147], v[184:187], 0
 s_lshl_b32 s79, s69, 6
 v_accvgpr_write_b32 a24, 0
 v_accvgpr_write_b32 a25, 0
 s_waitcnt lgkmcnt(10)
 v_mfma_f32_16x16x32_bf16 v[72:75], a[148:151], v[188:191], v[72:75]
 s_add_u32 s79, s79, s70
 v_accvgpr_write_b32 a26, 0
 v_accvgpr_write_b32 a27, 0
 s_waitcnt lgkmcnt(9)
 v_mfma_f32_16x16x32_bf16 v[72:75], a[152:155], v[192:195], v[72:75]
 s_mul_i32 s81, s79, 20736
 v_accvgpr_write_b32 a28, 0
 v_accvgpr_write_b32 a29, 0
 s_waitcnt lgkmcnt(8)
 v_mfma_f32_16x16x32_bf16 v[72:75], a[156:159], v[196:199], v[72:75]
 s_add_u32 s81, s81, s80
 v_accvgpr_write_b32 a30, 0
 v_accvgpr_write_b32 a31, 0
 v_mfma_f32_16x16x32_bf16 v[76:79], a[144:147], v[200:203], 0
 s_add_u32 s36, s96, s81
 v_accvgpr_write_b32 a32, 0
 v_accvgpr_write_b32 a33, 0
 v_mfma_f32_16x16x32_bf16 v[76:79], a[148:151], v[204:207], v[76:79]
 s_addc_u32 s37, s97, 0
 v_accvgpr_write_b32 a34, 0
 v_accvgpr_write_b32 a35, 0
 v_mfma_f32_16x16x32_bf16 v[76:79], a[152:155], v[208:211], v[76:79]
 s_mov_b32 s38, 0x4da0
 v_accvgpr_write_b32 a36, 0
 v_accvgpr_write_b32 a37, 0
 v_mfma_f32_16x16x32_bf16 v[76:79], a[156:159], v[212:215], v[76:79]
 s_mov_b32 s39, 0x00020000
 v_accvgpr_write_b32 a38, 0
 v_accvgpr_write_b32 a39, 0
 v_mfma_f32_16x16x32_bf16 v[80:83], a[144:147], v[216:219], 0
 s_and_b32 s86, s69, 1
 v_accvgpr_write_b32 a40, 0
 v_accvgpr_write_b32 a41, 0
 v_mfma_f32_16x16x32_bf16 v[80:83], a[148:151], v[220:223], v[80:83]
 s_lshl_b32 s85, s69, 3
 v_accvgpr_write_b32 a42, 0
 v_accvgpr_write_b32 a43, 0
 v_mfma_f32_16x16x32_bf16 v[80:83], a[152:155], v[224:227], v[80:83]
 s_lshl_b32 s82, s86, 1
 v_accvgpr_write_b32 a44, 0
 v_accvgpr_write_b32 a45, 0
 v_mfma_f32_16x16x32_bf16 v[80:83], a[156:159], v[228:231], v[80:83]
 s_add_u32 s85, s85, s82
 v_accvgpr_write_b32 a46, 0
 v_accvgpr_write_b32 a47, 0
 v_mfma_f32_16x16x32_bf16 v[84:87], a[144:147], v[232:235], 0
 s_lshl_b32 s86, s86, 3
 v_accvgpr_write_b32 a48, 0
 v_accvgpr_write_b32 a49, 0
 v_mfma_f32_16x16x32_bf16 v[84:87], a[148:151], v[236:239], v[84:87]
 s_sub_u32 s86, 20, s86
 v_accvgpr_write_b32 a50, 0
 v_accvgpr_write_b32 a51, 0
 v_mfma_f32_16x16x32_bf16 v[84:87], a[152:155], v[240:243], v[84:87]
 s_mul_i32 s88, s86, s70
 v_accvgpr_write_b32 a52, 0
 v_accvgpr_write_b32 a53, 0
 v_mfma_f32_16x16x32_bf16 v[84:87], a[156:159], v[244:247], v[84:87]
 s_lshl_b32 s81, s85, 7
 v_accvgpr_write_b32 a54, 0
 v_accvgpr_write_b32 a55, 0
 s_waitcnt lgkmcnt(7)
 v_mfma_f32_16x16x32_bf16 v[88:91], a[160:163], v[184:187], 0
 s_add_u32 s81, s81, s88
 v_accvgpr_write_b32 a56, 0
 v_accvgpr_write_b32 a57, 0
 s_waitcnt lgkmcnt(6)
 v_mfma_f32_16x16x32_bf16 v[88:91], a[164:167], v[188:191], v[88:91]
 s_mul_i32 s81, s81, 1152
 v_accvgpr_write_b32 a58, 0
 v_accvgpr_write_b32 a59, 0
 s_waitcnt lgkmcnt(5)
 v_mfma_f32_16x16x32_bf16 v[88:91], a[168:171], v[192:195], v[88:91]
 s_add_u32 s81, s81, s80
 v_accvgpr_write_b32 a60, 0
 v_accvgpr_write_b32 a61, 0
 s_waitcnt lgkmcnt(4)
 v_mfma_f32_16x16x32_bf16 v[88:91], a[172:175], v[196:199], v[88:91]
 s_mul_i32 s82, s86, 1152
 v_accvgpr_write_b32 a62, 0
 v_accvgpr_write_b32 a63, 0
 v_mfma_f32_16x16x32_bf16 v[92:95], a[160:163], v[200:203], 0
 s_sub_u32 s82, s82, 864
 v_accvgpr_write_b32 a64, 0
 v_accvgpr_write_b32 a65, 0
 v_mfma_f32_16x16x32_bf16 v[92:95], a[164:167], v[204:207], v[92:95]
 s_add_u32 s40, s94, s81
 v_accvgpr_write_b32 a66, 0
 v_accvgpr_write_b32 a67, 0
 v_mfma_f32_16x16x32_bf16 v[92:95], a[168:171], v[208:211], v[92:95]
 s_addc_u32 s41, s95, 0
 v_accvgpr_write_b32 a68, 0
 v_accvgpr_write_b32 a69, 0
 v_mfma_f32_16x16x32_bf16 v[92:95], a[172:175], v[212:215], v[92:95]
 s_mov_b32 s42, s82
 v_accvgpr_write_b32 a70, 0
 v_accvgpr_write_b32 a71, 0
 v_mfma_f32_16x16x32_bf16 v[96:99], a[160:163], v[216:219], 0
 s_mov_b32 s43, 0x00020000
 v_accvgpr_write_b32 a72, 0
 v_accvgpr_write_b32 a73, 0
 v_mfma_f32_16x16x32_bf16 v[96:99], a[164:167], v[220:223], v[96:99]
 s_lshl_b32 s79, s69, 2
 v_accvgpr_write_b32 a74, 0
 v_accvgpr_write_b32 a75, 0
 v_mfma_f32_16x16x32_bf16 v[96:99], a[168:171], v[224:227], v[96:99]
 s_add_u32 s80, s79, s52
 v_accvgpr_write_b32 a76, 0
 v_accvgpr_write_b32 a77, 0
 v_mfma_f32_16x16x32_bf16 v[96:99], a[172:175], v[228:231], v[96:99]
 s_mul_i32 s80, s80, 700416
 v_accvgpr_write_b32 a78, 0
 v_accvgpr_write_b32 a79, 0
 v_mfma_f32_16x16x32_bf16 v[100:103], a[160:163], v[232:235], 0
 s_add_u32 s80, s80, 0x6000000
 v_accvgpr_write_b32 a80, 0
 v_accvgpr_write_b32 a81, 0
 v_mfma_f32_16x16x32_bf16 v[100:103], a[164:167], v[236:239], v[100:103]
 s_mul_i32 s81, s70, 5184
 v_accvgpr_write_b32 a82, 0
 v_accvgpr_write_b32 a83, 0
 v_mfma_f32_16x16x32_bf16 v[100:103], a[168:171], v[240:243], v[100:103]
 s_add_u32 s81, s81, s80
 v_accvgpr_write_b32 a84, 0
 v_accvgpr_write_b32 a85, 0
 v_mfma_f32_16x16x32_bf16 v[100:103], a[172:175], v[244:247], v[100:103]
 s_add_u32 s44, s100, s81
 v_accvgpr_write_b32 a86, 0
 v_accvgpr_write_b32 a87, 0
 s_waitcnt lgkmcnt(3)
 v_mfma_f32_16x16x32_bf16 v[104:107], a[176:179], v[184:187], 0
 s_addc_u32 s45, s101, 0
 v_accvgpr_write_b32 a88, 0
 v_accvgpr_write_b32 a89, 0
 s_waitcnt lgkmcnt(2)
 v_mfma_f32_16x16x32_bf16 v[104:107], a[180:183], v[188:191], v[104:107]
 s_mov_b32 s46, 0x1440
 v_accvgpr_write_b32 a90, 0
 v_accvgpr_write_b32 a91, 0
 s_waitcnt lgkmcnt(1)
 v_mfma_f32_16x16x32_bf16 v[104:107], a[184:187], v[192:195], v[104:107]
 s_mov_b32 s47, 0x00020000
 v_accvgpr_write_b32 a92, 0
 v_accvgpr_write_b32 a93, 0
 s_waitcnt lgkmcnt(0)
 v_mfma_f32_16x16x32_bf16 v[104:107], a[188:191], v[196:199], v[104:107]
 s_mul_i32 s81, s88, 288
 v_accvgpr_write_b32 a94, 0
 v_accvgpr_write_b32 a95, 0
 v_mfma_f32_16x16x32_bf16 v[108:111], a[176:179], v[200:203], 0
 s_add_u32 s81, s81, s80
 v_accvgpr_write_b32 a96, 0
 v_accvgpr_write_b32 a97, 0
 v_mfma_f32_16x16x32_bf16 v[108:111], a[180:183], v[204:207], v[108:111]
 s_add_u32 s81, s81, 331776
 v_accvgpr_write_b32 a98, 0
 v_accvgpr_write_b32 a99, 0
 v_mfma_f32_16x16x32_bf16 v[108:111], a[184:187], v[208:211], v[108:111]
 s_mul_i32 s82, s86, 288
 v_accvgpr_write_b32 a100, 0
 v_accvgpr_write_b32 a101, 0
 v_mfma_f32_16x16x32_bf16 v[108:111], a[188:191], v[212:215], v[108:111]
 s_add_u32 s48, s100, s81
 v_accvgpr_write_b32 a102, 0
 v_accvgpr_write_b32 a103, 0
 v_mfma_f32_16x16x32_bf16 v[112:115], a[176:179], v[216:219], 0
 s_addc_u32 s49, s101, 0
 v_accvgpr_write_b32 a104, 0
 v_accvgpr_write_b32 a105, 0
 v_mfma_f32_16x16x32_bf16 v[112:115], a[180:183], v[220:223], v[112:115]
 s_mov_b32 s50, s82
 v_accvgpr_write_b32 a106, 0
 v_accvgpr_write_b32 a107, 0
 v_mfma_f32_16x16x32_bf16 v[112:115], a[184:187], v[224:227], v[112:115]
 s_mov_b32 s51, 0x00020000
 v_accvgpr_write_b32 a108, 0
 v_accvgpr_write_b32 a109, 0
 v_mfma_f32_16x16x32_bf16 v[112:115], a[188:191], v[228:231], v[112:115]
 s_mov_b32 s68, 0
 v_accvgpr_write_b32 a110, 0
 v_accvgpr_write_b32 a111, 0
 v_mfma_f32_16x16x32_bf16 v[116:119], a[176:179], v[232:235], 0
 s_and_b32 s69, s2, 3
 v_accvgpr_write_b32 a112, 0
 v_accvgpr_write_b32 a113, 0
 v_mfma_f32_16x16x32_bf16 v[116:119], a[180:183], v[236:239], v[116:119]
 s_and_b32 s79, s2, 4
 v_accvgpr_write_b32 a114, 0
 v_accvgpr_write_b32 a115, 0
 v_mfma_f32_16x16x32_bf16 v[116:119], a[184:187], v[240:243], v[116:119]
 s_lshr_b32 s80, s2, 6
 v_accvgpr_write_b32 a116, 0
 v_accvgpr_write_b32 a117, 0
 v_mfma_f32_16x16x32_bf16 v[116:119], a[188:191], v[244:247], v[116:119]
 s_add_u32 s79, s79, s80
 v_accvgpr_write_b32 a118, 0
 v_accvgpr_write_b32 a119, 0
 s_lshl_b32 s79, s79, 3
 s_bfe_u32 s80, s2, 0x30003
 s_add_u32 s70, s79, s80
 s_lshl_b32 s66, s69, 13
 s_and_b32 s82, s69, 1
 s_lshl_b32 s82, s82, 1
 s_lshl_b32 s85, s69, 3
 s_add_u32 s85, s85, s82
 s_lshl_b32 s79, s69, 2
 s_and_b32 s80, s70, 3
 s_add_u32 s80, s79, s80
 s_mul_i32 s80, s80, 700416
 s_add_u32 s80, s80, s60
 s_add_u32 s80, s80, 0x6000000
 s_add_u32 s12, s100, s80
 s_addc_u32 s13, s101, 0
 s_mov_b32 s14, 0xa4400
 s_mov_b32 s15, 0x00020000
 s_lshr_b32 s83, s70, 2
 s_lshl_b32 s84, s83, 2
 s_add_u32 s84, s84, s52
 s_mul_i32 s81, s84, 297472
 s_mul_i32 s82, s69, 36864
 s_add_u32 s81, s81, s82
 s_add_u32 s81, s81, 0x1800000
 s_add_u32 s20, s100, s81
 s_addc_u32 s21, s101, 0
 s_mov_b32 s22, 0x2d500
 s_mov_b32 s23, 0x00020000
 s_mul_i32 s81, s84, 264704
 s_lshl_b32 s82, s85, 12
 s_add_u32 s81, s81, s82
 s_add_u32 s81, s81, 0x400000
 s_add_u32 s24, s100, s81
 s_addc_u32 s25, s101, 0
 s_mov_b32 s26, 0x2a500
 s_mov_b32 s27, 0x00020000
 v_accvgpr_write_b32 a120, 0
 v_accvgpr_write_b32 a121, 0
 v_accvgpr_write_b32 a122, 0
 v_accvgpr_write_b32 a123, 0
 v_accvgpr_write_b32 a124, 0
 v_accvgpr_write_b32 a125, 0
 v_accvgpr_write_b32 a126, 0
 v_accvgpr_write_b32 a127, 0
 v_lshrrev_b32 v36, 2, v3
 v_and_b32 v37, 7, v36
 v_lshlrev_b32 v37, 5, v37
 v_lshl_add_u32 v37, v36, 8, v37
 v_and_b32 v36, 3, v3
 v_lshl_add_u32 v37, v36, 3, v37
 v_add_u32 v8, 0x10000, v37
 v_xor_b32 v9, 32, v8
 v_xor_b32 v10, 64, v8
 v_xor_b32 v11, 96, v8
 v_xor_b32 v12, 128, v8
 v_xor_b32 v13, 160, v8
 v_xor_b32 v14, 192, v8
 v_xor_b32 v15, 224, v8
 v_mov_b32 v16, 0
 v_mov_b32 v17, 0
 v_mov_b32 v18, 0
 v_mov_b32 v19, 0
 v_lshlrev_b32 v252, 20, v0
 v_mov_b32 v253, s54
 v_lshlrev_b32 v254, 7, v3
 s_getpc_b64 s[16:17]
L_ct3:
 s_add_u32 s16, s16, L_att_tail-L_ct3
 s_addc_u32 s17, s17, 0
 s_lshr_b32 s3, s2, 3
 s_lshl_b32 s3, s3, 11
 v_and_b32 v32, 15, v3
 v_lshlrev_b32 v32, 7, v32
 v_add_u32 v32, s3, v32
 v_min_u32 v32, L_code_end-L_att_tail-4, v32
 v_mov_b32 v33, s17
 v_add_co_u32 v32, vcc, s16, v32
 s_nop 1
 v_addc_co_u32 v33, vcc, 0, v33, vcc
 v_mov_b32 v20, v3
 v_mul_u32_u24 v21, 3641, v20
 v_lshrrev_b32 v21, 16, v21
 v_mul_u32_u24 v21, 864, v21
 v_lshl_add_u32 v21, v20, 4, v21
 v_add_u32 v20, 64, v20
 v_max3_f32 v28, v56, v57, v58
 v_max3_f32 v29, v60, v61, v62
 v_max3_f32 v30, v64, v65, v66
 v_max3_f32 v31, v68, v69, v70
 v_max3_f32 v28, v28, v59, v72
 v_max3_f32 v29, v29, v63, v76
 v_max3_f32 v30, v30, v67, v80
 v_max3_f32 v31, v31, v71, v84
 v_max3_f32 v28, v28, v73, v74
 v_max3_f32 v29, v29, v77, v78
 v_max3_f32 v30, v30, v81, v82
 v_max3_f32 v31, v31, v85, v86
 v_max3_f32 v28, v28, v75, v88
 v_max3_f32 v29, v29, v79, v92
 v_max3_f32 v30, v30, v83, v96
 v_max3_f32 v31, v31, v87, v100
 v_max3_f32 v28, v28, v89, v90
 v_max3_f32 v29, v29, v93, v94
 v_max3_f32 v30, v30, v97, v98
 v_max3_f32 v31, v31, v101, v102
 v_max3_f32 v28, v28, v91, v104
 v_max3_f32 v29, v29, v95, v108
 v_max3_f32 v30, v30, v99, v112
 v_max3_f32 v31, v31, v103, v116
 v_max3_f32 v28, v28, v105, v106
 v_max3_f32 v29, v29, v109, v110
 v_max3_f32 v30, v30, v113, v114
 v_max3_f32 v31, v31, v117, v118
 v_max_f32 v28, v28, v107
 v_max_f32 v29, v29, v111
 v_max_f32 v30, v30, v115
 v_max_f32 v31, v31, v119
 v_mov_b32 v34, v28
 v_mov_b32 v35, v29
 v_mov_b32 v36, v30
 v_mov_b32 v37, v31
 v_permlane32_swap_b32 v28, v34
 v_permlane32_swap_b32 v29, v35
 v_permlane32_swap_b32 v30, v36
 v_permlane32_swap_b32 v31, v37
 v_max_f32 v28, v28, v34
 v_max_f32 v29, v29, v35
 v_max_f32 v30, v30, v36
 v_max_f32 v31, v31, v37
 v_mov_b32 v34, v28
 v_mov_b32 v35, v29
 v_mov_b32 v36, v30
 v_mov_b32 v37, v31
 v_permlane16_swap_b32 v28, v34
 v_permlane16_swap_b32 v29, v35
 v_permlane16_swap_b32 v30, v36
 v_permlane16_swap_b32 v31, v37
 v_max_f32 v28, v28, v34
 v_max_f32 v29, v29, v35
 v_max_f32 v30, v30, v36
 v_max_f32 v31, v31, v37
 v_sub_f32 v40, 0, v28
 v_sub_f32 v41, 0, v28
 v_sub_f32 v42, 0, v28
 v_sub_f32 v43, 0, v28
 v_sub_f32 v44, 0, v29
 v_sub_f32 v45, 0, v29
 v_sub_f32 v46, 0, v29
 v_sub_f32 v47, 0, v29
 v_sub_f32 v48, 0, v30
 v_sub_f32 v49, 0, v30
 v_sub_f32 v50, 0, v30
 v_sub_f32 v51, 0, v30
 v_sub_f32 v52, 0, v31
 v_sub_f32 v53, 0, v31
 v_sub_f32 v54, 0, v31
 v_sub_f32 v55, 0, v31
 v_add_f32 v56, v56, v40
 v_add_f32 v57, v57, v40
 v_add_f32 v58, v58, v40
 v_add_f32 v59, v59, v40
 v_add_f32 v60, v60, v44
 v_add_f32 v61, v61, v44
 v_add_f32 v62, v62, v44
 v_add_f32 v63, v63, v44
 v_add_f32 v64, v64, v48
 v_add_f32 v65, v65, v48
 v_add_f32 v66, v66, v48
 v_add_f32 v67, v67, v48
 v_add_f32 v68, v68, v52
 v_add_f32 v69, v69, v52
 v_add_f32 v70, v70, v52
 v_add_f32 v71, v71, v52
 v_add_f32 v72, v72, v40
 v_add_f32 v73, v73, v40
 v_add_f32 v74, v74, v40
 v_add_f32 v75, v75, v40
 v_add_f32 v76, v76, v44
 v_add_f32 v77, v77, v44
 v_add_f32 v78, v78, v44
 v_add_f32 v79, v79, v44
 v_add_f32 v80, v80, v48
 v_add_f32 v81, v81, v48
 v_add_f32 v82, v82, v48
 v_add_f32 v83, v83, v48
 v_add_f32 v84, v84, v52
 v_add_f32 v85, v85, v52
 v_add_f32 v86, v86, v52
 v_add_f32 v87, v87, v52
 v_add_f32 v88, v88, v40
 v_add_f32 v89, v89, v40
 v_add_f32 v90, v90, v40
 v_add_f32 v91, v91, v40
 v_add_f32 v92, v92, v44
 v_add_f32 v93, v93, v44
 v_add_f32 v94, v94, v44
 v_add_f32 v95, v95, v44
 v_add_f32 v96, v96, v48
 v_add_f32 v97, v97, v48
 v_add_f32 v98, v98, v48
 v_add_f32 v99, v99, v48
 v_add_f32 v100, v100, v52
 v_add_f32 v101, v101, v52
 v_add_f32 v102, v102, v52
 v_add_f32 v103, v103, v52
 v_add_f32 v104, v104, v40
 v_add_f32 v105, v105, v40
 v_add_f32 v106, v106, v40
 v_add_f32 v107, v107, v40
 v_add_f32 v108, v108, v44
 v_add_f32 v109, v109, v44
 v_add_f32 v110, v110, v44
 v_add_f32 v111, v111, v44
 v_add_f32 v112, v112, v48
 v_add_f32 v113, v113, v48
 v_add_f32 v114, v114, v48
 v_add_f32 v115, v115, v48
 v_add_f32 v116, v116, v52
 v_add_f32 v117, v117, v52
 v_add_f32 v118, v118, v52
 v_add_f32 v119, v119, v52
 v_exp_f32 v28, v56
 v_exp_f32 v29, v57
 v_add_f32 v16, v16, v28
 v_exp_f32 v30, v58
 v_add_f32 v16, v16, v29
 v_cvt_pk_bf16_f32 v120, v28, v29
 v_exp_f32 v31, v59
 v_add_f32 v16, v16, v30
 v_exp_f32 v28, v60
 v_add_f32 v16, v16, v31
 v_cvt_pk_bf16_f32 v121, v30, v31
 v_exp_f32 v29, v61
 v_add_f32 v17, v17, v28
 v_exp_f32 v30, v62
 v_add_f32 v17, v17, v29
 v_cvt_pk_bf16_f32 v128, v28, v29
 v_exp_f32 v31, v63
 v_add_f32 v17, v17, v30
 v_exp_f32 v28, v64
 v_add_f32 v17, v17, v31
 v_cvt_pk_bf16_f32 v129, v30, v31
 v_exp_f32 v29, v65
 v_add_f32 v18, v18, v28
 v_exp_f32 v30, v66
 v_add_f32 v18, v18, v29
 v_cvt_pk_bf16_f32 v136, v28, v29
 v_exp_f32 v31, v67
 v_add_f32 v18, v18, v30
 v_exp_f32 v28, v68
 v_add_f32 v18, v18, v31
 v_cvt_pk_bf16_f32 v137, v30, v31
 v_exp_f32 v29, v69
 v_add_f32 v19, v19, v28
 v_exp_f32 v30, v70
 v_add_f32 v19, v19, v29
 v_cvt_pk_bf16_f32 v144, v28, v29
 v_exp_f32 v31, v71
 v_add_f32 v19, v19, v30
 v_exp_f32 v28, v72
 v_add_f32 v19, v19, v31
 v_cvt_pk_bf16_f32 v145, v30, v31
 v_exp_f32 v29, v73
 v_add_f32 v16, v16, v28
 v_exp_f32 v30, v74
 v_add_f32 v16, v16, v29
 v_cvt_pk_bf16_f32 v122, v28, v29
 v_exp_f32 v31, v75
 v_add_f32 v16, v16, v30
 v_exp_f32 v28, v76
 v_add_f32 v16, v16, v31
 v_cvt_pk_bf16_f32 v123, v30, v31
 v_exp_f32 v29, v77
 v_add_f32 v17, v17, v28
 v_exp_f32 v30, v78
 v_add_f32 v17, v17, v29
 v_cvt_pk_bf16_f32 v130, v28, v29
 v_exp_f32 v31, v79
 v_add_f32 v17, v17, v30
 v_exp_f32 v28, v80
 v_add_f32 v17, v17, v31
 v_cvt_pk_bf16_f32 v131, v30, v31
 v_exp_f32 v29, v81
 v_add_f32 v18, v18, v28
 v_exp_f32 v30, v82
 v_add_f32 v18, v18, v29
 v_cvt_pk_bf16_f32 v138, v28, v29
 v_exp_f32 v31, v83
 v_add_f32 v18, v18, v30
 s_nop 0
 v_add_f32 v18, v18, v31
 v_cvt_pk_bf16_f32 v139, v30, v31
 s_waitcnt vmcnt(20)
 s_barrier
 s_add_u32 m0, s53, 81920
 s_nop 0
 buffer_load_dwordx4 v26, s[8:11], s56 offen offset:0 nt lds
 buffer_load_dwordx4 v27, s[8:11], s56 offen offset:1024 nt lds
 buffer_load_dwordx4 v26, s[8:11], s56 offen offset:2048 nt lds
 buffer_load_dwordx4 v27, s[8:11], s56 offen offset:3072 nt lds
 s_add_u32 s56, s56, 16384
 ds_read_b128 a[128:131], v4 offset:16384
 ds_read_b128 a[132:135], v5 offset:16384
 ds_read_b128 a[136:139], v6 offset:16384
 ds_read_b128 a[140:143], v7 offset:16384
 ds_read_b128 a[144:147], v4 offset:20480
 ds_read_b128 a[148:151], v5 offset:20480
 ds_read_b128 a[152:155], v6 offset:20480
 s_waitcnt lgkmcnt(3)
 v_exp_f32 v28, v84
 v_exp_f32 v29, v85
 v_add_f32 v19, v19, v28
 v_exp_f32 v30, v86
 v_add_f32 v19, v19, v29
 v_cvt_pk_bf16_f32 v146, v28, v29
 v_exp_f32 v31, v87
 v_add_f32 v19, v19, v30
 v_exp_f32 v28, v88
 v_add_f32 v19, v19, v31
 v_cvt_pk_bf16_f32 v147, v30, v31
 v_exp_f32 v29, v89
 v_add_f32 v16, v16, v28
 v_exp_f32 v30, v90
 v_add_f32 v16, v16, v29
 v_cvt_pk_bf16_f32 v124, v28, v29
 v_exp_f32 v31, v91
 v_add_f32 v16, v16, v30
 v_exp_f32 v28, v92
 v_add_f32 v16, v16, v31
 v_cvt_pk_bf16_f32 v125, v30, v31
 v_exp_f32 v29, v93
 v_add_f32 v17, v17, v28
 v_exp_f32 v30, v94
 v_add_f32 v17, v17, v29
 v_cvt_pk_bf16_f32 v132, v28, v29
 v_exp_f32 v31, v95
 v_add_f32 v17, v17, v30
 v_exp_f32 v28, v96
 v_add_f32 v17, v17, v31
 v_cvt_pk_bf16_f32 v133, v30, v31
 v_exp_f32 v29, v97
 v_add_f32 v18, v18, v28
 v_exp_f32 v30, v98
 v_add_f32 v18, v18, v29
 v_cvt_pk_bf16_f32 v140, v28, v29
 v_exp_f32 v31, v99
 v_add_f32 v18, v18, v30
 v_exp_f32 v28, v100
 v_add_f32 v18, v18, v31
 v_cvt_pk_bf16_f32 v141, v30, v31
 v_exp_f32 v29, v101
 v_add_f32 v19, v19, v28
 v_exp_f32 v30, v102
 v_add_f32 v19, v19, v29
 v_cvt_pk_bf16_f32 v148, v28, v29
 v_exp_f32 v31, v103
 v_add_f32 v19, v19, v30
 v_exp_f32 v28, v104
 v_add_f32 v19, v19, v31
 v_cvt_pk_bf16_f32 v149, v30, v31
 v_exp_f32 v29, v105
 v_add_f32 v16, v16, v28
 v_exp_f32 v30, v106
 v_add_f32 v16, v16, v29
 v_cvt_pk_bf16_f32 v126, v28, v29
 v_exp_f32 v31, v107
 v_add_f32 v16, v16, v30
 v_exp_f32 v28, v108
 v_add_f32 v16, v16, v31
 v_cvt_pk_bf16_f32 v127, v30, v31
 v_exp_f32 v29, v109
 v_add_f32 v17, v17, v28
 v_exp_f32 v30, v110
 v_add_f32 v17, v17, v29
 v_cvt_pk_bf16_f32 v134, v28, v29
 v_exp_f32 v31, v111
 v_add_f32 v17, v17, v30
 v_exp_f32 v28, v112
 v_add_f32 v17, v17, v31
 v_cvt_pk_bf16_f32 v135, v30, v31
 v_exp_f32 v29, v113
 v_add_f32 v18, v18, v28
 v_exp_f32 v30, v114
 v_add_f32 v18, v18, v29
 v_cvt_pk_bf16_f32 v142, v28, v29
 v_exp_f32 v31, v115
 v_add_f32 v18, v18, v30
 s_nop 0
 v_add_f32 v18, v18, v31
 v_cvt_pk_bf16_f32 v143, v30, v31
 s_mov_b32 s57, 0
 s_lshl_b32 s62, s52, 4
 s_add_u32 s62, s62, 2
.p2align 6
L_att:
 v_mfma_f32_16x16x32_bf16 v[56:59], a[128:131], v[184:187], v[40:43]
 v_exp_f32 v28, v116
 v_mfma_f32_16x16x32_bf16 v[56:59], a[132:135], v[188:191], v[56:59]
 ds_read_b128 a[156:159], v7 offset:20480
 v_add_f32 v19, v19, v28
 v_mfma_f32_16x16x32_bf16 v[56:59], a[136:139], v[192:195], v[56:59]
 s_add_u32 m0, s53, 0
 v_exp_f32 v29, v117
 v_mfma_f32_16x16x32_bf16 v[56:59], a[140:143], v[196:199], v[56:59]
 v_add_f32 v19, v19, v29
 v_cvt_pk_bf16_f32 v150, v28, v29
 v_mfma_f32_16x16x32_bf16 v[60:63], a[128:131], v[200:203], v[44:47]
 ds_read_b128 a[160:163], v4 offset:24576
 v_exp_f32 v30, v118
 v_mfma_f32_16x16x32_bf16 v[60:63], a[132:135], v[204:207], v[60:63]
 ds_read_b128 a[164:167], v5 offset:24576
 v_add_f32 v19, v19, v30
 v_mfma_f32_16x16x32_bf16 v[60:63], a[136:139], v[208:211], v[60:63]
 buffer_load_dwordx4 v22, s[4:7], s55 offen offset:0 nt lds
 v_exp_f32 v31, v119
 v_mfma_f32_16x16x32_bf16 v[60:63], a[140:143], v[212:215], v[60:63]
 v_add_f32 v19, v19, v31
 v_cvt_pk_bf16_f32 v151, v30, v31
 v_mfma_f32_16x16x32_bf16 v[64:67], a[128:131], v[216:219], v[48:51]
 v_exp_f32 v28, v56
 v_mfma_f32_16x16x32_bf16 v[64:67], a[132:135], v[220:223], v[64:67]
 ds_read_b128 a[168:171], v6 offset:24576
 v_add_f32 v16, v16, v28
 v_mfma_f32_16x16x32_bf16 v[64:67], a[136:139], v[224:227], v[64:67]
 buffer_load_dwordx4 v23, s[4:7], s55 offen offset:1024 nt lds
 v_exp_f32 v29, v57
 v_mfma_f32_16x16x32_bf16 v[64:67], a[140:143], v[228:231], v[64:67]
 v_add_f32 v16, v16, v29
 v_cvt_pk_bf16_f32 v152, v28, v29
 v_mfma_f32_16x16x32_bf16 v[68:71], a[128:131], v[232:235], v[52:55]
 ds_read_b128 a[172:175], v7 offset:24576
 v_exp_f32 v30, v58
 v_mfma_f32_16x16x32_bf16 v[68:71], a[132:135], v[236:239], v[68:71]
 ds_read_b128 a[176:179], v4 offset:28672
 v_add_f32 v16, v16, v30
 v_mfma_f32_16x16x32_bf16 v[68:71], a[136:139], v[240:243], v[68:71]
 v_exp_f32 v31, v59
 v_mfma_f32_16x16x32_bf16 v[68:71], a[140:143], v[244:247], v[68:71]
 s_waitcnt lgkmcnt(5)
 v_add_f32 v16, v16, v31
 v_cvt_pk_bf16_f32 v153, v30, v31
 v_mfma_f32_16x16x32_bf16 v[72:75], a[144:147], v[184:187], v[40:43]
 v_exp_f32 v28, v60
 v_mfma_f32_16x16x32_bf16 v[72:75], a[148:151], v[188:191], v[72:75]
 ds_read_b128 a[180:183], v5 offset:28672
 v_add_f32 v17, v17, v28
 v_mfma_f32_16x16x32_bf16 v[72:75], a[152:155], v[192:195], v[72:75]
 buffer_load_dwordx4 v24, s[4:7], s55 offen offset:2048 nt lds
 v_exp_f32 v29, v61
 v_mfma_f32_16x16x32_bf16 v[72:75], a[156:159], v[196:199], v[72:75]
 v_add_f32 v17, v17, v29
 v_cvt_pk_bf16_f32 v160, v28, v29
 v_mfma_f32_16x16x32_bf16 v[76:79], a[144:147], v[200:203], v[44:47]
 ds_read_b128 a[184:187], v6 offset:28672
 v_exp_f32 v30, v62
 v_mfma_f32_16x16x32_bf16 v[76:79], a[148:151], v[204:207], v[76:79]
 ds_read_b128 a[188:191], v7 offset:28672
 v_add_f32 v17, v17, v30
 v_mfma_f32_16x16x32_bf16 v[76:79], a[152:155], v[208:211], v[76:79]
 v_exp_f32 v31, v63
 v_mfma_f32_16x16x32_bf16 v[76:79], a[156:159], v[212:215], v[76:79]
 v_add_f32 v17, v17, v31
 v_cvt_pk_bf16_f32 v161, v30, v31
 v_mfma_f32_16x16x32_bf16 v[80:83], a[144:147], v[216:219], v[48:51]
 v_exp_f32 v28, v64
 v_mfma_f32_16x16x32_bf16 v[80:83], a[148:151], v[220:223], v[80:83]
 ds_read_b64_tr_b16 a[192:193], v8 offset:49152
 v_add_f32 v18, v18, v28
 v_mfma_f32_16x16x32_bf16 v[80:83], a[152:155], v[224:227], v[80:83]
 buffer_load_dwordx4 v25, s[4:7], s55 offen offset:3072 nt lds
 v_exp_f32 v29, v65
 v_mfma_f32_16x16x32_bf16 v[80:83], a[156:159], v[228:231], v[80:83]
 s_add_u32 s55, s55, 16384
 v_add_f32 v18, v18, v29
 v_cvt_pk_bf16_f32 v168, v28, v29
 v_mfma_f32_16x16x32_bf16 v[84:87], a[144:147], v[232:235], v[52:55]
 ds_read_b64_tr_b16 a[194:195], v8 offset:53248
 v_exp_f32 v30, v66
 v_mfma_f32_16x16x32_bf16 v[84:87], a[148:151], v[236:239], v[84:87]
 ds_read_b64_tr_b16 a[196:197], v8 offset:57344
 v_add_f32 v18, v18, v30
 v_mfma_f32_16x16x32_bf16 v[84:87], a[152:155], v[240:243], v[84:87]
 v_exp_f32 v31, v67
 v_mfma_f32_16x16x32_bf16 v[84:87], a[156:159], v[244:247], v[84:87]
 s_waitcnt lgkmcnt(7)
 v_add_f32 v18, v18, v31
 v_cvt_pk_bf16_f32 v169, v30, v31
 v_mfma_f32_16x16x32_bf16 v[88:91], a[160:163], v[184:187], v[40:43]
 buffer_load_dwordx4 v[248:251], v21, s[36:39], 0 offen nt
 v_exp_f32 v28, v68
 v_mfma_f32_16x16x32_bf16 v[88:91], a[164:167], v[188:191], v[88:91]
 ds_read_b64_tr_b16 a[198:199], v8 offset:61440
 v_add_f32 v19, v19, v28
 v_mfma_f32_16x16x32_bf16 v[88:91], a[168:171], v[192:195], v[88:91]
 v_exp_f32 v29, v69
 v_mfma_f32_16x16x32_bf16 v[88:91], a[172:175], v[196:199], v[88:91]
 v_add_f32 v19, v19, v29
 v_cvt_pk_bf16_f32 v176, v28, v29
 v_mfma_f32_16x16x32_bf16 v[92:95], a[160:163], v[200:203], v[44:47]
 ds_read_b64_tr_b16 a[200:201], v9 offset:49152
 v_exp_f32 v30, v70
 v_mfma_f32_16x16x32_bf16 v[92:95], a[164:167], v[204:207], v[92:95]
 ds_read_b64_tr_b16 a[202:203], v9 offset:53248
 v_add_f32 v19, v19, v30
 v_mfma_f32_16x16x32_bf16 v[92:95], a[168:171], v[208:211], v[92:95]
 v_exp_f32 v31, v71
 v_mfma_f32_16x16x32_bf16 v[92:95], a[172:175], v[212:215], v[92:95]
 v_add_f32 v19, v19, v31
 v_cvt_pk_bf16_f32 v177, v30, v31
 v_mfma_f32_16x16x32_bf16 v[96:99], a[160:163], v[216:219], v[48:51]
 buffer_load_dwordx4 v[36:39], v21, s[40:43], 0 offen nt
 v_exp_f32 v28, v72
 v_mfma_f32_16x16x32_bf16 v[96:99], a[164:167], v[220:223], v[96:99]
 ds_read_b64_tr_b16 a[204:205], v9 offset:57344
 v_add_f32 v16, v16, v28
 v_mfma_f32_16x16x32_bf16 v[96:99], a[168:171], v[224:227], v[96:99]
 v_exp_f32 v29, v73
 v_mfma_f32_16x16x32_bf16 v[96:99], a[172:175], v[228:231], v[96:99]
 v_add_f32 v16, v16, v29
 v_cvt_pk_bf16_f32 v154, v28, v29
 v_mfma_f32_16x16x32_bf16 v[100:103], a[160:163], v[232:235], v[52:55]
 ds_read_b64_tr_b16 a[206:207], v9 offset:61440
 v_exp_f32 v30, v74
 v_mfma_f32_16x16x32_bf16 v[100:103], a[164:167], v[236:239], v[100:103]
 ds_read_b64_tr_b16 a[208:209], v10 offset:49152
 v_add_f32 v16, v16, v30
 v_mfma_f32_16x16x32_bf16 v[100:103], a[168:171], v[240:243], v[100:103]
 v_exp_f32 v31, v75
 v_mfma_f32_16x16x32_bf16 v[100:103], a[172:175], v[244:247], v[100:103]
 s_waitcnt lgkmcnt(9)
 v_add_f32 v16, v16, v31
 v_cvt_pk_bf16_f32 v155, v30, v31
 v_mfma_f32_16x16x32_bf16 v[104:107], a[176:179], v[184:187], v[40:43]
 v_exp_f32 v28, v76
 v_mfma_f32_16x16x32_bf16 v[104:107], a[180:183], v[188:191], v[104:107]
 ds_read_b64_tr_b16 a[210:211], v10 offset:53248
 v_add_f32 v17, v17, v28
 v_mfma_f32_16x16x32_bf16 v[104:107], a[184:187], v[192:195], v[104:107]
 v_exp_f32 v29, v77
 v_mfma_f32_16x16x32_bf16 v[104:107], a[188:191], v[196:199], v[104:107]
 v_add_f32 v17, v17, v29
 v_cvt_pk_bf16_f32 v162, v28, v29
 v_mfma_f32_16x16x32_bf16 v[108:111], a[176:179], v[200:203], v[44:47]
 ds_read_b64_tr_b16 a[212:213], v10 offset:57344
 v_exp_f32 v30, v78
 v_mfma_f32_16x16x32_bf16 v[108:111], a[180:183], v[204:207], v[108:111]
 ds_read_b64_tr_b16 a[214:215], v10 offset:61440
 v_add_f32 v17, v17, v30
 v_mfma_f32_16x16x32_bf16 v[108:111], a[184:187], v[208:211], v[108:111]
 v_exp_f32 v31, v79
 v_mfma_f32_16x16x32_bf16 v[108:111], a[188:191], v[212:215], v[108:111]
 v_add_f32 v17, v17, v31
 v_cvt_pk_bf16_f32 v163, v30, v31
 v_mfma_f32_16x16x32_bf16 v[112:115], a[176:179], v[216:219], v[48:51]
 v_exp_f32 v28, v80
 v_mfma_f32_16x16x32_bf16 v[112:115], a[180:183], v[220:223], v[112:115]
 ds_read_b64_tr_b16 a[216:217], v11 offset:49152
 v_add_f32 v18, v18, v28
 v_mfma_f32_16x16x32_bf16 v[112:115], a[184:187], v[224:227], v[112:115]
 v_exp_f32 v29, v81
 v_mfma_f32_16x16x32_bf16 v[112:115], a[188:191], v[228:231], v[112:115]
 v_add_f32 v18, v18, v29
 v_cvt_pk_bf16_f32 v170, v28, v29
 v_mfma_f32_16x16x32_bf16 v[116:119], a[176:179], v[232:235], v[52:55]
 ds_read_b64_tr_b16 a[218:219], v11 offset:53248
 v_exp_f32 v30, v82
 v_mfma_f32_16x16x32_bf16 v[116:119], a[180:183], v[236:239], v[116:119]
 ds_read_b64_tr_b16 a[220:221], v11 offset:57344
 v_add_f32 v18, v18, v30
 v_mfma_f32_16x16x32_bf16 v[116:119], a[184:187], v[240:243], v[116:119]
 v_exp_f32 v31, v83
 v_mfma_f32_16x16x32_bf16 v[116:119], a[188:191], v[244:247], v[116:119]
 s_waitcnt lgkmcnt(11)
 v_add_f32 v18, v18, v31
 v_cvt_pk_bf16_f32 v171, v30, v31
 v_mfma_f32_16x16x32_bf16 a[0:3], a[192:195], v[120:123], a[0:3]
 s_waitcnt vmcnt(17)
 v_exp_f32 v28, v84
 v_mfma_f32_16x16x32_bf16 a[0:3], a[196:199], v[124:127], a[0:3]
 s_barrier
 ds_read_b64_tr_b16 a[222:223], v11 offset:61440
 v_add_f32 v19, v19, v28
 v_mfma_f32_16x16x32_bf16 a[4:7], a[192:195], v[128:131], a[4:7]
 s_add_u32 m0, s53, 98304
 v_exp_f32 v29, v85
 v_mfma_f32_16x16x32_bf16 a[4:7], a[196:199], v[132:135], a[4:7]
 v_add_f32 v19, v19, v29
 v_cvt_pk_bf16_f32 v178, v28, v29
 v_mfma_f32_16x16x32_bf16 a[8:11], a[192:195], v[136:139], a[8:11]
 ds_read_b64_tr_b16 a[224:225], v12 offset:49152
 v_exp_f32 v30, v86
 v_mfma_f32_16x16x32_bf16 a[8:11], a[196:199], v[140:143], a[8:11]
 ds_read_b64_tr_b16 a[226:227], v12 offset:53248
 v_add_f32 v19, v19, v30
 v_mfma_f32_16x16x32_bf16 a[12:15], a[192:195], v[144:147], a[12:15]
 buffer_load_dwordx4 v26, s[8:11], s56 offen offset:0 nt lds
 v_exp_f32 v31, v87
 v_mfma_f32_16x16x32_bf16 a[12:15], a[196:199], v[148:151], a[12:15]
 s_waitcnt lgkmcnt(10)
 v_add_f32 v19, v19, v31
 v_cvt_pk_bf16_f32 v179, v30, v31
 v_mfma_f32_16x16x32_bf16 a[16:19], a[200:203], v[120:123], a[16:19]
 v_exp_f32 v28, v88
 v_mfma_f32_16x16x32_bf16 a[16:19], a[204:207], v[124:127], a[16:19]
 ds_read_b64_tr_b16 a[228:229], v12 offset:57344
 v_add_f32 v16, v16, v28
 v_mfma_f32_16x16x32_bf16 a[20:23], a[200:203], v[128:131], a[20:23]
 buffer_load_dwordx4 v27, s[8:11], s56 offen offset:1024 nt lds
 v_exp_f32 v29, v89
 v_mfma_f32_16x16x32_bf16 a[20:23], a[204:207], v[132:135], a[20:23]
 v_add_f32 v16, v16, v29
 v_cvt_pk_bf16_f32 v156, v28, v29
 v_mfma_f32_16x16x32_bf16 a[24:27], a[200:203], v[136:139], a[24:27]
 ds_read_b64_tr_b16 a[230:231], v12 offset:61440
 v_exp_f32 v30, v90
 v_mfma_f32_16x16x32_bf16 a[24:27], a[204:207], v[140:143], a[24:27]
 ds_read_b64_tr_b16 a[232:233], v13 offset:49152
 v_add_f32 v16, v16, v30
 v_mfma_f32_16x16x32_bf16 a[28:31], a[200:203], v[144:147], a[28:31]
 v_exp_f32 v31, v91
 v_mfma_f32_16x16x32_bf16 a[28:31], a[204:207], v[148:151], a[28:31]
 s_waitcnt lgkmcnt(9)
 v_add_f32 v16, v16, v31
 v_cvt_pk_bf16_f32 v157, v30, v31
 v_mfma_f32_16x16x32_bf16 a[32:35], a[208:211], v[120:123], a[32:35]
 v_exp_f32 v28, v92
 v_mfma_f32_16x16x32_bf16 a[32:35], a[212:215], v[124:127], a[32:35]
 ds_read_b64_tr_b16 a[234:235], v13 offset:53248
 v_add_f32 v17, v17, v28
 v_mfma_f32_16x16x32_bf16 a[36:39], a[208:211], v[128:131], a[36:39]
 buffer_load_dwordx4 v26, s[8:11], s56 offen offset:2048 nt lds
 v_exp_f32 v29, v93
 v_mfma_f32_16x16x32_bf16 a[36:39], a[212:215], v[132:135], a[36:39]
 v_add_f32 v17, v17, v29
 v_cvt_pk_bf16_f32 v164, v28, v29
 v_mfma_f32_16x16x32_bf16 a[40:43], a[208:211], v[136:139], a[40:43]
 ds_read_b64_tr_b16 a[236:237], v13 offset:57344
 v_exp_f32 v30, v94
 v_mfma_f32_16x16x32_bf16 a[40:43], a[212:215], v[140:143], a[40:43]
 ds_read_b64_tr_b16 a[238:239], v13 offset:61440
 v_add_f32 v17, v17, v30
 v_mfma_f32_16x16x32_bf16 a[44:47], a[208:211], v[144:147], a[44:47]
 v_exp_f32 v31, v95
 v_mfma_f32_16x16x32_bf16 a[44:47], a[212:215], v[148:151], a[44:47]
 s_waitcnt lgkmcnt(8)
 v_add_f32 v17, v17, v31
 v_cvt_pk_bf16_f32 v165, v30, v31
 v_mfma_f32_16x16x32_bf16 a[48:51], a[216:219], v[120:123], a[48:51]
 v_exp_f32 v28, v96
 v_mfma_f32_16x16x32_bf16 a[48:51], a[220:223], v[124:127], a[48:51]
 ds_read_b64_tr_b16 a[240:241], v14 offset:49152
 v_add_f32 v18, v18, v28
 v_mfma_f32_16x16x32_bf16 a[52:55], a[216:219], v[128:131], a[52:55]
 buffer_load_dwordx4 v27, s[8:11], s56 offen offset:3072 nt lds
 v_exp_f32 v29, v97
 v_mfma_f32_16x16x32_bf16 a[52:55], a[220:223], v[132:135], a[52:55]
 s_add_u32 s56, s56, 16384
 v_add_f32 v18, v18, v29
 v_cvt_pk_bf16_f32 v172, v28, v29
 v_mfma_f32_16x16x32_bf16 a[56:59], a[216:219], v[136:139], a[56:59]
 ds_read_b64_tr_b16 a[242:243], v14 offset:53248
 v_exp_f32 v30, v98
 v_mfma_f32_16x16x32_bf16 a[56:59], a[220:223], v[140:143], a[56:59]
 ds_read_b64_tr_b16 a[244:245], v14 offset:57344
 v_add_f32 v18, v18, v30
 v_mfma_f32_16x16x32_bf16 a[60:63], a[216:219], v[144:147], a[60:63]
 v_exp_f32 v31, v99
 v_mfma_f32_16x16x32_bf16 a[60:63], a[220:223], v[148:151], a[60:63]
 s_waitcnt lgkmcnt(7)
 v_add_f32 v18, v18, v31
 v_cvt_pk_bf16_f32 v173, v30, v31
 v_mfma_f32_16x16x32_bf16 a[64:67], a[224:227], v[120:123], a[64:67]
 v_exp_f32 v28, v100
 v_mfma_f32_16x16x32_bf16 a[64:67], a[228:231], v[124:127], a[64:67]
 ds_read_b64_tr_b16 a[246:247], v14 offset:61440
 v_add_f32 v19, v19, v28
 v_mfma_f32_16x16x32_bf16 a[68:71], a[224:227], v[128:131], a[68:71]
 v_exp_f32 v29, v101
 v_mfma_f32_16x16x32_bf16 a[68:71], a[228:231], v[132:135], a[68:71]
 v_add_f32 v19, v19, v29
 v_cvt_pk_bf16_f32 v180, v28, v29
 v_mfma_f32_16x16x32_bf16 a[72:75], a[224:227], v[136:139], a[72:75]
 ds_read_b64_tr_b16 a[248:249], v15 offset:49152
 v_exp_f32 v30, v102
 v_mfma_f32_16x16x32_bf16 a[72:75], a[228:231], v[140:143], a[72:75]
 ds_read_b64_tr_b16 a[250:251], v15 offset:53248
 v_add_f32 v19, v19, v30
 v_mfma_f32_16x16x32_bf16 a[76:79], a[224:227], v[144:147], a[76:79]
 v_exp_f32 v31, v103
 v_mfma_f32_16x16x32_bf16 a[76:79], a[228:231], v[148:151], a[76:79]
 s_waitcnt lgkmcnt(6)
 v_add_f32 v19, v19, v31
 v_cvt_pk_bf16_f32 v181, v30, v31
 v_mfma_f32_16x16x32_bf16 a[80:83], a[232:235], v[120:123], a[80:83]
 v_exp_f32 v28, v104
 v_mfma_f32_16x16x32_bf16 a[80:83], a[236:239], v[124:127], a[80:83]
 ds_read_b64_tr_b16 a[252:253], v15 offset:57344
 v_add_f32 v16, v16, v28
 v_mfma_f32_16x16x32_bf16 a[84:87], a[232:235], v[128:131], a[84:87]
 v_exp_f32 v29, v105
 v_mfma_f32_16x16x32_bf16 a[84:87], a[236:239], v[132:135], a[84:87]
 v_add_f32 v16, v16, v29
 v_cvt_pk_bf16_f32 v158, v28, v29
 v_mfma_f32_16x16x32_bf16 a[88:91], a[232:235], v[136:139], a[88:91]
 ds_read_b64_tr_b16 a[254:255], v15 offset:61440
 v_exp_f32 v30, v106
 v_mfma_f32_16x16x32_bf16 a[88:91], a[236:239], v[140:143], a[88:91]
 ds_read_b128 a[128:131], v4 offset:32768
 v_add_f32 v16, v16, v30
 v_mfma_f32_16x16x32_bf16 a[92:95], a[232:235], v[144:147], a[92:95]
 v_exp_f32 v31, v107
 v_mfma_f32_16x16x32_bf16 a[92:95], a[236:239], v[148:151], a[92:95]
 s_waitcnt lgkmcnt(5)
 v_add_f32 v16, v16, v31
 v_cvt_pk_bf16_f32 v159, v30, v31
 v_mfma_f32_16x16x32_bf16 a[96:99], a[240:243], v[120:123], a[96:99]
 v_exp_f32 v28, v108
 v_mfma_f32_16x16x32_bf16 a[96:99], a[244:247], v[124:127], a[96:99]
 ds_read_b128 a[132:135], v5 offset:32768
 v_add_f32 v17, v17, v28
 v_mfma_f32_16x16x32_bf16 a[100:103], a[240:243], v[128:131], a[100:103]
 v_exp_f32 v29, v109
 v_mfma_f32_16x16x32_bf16 a[100:103], a[244:247], v[132:135], a[100:103]
 v_add_f32 v17, v17, v29
 v_cvt_pk_bf16_f32 v166, v28, v29
 v_mfma_f32_16x16x32_bf16 a[104:107], a[240:243], v[136:139], a[104:107]
 ds_read_b128 a[136:139], v6 offset:32768
 v_exp_f32 v30, v110
 v_mfma_f32_16x16x32_bf16 a[104:107], a[244:247], v[140:143], a[104:107]
 ds_read_b128 a[140:143], v7 offset:32768
 v_add_f32 v17, v17, v30
 v_mfma_f32_16x16x32_bf16 a[108:111], a[240:243], v[144:147], a[108:111]
 v_exp_f32 v31, v111
 v_mfma_f32_16x16x32_bf16 a[108:111], a[244:247], v[148:151], a[108:111]
 s_waitcnt lgkmcnt(4)
 v_add_f32 v17, v17, v31
 v_cvt_pk_bf16_f32 v167, v30, v31
 v_mfma_f32_16x16x32_bf16 a[112:115], a[248:251], v[120:123], a[112:115]
 v_exp_f32 v28, v112
 v_mfma_f32_16x16x32_bf16 a[112:115], a[252:255], v[124:127], a[112:115]
 ds_read_b128 a[144:147], v4 offset:36864
 v_add_f32 v18, v18, v28
 v_mfma_f32_16x16x32_bf16 a[116:119], a[248:251], v[128:131], a[116:119]
 v_exp_f32 v29, v113
 v_mfma_f32_16x16x32_bf16 a[116:119], a[252:255], v[132:135], a[116:119]
 v_add_f32 v18, v18, v29
 v_cvt_pk_bf16_f32 v174, v28, v29
 v_mfma_f32_16x16x32_bf16 a[120:123], a[248:251], v[136:139], a[120:123]
 ds_read_b128 a[148:151], v5 offset:36864
 v_exp_f32 v30, v114
 v_mfma_f32_16x16x32_bf16 a[120:123], a[252:255], v[140:143], a[120:123]
 ds_read_b128 a[152:155], v6 offset:36864
 v_add_f32 v18, v18, v30
 v_mfma_f32_16x16x32_bf16 a[124:127], a[248:251], v[144:147], a[124:127]
 v_exp_f32 v31, v115
 v_mfma_f32_16x16x32_bf16 a[124:127], a[252:255], v[148:151], a[124:127]
 s_waitcnt lgkmcnt(3)
 v_add_f32 v18, v18, v31
 v_cvt_pk_bf16_f32 v175, v30, v31
 s_add_u32 s57, s57, 1
 s_cmp_eq_u32 s57, 8
 s_cbranch_scc1 L_att_tail
 v_mfma_f32_16x16x32_bf16 v[56:59], a[128:131], v[184:187], v[40:43]
 v_exp_f32 v28, v116
 v_mul_u32_u24 v21, 3641, v20
 v_mfma_f32_16x16x32_bf16 v[56:59], a[132:135], v[188:191], v[56:59]
 ds_read_b128 a[156:159], v7 offset:36864
 v_add_f32 v19, v19, v28
 v_lshrrev_b32 v21, 16, v21
 v_mfma_f32_16x16x32_bf16 v[56:59], a[136:139], v[192:195], v[56:59]
 s_add_u32 m0, s53, 16384
 v_exp_f32 v29, v117
 v_mul_u32_u24 v21, 864, v21
 v_mfma_f32_16x16x32_bf16 v[56:59], a[140:143], v[196:199], v[56:59]
 v_add_f32 v19, v19, v29
 v_cvt_pk_bf16_f32 v182, v28, v29
 v_lshl_add_u32 v21, v20, 4, v21
 v_mfma_f32_16x16x32_bf16 v[60:63], a[128:131], v[200:203], v[44:47]
 ds_read_b128 a[160:163], v4 offset:40960
 v_exp_f32 v30, v118
 v_mfma_f32_16x16x32_bf16 v[60:63], a[132:135], v[204:207], v[60:63]
 ds_read_b128 a[164:167], v5 offset:40960
 v_add_f32 v19, v19, v30
 v_add_u32 v20, 64, v20
 v_mfma_f32_16x16x32_bf16 v[60:63], a[136:139], v[208:211], v[60:63]
 buffer_load_dwordx4 v22, s[4:7], s55 offen offset:0 nt lds
 v_exp_f32 v31, v119
 v_mfma_f32_16x16x32_bf16 v[60:63], a[140:143], v[212:215], v[60:63]
 v_add_f32 v19, v19, v31
 v_cvt_pk_bf16_f32 v183, v30, v31
 v_mfma_f32_16x16x32_bf16 v[64:67], a[128:131], v[216:219], v[48:51]
 v_exp_f32 v28, v56
 v_mfma_f32_16x16x32_bf16 v[64:67], a[132:135], v[220:223], v[64:67]
 ds_read_b128 a[168:171], v6 offset:40960
 v_add_f32 v16, v16, v28
 v_mfma_f32_16x16x32_bf16 v[64:67], a[136:139], v[224:227], v[64:67]
 buffer_load_dwordx4 v23, s[4:7], s55 offen offset:1024 nt lds
 v_exp_f32 v29, v57
 v_mfma_f32_16x16x32_bf16 v[64:67], a[140:143], v[228:231], v[64:67]
 v_add_f32 v16, v16, v29
 v_cvt_pk_bf16_f32 v120, v28, v29
 v_mfma_f32_16x16x32_bf16 v[68:71], a[128:131], v[232:235], v[52:55]
 ds_read_b128 a[172:175], v7 offset:40960
 v_exp_f32 v30, v58
 v_mfma_f32_16x16x32_bf16 v[68:71], a[132:135], v[236:239], v[68:71]
 ds_read_b128 a[176:179], v4 offset:45056
 v_add_f32 v16, v16, v30
 v_mfma_f32_16x16x32_bf16 v[68:71], a[136:139], v[240:243], v[68:71]
 v_exp_f32 v31, v59
 v_mfma_f32_16x16x32_bf16 v[68:71], a[140:143], v[244:247], v[68:71]
 s_waitcnt lgkmcnt(5)
 v_add_f32 v16, v16, v31
 v_cvt_pk_bf16_f32 v121, v30, v31
 v_mfma_f32_16x16x32_bf16 v[72:75], a[144:147], v[184:187], v[40:43]
 v_exp_f32 v28, v60
 v_mfma_f32_16x16x32_bf16 v[72:75], a[148:151], v[188:191], v[72:75]
 ds_read_b128 a[180:183], v5 offset:45056
 v_add_f32 v17, v17, v28
 v_mfma_f32_16x16x32_bf16 v[72:75], a[152:155], v[192:195], v[72:75]
 buffer_load_dwordx4 v24, s[4:7], s55 offen offset:2048 nt lds
 v_exp_f32 v29, v61
 v_mfma_f32_16x16x32_bf16 v[72:75], a[156:159], v[196:199], v[72:75]
 v_add_f32 v17, v17, v29
 v_cvt_pk_bf16_f32 v128, v28, v29
 v_mfma_f32_16x16x32_bf16 v[76:79], a[144:147], v[200:203], v[44:47]
 ds_read_b128 a[184:187], v6 offset:45056
 v_exp_f32 v30, v62
 v_mfma_f32_16x16x32_bf16 v[76:79], a[148:151], v[204:207], v[76:79]
 ds_read_b128 a[188:191], v7 offset:45056
 v_add_f32 v17, v17, v30
 v_mfma_f32_16x16x32_bf16 v[76:79], a[152:155], v[208:211], v[76:79]
 v_exp_f32 v31, v63
 v_mfma_f32_16x16x32_bf16 v[76:79], a[156:159], v[212:215], v[76:79]
 v_add_f32 v17, v17, v31
 v_cvt_pk_bf16_f32 v129, v30, v31
 v_mfma_f32_16x16x32_bf16 v[80:83], a[144:147], v[216:219], v[48:51]
 v_exp_f32 v28, v64
 v_mfma_f32_16x16x32_bf16 v[80:83], a[148:151], v[220:223], v[80:83]
 ds_read_b64_tr_b16 a[192:193], v8 offset:0
 v_add_f32 v18, v18, v28
 v_mfma_f32_16x16x32_bf16 v[80:83], a[152:155], v[224:227], v[80:83]
 buffer_load_dwordx4 v25, s[4:7], s55 offen offset:3072 nt lds
 v_exp_f32 v29, v65
 v_mfma_f32_16x16x32_bf16 v[80:83], a[156:159], v[228:231], v[80:83]
 s_add_u32 s55, s55, 16384
 v_add_f32 v18, v18, v29
 v_cvt_pk_bf16_f32 v136, v28, v29
 v_mfma_f32_16x16x32_bf16 v[84:87], a[144:147], v[232:235], v[52:55]
 ds_read_b64_tr_b16 a[194:195], v8 offset:4096
 v_exp_f32 v30, v66
 v_mfma_f32_16x16x32_bf16 v[84:87], a[148:151], v[236:239], v[84:87]
 ds_read_b64_tr_b16 a[196:197], v8 offset:8192
 v_add_f32 v18, v18, v30
 v_mfma_f32_16x16x32_bf16 v[84:87], a[152:155], v[240:243], v[84:87]
 v_exp_f32 v31, v67
 v_mfma_f32_16x16x32_bf16 v[84:87], a[156:159], v[244:247], v[84:87]
 s_waitcnt lgkmcnt(7)
 v_add_f32 v18, v18, v31
 v_cvt_pk_bf16_f32 v137, v30, v31
 v_mfma_f32_16x16x32_bf16 v[88:91], a[160:163], v[184:187], v[40:43]
 v_exp_f32 v28, v68
 v_mfma_f32_16x16x32_bf16 v[88:91], a[164:167], v[188:191], v[88:91]
 ds_read_b64_tr_b16 a[198:199], v8 offset:12288
 v_add_f32 v19, v19, v28
 v_mfma_f32_16x16x32_bf16 v[88:91], a[168:171], v[192:195], v[88:91]
 v_exp_f32 v29, v69
 v_mfma_f32_16x16x32_bf16 v[88:91], a[172:175], v[196:199], v[88:91]
 v_add_f32 v19, v19, v29
 v_cvt_pk_bf16_f32 v144, v28, v29
 v_mfma_f32_16x16x32_bf16 v[92:95], a[160:163], v[200:203], v[44:47]
 ds_read_b64_tr_b16 a[200:201], v9 offset:0
 v_exp_f32 v30, v70
 v_mfma_f32_16x16x32_bf16 v[92:95], a[164:167], v[204:207], v[92:95]
 ds_read_b64_tr_b16 a[202:203], v9 offset:4096
 v_add_f32 v19, v19, v30
 v_mfma_f32_16x16x32_bf16 v[92:95], a[168:171], v[208:211], v[92:95]
 v_exp_f32 v31, v71
 v_mfma_f32_16x16x32_bf16 v[92:95], a[172:175], v[212:215], v[92:95]
 v_add_f32 v19, v19, v31
 v_cvt_pk_bf16_f32 v145, v30, v31
 v_mfma_f32_16x16x32_bf16 v[96:99], a[160:163], v[216:219], v[48:51]
 v_exp_f32 v28, v72
 v_mfma_f32_16x16x32_bf16 v[96:99], a[164:167], v[220:223], v[96:99]
 ds_read_b64_tr_b16 a[204:205], v9 offset:8192
 v_add_f32 v16, v16, v28
 v_mfma_f32_16x16x32_bf16 v[96:99], a[168:171], v[224:227], v[96:99]
 v_exp_f32 v29, v73
 v_mfma_f32_16x16x32_bf16 v[96:99], a[172:175], v[228:231], v[96:99]
 v_add_f32 v16, v16, v29
 v_cvt_pk_bf16_f32 v122, v28, v29
 v_mfma_f32_16x16x32_bf16 v[100:103], a[160:163], v[232:235], v[52:55]
 ds_read_b64_tr_b16 a[206:207], v9 offset:12288
 v_exp_f32 v30, v74
 v_mfma_f32_16x16x32_bf16 v[100:103], a[164:167], v[236:239], v[100:103]
 ds_read_b64_tr_b16 a[208:209], v10 offset:0
 v_add_f32 v16, v16, v30
 v_mfma_f32_16x16x32_bf16 v[100:103], a[168:171], v[240:243], v[100:103]
 v_exp_f32 v31, v75
 v_mfma_f32_16x16x32_bf16 v[100:103], a[172:175], v[244:247], v[100:103]
 s_waitcnt lgkmcnt(9)
 v_add_f32 v16, v16, v31
 v_cvt_pk_bf16_f32 v123, v30, v31
 v_mfma_f32_16x16x32_bf16 v[104:107], a[176:179], v[184:187], v[40:43]
 v_exp_f32 v28, v76
 v_mfma_f32_16x16x32_bf16 v[104:107], a[180:183], v[188:191], v[104:107]
 ds_read_b64_tr_b16 a[210:211], v10 offset:4096
 v_add_f32 v17, v17, v28
 v_mfma_f32_16x16x32_bf16 v[104:107], a[184:187], v[192:195], v[104:107]
 v_exp_f32 v29, v77
 v_mfma_f32_16x16x32_bf16 v[104:107], a[188:191], v[196:199], v[104:107]
 v_add_f32 v17, v17, v29
 v_cvt_pk_bf16_f32 v130, v28, v29
 v_mfma_f32_16x16x32_bf16 v[108:111], a[176:179], v[200:203], v[44:47]
 ds_read_b64_tr_b16 a[212:213], v10 offset:8192
 v_exp_f32 v30, v78
 v_mfma_f32_16x16x32_bf16 v[108:111], a[180:183], v[204:207], v[108:111]
 ds_read_b64_tr_b16 a[214:215], v10 offset:12288
 v_add_f32 v17, v17, v30
 v_mfma_f32_16x16x32_bf16 v[108:111], a[184:187], v[208:211], v[108:111]
 v_exp_f32 v31, v79
 v_mfma_f32_16x16x32_bf16 v[108:111], a[188:191], v[212:215], v[108:111]
 v_add_f32 v17, v17, v31
 v_cvt_pk_bf16_f32 v131, v30, v31
 v_mfma_f32_16x16x32_bf16 v[112:115], a[176:179], v[216:219], v[48:51]
 v_exp_f32 v28, v80
 v_mfma_f32_16x16x32_bf16 v[112:115], a[180:183], v[220:223], v[112:115]
 ds_read_b64_tr_b16 a[216:217], v11 offset:0
 v_add_f32 v18, v18, v28
 v_mfma_f32_16x16x32_bf16 v[112:115], a[184:187], v[224:227], v[112:115]
 v_exp_f32 v29, v81
 v_mfma_f32_16x16x32_bf16 v[112:115], a[188:191], v[228:231], v[112:115]
 v_add_f32 v18, v18, v29
 v_cvt_pk_bf16_f32 v138, v28, v29
 v_mfma_f32_16x16x32_bf16 v[116:119], a[176:179], v[232:235], v[52:55]
 ds_read_b64_tr_b16 a[218:219], v11 offset:4096
 v_exp_f32 v30, v82
 v_mfma_f32_16x16x32_bf16 v[116:119], a[180:183], v[236:239], v[116:119]
 ds_read_b64_tr_b16 a[220:221], v11 offset:8192
 v_add_f32 v18, v18, v30
 v_mfma_f32_16x16x32_bf16 v[116:119], a[184:187], v[240:243], v[116:119]
 v_exp_f32 v31, v83
 v_mfma_f32_16x16x32_bf16 v[116:119], a[188:191], v[244:247], v[116:119]
 s_waitcnt lgkmcnt(11)
 v_add_f32 v18, v18, v31
 v_cvt_pk_bf16_f32 v139, v30, v31
 v_mfma_f32_16x16x32_bf16 a[0:3], a[192:195], v[152:155], a[0:3]
 s_waitcnt vmcnt(14)
 v_exp_f32 v28, v84
 v_mfma_f32_16x16x32_bf16 a[0:3], a[196:199], v[156:159], a[0:3]
 s_barrier
 ds_read_b64_tr_b16 a[222:223], v11 offset:12288
 v_add_f32 v19, v19, v28
 v_mfma_f32_16x16x32_bf16 a[4:7], a[192:195], v[160:163], a[4:7]
 s_add_u32 m0, s53, 114688
 v_exp_f32 v29, v85
 v_mfma_f32_16x16x32_bf16 a[4:7], a[196:199], v[164:167], a[4:7]
 v_add_f32 v19, v19, v29
 v_cvt_pk_bf16_f32 v146, v28, v29
 v_mfma_f32_16x16x32_bf16 a[8:11], a[192:195], v[168:171], a[8:11]
 ds_read_b64_tr_b16 a[224:225], v12 offset:0
 v_exp_f32 v30, v86
 v_mfma_f32_16x16x32_bf16 a[8:11], a[196:199], v[172:175], a[8:11]
 ds_read_b64_tr_b16 a[226:227], v12 offset:4096
 v_add_f32 v19, v19, v30
 v_mfma_f32_16x16x32_bf16 a[12:15], a[192:195], v[176:179], a[12:15]
 buffer_load_dwordx4 v26, s[8:11], s56 offen offset:0 nt lds
 v_exp_f32 v31, v87
 v_mfma_f32_16x16x32_bf16 a[12:15], a[196:199], v[180:183], a[12:15]
 s_waitcnt lgkmcnt(10)
 v_add_f32 v19, v19, v31
 v_cvt_pk_bf16_f32 v147, v30, v31
 v_mfma_f32_16x16x32_bf16 a[16:19], a[200:203], v[152:155], a[16:19]
 v_exp_f32 v28, v88
 v_mfma_f32_16x16x32_bf16 a[16:19], a[204:207], v[156:159], a[16:19]
 ds_read_b64_tr_b16 a[228:229], v12 offset:8192
 v_add_f32 v16, v16, v28
 v_mfma_f32_16x16x32_bf16 a[20:23], a[200:203], v[160:163], a[20:23]
 buffer_load_dwordx4 v27, s[8:11], s56 offen offset:1024 nt lds
 v_exp_f32 v29, v89
 v_mfma_f32_16x16x32_bf16 a[20:23], a[204:207], v[164:167], a[20:23]
 v_add_f32 v16, v16, v29
 v_cvt_pk_bf16_f32 v124, v28, v29
 v_mfma_f32_16x16x32_bf16 a[24:27], a[200:203], v[168:171], a[24:27]
 ds_read_b64_tr_b16 a[230:231], v12 offset:12288
 v_exp_f32 v30, v90
 v_mfma_f32_16x16x32_bf16 a[24:27], a[204:207], v[172:175], a[24:27]
 ds_read_b64_tr_b16 a[232:233], v13 offset:0
 v_add_f32 v16, v16, v30
 v_mfma_f32_16x16x32_bf16 a[28:31], a[200:203], v[176:179], a[28:31]
 v_exp_f32 v31, v91
 v_mfma_f32_16x16x32_bf16 a[28:31], a[204:207], v[180:183], a[28:31]
 s_waitcnt lgkmcnt(9)
 v_add_f32 v16, v16, v31
 v_cvt_pk_bf16_f32 v125, v30, v31
 v_mfma_f32_16x16x32_bf16 a[32:35], a[208:211], v[152:155], a[32:35]
 v_exp_f32 v28, v92
 v_mfma_f32_16x16x32_bf16 a[32:35], a[212:215], v[156:159], a[32:35]
 ds_read_b64_tr_b16 a[234:235], v13 offset:4096
 v_add_f32 v17, v17, v28
 v_mfma_f32_16x16x32_bf16 a[36:39], a[208:211], v[160:163], a[36:39]
 buffer_load_dwordx4 v26, s[8:11], s56 offen offset:2048 nt lds
 v_exp_f32 v29, v93
 v_mfma_f32_16x16x32_bf16 a[36:39], a[212:215], v[164:167], a[36:39]
 v_add_f32 v17, v17, v29
 v_cvt_pk_bf16_f32 v132, v28, v29
 v_mfma_f32_16x16x32_bf16 a[40:43], a[208:211], v[168:171], a[40:43]
 ds_read_b64_tr_b16 a[236:237], v13 offset:8192
 v_exp_f32 v30, v94
 v_mfma_f32_16x16x32_bf16 a[40:43], a[212:215], v[172:175], a[40:43]
 ds_read_b64_tr_b16 a[238:239], v13 offset:12288
 v_add_f32 v17, v17, v30
 v_mfma_f32_16x16x32_bf16 a[44:47], a[208:211], v[176:179], a[44:47]
 v_exp_f32 v31, v95
 v_mfma_f32_16x16x32_bf16 a[44:47], a[212:215], v[180:183], a[44:47]
 s_waitcnt lgkmcnt(8)
 v_add_f32 v17, v17, v31
 v_cvt_pk_bf16_f32 v133, v30, v31
 v_mfma_f32_16x16x32_bf16 a[48:51], a[216:219], v[152:155], a[48:51]
 v_exp_f32 v28, v96
 v_mfma_f32_16x16x32_bf16 a[48:51], a[220:223], v[156:159], a[48:51]
 ds_read_b64_tr_b16 a[240:241], v14 offset:0
 v_add_f32 v18, v18, v28
 v_mfma_f32_16x16x32_bf16 a[52:55], a[216:219], v[160:163], a[52:55]
 buffer_load_dwordx4 v27, s[8:11], s56 offen offset:3072 nt lds
 v_exp_f32 v29, v97
 v_mfma_f32_16x16x32_bf16 a[52:55], a[220:223], v[164:167], a[52:55]
 s_add_u32 s56, s56, 16384
 v_add_f32 v18, v18, v29
 v_cvt_pk_bf16_f32 v140, v28, v29
 v_mfma_f32_16x16x32_bf16 a[56:59], a[216:219], v[168:171], a[56:59]
 ds_read_b64_tr_b16 a[242:243], v14 offset:4096
 v_exp_f32 v30, v98
 v_mfma_f32_16x16x32_bf16 a[56:59], a[220:223], v[172:175], a[56:59]
 ds_read_b64_tr_b16 a[244:245], v14 offset:8192
 v_add_f32 v18, v18, v30
 s_cmp_eq_u32 s57, 4
 s_cselect_b32 s79, s65, 0x100000
 v_mfma_f32_16x16x32_bf16 a[60:63], a[216:219], v[176:179], a[60:63]
 buffer_store_dword v253, v252, s[32:35], s79 offen sc1
 v_exp_f32 v31, v99
 v_mfma_f32_16x16x32_bf16 a[60:63], a[220:223], v[180:183], a[60:63]
 s_waitcnt lgkmcnt(7)
 v_add_f32 v18, v18, v31
 v_cvt_pk_bf16_f32 v141, v30, v31
 v_mfma_f32_16x16x32_bf16 a[64:67], a[224:227], v[152:155], a[64:67]
 v_exp_f32 v28, v100
 v_mfma_f32_16x16x32_bf16 a[64:67], a[228:231], v[156:159], a[64:67]
 ds_read_b64_tr_b16 a[246:247], v14 offset:12288
 s_waitcnt vmcnt(14)
 buffer_store_dwordx4 v[248:251], v2, s[44:47], s68 offen sc1
 v_add_f32 v19, v19, v28
 v_mfma_f32_16x16x32_bf16 a[68:71], a[224:227], v[160:163], a[68:71]
 v_exp_f32 v29, v101
 v_mfma_f32_16x16x32_bf16 a[68:71], a[228:231], v[164:167], a[68:71]
 v_add_f32 v19, v19, v29
 v_cvt_pk_bf16_f32 v148, v28, v29
 v_mfma_f32_16x16x32_bf16 a[72:75], a[224:227], v[168:171], a[72:75]
 ds_read_b64_tr_b16 a[248:249], v15 offset:0
 v_exp_f32 v30, v102
 v_mfma_f32_16x16x32_bf16 a[72:75], a[228:231], v[172:175], a[72:75]
 ds_read_b64_tr_b16 a[250:251], v15 offset:4096
 s_waitcnt vmcnt(14)
 buffer_store_dwordx4 v[36:39], v2, s[48:51], s68 offen sc1
 v_add_f32 v19, v19, v30
 v_mfma_f32_16x16x32_bf16 a[76:79], a[224:227], v[176:179], a[76:79]
 s_add_u32 s68, s68, 1024
 v_exp_f32 v31, v103
 v_mfma_f32_16x16x32_bf16 a[76:79], a[228:231], v[180:183], a[76:79]
 s_waitcnt lgkmcnt(6)
 v_add_f32 v19, v19, v31
 v_cvt_pk_bf16_f32 v149, v30, v31
 v_mfma_f32_16x16x32_bf16 a[80:83], a[232:235], v[152:155], a[80:83]
 v_exp_f32 v28, v104
 v_mfma_f32_16x16x32_bf16 a[80:83], a[236:239], v[156:159], a[80:83]
 ds_read_b64_tr_b16 a[252:253], v15 offset:8192
 v_add_f32 v16, v16, v28
 v_mfma_f32_16x16x32_bf16 a[84:87], a[232:235], v[160:163], a[84:87]
 v_exp_f32 v29, v105
 v_mfma_f32_16x16x32_bf16 a[84:87], a[236:239], v[164:167], a[84:87]
 v_add_f32 v16, v16, v29
 v_cvt_pk_bf16_f32 v126, v28, v29
 v_mfma_f32_16x16x32_bf16 a[88:91], a[232:235], v[168:171], a[88:91]
 ds_read_b64_tr_b16 a[254:255], v15 offset:12288
 v_exp_f32 v30, v106
 v_mfma_f32_16x16x32_bf16 a[88:91], a[236:239], v[172:175], a[88:91]
 ds_read_b128 a[128:131], v4 offset:49152
 v_add_f32 v16, v16, v30
 v_mfma_f32_16x16x32_bf16 a[92:95], a[232:235], v[176:179], a[92:95]
 v_exp_f32 v31, v107
 v_mfma_f32_16x16x32_bf16 a[92:95], a[236:239], v[180:183], a[92:95]
 s_waitcnt lgkmcnt(5)
 v_add_f32 v16, v16, v31
 v_cvt_pk_bf16_f32 v127, v30, v31
 v_mfma_f32_16x16x32_bf16 a[96:99], a[240:243], v[152:155], a[96:99]
 v_exp_f32 v28, v108
 v_mfma_f32_16x16x32_bf16 a[96:99], a[244:247], v[156:159], a[96:99]
 ds_read_b128 a[132:135], v5 offset:49152
 v_add_f32 v17, v17, v28
 v_mfma_f32_16x16x32_bf16 a[100:103], a[240:243], v[160:163], a[100:103]
 v_exp_f32 v29, v109
 v_mfma_f32_16x16x32_bf16 a[100:103], a[244:247], v[164:167], a[100:103]
 v_add_f32 v17, v17, v29
 v_cvt_pk_bf16_f32 v134, v28, v29
 v_mfma_f32_16x16x32_bf16 a[104:107], a[240:243], v[168:171], a[104:107]
 ds_read_b128 a[136:139], v6 offset:49152
 v_exp_f32 v30, v110
 v_mfma_f32_16x16x32_bf16 a[104:107], a[244:247], v[172:175], a[104:107]
 ds_read_b128 a[140:143], v7 offset:49152
 v_add_f32 v17, v17, v30
 v_mfma_f32_16x16x32_bf16 a[108:111], a[240:243], v[176:179], a[108:111]
 v_exp_f32 v31, v111
 v_mfma_f32_16x16x32_bf16 a[108:111], a[244:247], v[180:183], a[108:111]
 s_waitcnt lgkmcnt(4)
 v_add_f32 v17, v17, v31
 v_cvt_pk_bf16_f32 v135, v30, v31
 v_mfma_f32_16x16x32_bf16 a[112:115], a[248:251], v[152:155], a[112:115]
 v_exp_f32 v28, v112
 v_mfma_f32_16x16x32_bf16 a[112:115], a[252:255], v[156:159], a[112:115]
 ds_read_b128 a[144:147], v4 offset:53248
 v_add_f32 v18, v18, v28
 v_mfma_f32_16x16x32_bf16 a[116:119], a[248:251], v[160:163], a[116:119]
 v_exp_f32 v29, v113
 v_mfma_f32_16x16x32_bf16 a[116:119], a[252:255], v[164:167], a[116:119]
 v_add_f32 v18, v18, v29
 v_cvt_pk_bf16_f32 v142, v28, v29
 v_mfma_f32_16x16x32_bf16 a[120:123], a[248:251], v[168:171], a[120:123]
 ds_read_b128 a[148:151], v5 offset:53248
 v_exp_f32 v30, v114
 v_mfma_f32_16x16x32_bf16 a[120:123], a[252:255], v[172:175], a[120:123]
 ds_read_b128 a[152:155], v6 offset:53248
 v_add_f32 v18, v18, v30
 v_mfma_f32_16x16x32_bf16 a[124:127], a[248:251], v[176:179], a[124:127]
 v_exp_f32 v31, v115
 v_mfma_f32_16x16x32_bf16 a[124:127], a[252:255], v[180:183], a[124:127]
 s_waitcnt lgkmcnt(3)
 v_add_f32 v18, v18, v31
 v_cvt_pk_bf16_f32 v143, v30, v31
 v_mfma_f32_16x16x32_bf16 v[56:59], a[128:131], v[184:187], v[40:43]
 v_exp_f32 v28, v116
 v_mfma_f32_16x16x32_bf16 v[56:59], a[132:135], v[188:191], v[56:59]
 ds_read_b128 a[156:159], v7 offset:53248
 v_add_f32 v19, v19, v28
 v_mfma_f32_16x16x32_bf16 v[56:59], a[136:139], v[192:195], v[56:59]
 s_add_u32 m0, s53, 32768
 v_exp_f32 v29, v117
 v_mfma_f32_16x16x32_bf16 v[56:59], a[140:143], v[196:199], v[56:59]
 v_add_f32 v19, v19, v29
 v_cvt_pk_bf16_f32 v150, v28, v29
 v_mfma_f32_16x16x32_bf16 v[60:63], a[128:131], v[200:203], v[44:47]
 ds_read_b128 a[160:163], v4 offset:57344
 v_exp_f32 v30, v118
 v_mfma_f32_16x16x32_bf16 v[60:63], a[132:135], v[204:207], v[60:63]
 ds_read_b128 a[164:167], v5 offset:57344
 v_add_f32 v19, v19, v30
 v_mfma_f32_16x16x32_bf16 v[60:63], a[136:139], v[208:211], v[60:63]
 buffer_load_dwordx4 v22, s[4:7], s55 offen offset:0 nt lds
 v_exp_f32 v31, v119
 v_mfma_f32_16x16x32_bf16 v[60:63], a[140:143], v[212:215], v[60:63]
 v_add_f32 v19, v19, v31
 v_cvt_pk_bf16_f32 v151, v30, v31
 v_mfma_f32_16x16x32_bf16 v[64:67], a[128:131], v[216:219], v[48:51]
 v_exp_f32 v28, v56
 v_mfma_f32_16x16x32_bf16 v[64:67], a[132:135], v[220:223], v[64:67]
 ds_read_b128 a[168:171], v6 offset:57344
 v_add_f32 v16, v16, v28
 v_mfma_f32_16x16x32_bf16 v[64:67], a[136:139], v[224:227], v[64:67]
 buffer_load_dwordx4 v23, s[4:7], s55 offen offset:1024 nt lds
 v_exp_f32 v29, v57
 v_mfma_f32_16x16x32_bf16 v[64:67], a[140:143], v[228:231], v[64:67]
 v_add_f32 v16, v16, v29
 v_cvt_pk_bf16_f32 v152, v28, v29
 v_mfma_f32_16x16x32_bf16 v[68:71], a[128:131], v[232:235], v[52:55]
 ds_read_b128 a[172:175], v7 offset:57344
 v_exp_f32 v30, v58
 v_mfma_f32_16x16x32_bf16 v[68:71], a[132:135], v[236:239], v[68:71]
 ds_read_b128 a[176:179], v4 offset:61440
 v_add_f32 v16, v16, v30
 v_mfma_f32_16x16x32_bf16 v[68:71], a[136:139], v[240:243], v[68:71]
 v_exp_f32 v31, v59
 v_mfma_f32_16x16x32_bf16 v[68:71], a[140:143], v[244:247], v[68:71]
 s_waitcnt lgkmcnt(5)
 v_add_f32 v16, v16, v31
 v_cvt_pk_bf16_f32 v153, v30, v31
 v_mfma_f32_16x16x32_bf16 v[72:75], a[144:147], v[184:187], v[40:43]
 v_exp_f32 v28, v60
 v_mfma_f32_16x16x32_bf16 v[72:75], a[148:151], v[188:191], v[72:75]
 ds_read_b128 a[180:183], v5 offset:61440
 v_add_f32 v17, v17, v28
 v_mfma_f32_16x16x32_bf16 v[72:75], a[152:155], v[192:195], v[72:75]
 buffer_load_dwordx4 v24, s[4:7], s55 offen offset:2048 nt lds
 v_exp_f32 v29, v61
 v_mfma_f32_16x16x32_bf16 v[72:75], a[156:159], v[196:199], v[72:75]
 v_add_f32 v17, v17, v29
 v_cvt_pk_bf16_f32 v160, v28, v29
 v_mfma_f32_16x16x32_bf16 v[76:79], a[144:147], v[200:203], v[44:47]
 ds_read_b128 a[184:187], v6 offset:61440
 v_exp_f32 v30, v62
 v_mfma_f32_16x16x32_bf16 v[76:79], a[148:151], v[204:207], v[76:79]
 ds_read_b128 a[188:191], v7 offset:61440
 v_add_f32 v17, v17, v30
 v_mfma_f32_16x16x32_bf16 v[76:79], a[152:155], v[208:211], v[76:79]
 v_exp_f32 v31, v63
 v_mfma_f32_16x16x32_bf16 v[76:79], a[156:159], v[212:215], v[76:79]
 v_add_f32 v17, v17, v31
 v_cvt_pk_bf16_f32 v161, v30, v31
 v_mfma_f32_16x16x32_bf16 v[80:83], a[144:147], v[216:219], v[48:51]
 v_exp_f32 v28, v64
 v_mfma_f32_16x16x32_bf16 v[80:83], a[148:151], v[220:223], v[80:83]
 ds_read_b64_tr_b16 a[192:193], v8 offset:16384
 v_add_f32 v18, v18, v28
 v_mfma_f32_16x16x32_bf16 v[80:83], a[152:155], v[224:227], v[80:83]
 buffer_load_dwordx4 v25, s[4:7], s55 offen offset:3072 nt lds
 v_exp_f32 v29, v65
 v_mfma_f32_16x16x32_bf16 v[80:83], a[156:159], v[228:231], v[80:83]
 s_add_u32 s55, s55, 16384
 v_add_f32 v18, v18, v29
 v_cvt_pk_bf16_f32 v168, v28, v29
 v_mfma_f32_16x16x32_bf16 v[84:87], a[144:147], v[232:235], v[52:55]
 ds_read_b64_tr_b16 a[194:195], v8 offset:20480
 v_exp_f32 v30, v66
 v_mfma_f32_16x16x32_bf16 v[84:87], a[148:151], v[236:239], v[84:87]
 ds_read_b64_tr_b16 a[196:197], v8 offset:24576
 v_add_f32 v18, v18, v30
 v_mfma_f32_16x16x32_bf16 v[84:87], a[152:155], v[240:243], v[84:87]
 v_exp_f32 v31, v67
 v_mfma_f32_16x16x32_bf16 v[84:87], a[156:159], v[244:247], v[84:87]
 s_waitcnt lgkmcnt(7)
 v_add_f32 v18, v18, v31
 v_cvt_pk_bf16_f32 v169, v30, v31
 v_mfma_f32_16x16x32_bf16 v[88:91], a[160:163], v[184:187], v[40:43]
 buffer_load_dwordx4 v[248:251], v21, s[36:39], 0 offen nt
 v_exp_f32 v28, v68
 v_mfma_f32_16x16x32_bf16 v[88:91], a[164:167], v[188:191], v[88:91]
 ds_read_b64_tr_b16 a[198:199], v8 offset:28672
 v_add_f32 v19, v19, v28
 v_mfma_f32_16x16x32_bf16 v[88:91], a[168:171], v[192:195], v[88:91]
 v_exp_f32 v29, v69
 v_mfma_f32_16x16x32_bf16 v[88:91], a[172:175], v[196:199], v[88:91]
 v_add_f32 v19, v19, v29
 v_cvt_pk_bf16_f32 v176, v28, v29
 v_mfma_f32_16x16x32_bf16 v[92:95], a[160:163], v[200:203], v[44:47]
 ds_read_b64_tr_b16 a[200:201], v9 offset:16384
 v_exp_f32 v30, v70
 v_mfma_f32_16x16x32_bf16 v[92:95], a[164:167], v[204:207], v[92:95]
 ds_read_b64_tr_b16 a[202:203], v9 offset:20480
 v_add_f32 v19, v19, v30
 v_mfma_f32_16x16x32_bf16 v[92:95], a[168:171], v[208:211], v[92:95]
 v_exp_f32 v31, v71
 v_mfma_f32_16x16x32_bf16 v[92:95], a[172:175], v[212:215], v[92:95]
 v_add_f32 v19, v19, v31
 v_cvt_pk_bf16_f32 v177, v30, v31
 v_mfma_f32_16x16x32_bf16 v[96:99], a[160:163], v[216:219], v[48:51]
 buffer_load_dwordx4 v[36:39], v21, s[40:43], 0 offen nt
 v_exp_f32 v28, v72
 v_mfma_f32_16x16x32_bf16 v[96:99], a[164:167], v[220:223], v[96:99]
 ds_read_b64_tr_b16 a[204:205], v9 offset:24576
 v_add_f32 v16, v16, v28
 v_mfma_f32_16x16x32_bf16 v[96:99], a[168:171], v[224:227], v[96:99]
 v_exp_f32 v29, v73
 v_mfma_f32_16x16x32_bf16 v[96:99], a[172:175], v[228:231], v[96:99]
 v_add_f32 v16, v16, v29
 v_cvt_pk_bf16_f32 v154, v28, v29
 v_mfma_f32_16x16x32_bf16 v[100:103], a[160:163], v[232:235], v[52:55]
 ds_read_b64_tr_b16 a[206:207], v9 offset:28672
 v_exp_f32 v30, v74
 v_mfma_f32_16x16x32_bf16 v[100:103], a[164:167], v[236:239], v[100:103]
 ds_read_b64_tr_b16 a[208:209], v10 offset:16384
 v_add_f32 v16, v16, v30
 v_mfma_f32_16x16x32_bf16 v[100:103], a[168:171], v[240:243], v[100:103]
 v_exp_f32 v31, v75
 v_mfma_f32_16x16x32_bf16 v[100:103], a[172:175], v[244:247], v[100:103]
 s_waitcnt lgkmcnt(9)
 v_add_f32 v16, v16, v31
 v_cvt_pk_bf16_f32 v155, v30, v31
 v_mfma_f32_16x16x32_bf16 v[104:107], a[176:179], v[184:187], v[40:43]
 v_exp_f32 v28, v76
 v_mfma_f32_16x16x32_bf16 v[104:107], a[180:183], v[188:191], v[104:107]
 ds_read_b64_tr_b16 a[210:211], v10 offset:20480
 v_add_f32 v17, v17, v28
 v_mfma_f32_16x16x32_bf16 v[104:107], a[184:187], v[192:195], v[104:107]
 v_exp_f32 v29, v77
 v_mfma_f32_16x16x32_bf16 v[104:107], a[188:191], v[196:199], v[104:107]
 v_add_f32 v17, v17, v29
 v_cvt_pk_bf16_f32 v162, v28, v29
 v_mfma_f32_16x16x32_bf16 v[108:111], a[176:179], v[200:203], v[44:47]
 ds_read_b64_tr_b16 a[212:213], v10 offset:24576
 v_exp_f32 v30, v78
 v_mfma_f32_16x16x32_bf16 v[108:111], a[180:183], v[204:207], v[108:111]
 ds_read_b64_tr_b16 a[214:215], v10 offset:28672
 v_add_f32 v17, v17, v30
 v_mfma_f32_16x16x32_bf16 v[108:111], a[184:187], v[208:211], v[108:111]
 v_exp_f32 v31, v79
 v_mfma_f32_16x16x32_bf16 v[108:111], a[188:191], v[212:215], v[108:111]
 v_add_f32 v17, v17, v31
 v_cvt_pk_bf16_f32 v163, v30, v31
 v_mfma_f32_16x16x32_bf16 v[112:115], a[176:179], v[216:219], v[48:51]
 v_exp_f32 v28, v80
 v_mfma_f32_16x16x32_bf16 v[112:115], a[180:183], v[220:223], v[112:115]
 ds_read_b64_tr_b16 a[216:217], v11 offset:16384
 v_add_f32 v18, v18, v28
 v_mfma_f32_16x16x32_bf16 v[112:115], a[184:187], v[224:227], v[112:115]
 v_exp_f32 v29, v81
 v_mfma_f32_16x16x32_bf16 v[112:115], a[188:191], v[228:231], v[112:115]
 v_add_f32 v18, v18, v29
 v_cvt_pk_bf16_f32 v170, v28, v29
 v_mfma_f32_16x16x32_bf16 v[116:119], a[176:179], v[232:235], v[52:55]
 ds_read_b64_tr_b16 a[218:219], v11 offset:20480
 v_exp_f32 v30, v82
 v_mfma_f32_16x16x32_bf16 v[116:119], a[180:183], v[236:239], v[116:119]
 ds_read_b64_tr_b16 a[220:221], v11 offset:24576
 v_add_f32 v18, v18, v30
 v_mfma_f32_16x16x32_bf16 v[116:119], a[184:187], v[240:243], v[116:119]
 v_exp_f32 v31, v83
 v_mfma_f32_16x16x32_bf16 v[116:119], a[188:191], v[244:247], v[116:119]
 s_waitcnt lgkmcnt(11)
 v_add_f32 v18, v18, v31
 v_cvt_pk_bf16_f32 v171, v30, v31
 v_mfma_f32_16x16x32_bf16 a[0:3], a[192:195], v[120:123], a[0:3]
 s_waitcnt vmcnt(17)
 v_exp_f32 v28, v84
 v_mul_u32_u24 v21, 3641, v20
 v_mfma_f32_16x16x32_bf16 a[0:3], a[196:199], v[124:127], a[0:3]
 s_barrier
 ds_read_b64_tr_b16 a[222:223], v11 offset:28672
 v_add_f32 v19, v19, v28
 v_lshrrev_b32 v21, 16, v21
 v_mfma_f32_16x16x32_bf16 a[4:7], a[192:195], v[128:131], a[4:7]
 s_add_u32 m0, s53, 65536
 v_exp_f32 v29, v85
 v_mul_u32_u24 v21, 864, v21
 v_mfma_f32_16x16x32_bf16 a[4:7], a[196:199], v[132:135], a[4:7]
 v_add_f32 v19, v19, v29
 v_cvt_pk_bf16_f32 v178, v28, v29
 v_lshl_add_u32 v21, v20, 4, v21
 v_mfma_f32_16x16x32_bf16 a[8:11], a[192:195], v[136:139], a[8:11]
 ds_read_b64_tr_b16 a[224:225], v12 offset:16384
 v_exp_f32 v30, v86
 v_mfma_f32_16x16x32_bf16 a[8:11], a[196:199], v[140:143], a[8:11]
 ds_read_b64_tr_b16 a[226:227], v12 offset:20480
 v_add_f32 v19, v19, v30
 v_add_u32 v20, 64, v20
 v_mfma_f32_16x16x32_bf16 a[12:15], a[192:195], v[144:147], a[12:15]
 buffer_load_dwordx4 v26, s[8:11], s56 offen offset:0 nt lds
 v_exp_f32 v31, v87
 v_mfma_f32_16x16x32_bf16 a[12:15], a[196:199], v[148:151], a[12:15]
 s_waitcnt lgkmcnt(10)
 v_add_f32 v19, v19, v31
 v_cvt_pk_bf16_f32 v179, v30, v31
 v_mfma_f32_16x16x32_bf16 a[16:19], a[200:203], v[120:123], a[16:19]
 v_exp_f32 v28, v88
 v_mfma_f32_16x16x32_bf16 a[16:19], a[204:207], v[124:127], a[16:19]
 ds_read_b64_tr_b16 a[228:229], v12 offset:24576
 v_add_f32 v16, v16, v28
 v_mfma_f32_16x16x32_bf16 a[20:23], a[200:203], v[128:131], a[20:23]
 buffer_load_dwordx4 v27, s[8:11], s56 offen offset:1024 nt lds
 v_exp_f32 v29, v89
 v_mfma_f32_16x16x32_bf16 a[20:23], a[204:207], v[132:135], a[20:23]
 v_add_f32 v16, v16, v29
 v_cvt_pk_bf16_f32 v156, v28, v29
 v_mfma_f32_16x16x32_bf16 a[24:27], a[200:203], v[136:139], a[24:27]
 ds_read_b64_tr_b16 a[230:231], v12 offset:28672
 v_exp_f32 v30, v90
 v_mfma_f32_16x16x32_bf16 a[24:27], a[204:207], v[140:143], a[24:27]
 ds_read_b64_tr_b16 a[232:233], v13 offset:16384
 v_add_f32 v16, v16, v30
 v_mfma_f32_16x16x32_bf16 a[28:31], a[200:203], v[144:147], a[28:31]
 v_exp_f32 v31, v91
 v_mfma_f32_16x16x32_bf16 a[28:31], a[204:207], v[148:151], a[28:31]
 s_waitcnt lgkmcnt(9)
 v_add_f32 v16, v16, v31
 v_cvt_pk_bf16_f32 v157, v30, v31
 v_mfma_f32_16x16x32_bf16 a[32:35], a[208:211], v[120:123], a[32:35]
 v_exp_f32 v28, v92
 v_mfma_f32_16x16x32_bf16 a[32:35], a[212:215], v[124:127], a[32:35]
 ds_read_b64_tr_b16 a[234:235], v13 offset:20480
 v_add_f32 v17, v17, v28
 v_mfma_f32_16x16x32_bf16 a[36:39], a[208:211], v[128:131], a[36:39]
 buffer_load_dwordx4 v26, s[8:11], s56 offen offset:2048 nt lds
 v_exp_f32 v29, v93
 v_mfma_f32_16x16x32_bf16 a[36:39], a[212:215], v[132:135], a[36:39]
 v_add_f32 v17, v17, v29
 v_cvt_pk_bf16_f32 v164, v28, v29
 v_mfma_f32_16x16x32_bf16 a[40:43], a[208:211], v[136:139], a[40:43]
 ds_read_b64_tr_b16 a[236:237], v13 offset:24576
 v_exp_f32 v30, v94
 v_mfma_f32_16x16x32_bf16 a[40:43], a[212:215], v[140:143], a[40:43]
 ds_read_b64_tr_b16 a[238:239], v13 offset:28672
 v_add_f32 v17, v17, v30
 v_mfma_f32_16x16x32_bf16 a[44:47], a[208:211], v[144:147], a[44:47]
 v_exp_f32 v31, v95
 v_mfma_f32_16x16x32_bf16 a[44:47], a[212:215], v[148:151], a[44:47]
 s_waitcnt lgkmcnt(8)
 v_add_f32 v17, v17, v31
 v_cvt_pk_bf16_f32 v165, v30, v31
 v_mfma_f32_16x16x32_bf16 a[48:51], a[216:219], v[120:123], a[48:51]
 v_exp_f32 v28, v96
 v_mfma_f32_16x16x32_bf16 a[48:51], a[220:223], v[124:127], a[48:51]
 ds_read_b64_tr_b16 a[240:241], v14 offset:16384
 v_add_f32 v18, v18, v28
 v_mfma_f32_16x16x32_bf16 a[52:55], a[216:219], v[128:131], a[52:55]
 buffer_load_dwordx4 v27, s[8:11], s56 offen offset:3072 nt lds
 v_exp_f32 v29, v97
 v_mfma_f32_16x16x32_bf16 a[52:55], a[220:223], v[132:135], a[52:55]
 s_add_u32 s56, s56, 16384
 v_add_f32 v18, v18, v29
 v_cvt_pk_bf16_f32 v172, v28, v29
 v_mfma_f32_16x16x32_bf16 a[56:59], a[216:219], v[136:139], a[56:59]
 ds_read_b64_tr_b16 a[242:243], v14 offset:20480
 v_exp_f32 v30, v98
 v_mfma_f32_16x16x32_bf16 a[56:59], a[220:223], v[140:143], a[56:59]
 ds_read_b64_tr_b16 a[244:245], v14 offset:24576
 v_add_f32 v18, v18, v30
 v_mfma_f32_16x16x32_bf16 a[60:63], a[216:219], v[144:147], a[60:63]
 v_exp_f32 v31, v99
 v_mfma_f32_16x16x32_bf16 a[60:63], a[220:223], v[148:151], a[60:63]
 s_waitcnt lgkmcnt(7)
 v_add_f32 v18, v18, v31
 v_cvt_pk_bf16_f32 v173, v30, v31
 v_mfma_f32_16x16x32_bf16 a[64:67], a[224:227], v[120:123], a[64:67]
 v_exp_f32 v28, v100
 v_mfma_f32_16x16x32_bf16 a[64:67], a[228:231], v[124:127], a[64:67]
 ds_read_b64_tr_b16 a[246:247], v14 offset:28672
 v_add_f32 v19, v19, v28
 v_mfma_f32_16x16x32_bf16 a[68:71], a[224:227], v[128:131], a[68:71]
 v_exp_f32 v29, v101
 v_mfma_f32_16x16x32_bf16 a[68:71], a[228:231], v[132:135], a[68:71]
 v_add_f32 v19, v19, v29
 v_cvt_pk_bf16_f32 v180, v28, v29
 v_mfma_f32_16x16x32_bf16 a[72:75], a[224:227], v[136:139], a[72:75]
 ds_read_b64_tr_b16 a[248:249], v15 offset:16384
 v_exp_f32 v30, v102
 v_mfma_f32_16x16x32_bf16 a[72:75], a[228:231], v[140:143], a[72:75]
 ds_read_b64_tr_b16 a[250:251], v15 offset:20480
 v_add_f32 v19, v19, v30
 v_mfma_f32_16x16x32_bf16 a[76:79], a[224:227], v[144:147], a[76:79]
 v_exp_f32 v31, v103
 v_mfma_f32_16x16x32_bf16 a[76:79], a[228:231], v[148:151], a[76:79]
 s_waitcnt lgkmcnt(6)
 v_add_f32 v19, v19, v31
 v_cvt_pk_bf16_f32 v181, v30, v31
 v_mfma_f32_16x16x32_bf16 a[80:83], a[232:235], v[120:123], a[80:83]
 v_exp_f32 v28, v104
 v_mfma_f32_16x16x32_bf16 a[80:83], a[236:239], v[124:127], a[80:83]
 ds_read_b64_tr_b16 a[252:253], v15 offset:24576
 v_add_f32 v16, v16, v28
 v_mfma_f32_16x16x32_bf16 a[84:87], a[232:235], v[128:131], a[84:87]
 v_exp_f32 v29, v105
 v_mfma_f32_16x16x32_bf16 a[84:87], a[236:239], v[132:135], a[84:87]
 v_add_f32 v16, v16, v29
 v_cvt_pk_bf16_f32 v158, v28, v29
 v_mfma_f32_16x16x32_bf16 a[88:91], a[232:235], v[136:139], a[88:91]
 ds_read_b64_tr_b16 a[254:255], v15 offset:28672
 v_exp_f32 v30, v106
 v_mfma_f32_16x16x32_bf16 a[88:91], a[236:239], v[140:143], a[88:91]
 ds_read_b128 a[128:131], v4 offset:0
 v_add_f32 v16, v16, v30
 v_mfma_f32_16x16x32_bf16 a[92:95], a[232:235], v[144:147], a[92:95]
 v_exp_f32 v31, v107
 v_mfma_f32_16x16x32_bf16 a[92:95], a[236:239], v[148:151], a[92:95]
 s_waitcnt lgkmcnt(5)
 v_add_f32 v16, v16, v31
 v_cvt_pk_bf16_f32 v159, v30, v31
 v_mfma_f32_16x16x32_bf16 a[96:99], a[240:243], v[120:123], a[96:99]
 v_exp_f32 v28, v108
 v_mfma_f32_16x16x32_bf16 a[96:99], a[244:247], v[124:127], a[96:99]
 ds_read_b128 a[132:135], v5 offset:0
 v_add_f32 v17, v17, v28
 v_mfma_f32_16x16x32_bf16 a[100:103], a[240:243], v[128:131], a[100:103]
 v_exp_f32 v29, v109
 v_mfma_f32_16x16x32_bf16 a[100:103], a[244:247], v[132:135], a[100:103]
 v_add_f32 v17, v17, v29
 v_cvt_pk_bf16_f32 v166, v28, v29
 v_mfma_f32_16x16x32_bf16 a[104:107], a[240:243], v[136:139], a[104:107]
 ds_read_b128 a[136:139], v6 offset:0
 v_exp_f32 v30, v110
 v_mfma_f32_16x16x32_bf16 a[104:107], a[244:247], v[140:143], a[104:107]
 ds_read_b128 a[140:143], v7 offset:0
 v_add_f32 v17, v17, v30
 v_mfma_f32_16x16x32_bf16 a[108:111], a[240:243], v[144:147], a[108:111]
 v_exp_f32 v31, v111
 v_mfma_f32_16x16x32_bf16 a[108:111], a[244:247], v[148:151], a[108:111]
 s_waitcnt lgkmcnt(4)
 v_add_f32 v17, v17, v31
 v_cvt_pk_bf16_f32 v167, v30, v31
 v_mfma_f32_16x16x32_bf16 a[112:115], a[248:251], v[120:123], a[112:115]
 v_exp_f32 v28, v112
 v_mfma_f32_16x16x32_bf16 a[112:115], a[252:255], v[124:127], a[112:115]
 ds_read_b128 a[144:147], v4 offset:4096
 v_add_f32 v18, v18, v28
 v_mfma_f32_16x16x32_bf16 a[116:119], a[248:251], v[128:131], a[116:119]
 v_exp_f32 v29, v113
 v_mfma_f32_16x16x32_bf16 a[116:119], a[252:255], v[132:135], a[116:119]
 v_add_f32 v18, v18, v29
 v_cvt_pk_bf16_f32 v174, v28, v29
 v_mfma_f32_16x16x32_bf16 a[120:123], a[248:251], v[136:139], a[120:123]
 ds_read_b128 a[148:151], v5 offset:4096
 v_exp_f32 v30, v114
 v_mfma_f32_16x16x32_bf16 a[120:123], a[252:255], v[140:143], a[120:123]
 ds_read_b128 a[152:155], v6 offset:4096
 v_add_f32 v18, v18, v30
 v_mfma_f32_16x16x32_bf16 a[124:127], a[248:251], v[144:147], a[124:127]
 v_exp_f32 v31, v115
 v_mfma_f32_16x16x32_bf16 a[124:127], a[252:255], v[148:151], a[124:127]
 s_waitcnt lgkmcnt(3)
 v_add_f32 v18, v18, v31
 v_cvt_pk_bf16_f32 v175, v30, v31
 v_mfma_f32_16x16x32_bf16 v[56:59], a[128:131], v[184:187], v[40:43]
 v_exp_f32 v28, v116
 v_mfma_f32_16x16x32_bf16 v[56:59], a[132:135], v[188:191], v[56:59]
 ds_read_b128 a[156:159], v7 offset:4096
 v_add_f32 v19, v19, v28
 v_mfma_f32_16x16x32_bf16 v[56:59], a[136:139], v[192:195], v[56:59]
 s_add_u32 m0, s53, 49152
 v_exp_f32 v29, v117
 v_mfma_f32_16x16x32_bf16 v[56:59], a[140:143], v[196:199], v[56:59]
 v_add_f32 v19, v19, v29
 v_cvt_pk_bf16_f32 v182, v28, v29
 v_mfma_f32_16x16x32_bf16 v[60:63], a[128:131], v[200:203], v[44:47]
 ds_read_b128 a[160:163], v4 offset:8192
 v_exp_f32 v30, v118
 v_mfma_f32_16x16x32_bf16 v[60:63], a[132:135], v[204:207], v[60:63]
 ds_read_b128 a[164:167], v5 offset:8192
 v_add_f32 v19, v19, v30
 v_mfma_f32_16x16x32_bf16 v[60:63], a[136:139], v[208:211], v[60:63]
 buffer_load_dwordx4 v22, s[4:7], s55 offen offset:0 nt lds
 v_exp_f32 v31, v119
 v_mfma_f32_16x16x32_bf16 v[60:63], a[140:143], v[212:215], v[60:63]
 v_add_f32 v19, v19, v31
 v_cvt_pk_bf16_f32 v183, v30, v31
 v_mfma_f32_16x16x32_bf16 v[64:67], a[128:131], v[216:219], v[48:51]
 v_exp_f32 v28, v56
 v_mfma_f32_16x16x32_bf16 v[64:67], a[132:135], v[220:223], v[64:67]
 ds_read_b128 a[168:171], v6 offset:8192
 v_add_f32 v16, v16, v28
 v_mfma_f32_16x16x32_bf16 v[64:67], a[136:139], v[224:227], v[64:67]
 buffer_load_dwordx4 v23, s[4:7], s55 offen offset:1024 nt lds
 v_exp_f32 v29, v57
 v_mfma_f32_16x16x32_bf16 v[64:67], a[140:143], v[228:231], v[64:67]
 v_add_f32 v16, v16, v29
 v_cvt_pk_bf16_f32 v120, v28, v29
 v_mfma_f32_16x16x32_bf16 v[68:71], a[128:131], v[232:235], v[52:55]
 ds_read_b128 a[172:175], v7 offset:8192
 v_exp_f32 v30, v58
 v_mfma_f32_16x16x32_bf16 v[68:71], a[132:135], v[236:239], v[68:71]
 ds_read_b128 a[176:179], v4 offset:12288
 v_add_f32 v16, v16, v30
 v_mfma_f32_16x16x32_bf16 v[68:71], a[136:139], v[240:243], v[68:71]
 v_exp_f32 v31, v59
 v_mfma_f32_16x16x32_bf16 v[68:71], a[140:143], v[244:247], v[68:71]
 s_waitcnt lgkmcnt(5)
 v_add_f32 v16, v16, v31
 v_cvt_pk_bf16_f32 v121, v30, v31
 v_mfma_f32_16x16x32_bf16 v[72:75], a[144:147], v[184:187], v[40:43]
 v_exp_f32 v28, v60
 v_mfma_f32_16x16x32_bf16 v[72:75], a[148:151], v[188:191], v[72:75]
 ds_read_b128 a[180:183], v5 offset:12288
 v_add_f32 v17, v17, v28
 v_mfma_f32_16x16x32_bf16 v[72:75], a[152:155], v[192:195], v[72:75]
 buffer_load_dwordx4 v24, s[4:7], s55 offen offset:2048 nt lds
 v_exp_f32 v29, v61
 v_mfma_f32_16x16x32_bf16 v[72:75], a[156:159], v[196:199], v[72:75]
 v_add_f32 v17, v17, v29
 v_cvt_pk_bf16_f32 v128, v28, v29
 v_mfma_f32_16x16x32_bf16 v[76:79], a[144:147], v[200:203], v[44:47]
 ds_read_b128 a[184:187], v6 offset:12288
 v_exp_f32 v30, v62
 v_mfma_f32_16x16x32_bf16 v[76:79], a[148:151], v[204:207], v[76:79]
 ds_read_b128 a[188:191], v7 offset:12288
 v_add_f32 v17, v17, v30
 v_mfma_f32_16x16x32_bf16 v[76:79], a[152:155], v[208:211], v[76:79]
 v_exp_f32 v31, v63
 v_mfma_f32_16x16x32_bf16 v[76:79], a[156:159], v[212:215], v[76:79]
 v_add_f32 v17, v17, v31
 v_cvt_pk_bf16_f32 v129, v30, v31
 v_mfma_f32_16x16x32_bf16 v[80:83], a[144:147], v[216:219], v[48:51]
 v_exp_f32 v28, v64
 v_mfma_f32_16x16x32_bf16 v[80:83], a[148:151], v[220:223], v[80:83]
 ds_read_b64_tr_b16 a[192:193], v8 offset:32768
 v_add_f32 v18, v18, v28
 v_mfma_f32_16x16x32_bf16 v[80:83], a[152:155], v[224:227], v[80:83]
 buffer_load_dwordx4 v25, s[4:7], s55 offen offset:3072 nt lds
 v_exp_f32 v29, v65
 v_mfma_f32_16x16x32_bf16 v[80:83], a[156:159], v[228:231], v[80:83]
 s_add_u32 s55, s55, 16384
 v_add_f32 v18, v18, v29
 v_cvt_pk_bf16_f32 v136, v28, v29
 v_mfma_f32_16x16x32_bf16 v[84:87], a[144:147], v[232:235], v[52:55]
 ds_read_b64_tr_b16 a[194:195], v8 offset:36864
 v_exp_f32 v30, v66
 v_mfma_f32_16x16x32_bf16 v[84:87], a[148:151], v[236:239], v[84:87]
 ds_read_b64_tr_b16 a[196:197], v8 offset:40960
 v_add_f32 v18, v18, v30
 v_mfma_f32_16x16x32_bf16 v[84:87], a[152:155], v[240:243], v[84:87]
 v_exp_f32 v31, v67
 v_mfma_f32_16x16x32_bf16 v[84:87], a[156:159], v[244:247], v[84:87]
 s_waitcnt lgkmcnt(7)
 v_add_f32 v18, v18, v31
 v_cvt_pk_bf16_f32 v137, v30, v31
 v_mfma_f32_16x16x32_bf16 v[88:91], a[160:163], v[184:187], v[40:43]
 global_load_dword v34, v[32:33], off
 v_exp_f32 v28, v68
 v_mfma_f32_16x16x32_bf16 v[88:91], a[164:167], v[188:191], v[88:91]
 ds_read_b64_tr_b16 a[198:199], v8 offset:45056
 v_add_f32 v19, v19, v28
 v_mfma_f32_16x16x32_bf16 v[88:91], a[168:171], v[192:195], v[88:91]
 v_exp_f32 v29, v69
 v_mfma_f32_16x16x32_bf16 v[88:91], a[172:175], v[196:199], v[88:91]
 v_add_f32 v19, v19, v29
 v_cvt_pk_bf16_f32 v144, v28, v29
 v_mfma_f32_16x16x32_bf16 v[92:95], a[160:163], v[200:203], v[44:47]
 ds_read_b64_tr_b16 a[200:201], v9 offset:32768
 v_exp_f32 v30, v70
 v_mfma_f32_16x16x32_bf16 v[92:95], a[164:167], v[204:207], v[92:95]
 ds_read_b64_tr_b16 a[202:203], v9 offset:36864
 v_add_f32 v19, v19, v30
 v_mfma_f32_16x16x32_bf16 v[92:95], a[168:171], v[208:211], v[92:95]
 v_exp_f32 v31, v71
 v_mfma_f32_16x16x32_bf16 v[92:95], a[172:175], v[212:215], v[92:95]
 v_add_f32 v19, v19, v31
 v_cvt_pk_bf16_f32 v145, v30, v31
 v_mfma_f32_16x16x32_bf16 v[96:99], a[160:163], v[216:219], v[48:51]
 v_exp_f32 v28, v72
 v_mfma_f32_16x16x32_bf16 v[96:99], a[164:167], v[220:223], v[96:99]
 ds_read_b64_tr_b16 a[204:205], v9 offset:40960
 v_add_f32 v16, v16, v28
 v_mfma_f32_16x16x32_bf16 v[96:99], a[168:171], v[224:227], v[96:99]
 v_exp_f32 v29, v73
 v_mfma_f32_16x16x32_bf16 v[96:99], a[172:175], v[228:231], v[96:99]
 v_add_f32 v16, v16, v29
 v_cvt_pk_bf16_f32 v122, v28, v29
 v_mfma_f32_16x16x32_bf16 v[100:103], a[160:163], v[232:235], v[52:55]
 ds_read_b64_tr_b16 a[206:207], v9 offset:45056
 v_exp_f32 v30, v74
 v_mfma_f32_16x16x32_bf16 v[100:103], a[164:167], v[236:239], v[100:103]
 ds_read_b64_tr_b16 a[208:209], v10 offset:32768
 v_add_f32 v16, v16, v30
 v_mfma_f32_16x16x32_bf16 v[100:103], a[168:171], v[240:243], v[100:103]
 v_exp_f32 v31, v75
 v_mfma_f32_16x16x32_bf16 v[100:103], a[172:175], v[244:247], v[100:103]
 s_waitcnt lgkmcnt(9)
 v_add_f32 v16, v16, v31
 v_cvt_pk_bf16_f32 v123, v30, v31
 v_mfma_f32_16x16x32_bf16 v[104:107], a[176:179], v[184:187], v[40:43]
 v_exp_f32 v28, v76
 v_mfma_f32_16x16x32_bf16 v[104:107], a[180:183], v[188:191], v[104:107]
 ds_read_b64_tr_b16 a[210:211], v10 offset:36864
 v_add_f32 v17, v17, v28
 v_mfma_f32_16x16x32_bf16 v[104:107], a[184:187], v[192:195], v[104:107]
 v_exp_f32 v29, v77
 v_mfma_f32_16x16x32_bf16 v[104:107], a[188:191], v[196:199], v[104:107]
 v_add_f32 v17, v17, v29
 v_cvt_pk_bf16_f32 v130, v28, v29
 v_mfma_f32_16x16x32_bf16 v[108:111], a[176:179], v[200:203], v[44:47]
 ds_read_b64_tr_b16 a[212:213], v10 offset:40960
 v_exp_f32 v30, v78
 v_mfma_f32_16x16x32_bf16 v[108:111], a[180:183], v[204:207], v[108:111]
 ds_read_b64_tr_b16 a[214:215], v10 offset:45056
 v_add_f32 v17, v17, v30
 v_mfma_f32_16x16x32_bf16 v[108:111], a[184:187], v[208:211], v[108:111]
 v_exp_f32 v31, v79
 v_mfma_f32_16x16x32_bf16 v[108:111], a[188:191], v[212:215], v[108:111]
 v_add_f32 v17, v17, v31
 v_cvt_pk_bf16_f32 v131, v30, v31
 v_mfma_f32_16x16x32_bf16 v[112:115], a[176:179], v[216:219], v[48:51]
 v_exp_f32 v28, v80
 v_mfma_f32_16x16x32_bf16 v[112:115], a[180:183], v[220:223], v[112:115]
 ds_read_b64_tr_b16 a[216:217], v11 offset:32768
 v_add_f32 v18, v18, v28
 v_mfma_f32_16x16x32_bf16 v[112:115], a[184:187], v[224:227], v[112:115]
 v_exp_f32 v29, v81
 v_mfma_f32_16x16x32_bf16 v[112:115], a[188:191], v[228:231], v[112:115]
 v_add_f32 v18, v18, v29
 v_cvt_pk_bf16_f32 v138, v28, v29
 v_mfma_f32_16x16x32_bf16 v[116:119], a[176:179], v[232:235], v[52:55]
 ds_read_b64_tr_b16 a[218:219], v11 offset:36864
 v_exp_f32 v30, v82
 v_mfma_f32_16x16x32_bf16 v[116:119], a[180:183], v[236:239], v[116:119]
 ds_read_b64_tr_b16 a[220:221], v11 offset:40960
 v_add_f32 v18, v18, v30
 v_mfma_f32_16x16x32_bf16 v[116:119], a[184:187], v[240:243], v[116:119]
 v_exp_f32 v31, v83
 v_mfma_f32_16x16x32_bf16 v[116:119], a[188:191], v[244:247], v[116:119]
 s_waitcnt lgkmcnt(11)
 v_add_f32 v18, v18, v31
 v_cvt_pk_bf16_f32 v139, v30, v31
 v_mfma_f32_16x16x32_bf16 a[0:3], a[192:195], v[152:155], a[0:3]
 s_waitcnt vmcnt(18)
 v_exp_f32 v28, v84
 v_mfma_f32_16x16x32_bf16 a[0:3], a[196:199], v[156:159], a[0:3]
 s_barrier
 ds_read_b64_tr_b16 a[222:223], v11 offset:45056
 v_add_f32 v19, v19, v28
 v_mfma_f32_16x16x32_bf16 a[4:7], a[192:195], v[160:163], a[4:7]
 s_add_u32 m0, s53, 81920
 v_exp_f32 v29, v85
 v_mfma_f32_16x16x32_bf16 a[4:7], a[196:199], v[164:167], a[4:7]
 v_add_f32 v19, v19, v29
 v_cvt_pk_bf16_f32 v146, v28, v29
 v_mfma_f32_16x16x32_bf16 a[8:11], a[192:195], v[168:171], a[8:11]
 ds_read_b64_tr_b16 a[224:225], v12 offset:32768
 v_exp_f32 v30, v86
 v_mfma_f32_16x16x32_bf16 a[8:11], a[196:199], v[172:175], a[8:11]
 ds_read_b64_tr_b16 a[226:227], v12 offset:36864
 v_add_f32 v19, v19, v30
 v_mfma_f32_16x16x32_bf16 a[12:15], a[192:195], v[176:179], a[12:15]
 buffer_load_dwordx4 v26, s[8:11], s56 offen offset:0 nt lds
 v_exp_f32 v31, v87
 v_mfma_f32_16x16x32_bf16 a[12:15], a[196:199], v[180:183], a[12:15]
 s_waitcnt lgkmcnt(10)
 v_add_f32 v19, v19, v31
 v_cvt_pk_bf16_f32 v147, v30, v31
 v_mfma_f32_16x16x32_bf16 a[16:19], a[200:203], v[152:155], a[16:19]
 v_exp_f32 v28, v88
 v_mfma_f32_16x16x32_bf16 a[16:19], a[204:207], v[156:159], a[16:19]
 ds_read_b64_tr_b16 a[228:229], v12 offset:40960
 v_add_f32 v16, v16, v28
 v_mfma_f32_16x16x32_bf16 a[20:23], a[200:203], v[160:163], a[20:23]
 buffer_load_dwordx4 v27, s[8:11], s56 offen offset:1024 nt lds
 v_exp_f32 v29, v89
 v_mfma_f32_16x16x32_bf16 a[20:23], a[204:207], v[164:167], a[20:23]
 v_add_f32 v16, v16, v29
 v_cvt_pk_bf16_f32 v124, v28, v29
 v_mfma_f32_16x16x32_bf16 a[24:27], a[200:203], v[168:171], a[24:27]
 ds_read_b64_tr_b16 a[230:231], v12 offset:45056
 v_exp_f32 v30, v90
 v_mfma_f32_16x16x32_bf16 a[24:27], a[204:207], v[172:175], a[24:27]
 ds_read_b64_tr_b16 a[232:233], v13 offset:32768
 v_add_f32 v16, v16, v30
 v_mfma_f32_16x16x32_bf16 a[28:31], a[200:203], v[176:179], a[28:31]
 v_exp_f32 v31, v91
 v_mfma_f32_16x16x32_bf16 a[28:31], a[204:207], v[180:183], a[28:31]
 s_waitcnt lgkmcnt(9)
 v_add_f32 v16, v16, v31
 v_cvt_pk_bf16_f32 v125, v30, v31
 v_mfma_f32_16x16x32_bf16 a[32:35], a[208:211], v[152:155], a[32:35]
 v_exp_f32 v28, v92
 v_mfma_f32_16x16x32_bf16 a[32:35], a[212:215], v[156:159], a[32:35]
 ds_read_b64_tr_b16 a[234:235], v13 offset:36864
 v_add_f32 v17, v17, v28
 v_mfma_f32_16x16x32_bf16 a[36:39], a[208:211], v[160:163], a[36:39]
 buffer_load_dwordx4 v26, s[8:11], s56 offen offset:2048 nt lds
 v_exp_f32 v29, v93
 v_mfma_f32_16x16x32_bf16 a[36:39], a[212:215], v[164:167], a[36:39]
 v_add_f32 v17, v17, v29
 v_cvt_pk_bf16_f32 v132, v28, v29
 v_mfma_f32_16x16x32_bf16 a[40:43], a[208:211], v[168:171], a[40:43]
 ds_read_b64_tr_b16 a[236:237], v13 offset:40960
 v_exp_f32 v30, v94
 v_mfma_f32_16x16x32_bf16 a[40:43], a[212:215], v[172:175], a[40:43]
 ds_read_b64_tr_b16 a[238:239], v13 offset:45056
 v_add_f32 v17, v17, v30
 v_mfma_f32_16x16x32_bf16 a[44:47], a[208:211], v[176:179], a[44:47]
 v_exp_f32 v31, v95
 v_mfma_f32_16x16x32_bf16 a[44:47], a[212:215], v[180:183], a[44:47]
 s_waitcnt lgkmcnt(8)
 v_add_f32 v17, v17, v31
 v_cvt_pk_bf16_f32 v133, v30, v31
 v_mfma_f32_16x16x32_bf16 a[48:51], a[216:219], v[152:155], a[48:51]
 v_exp_f32 v28, v96
 v_mfma_f32_16x16x32_bf16 a[48:51], a[220:223], v[156:159], a[48:51]
 ds_read_b64_tr_b16 a[240:241], v14 offset:32768
 v_add_f32 v18, v18, v28
 v_mfma_f32_16x16x32_bf16 a[52:55], a[216:219], v[160:163], a[52:55]
 buffer_load_dwordx4 v27, s[8:11], s56 offen offset:3072 nt lds
 v_exp_f32 v29, v97
 v_mfma_f32_16x16x32_bf16 a[52:55], a[220:223], v[164:167], a[52:55]
 s_add_u32 s56, s56, 16384
 v_add_f32 v18, v18, v29
 v_cvt_pk_bf16_f32 v140, v28, v29
 v_mfma_f32_16x16x32_bf16 a[56:59], a[216:219], v[168:171], a[56:59]
 ds_read_b64_tr_b16 a[242:243], v14 offset:36864
 v_exp_f32 v30, v98
 v_mfma_f32_16x16x32_bf16 a[56:59], a[220:223], v[172:175], a[56:59]
 ds_read_b64_tr_b16 a[244:245], v14 offset:40960
 v_add_f32 v18, v18, v30
 v_mfma_f32_16x16x32_bf16 a[60:63], a[216:219], v[176:179], a[60:63]
 s_waitcnt vmcnt(14)
 buffer_store_dwordx4 v[248:251], v2, s[44:47], s68 offen sc1
 v_exp_f32 v31, v99
 v_mfma_f32_16x16x32_bf16 a[60:63], a[220:223], v[180:183], a[60:63]
 s_waitcnt lgkmcnt(7)
 v_add_f32 v18, v18, v31
 v_cvt_pk_bf16_f32 v141, v30, v31
 v_mfma_f32_16x16x32_bf16 a[64:67], a[224:227], v[152:155], a[64:67]
 v_exp_f32 v28, v100
 v_mfma_f32_16x16x32_bf16 a[64:67], a[228:231], v[156:159], a[64:67]
 ds_read_b64_tr_b16 a[246:247], v14 offset:45056
 s_waitcnt vmcnt(14)
 buffer_store_dwordx4 v[36:39], v2, s[48:51], s68 offen sc1
 v_add_f32 v19, v19, v28
 v_mfma_f32_16x16x32_bf16 a[68:71], a[224:227], v[160:163], a[68:71]
 s_add_u32 s68, s68, 1024
 v_exp_f32 v29, v101
 v_mfma_f32_16x16x32_bf16 a[68:71], a[228:231], v[164:167], a[68:71]
 v_add_f32 v19, v19, v29
 v_cvt_pk_bf16_f32 v148, v28, v29
 v_mfma_f32_16x16x32_bf16 a[72:75], a[224:227], v[168:171], a[72:75]
 ds_read_b64_tr_b16 a[248:249], v15 offset:32768
 v_exp_f32 v30, v102
 v_mfma_f32_16x16x32_bf16 a[72:75], a[228:231], v[172:175], a[72:75]
 ds_read_b64_tr_b16 a[250:251], v15 offset:36864
 v_add_f32 v19, v19, v30
 v_mfma_f32_16x16x32_bf16 a[76:79], a[224:227], v[176:179], a[76:79]
 v_exp_f32 v31, v103
 v_mfma_f32_16x16x32_bf16 a[76:79], a[228:231], v[180:183], a[76:79]
 s_waitcnt lgkmcnt(6)
 v_add_f32 v19, v19, v31
 v_cvt_pk_bf16_f32 v149, v30, v31
 v_mfma_f32_16x16x32_bf16 a[80:83], a[232:235], v[152:155], a[80:83]
 v_exp_f32 v28, v104
 v_mfma_f32_16x16x32_bf16 a[80:83], a[236:239], v[156:159], a[80:83]
 ds_read_b64_tr_b16 a[252:253], v15 offset:40960
 v_add_f32 v16, v16, v28
 v_mfma_f32_16x16x32_bf16 a[84:87], a[232:235], v[160:163], a[84:87]
 v_exp_f32 v29, v105
 v_mfma_f32_16x16x32_bf16 a[84:87], a[236:239], v[164:167], a[84:87]
 v_add_f32 v16, v16, v29
 v_cvt_pk_bf16_f32 v126, v28, v29
 v_mfma_f32_16x16x32_bf16 a[88:91], a[232:235], v[168:171], a[88:91]
 ds_read_b64_tr_b16 a[254:255], v15 offset:45056
 v_exp_f32 v30, v106
 v_mfma_f32_16x16x32_bf16 a[88:91], a[236:239], v[172:175], a[88:91]
 ds_read_b128 a[128:131], v4 offset:16384
 v_add_f32 v16, v16, v30
 v_mfma_f32_16x16x32_bf16 a[92:95], a[232:235], v[176:179], a[92:95]
 v_exp_f32 v31, v107
 v_mfma_f32_16x16x32_bf16 a[92:95], a[236:239], v[180:183], a[92:95]
 s_waitcnt lgkmcnt(5)
 v_add_f32 v16, v16, v31
 v_cvt_pk_bf16_f32 v127, v30, v31
 v_mfma_f32_16x16x32_bf16 a[96:99], a[240:243], v[152:155], a[96:99]
 v_exp_f32 v28, v108
 v_mfma_f32_16x16x32_bf16 a[96:99], a[244:247], v[156:159], a[96:99]
 ds_read_b128 a[132:135], v5 offset:16384
 v_add_f32 v17, v17, v28
 v_mfma_f32_16x16x32_bf16 a[100:103], a[240:243], v[160:163], a[100:103]
 v_exp_f32 v29, v109
 v_mfma_f32_16x16x32_bf16 a[100:103], a[244:247], v[164:167], a[100:103]
 v_add_f32 v17, v17, v29
 v_cvt_pk_bf16_f32 v134, v28, v29
 v_mfma_f32_16x16x32_bf16 a[104:107], a[240:243], v[168:171], a[104:107]
 ds_read_b128 a[136:139], v6 offset:16384
 v_exp_f32 v30, v110
 v_mfma_f32_16x16x32_bf16 a[104:107], a[244:247], v[172:175], a[104:107]
 ds_read_b128 a[140:143], v7 offset:16384
 v_add_f32 v17, v17, v30
 v_mfma_f32_16x16x32_bf16 a[108:111], a[240:243], v[176:179], a[108:111]
 v_exp_f32 v31, v111
 v_mfma_f32_16x16x32_bf16 a[108:111], a[244:247], v[180:183], a[108:111]
 s_waitcnt lgkmcnt(4)
 v_add_f32 v17, v17, v31
 v_cvt_pk_bf16_f32 v135, v30, v31
 v_mfma_f32_16x16x32_bf16 a[112:115], a[248:251], v[152:155], a[112:115]
 v_exp_f32 v28, v112
 v_mfma_f32_16x16x32_bf16 a[112:115], a[252:255], v[156:159], a[112:115]
 ds_read_b128 a[144:147], v4 offset:20480
 v_add_f32 v18, v18, v28
 v_mfma_f32_16x16x32_bf16 a[116:119], a[248:251], v[160:163], a[116:119]
 v_exp_f32 v29, v113
 v_mfma_f32_16x16x32_bf16 a[116:119], a[252:255], v[164:167], a[116:119]
 v_add_f32 v18, v18, v29
 v_cvt_pk_bf16_f32 v142, v28, v29
 v_mfma_f32_16x16x32_bf16 a[120:123], a[248:251], v[168:171], a[120:123]
 ds_read_b128 a[148:151], v5 offset:20480
 v_exp_f32 v30, v114
 v_mfma_f32_16x16x32_bf16 a[120:123], a[252:255], v[172:175], a[120:123]
 ds_read_b128 a[152:155], v6 offset:20480
 v_add_f32 v18, v18, v30
 v_mfma_f32_16x16x32_bf16 a[124:127], a[248:251], v[176:179], a[124:127]
 v_exp_f32 v31, v115
 v_mfma_f32_16x16x32_bf16 a[124:127], a[252:255], v[180:183], a[124:127]
 s_waitcnt lgkmcnt(3)
 v_add_f32 v18, v18, v31
 v_cvt_pk_bf16_f32 v143, v30, v31
 s_branch L_att
L_att_tail:
 v_mfma_f32_16x16x32_bf16 v[56:59], a[128:131], v[184:187], v[40:43]
 buffer_load_dword v255, v254, s[32:35], s66 offen sc1
 v_exp_f32 v28, v116
 v_mfma_f32_16x16x32_bf16 v[56:59], a[132:135], v[188:191], v[56:59]
 s_lshl_b32 s81, s70, 2
 ds_read_b128 a[156:159], v7 offset:36864
 v_add_f32 v19, v19, v28
 v_mfma_f32_16x16x32_bf16 v[56:59], a[136:139], v[192:195], v[56:59]
 s_add_u32 s81, s81, s69
 v_exp_f32 v29, v117
 v_mfma_f32_16x16x32_bf16 v[56:59], a[140:143], v[196:199], v[56:59]
 s_lshl_b32 s67, s81, 7
 v_add_f32 v19, v19, v29
 v_cvt_pk_bf16_f32 v182, v28, v29
 v_mfma_f32_16x16x32_bf16 v[60:63], a[128:131], v[200:203], v[44:47]
 s_add_u32 s67, s67, 0x10000
 ds_read_b128 a[160:163], v4 offset:40960
 v_exp_f32 v30, v118
 v_mfma_f32_16x16x32_bf16 v[60:63], a[132:135], v[204:207], v[60:63]
 s_lshl_b32 s81, s81, 2
 ds_read_b128 a[164:167], v5 offset:40960
 v_add_f32 v19, v19, v30
 v_mfma_f32_16x16x32_bf16 v[60:63], a[136:139], v[208:211], v[60:63]
 s_add_u32 s81, s81, s52
 v_exp_f32 v31, v119
 v_mfma_f32_16x16x32_bf16 v[60:63], a[140:143], v[212:215], v[60:63]
 s_mul_i32 s81, s81, 9216
 v_add_f32 v19, v19, v31
 v_cvt_pk_bf16_f32 v183, v30, v31
 v_mfma_f32_16x16x32_bf16 v[64:67], a[128:131], v[216:219], v[48:51]
 s_add_u32 s81, s81, 0x3000000
 v_exp_f32 v28, v56
 v_mfma_f32_16x16x32_bf16 v[64:67], a[132:135], v[220:223], v[64:67]
 s_add_u32 s36, s100, s81
 ds_read_b128 a[168:171], v6 offset:40960
 v_add_f32 v16, v16, v28
 v_mfma_f32_16x16x32_bf16 v[64:67], a[136:139], v[224:227], v[64:67]
 s_addc_u32 s37, s101, 0
 v_exp_f32 v29, v57
 v_mfma_f32_16x16x32_bf16 v[64:67], a[140:143], v[228:231], v[64:67]
 s_mov_b32 s38, 0x902400
 v_add_f32 v16, v16, v29
 v_cvt_pk_bf16_f32 v120, v28, v29
 v_mfma_f32_16x16x32_bf16 v[68:71], a[128:131], v[232:235], v[52:55]
 s_mov_b32 s39, 0x00020000
 ds_read_b128 a[172:175], v7 offset:40960
 v_exp_f32 v30, v58
 v_mfma_f32_16x16x32_bf16 v[68:71], a[132:135], v[236:239], v[68:71]
 s_lshl_b32 s81, s70, 4
 ds_read_b128 a[176:179], v4 offset:45056
 v_add_f32 v16, v16, v30
 v_mfma_f32_16x16x32_bf16 v[68:71], a[136:139], v[240:243], v[68:71]
 s_add_u32 s81, s81, s69
 v_exp_f32 v31, v59
 v_mfma_f32_16x16x32_bf16 v[68:71], a[140:143], v[244:247], v[68:71]
 s_waitcnt lgkmcnt(5)
 v_add_f32 v16, v16, v31
 v_cvt_pk_bf16_f32 v121, v30, v31
 v_mfma_f32_16x16x32_bf16 v[72:75], a[144:147], v[184:187], v[40:43]
 s_mul_i32 s81, s81, 9216
 v_exp_f32 v28, v60
 v_mfma_f32_16x16x32_bf16 v[72:75], a[148:151], v[188:191], v[72:75]
 s_lshl_b32 s82, s52, 10
 ds_read_b128 a[180:183], v5 offset:45056
 v_add_f32 v17, v17, v28
 v_mfma_f32_16x16x32_bf16 v[72:75], a[152:155], v[192:195], v[72:75]
 s_add_u32 s81, s81, s82
 v_exp_f32 v29, v61
 v_mfma_f32_16x16x32_bf16 v[72:75], a[156:159], v[196:199], v[72:75]
 s_add_u32 s81, s81, 0x3000000
 v_add_f32 v17, v17, v29
 v_cvt_pk_bf16_f32 v128, v28, v29
 v_mfma_f32_16x16x32_bf16 v[76:79], a[144:147], v[200:203], v[44:47]
 s_add_u32 s40, s100, s81
 ds_read_b128 a[184:187], v6 offset:45056
 v_exp_f32 v30, v62
 v_mfma_f32_16x16x32_bf16 v[76:79], a[148:151], v[204:207], v[76:79]
 s_addc_u32 s41, s101, 0
 ds_read_b128 a[188:191], v7 offset:45056
 v_add_f32 v17, v17, v30
 v_mfma_f32_16x16x32_bf16 v[76:79], a[152:155], v[208:211], v[76:79]
 s_mov_b32 s42, 0x91f800
 v_exp_f32 v31, v63
 v_mfma_f32_16x16x32_bf16 v[76:79], a[156:159], v[212:215], v[76:79]
 s_mov_b32 s43, 0x00020000
 v_add_f32 v17, v17, v31
 v_cvt_pk_bf16_f32 v129, v30, v31
 v_mfma_f32_16x16x32_bf16 v[80:83], a[144:147], v[216:219], v[48:51]
 s_and_b32 s80, s70, 3
 v_exp_f32 v28, v64
 v_mfma_f32_16x16x32_bf16 v[80:83], a[148:151], v[220:223], v[80:83]
 s_mul_i32 s80, s80, 288
 ds_read_b64_tr_b16 a[192:193], v8 offset:0
 v_add_f32 v18, v18, v28
 v_mfma_f32_16x16x32_bf16 v[80:83], a[152:155], v[224:227], v[80:83]
 s_andn2_b32 s81, s70, 3
 v_exp_f32 v29, v65
 v_mfma_f32_16x16x32_bf16 v[80:83], a[156:159], v[228:231], v[80:83]
 s_add_u32 s81, s81, s69
 v_add_f32 v18, v18, v29
 v_cvt_pk_bf16_f32 v136, v28, v29
 v_mfma_f32_16x16x32_bf16 v[84:87], a[144:147], v[232:235], v[52:55]
 s_mul_i32 s81, s81, 36864
 ds_read_b64_tr_b16 a[194:195], v8 offset:4096
 v_exp_f32 v30, v66
 v_mfma_f32_16x16x32_bf16 v[84:87], a[148:151], v[236:239], v[84:87]
 s_add_u32 s81, s81, s80
 ds_read_b64_tr_b16 a[196:197], v8 offset:8192
 v_add_f32 v18, v18, v30
 v_mfma_f32_16x16x32_bf16 v[84:87], a[152:155], v[240:243], v[84:87]
 s_add_u32 s44, s92, s81
 v_exp_f32 v31, v67
 v_mfma_f32_16x16x32_bf16 v[84:87], a[156:159], v[244:247], v[84:87]
 s_waitcnt lgkmcnt(7)
 v_add_f32 v18, v18, v31
 v_cvt_pk_bf16_f32 v137, v30, v31
 v_mfma_f32_16x16x32_bf16 v[88:91], a[160:163], v[184:187], v[40:43]
 s_addc_u32 s45, s93, 0
 v_exp_f32 v28, v68
 v_mfma_f32_16x16x32_bf16 v[88:91], a[164:167], v[188:191], v[88:91]
 s_mov_b32 s46, 0x8ca0
 ds_read_b64_tr_b16 a[198:199], v8 offset:12288
 v_add_f32 v19, v19, v28
 v_mfma_f32_16x16x32_bf16 v[88:91], a[168:171], v[192:195], v[88:91]
 s_mov_b32 s47, 0x00020000
 v_exp_f32 v29, v69
 v_mfma_f32_16x16x32_bf16 v[88:91], a[172:175], v[196:199], v[88:91]
 s_add_u32 s48, s98, s81
 v_add_f32 v19, v19, v29
 v_cvt_pk_bf16_f32 v144, v28, v29
 v_mfma_f32_16x16x32_bf16 v[92:95], a[160:163], v[200:203], v[44:47]
 s_addc_u32 s49, s99, 0
 ds_read_b64_tr_b16 a[200:201], v9 offset:0
 v_exp_f32 v30, v70
 v_mfma_f32_16x16x32_bf16 v[92:95], a[164:167], v[204:207], v[92:95]
 s_mov_b32 s50, 0x8ca0
 ds_read_b64_tr_b16 a[202:203], v9 offset:4096
 v_add_f32 v19, v19, v30
 v_mfma_f32_16x16x32_bf16 v[92:95], a[168:171], v[208:211], v[92:95]
 s_mov_b32 s51, 0x00020000
 v_exp_f32 v31, v71
 v_mfma_f32_16x16x32_bf16 v[92:95], a[172:175], v[212:215], v[92:95]
 s_lshl_b32 s62, s52, 28
 v_add_f32 v19, v19, v31
 v_cvt_pk_bf16_f32 v145, v30, v31
 v_mfma_f32_16x16x32_bf16 v[96:99], a[160:163], v[216:219], v[48:51]
 s_mov_b32 s63, 0x40053526
 v_exp_f32 v28, v72
 v_mfma_f32_16x16x32_bf16 v[96:99], a[164:167], v[220:223], v[96:99]
 s_mul_i32 s71, s52, 529408
 ds_read_b64_tr_b16 a[204:205], v9 offset:8192
 v_add_f32 v16, v16, v28
 v_mfma_f32_16x16x32_bf16 v[96:99], a[168:171], v[224:227], v[96:99]
 s_add_u32 s72, s71, 0x20500
 v_exp_f32 v29, v73
 v_mfma_f32_16x16x32_bf16 v[96:99], a[172:175], v[228:231], v[96:99]
 s_add_u32 s73, s71, 0x40a00
 v_add_f32 v16, v16, v29
 v_cvt_pk_bf16_f32 v122, v28, v29
 v_mfma_f32_16x16x32_bf16 v[100:103], a[160:163], v[232:235], v[52:55]
 s_add_u32 s74, s71, 0x60f00
 ds_read_b64_tr_b16 a[206:207], v9 offset:12288
 v_exp_f32 v30, v74
 v_mfma_f32_16x16x32_bf16 v[100:103], a[164:167], v[236:239], v[100:103]
 s_lshl_b32 s75, s52, 5
 ds_read_b64_tr_b16 a[208:209], v10 offset:0
 v_add_f32 v16, v16, v30
 v_mfma_f32_16x16x32_bf16 v[100:103], a[168:171], v[240:243], v[100:103]
 s_add_u32 s76, s75, 18432
 v_exp_f32 v31, v75
 v_mfma_f32_16x16x32_bf16 v[100:103], a[172:175], v[244:247], v[100:103]
 s_waitcnt lgkmcnt(9)
 v_add_f32 v16, v16, v31
 v_cvt_pk_bf16_f32 v123, v30, v31
 v_mfma_f32_16x16x32_bf16 v[104:107], a[176:179], v[184:187], v[40:43]
 s_lshl_b32 s77, s52, 20
 v_exp_f32 v28, v76
 v_mfma_f32_16x16x32_bf16 v[104:107], a[180:183], v[188:191], v[104:107]
 s_add_u32 s78, s77, 18432
 ds_read_b64_tr_b16 a[210:211], v10 offset:4096
 v_add_f32 v17, v17, v28
 v_mfma_f32_16x16x32_bf16 v[104:107], a[184:187], v[192:195], v[104:107]
 v_exp_f32 v29, v77
 v_mfma_f32_16x16x32_bf16 v[104:107], a[188:191], v[196:199], v[104:107]
 v_add_f32 v17, v17, v29
 v_cvt_pk_bf16_f32 v130, v28, v29
 v_mfma_f32_16x16x32_bf16 v[108:111], a[176:179], v[200:203], v[44:47]
 ds_read_b64_tr_b16 a[212:213], v10 offset:8192
 v_exp_f32 v30, v78
 v_mfma_f32_16x16x32_bf16 v[108:111], a[180:183], v[204:207], v[108:111]
 ds_read_b64_tr_b16 a[214:215], v10 offset:12288
 v_add_f32 v17, v17, v30
 v_mfma_f32_16x16x32_bf16 v[108:111], a[184:187], v[208:211], v[108:111]
 v_exp_f32 v31, v79
 v_mfma_f32_16x16x32_bf16 v[108:111], a[188:191], v[212:215], v[108:111]
 v_add_f32 v17, v17, v31
 v_cvt_pk_bf16_f32 v131, v30, v31
 v_mfma_f32_16x16x32_bf16 v[112:115], a[176:179], v[216:219], v[48:51]
 v_exp_f32 v28, v80
 v_mfma_f32_16x16x32_bf16 v[112:115], a[180:183], v[220:223], v[112:115]
 ds_read_b64_tr_b16 a[216:217], v11 offset:0
 v_add_f32 v18, v18, v28
 v_mfma_f32_16x16x32_bf16 v[112:115], a[184:187], v[224:227], v[112:115]
 v_exp_f32 v29, v81
 v_mfma_f32_16x16x32_bf16 v[112:115], a[188:191], v[228:231], v[112:115]
 v_add_f32 v18, v18, v29
 v_cvt_pk_bf16_f32 v138, v28, v29
 v_mfma_f32_16x16x32_bf16 v[116:119], a[176:179], v[232:235], v[52:55]
 ds_read_b64_tr_b16 a[218:219], v11 offset:4096
 v_exp_f32 v30, v82
 v_mfma_f32_16x16x32_bf16 v[116:119], a[180:183], v[236:239], v[116:119]
 ds_read_b64_tr_b16 a[220:221], v11 offset:8192
 v_add_f32 v18, v18, v30
 v_mfma_f32_16x16x32_bf16 v[116:119], a[184:187], v[240:243], v[116:119]
 v_exp_f32 v31, v83
 v_mfma_f32_16x16x32_bf16 v[116:119], a[188:191], v[244:247], v[116:119]
 s_waitcnt lgkmcnt(11)
 v_add_f32 v18, v18, v31
 v_cvt_pk_bf16_f32 v139, v30, v31
 s_waitcnt vmcnt(0)
 v_cmp_ne_u32 vcc, s54, v255
 s_cbranch_vccnz L_spin_h
L_ok_h:
L_donly:
 v_mfma_f32_16x16x32_bf16 a[0:3], a[192:195], v[152:155], a[0:3]
 v_exp_f32 v28, v84
 v_mfma_f32_16x16x32_bf16 a[0:3], a[196:199], v[156:159], a[0:3]
 s_barrier
 ds_read_b64_tr_b16 a[222:223], v11 offset:12288
 v_add_f32 v19, v19, v28
 v_mfma_f32_16x16x32_bf16 a[4:7], a[192:195], v[160:163], a[4:7]
 s_mov_b32 s87, 0
 v_exp_f32 v29, v85
 v_and_b32 v254, 0x380, v254
 v_mfma_f32_16x16x32_bf16 a[4:7], a[196:199], v[164:167], a[4:7]
 s_add_u32 m0, s60, 0
 v_add_f32 v19, v19, v29
 v_cvt_pk_bf16_f32 v146, v28, v29
 v_mfma_f32_16x16x32_bf16 a[8:11], a[192:195], v[168:171], a[8:11]
 ds_read_b64_tr_b16 a[224:225], v12 offset:0
 v_exp_f32 v30, v86
 v_mfma_f32_16x16x32_bf16 a[8:11], a[196:199], v[172:175], a[8:11]
 ds_read_b64_tr_b16 a[226:227], v12 offset:4096
 buffer_load_dwordx4 v2, s[12:15], s87 offen offset:0 sc1 lds
 v_add_f32 v19, v19, v30
 v_mfma_f32_16x16x32_bf16 a[12:15], a[192:195], v[176:179], a[12:15]
 v_exp_f32 v31, v87
 v_mfma_f32_16x16x32_bf16 a[12:15], a[196:199], v[180:183], a[12:15]
 s_waitcnt lgkmcnt(10)
 v_add_f32 v19, v19, v31
 v_cvt_pk_bf16_f32 v147, v30, v31
 v_mfma_f32_16x16x32_bf16 a[16:19], a[200:203], v[152:155], a[16:19]
 v_exp_f32 v28, v88
 v_mfma_f32_16x16x32_bf16 a[16:19], a[204:207], v[156:159], a[16:19]
 ds_read_b64_tr_b16 a[228:229], v12 offset:8192
 v_add_f32 v16, v16, v28
 v_mfma_f32_16x16x32_bf16 a[20:23], a[200:203], v[160:163], a[20:23]
 buffer_load_dwordx4 v2, s[12:15], s87 offen offset:1024 sc1 lds
 v_exp_f32 v29, v89
 v_mfma_f32_16x16x32_bf16 a[20:23], a[204:207], v[164:167], a[20:23]
 v_add_f32 v16, v16, v29
 v_cvt_pk_bf16_f32 v124, v28, v29
 v_mfma_f32_16x16x32_bf16 a[24:27], a[200:203], v[168:171], a[24:27]
 ds_read_b64_tr_b16 a[230:231], v12 offset:12288
 v_exp_f32 v30, v90
 v_mfma_f32_16x16x32_bf16 a[24:27], a[204:207], v[172:175], a[24:27]
 ds_read_b64_tr_b16 a[232:233], v13 offset:0
 v_add_f32 v16, v16, v30
 v_mfma_f32_16x16x32_bf16 a[28:31], a[200:203], v[176:179], a[28:31]
 v_exp_f32 v31, v91
 v_mfma_f32_16x16x32_bf16 a[28:31], a[204:207], v[180:183], a[28:31]
 s_waitcnt lgkmcnt(9)
 buffer_load_dwordx4 v2, s[12:15], s87 offen offset:2048 sc1 lds
 v_add_f32 v16, v16, v31
 v_cvt_pk_bf16_f32 v125, v30, v31
 v_mfma_f32_16x16x32_bf16 a[32:35], a[208:211], v[152:155], a[32:35]
 v_exp_f32 v28, v92
 v_mfma_f32_16x16x32_bf16 a[32:35], a[212:215], v[156:159], a[32:35]
 ds_read_b64_tr_b16 a[234:235], v13 offset:4096
 v_add_f32 v17, v17, v28
 v_mfma_f32_16x16x32_bf16 a[36:39], a[208:211], v[160:163], a[36:39]
 v_exp_f32 v29, v93
 v_mfma_f32_16x16x32_bf16 a[36:39], a[212:215], v[164:167], a[36:39]
 v_add_f32 v17, v17, v29
 v_cvt_pk_bf16_f32 v132, v28, v29
 v_mfma_f32_16x16x32_bf16 a[40:43], a[208:211], v[168:171], a[40:43]
 ds_read_b64_tr_b16 a[236:237], v13 offset:8192
 v_exp_f32 v30, v94
 v_mfma_f32_16x16x32_bf16 a[40:43], a[212:215], v[172:175], a[40:43]
 ds_read_b64_tr_b16 a[238:239], v13 offset:12288
 buffer_load_dwordx4 v2, s[12:15], s87 offen offset:3072 sc1 lds
 v_add_f32 v17, v17, v30
 v_mfma_f32_16x16x32_bf16 a[44:47], a[208:211], v[176:179], a[44:47]
 s_mov_b32 s87, 4096
 v_exp_f32 v31, v95
 v_mfma_f32_16x16x32_bf16 a[44:47], a[212:215], v[180:183], a[44:47]
 s_waitcnt lgkmcnt(8)
 v_add_f32 v17, v17, v31
 v_cvt_pk_bf16_f32 v133, v30, v31
 v_mfma_f32_16x16x32_bf16 a[48:51], a[216:219], v[152:155], a[48:51]
 s_add_u32 m0, s60, 4096
 v_exp_f32 v28, v96
 v_mfma_f32_16x16x32_bf16 a[48:51], a[220:223], v[156:159], a[48:51]
 ds_read_b64_tr_b16 a[240:241], v14 offset:0
 v_add_f32 v18, v18, v28
 v_mfma_f32_16x16x32_bf16 a[52:55], a[216:219], v[160:163], a[52:55]
 buffer_load_dwordx4 v2, s[12:15], s87 offen offset:0 sc1 lds
 v_exp_f32 v29, v97
 v_mfma_f32_16x16x32_bf16 a[52:55], a[220:223], v[164:167], a[52:55]
 v_add_f32 v18, v18, v29
 v_cvt_pk_bf16_f32 v140, v28, v29
 v_mfma_f32_16x16x32_bf16 a[56:59], a[216:219], v[168:171], a[56:59]
 ds_read_b64_tr_b16 a[242:243], v14 offset:4096
 v_exp_f32 v30, v98
 v_mfma_f32_16x16x32_bf16 a[56:59], a[220:223], v[172:175], a[56:59]
 ds_read_b64_tr_b16 a[244:245], v14 offset:8192
 v_add_f32 v18, v18, v30
 v_mfma_f32_16x16x32_bf16 a[60:63], a[216:219], v[176:179], a[60:63]
 v_exp_f32 v31, v99
 v_mfma_f32_16x16x32_bf16 a[60:63], a[220:223], v[180:183], a[60:63]
 s_waitcnt lgkmcnt(7)
 buffer_load_dwordx4 v2, s[12:15], s87 offen offset:1024 sc1 lds
 v_add_f32 v18, v18, v31
 v_cvt_pk_bf16_f32 v141, v30, v31
 v_mfma_f32_16x16x32_bf16 a[64:67], a[224:227], v[152:155], a[64:67]
 v_exp_f32 v28, v100
 v_mfma_f32_16x16x32_bf16 a[64:67], a[228:231], v[156:159], a[64:67]
 ds_read_b64_tr_b16 a[246:247], v14 offset:12288
 v_add_f32 v19, v19, v28
 v_mfma_f32_16x16x32_bf16 a[68:71], a[224:227], v[160:163], a[68:71]
 v_exp_f32 v29, v101
 v_mfma_f32_16x16x32_bf16 a[68:71], a[228:231], v[164:167], a[68:71]
 v_add_f32 v19, v19, v29
 v_cvt_pk_bf16_f32 v148, v28, v29
 v_mfma_f32_16x16x32_bf16 a[72:75], a[224:227], v[168:171], a[72:75]
 ds_read_b64_tr_b16 a[248:249], v15 offset:0
 v_exp_f32 v30, v102
 v_mfma_f32_16x16x32_bf16 a[72:75], a[228:231], v[172:175], a[72:75]
 ds_read_b64_tr_b16 a[250:251], v15 offset:4096
 buffer_load_dwordx4 v2, s[12:15], s87 offen offset:2048 sc1 lds
 v_add_f32 v19, v19, v30
 v_mfma_f32_16x16x32_bf16 a[76:79], a[224:227], v[176:179], a[76:79]
 v_exp_f32 v31, v103
 v_mfma_f32_16x16x32_bf16 a[76:79], a[228:231], v[180:183], a[76:79]
 s_waitcnt lgkmcnt(6)
 v_add_f32 v19, v19, v31
 v_cvt_pk_bf16_f32 v149, v30, v31
 v_mfma_f32_16x16x32_bf16 a[80:83], a[232:235], v[152:155], a[80:83]
 v_exp_f32 v28, v104
 v_mfma_f32_16x16x32_bf16 a[80:83], a[236:239], v[156:159], a[80:83]
 ds_read_b64_tr_b16 a[252:253], v15 offset:8192
 v_add_f32 v16, v16, v28
 v_mfma_f32_16x16x32_bf16 a[84:87], a[232:235], v[160:163], a[84:87]
 buffer_load_dwordx4 v2, s[12:15], s87 offen offset:3072 sc1 lds
 v_exp_f32 v29, v105
 v_mfma_f32_16x16x32_bf16 a[84:87], a[236:239], v[164:167], a[84:87]
 s_mov_b32 s87, 8192
 v_add_f32 v16, v16, v29
 v_cvt_pk_bf16_f32 v126, v28, v29
 v_mfma_f32_16x16x32_bf16 a[88:91], a[232:235], v[168:171], a[88:91]
 s_add_u32 m0, s60, 8192
 ds_read_b64_tr_b16 a[254:255], v15 offset:12288
 v_exp_f32 v30, v106
 v_mfma_f32_16x16x32_bf16 a[88:91], a[236:239], v[172:175], a[88:91]
 ds_read_b128 a[128:131], v4 offset:49152
 v_add_f32 v16, v16, v30
 v_mfma_f32_16x16x32_bf16 a[92:95], a[232:235], v[176:179], a[92:95]
 v_exp_f32 v31, v107
 v_mfma_f32_16x16x32_bf16 a[92:95], a[236:239], v[180:183], a[92:95]
 s_waitcnt lgkmcnt(5)
 buffer_load_dwordx4 v2, s[12:15], s87 offen offset:0 sc1 lds
 v_add_f32 v16, v16, v31
 v_cvt_pk_bf16_f32 v127, v30, v31
 v_mfma_f32_16x16x32_bf16 a[96:99], a[240:243], v[152:155], a[96:99]
 s_mov_b32 s87, 36864
 v_exp_f32 v28, v108
 v_mfma_f32_16x16x32_bf16 a[96:99], a[244:247], v[156:159], a[96:99]
 s_add_u32 m0, s60, 126976
 ds_read_b128 a[132:135], v5 offset:49152
 v_add_f32 v17, v17, v28
 v_mfma_f32_16x16x32_bf16 a[100:103], a[240:243], v[160:163], a[100:103]
 v_exp_f32 v29, v109
 v_mfma_f32_16x16x32_bf16 a[100:103], a[244:247], v[164:167], a[100:103]
 v_add_f32 v17, v17, v29
 v_cvt_pk_bf16_f32 v134, v28, v29
 v_mfma_f32_16x16x32_bf16 a[104:107], a[240:243], v[168:171], a[104:107]
 ds_read_b128 a[136:139], v6 offset:49152
 v_exp_f32 v30, v110
 v_mfma_f32_16x16x32_bf16 a[104:107], a[244:247], v[172:175], a[104:107]
 ds_read_b128 a[140:143], v7 offset:49152
 buffer_load_dwordx4 v2, s[12:15], s87 offen offset:0 sc1 lds
 v_add_f32 v17, v17, v30
 v_mfma_f32_16x16x32_bf16 a[108:111], a[240:243], v[176:179], a[108:111]
 v_exp_f32 v31, v111
 v_mfma_f32_16x16x32_bf16 a[108:111], a[244:247], v[180:183], a[108:111]
 s_waitcnt lgkmcnt(4)
 v_add_f32 v17, v17, v31
 v_cvt_pk_bf16_f32 v135, v30, v31
 v_mfma_f32_16x16x32_bf16 a[112:115], a[248:251], v[152:155], a[112:115]
 v_exp_f32 v28, v112
 v_mfma_f32_16x16x32_bf16 a[112:115], a[252:255], v[156:159], a[112:115]
 ds_read_b128 a[144:147], v4 offset:53248
 v_add_f32 v18, v18, v28
 v_mfma_f32_16x16x32_bf16 a[116:119], a[248:251], v[160:163], a[116:119]
 buffer_load_dwordx4 v2, s[12:15], s87 offen offset:1024 sc1 lds
 v_exp_f32 v29, v113
 v_mfma_f32_16x16x32_bf16 a[116:119], a[252:255], v[164:167], a[116:119]
 v_add_f32 v18, v18, v29
 v_cvt_pk_bf16_f32 v142, v28, v29
 v_mfma_f32_16x16x32_bf16 a[120:123], a[248:251], v[168:171], a[120:123]
 ds_read_b128 a[148:151], v5 offset:53248
 v_exp_f32 v30, v114
 v_mfma_f32_16x16x32_bf16 a[120:123], a[252:255], v[172:175], a[120:123]
 ds_read_b128 a[152:155], v6 offset:53248
 v_add_f32 v18, v18, v30
 v_mfma_f32_16x16x32_bf16 a[124:127], a[248:251], v[176:179], a[124:127]
 v_exp_f32 v31, v115
 v_mfma_f32_16x16x32_bf16 a[124:127], a[252:255], v[180:183], a[124:127]
 s_waitcnt lgkmcnt(3)
 buffer_load_dwordx4 v2, s[12:15], s87 offen offset:2048 sc1 lds
 v_add_f32 v18, v18, v31
 v_cvt_pk_bf16_f32 v143, v30, v31
 v_mfma_f32_16x16x32_bf16 v[56:59], a[128:131], v[184:187], v[40:43]
 v_exp_f32 v28, v116
 v_mfma_f32_16x16x32_bf16 v[56:59], a[132:135], v[188:191], v[56:59]
 ds_read_b128 a[156:159], v7 offset:53248
 v_add_f32 v19, v19, v28
 v_mfma_f32_16x16x32_bf16 v[56:59], a[136:139], v[192:195], v[56:59]
 v_exp_f32 v29, v117
 v_mfma_f32_16x16x32_bf16 v[56:59], a[140:143], v[196:199], v[56:59]
 v_add_f32 v19, v19, v29
 v_cvt_pk_bf16_f32 v150, v28, v29
 v_mfma_f32_16x16x32_bf16 v[60:63], a[128:131], v[200:203], v[44:47]
 ds_read_b128 a[160:163], v4 offset:57344
 v_exp_f32 v30, v118
 v_mfma_f32_16x16x32_bf16 v[60:63], a[132:135], v[204:207], v[60:63]
 ds_read_b128 a[164:167], v5 offset:57344
 buffer_load_dwordx4 v2, s[12:15], s87 offen offset:3072 sc1 lds
 v_add_f32 v19, v19, v30
 v_mfma_f32_16x16x32_bf16 v[60:63], a[136:139], v[208:211], v[60:63]
 s_mov_b32 s87, 40960
 v_exp_f32 v31, v119
 v_mfma_f32_16x16x32_bf16 v[60:63], a[140:143], v[212:215], v[60:63]
 s_add_u32 m0, s60, 131072
 v_add_f32 v19, v19, v31
 v_cvt_pk_bf16_f32 v151, v30, v31
 v_mfma_f32_16x16x32_bf16 v[64:67], a[128:131], v[216:219], v[48:51]
 v_exp_f32 v28, v56
 v_mfma_f32_16x16x32_bf16 v[64:67], a[132:135], v[220:223], v[64:67]
 ds_read_b128 a[168:171], v6 offset:57344
 v_add_f32 v16, v16, v28
 v_mfma_f32_16x16x32_bf16 v[64:67], a[136:139], v[224:227], v[64:67]
 buffer_load_dwordx4 v2, s[12:15], s87 offen offset:0 sc1 lds
 v_exp_f32 v29, v57
 v_mfma_f32_16x16x32_bf16 v[64:67], a[140:143], v[228:231], v[64:67]
 v_add_f32 v16, v16, v29
 v_cvt_pk_bf16_f32 v152, v28, v29
 v_mfma_f32_16x16x32_bf16 v[68:71], a[128:131], v[232:235], v[52:55]
 ds_read_b128 a[172:175], v7 offset:57344
 v_exp_f32 v30, v58
 v_mfma_f32_16x16x32_bf16 v[68:71], a[132:135], v[236:239], v[68:71]
 ds_read_b128 a[176:179], v4 offset:61440
 v_add_f32 v16, v16, v30
 v_mfma_f32_16x16x32_bf16 v[68:71], a[136:139], v[240:243], v[68:71]
 v_exp_f32 v31, v59
 v_mfma_f32_16x16x32_bf16 v[68:71], a[140:143], v[244:247], v[68:71]
 s_waitcnt lgkmcnt(5)
 buffer_load_dwordx4 v2, s[12:15], s87 offen offset:1024 sc1 lds
 v_add_f32 v16, v16, v31
 v_cvt_pk_bf16_f32 v153, v30, v31
 v_mfma_f32_16x16x32_bf16 v[72:75], a[144:147], v[184:187], v[40:43]
 v_exp_f32 v28, v60
 v_mfma_f32_16x16x32_bf16 v[72:75], a[148:151], v[188:191], v[72:75]
 ds_read_b128 a[180:183], v5 offset:61440
 v_add_f32 v17, v17, v28
 v_mfma_f32_16x16x32_bf16 v[72:75], a[152:155], v[192:195], v[72:75]
 v_exp_f32 v29, v61
 v_mfma_f32_16x16x32_bf16 v[72:75], a[156:159], v[196:199], v[72:75]
 v_add_f32 v17, v17, v29
 v_cvt_pk_bf16_f32 v160, v28, v29
 v_mfma_f32_16x16x32_bf16 v[76:79], a[144:147], v[200:203], v[44:47]
 ds_read_b128 a[184:187], v6 offset:61440
 v_exp_f32 v30, v62
 v_mfma_f32_16x16x32_bf16 v[76:79], a[148:151], v[204:207], v[76:79]
 ds_read_b128 a[188:191], v7 offset:61440
 buffer_load_dwordx4 v2, s[12:15], s87 offen offset:2048 sc1 lds
 v_add_f32 v17, v17, v30
 v_mfma_f32_16x16x32_bf16 v[76:79], a[152:155], v[208:211], v[76:79]
 v_exp_f32 v31, v63
 v_mfma_f32_16x16x32_bf16 v[76:79], a[156:159], v[212:215], v[76:79]
 v_add_f32 v17, v17, v31
 v_cvt_pk_bf16_f32 v161, v30, v31
 v_mfma_f32_16x16x32_bf16 v[80:83], a[144:147], v[216:219], v[48:51]
 v_exp_f32 v28, v64
 v_mfma_f32_16x16x32_bf16 v[80:83], a[148:151], v[220:223], v[80:83]
 ds_read_b64_tr_b16 a[192:193], v8 offset:16384
 v_add_f32 v18, v18, v28
 v_mfma_f32_16x16x32_bf16 v[80:83], a[152:155], v[224:227], v[80:83]
 buffer_load_dwordx4 v2, s[12:15], s87 offen offset:3072 sc1 lds
 v_exp_f32 v29, v65
 v_mfma_f32_16x16x32_bf16 v[80:83], a[156:159], v[228:231], v[80:83]
 s_mov_b32 s87, 45056
 v_add_f32 v18, v18, v29
 v_cvt_pk_bf16_f32 v168, v28, v29
 v_mfma_f32_16x16x32_bf16 v[84:87], a[144:147], v[232:235], v[52:55]
 s_add_u32 m0, s60, 135168
 ds_read_b64_tr_b16 a[194:195], v8 offset:20480
 v_exp_f32 v30, v66
 v_mfma_f32_16x16x32_bf16 v[84:87], a[148:151], v[236:239], v[84:87]
 ds_read_b64_tr_b16 a[196:197], v8 offset:24576
 v_add_f32 v18, v18, v30
 v_mfma_f32_16x16x32_bf16 v[84:87], a[152:155], v[240:243], v[84:87]
 v_exp_f32 v31, v67
 v_mfma_f32_16x16x32_bf16 v[84:87], a[156:159], v[244:247], v[84:87]
 s_waitcnt lgkmcnt(7)
 buffer_load_dwordx4 v2, s[12:15], s87 offen offset:0 sc1 lds
 v_add_f32 v18, v18, v31
 v_cvt_pk_bf16_f32 v169, v30, v31
 v_mfma_f32_16x16x32_bf16 v[88:91], a[160:163], v[184:187], v[40:43]
 s_add_u32 s65, s65, 32768
 v_exp_f32 v28, v68
 v_mfma_f32_16x16x32_bf16 v[88:91], a[164:167], v[188:191], v[88:91]
 s_and_b32 s79, s70, 0x38
 ds_read_b64_tr_b16 a[198:199], v8 offset:28672
 v_add_f32 v19, v19, v28
 v_mfma_f32_16x16x32_bf16 v[88:91], a[168:171], v[192:195], v[88:91]
 s_lshl_b32 s79, s79, 7
 v_exp_f32 v29, v69
 v_mfma_f32_16x16x32_bf16 v[88:91], a[172:175], v[196:199], v[88:91]
 s_add_u32 s66, s66, s79
 v_add_f32 v19, v19, v29
 v_cvt_pk_bf16_f32 v176, v28, v29
 v_mfma_f32_16x16x32_bf16 v[92:95], a[160:163], v[200:203], v[44:47]
 s_add_u32 s66, s66, 32768
 ds_read_b64_tr_b16 a[200:201], v9 offset:16384
 v_exp_f32 v30, v70
 v_mfma_f32_16x16x32_bf16 v[92:95], a[164:167], v[204:207], v[92:95]
 s_add_u32 s61, s66, 8192
 ds_read_b64_tr_b16 a[202:203], v9 offset:20480
 v_add_f32 v19, v19, v30
 v_mfma_f32_16x16x32_bf16 v[92:95], a[168:171], v[208:211], v[92:95]
 s_and_b32 s56, s69, 1
 v_exp_f32 v31, v71
 v_mfma_f32_16x16x32_bf16 v[92:95], a[172:175], v[212:215], v[92:95]
 s_lshl_b32 s80, s56, 9
 v_add_f32 v19, v19, v31
 v_cvt_pk_bf16_f32 v177, v30, v31
 v_mfma_f32_16x16x32_bf16 v[96:99], a[160:163], v[216:219], v[48:51]
 s_or_b32 s80, s80, 0x180
 v_exp_f32 v28, v72
 v_and_b32 v250, s80, v254
 v_mfma_f32_16x16x32_bf16 v[96:99], a[164:167], v[220:223], v[96:99]
 s_mul_i32 s55, s56, -147456
 ds_read_b64_tr_b16 a[204:205], v9 offset:24576
 v_add_f32 v16, v16, v28
 v_mfma_f32_16x16x32_bf16 v[96:99], a[168:171], v[224:227], v[96:99]
 s_mul_i32 s56, s56, -16384
 v_exp_f32 v29, v73
 v_mfma_f32_16x16x32_bf16 v[96:99], a[172:175], v[228:231], v[96:99]
 s_mov_b32 s88, 0
 buffer_load_dwordx4 a[128:131], v2, s[20:23], s88 offen offset:0 sc1
 v_add_f32 v16, v16, v29
 v_cvt_pk_bf16_f32 v154, v28, v29
 v_mfma_f32_16x16x32_bf16 v[100:103], a[160:163], v[232:235], v[52:55]
 ds_read_b64_tr_b16 a[206:207], v9 offset:28672
 v_exp_f32 v30, v74
 v_mfma_f32_16x16x32_bf16 v[100:103], a[164:167], v[236:239], v[100:103]
 ds_read_b64_tr_b16 a[208:209], v10 offset:16384
 v_add_f32 v16, v16, v30
 v_mfma_f32_16x16x32_bf16 v[100:103], a[168:171], v[240:243], v[100:103]
 v_exp_f32 v31, v75
 v_mfma_f32_16x16x32_bf16 v[100:103], a[172:175], v[244:247], v[100:103]
 s_waitcnt lgkmcnt(9)
 buffer_load_dwordx4 a[132:135], v2, s[20:23], s88 offen offset:1024 sc1
 v_add_f32 v16, v16, v31
 v_cvt_pk_bf16_f32 v155, v30, v31
 v_mfma_f32_16x16x32_bf16 v[104:107], a[176:179], v[184:187], v[40:43]
 v_exp_f32 v28, v76
 v_mfma_f32_16x16x32_bf16 v[104:107], a[180:183], v[188:191], v[104:107]
 ds_read_b64_tr_b16 a[210:211], v10 offset:20480
 v_add_f32 v17, v17, v28
 v_mfma_f32_16x16x32_bf16 v[104:107], a[184:187], v[192:195], v[104:107]
 v_exp_f32 v29, v77
 v_mfma_f32_16x16x32_bf16 v[104:107], a[188:191], v[196:199], v[104:107]
 buffer_load_dwordx4 a[136:139], v2, s[20:23], s88 offen offset:2048 sc1
 v_add_f32 v17, v17, v29
 v_cvt_pk_bf16_f32 v162, v28, v29
 v_mfma_f32_16x16x32_bf16 v[108:111], a[176:179], v[200:203], v[44:47]
 ds_read_b64_tr_b16 a[212:213], v10 offset:24576
 v_exp_f32 v30, v78
 v_mfma_f32_16x16x32_bf16 v[108:111], a[180:183], v[204:207], v[108:111]
 ds_read_b64_tr_b16 a[214:215], v10 offset:28672
 v_add_f32 v17, v17, v30
 v_mfma_f32_16x16x32_bf16 v[108:111], a[184:187], v[208:211], v[108:111]
 v_exp_f32 v31, v79
 v_mfma_f32_16x16x32_bf16 v[108:111], a[188:191], v[212:215], v[108:111]
 buffer_load_dwordx4 a[140:143], v2, s[20:23], s88 offen offset:3072 sc1
 v_add_f32 v17, v17, v31
 v_cvt_pk_bf16_f32 v163, v30, v31
 v_mfma_f32_16x16x32_bf16 v[112:115], a[176:179], v[216:219], v[48:51]
 s_mov_b32 s89, 148736
 v_exp_f32 v28, v80
 v_mfma_f32_16x16x32_bf16 v[112:115], a[180:183], v[220:223], v[112:115]
 ds_read_b64_tr_b16 a[216:217], v11 offset:16384
 v_add_f32 v18, v18, v28
 v_mfma_f32_16x16x32_bf16 v[112:115], a[184:187], v[224:227], v[112:115]
 v_exp_f32 v29, v81
 v_mfma_f32_16x16x32_bf16 v[112:115], a[188:191], v[228:231], v[112:115]
 buffer_load_dwordx4 a[144:147], v2, s[20:23], s89 offen offset:0 sc1
 v_add_f32 v18, v18, v29
 v_cvt_pk_bf16_f32 v170, v28, v29
 v_mfma_f32_16x16x32_bf16 v[116:119], a[176:179], v[232:235], v[52:55]
 ds_read_b64_tr_b16 a[218:219], v11 offset:20480
 v_exp_f32 v30, v82
 v_mfma_f32_16x16x32_bf16 v[116:119], a[180:183], v[236:239], v[116:119]
 ds_read_b64_tr_b16 a[220:221], v11 offset:24576
 v_add_f32 v18, v18, v30
 v_mfma_f32_16x16x32_bf16 v[116:119], a[184:187], v[240:243], v[116:119]
 v_exp_f32 v31, v83
 v_mfma_f32_16x16x32_bf16 v[116:119], a[188:191], v[244:247], v[116:119]
 s_waitcnt lgkmcnt(11)
 buffer_load_dwordx4 a[148:151], v2, s[20:23], s89 offen offset:1024 sc1
 v_add_f32 v18, v18, v31
 v_cvt_pk_bf16_f32 v171, v30, v31
 v_mfma_f32_16x16x32_bf16 a[0:3], a[192:195], v[120:123], a[0:3]
 v_exp_f32 v28, v84
 v_mfma_f32_16x16x32_bf16 a[0:3], a[196:199], v[124:127], a[0:3]
 s_barrier
 ds_read_b64_tr_b16 a[222:223], v11 offset:28672
 v_add_f32 v19, v19, v28
 v_mfma_f32_16x16x32_bf16 a[4:7], a[192:195], v[128:131], a[4:7]
 v_exp_f32 v29, v85
 v_lshrrev_b32 v34, 2, v3
 v_mul_u32_u24 v35, 288, v34
 v_mfma_f32_16x16x32_bf16 a[4:7], a[196:199], v[132:135], a[4:7]
 buffer_load_dwordx4 a[152:155], v2, s[20:23], s89 offen offset:2048 sc1
 v_add_f32 v19, v19, v29
 v_cvt_pk_bf16_f32 v178, v28, v29
 v_mfma_f32_16x16x32_bf16 a[8:11], a[192:195], v[136:139], a[8:11]
 ds_read_b64_tr_b16 a[224:225], v12 offset:16384
 v_exp_f32 v30, v86
 v_and_b32 v36, 3, v3
 v_mfma_f32_16x16x32_bf16 a[8:11], a[196:199], v[140:143], a[8:11]
 ds_read_b64_tr_b16 a[226:227], v12 offset:20480
 v_add_f32 v19, v19, v30
 v_lshl_add_u32 v40, v36, 3, v35
 v_add_u32 v41, 126976, v40
 v_mfma_f32_16x16x32_bf16 a[12:15], a[192:195], v[144:147], a[12:15]
 buffer_load_dwordx4 a[156:159], v2, s[20:23], s89 offen offset:3072 sc1
 v_exp_f32 v31, v87
 v_mfma_f32_16x16x32_bf16 a[12:15], a[196:199], v[148:151], a[12:15]
 s_waitcnt lgkmcnt(10)
 v_add_f32 v19, v19, v31
 v_cvt_pk_bf16_f32 v179, v30, v31
 v_add_u32 v42, 36864, v40
 v_add_u32 v43, 73728, v40
 v_mfma_f32_16x16x32_bf16 a[16:19], a[200:203], v[120:123], a[16:19]
 s_mov_b32 s88, 4096
 v_exp_f32 v28, v88
 v_mov_b32 v20, 0x4e800000
 v_mfma_f32_16x16x32_bf16 a[16:19], a[204:207], v[124:127], a[16:19]
 ds_read_b64_tr_b16 a[228:229], v12 offset:24576
 buffer_load_dwordx4 a[160:163], v2, s[20:23], s88 offen offset:0 sc1
 v_add_f32 v16, v16, v28
 v_mfma_f32_16x16x32_bf16 a[20:23], a[200:203], v[128:131], a[20:23]
 v_exp_f32 v29, v89
 v_mfma_f32_16x16x32_bf16 a[20:23], a[204:207], v[132:135], a[20:23]
 v_add_f32 v16, v16, v29
 v_cvt_pk_bf16_f32 v156, v28, v29
 v_mfma_f32_16x16x32_bf16 a[24:27], a[200:203], v[136:139], a[24:27]
 ds_read_b64_tr_b16 a[230:231], v12 offset:28672
 v_exp_f32 v30, v90
 v_mfma_f32_16x16x32_bf16 a[24:27], a[204:207], v[140:143], a[24:27]
 ds_read_b64_tr_b16 a[232:233], v13 offset:16384
 buffer_load_dwordx4 a[164:167], v2, s[20:23], s88 offen offset:1024 sc1
 v_add_f32 v16, v16, v30
 v_mfma_f32_16x16x32_bf16 a[28:31], a[200:203], v[144:147], a[28:31]
 v_exp_f32 v31, v91
 v_mfma_f32_16x16x32_bf16 a[28:31], a[204:207], v[148:151], a[28:31]
 s_waitcnt lgkmcnt(9)
 v_add_f32 v16, v16, v31
 v_cvt_pk_bf16_f32 v157, v30, v31
 v_mfma_f32_16x16x32_bf16 a[32:35], a[208:211], v[120:123], a[32:35]
 buffer_load_dwordx4 a[168:171], v2, s[20:23], s88 offen offset:2048 sc1
 v_exp_f32 v28, v92
 v_mfma_f32_16x16x32_bf16 a[32:35], a[212:215], v[124:127], a[32:35]
 ds_read_b64_tr_b16 a[234:235], v13 offset:20480
 v_add_f32 v17, v17, v28
 v_mfma_f32_16x16x32_bf16 a[36:39], a[208:211], v[128:131], a[36:39]
 v_exp_f32 v29, v93
 v_mfma_f32_16x16x32_bf16 a[36:39], a[212:215], v[132:135], a[36:39]
 buffer_load_dwordx4 a[172:175], v2, s[20:23], s88 offen offset:3072 sc1
 v_add_f32 v17, v17, v29
 v_cvt_pk_bf16_f32 v164, v28, v29
 v_mfma_f32_16x16x32_bf16 a[40:43], a[208:211], v[136:139], a[40:43]
 s_mov_b32 s89, 152832
 ds_read_b64_tr_b16 a[236:237], v13 offset:24576
 v_exp_f32 v30, v94
 v_mfma_f32_16x16x32_bf16 a[40:43], a[212:215], v[140:143], a[40:43]
 ds_read_b64_tr_b16 a[238:239], v13 offset:28672
 v_add_f32 v17, v17, v30
 v_mfma_f32_16x16x32_bf16 a[44:47], a[208:211], v[144:147], a[44:47]
 buffer_load_dwordx4 a[176:179], v2, s[20:23], s89 offen offset:0 sc1
 v_exp_f32 v31, v95
 v_mfma_f32_16x16x32_bf16 a[44:47], a[212:215], v[148:151], a[44:47]
 s_waitcnt lgkmcnt(8)
 v_add_f32 v17, v17, v31
 v_cvt_pk_bf16_f32 v165, v30, v31
 v_mfma_f32_16x16x32_bf16 a[48:51], a[216:219], v[120:123], a[48:51]
 v_exp_f32 v28, v96
 v_mfma_f32_16x16x32_bf16 a[48:51], a[220:223], v[124:127], a[48:51]
 ds_read_b64_tr_b16 a[240:241], v14 offset:16384
 buffer_load_dwordx4 a[180:183], v2, s[20:23], s89 offen offset:1024 sc1
 v_add_f32 v18, v18, v28
 v_mfma_f32_16x16x32_bf16 a[52:55], a[216:219], v[128:131], a[52:55]
 v_exp_f32 v29, v97
 v_mfma_f32_16x16x32_bf16 a[52:55], a[220:223], v[132:135], a[52:55]
 v_add_f32 v18, v18, v29
 v_cvt_pk_bf16_f32 v172, v28, v29
 v_mfma_f32_16x16x32_bf16 a[56:59], a[216:219], v[136:139], a[56:59]
 ds_read_b64_tr_b16 a[242:243], v14 offset:20480
 v_exp_f32 v30, v98
 v_mfma_f32_16x16x32_bf16 a[56:59], a[220:223], v[140:143], a[56:59]
 ds_read_b64_tr_b16 a[244:245], v14 offset:24576
 buffer_load_dwordx4 a[184:187], v2, s[20:23], s89 offen offset:2048 sc1
 v_add_f32 v18, v18, v30
 v_mfma_f32_16x16x32_bf16 a[60:63], a[216:219], v[144:147], a[60:63]
 v_exp_f32 v31, v99
 v_mfma_f32_16x16x32_bf16 a[60:63], a[220:223], v[148:151], a[60:63]
 s_waitcnt lgkmcnt(7)
 v_add_f32 v18, v18, v31
 v_cvt_pk_bf16_f32 v173, v30, v31
 v_mfma_f32_16x16x32_bf16 a[64:67], a[224:227], v[120:123], a[64:67]
 buffer_load_dwordx4 a[188:191], v2, s[20:23], s89 offen offset:3072 sc1
 v_exp_f32 v28, v100
 v_mfma_f32_16x16x32_bf16 a[64:67], a[228:231], v[124:127], a[64:67]
 s_mov_b32 s87, 73728
 ds_read_b64_tr_b16 a[246:247], v14 offset:28672
 v_add_f32 v19, v19, v28
 v_mfma_f32_16x16x32_bf16 a[68:71], a[224:227], v[128:131], a[68:71]
 s_add_u32 m0, s60, 36864
 v_exp_f32 v29, v101
 v_mfma_f32_16x16x32_bf16 a[68:71], a[228:231], v[132:135], a[68:71]
 buffer_load_dwordx4 v2, s[12:15], s87 offen offset:0 sc1 lds
 v_add_f32 v19, v19, v29
 v_cvt_pk_bf16_f32 v180, v28, v29
 v_mfma_f32_16x16x32_bf16 a[72:75], a[224:227], v[136:139], a[72:75]
 ds_read_b64_tr_b16 a[248:249], v15 offset:16384
 v_exp_f32 v30, v102
 v_mfma_f32_16x16x32_bf16 a[72:75], a[228:231], v[140:143], a[72:75]
 ds_read_b64_tr_b16 a[250:251], v15 offset:20480
 v_add_f32 v19, v19, v30
 v_mfma_f32_16x16x32_bf16 a[76:79], a[224:227], v[144:147], a[76:79]
 buffer_load_dwordx4 v2, s[12:15], s87 offen offset:1024 sc1 lds
 v_exp_f32 v31, v103
 v_mfma_f32_16x16x32_bf16 a[76:79], a[228:231], v[148:151], a[76:79]
 s_waitcnt lgkmcnt(6)
 v_add_f32 v19, v19, v31
 v_cvt_pk_bf16_f32 v181, v30, v31
 v_mfma_f32_16x16x32_bf16 a[80:83], a[232:235], v[120:123], a[80:83]
 v_exp_f32 v28, v104
 v_mfma_f32_16x16x32_bf16 a[80:83], a[236:239], v[124:127], a[80:83]
 ds_read_b64_tr_b16 a[252:253], v15 offset:24576
 buffer_load_dwordx4 v2, s[12:15], s87 offen offset:2048 sc1 lds
 v_add_f32 v16, v16, v28
 v_mfma_f32_16x16x32_bf16 a[84:87], a[232:235], v[128:131], a[84:87]
 v_exp_f32 v29, v105
 v_mfma_f32_16x16x32_bf16 a[84:87], a[236:239], v[132:135], a[84:87]
 v_add_f32 v16, v16, v29
 v_cvt_pk_bf16_f32 v158, v28, v29
 v_mfma_f32_16x16x32_bf16 a[88:91], a[232:235], v[136:139], a[88:91]
 ds_read_b64_tr_b16 a[254:255], v15 offset:28672
 v_exp_f32 v30, v106
 v_mfma_f32_16x16x32_bf16 a[88:91], a[236:239], v[140:143], a[88:91]
 buffer_load_dwordx4 v2, s[12:15], s87 offen offset:3072 sc1 lds
 v_add_f32 v16, v16, v30
 v_mfma_f32_16x16x32_bf16 a[92:95], a[232:235], v[144:147], a[92:95]
 s_mov_b32 s87, 77824
 ds_read_b64_tr_b16 a[192:193], v8 offset:32768
 v_exp_f32 v31, v107
 v_mfma_f32_16x16x32_bf16 a[92:95], a[236:239], v[148:151], a[92:95]
 s_waitcnt lgkmcnt(5)
 ds_read_b64_tr_b16 a[194:195], v8 offset:36864
 v_add_f32 v16, v16, v31
 v_cvt_pk_bf16_f32 v159, v30, v31
 v_mfma_f32_16x16x32_bf16 a[96:99], a[240:243], v[120:123], a[96:99]
 s_add_u32 m0, s60, 40960
 ds_read_b64_tr_b16 a[196:197], v8 offset:40960
 v_exp_f32 v28, v108
 v_mfma_f32_16x16x32_bf16 a[96:99], a[244:247], v[124:127], a[96:99]
 ds_read_b64_tr_b16 a[198:199], v8 offset:45056
 buffer_load_dwordx4 v2, s[12:15], s87 offen offset:0 sc1 lds
 v_add_f32 v17, v17, v28
 v_mfma_f32_16x16x32_bf16 a[100:103], a[240:243], v[128:131], a[100:103]
 ds_read_b64_tr_b16 a[200:201], v9 offset:32768
 v_exp_f32 v29, v109
 v_mfma_f32_16x16x32_bf16 a[100:103], a[244:247], v[132:135], a[100:103]
 ds_read_b64_tr_b16 a[202:203], v9 offset:36864
 v_add_f32 v17, v17, v29
 v_cvt_pk_bf16_f32 v166, v28, v29
 v_mfma_f32_16x16x32_bf16 a[104:107], a[240:243], v[136:139], a[104:107]
 ds_read_b64_tr_b16 a[204:205], v9 offset:40960
 v_exp_f32 v30, v110
 v_mfma_f32_16x16x32_bf16 a[104:107], a[244:247], v[140:143], a[104:107]
 ds_read_b64_tr_b16 a[206:207], v9 offset:45056
 buffer_load_dwordx4 v2, s[12:15], s87 offen offset:1024 sc1 lds
 v_add_f32 v17, v17, v30
 v_mfma_f32_16x16x32_bf16 a[108:111], a[240:243], v[144:147], a[108:111]
 ds_read_b64_tr_b16 a[208:209], v10 offset:32768
 v_exp_f32 v31, v111
 v_mfma_f32_16x16x32_bf16 a[108:111], a[244:247], v[148:151], a[108:111]
 s_waitcnt lgkmcnt(9)
 ds_read_b64_tr_b16 a[210:211], v10 offset:36864
 v_add_f32 v17, v17, v31
 v_cvt_pk_bf16_f32 v167, v30, v31
 v_mfma_f32_16x16x32_bf16 a[112:115], a[248:251], v[120:123], a[112:115]
 ds_read_b64_tr_b16 a[212:213], v10 offset:40960
 v_exp_f32 v28, v112
 v_mfma_f32_16x16x32_bf16 a[112:115], a[252:255], v[124:127], a[112:115]
 ds_read_b64_tr_b16 a[214:215], v10 offset:45056
 buffer_load_dwordx4 v2, s[12:15], s87 offen offset:2048 sc1 lds
 v_add_f32 v18, v18, v28
 v_mfma_f32_16x16x32_bf16 a[116:119], a[248:251], v[128:131], a[116:119]
 ds_read_b64_tr_b16 a[216:217], v11 offset:32768
 v_exp_f32 v29, v113
 v_mfma_f32_16x16x32_bf16 a[116:119], a[252:255], v[132:135], a[116:119]
 ds_read_b64_tr_b16 a[218:219], v11 offset:36864
 v_add_f32 v18, v18, v29
 v_cvt_pk_bf16_f32 v174, v28, v29
 v_mfma_f32_16x16x32_bf16 a[120:123], a[248:251], v[136:139], a[120:123]
 ds_read_b64_tr_b16 a[220:221], v11 offset:40960
 v_exp_f32 v30, v114
 v_mfma_f32_16x16x32_bf16 a[120:123], a[252:255], v[140:143], a[120:123]
 buffer_load_dwordx4 v2, s[12:15], s87 offen offset:3072 sc1 lds
 v_add_f32 v18, v18, v30
 v_mfma_f32_16x16x32_bf16 a[124:127], a[248:251], v[144:147], a[124:127]
 s_mov_b32 s87, 81920
 v_exp_f32 v31, v115
 v_mfma_f32_16x16x32_bf16 a[124:127], a[252:255], v[148:151], a[124:127]
 s_add_u32 m0, s60, 45056
 v_add_f32 v18, v18, v31
 v_cvt_pk_bf16_f32 v175, v30, v31
 buffer_load_dwordx4 v2, s[12:15], s87 offen offset:0 sc1 lds
 v_exp_f32 v28, v116
 v_exp_f32 v29, v117
 v_add_f32 v19, v19, v28
 v_exp_f32 v30, v118
 v_add_f32 v19, v19, v29
 v_cvt_pk_bf16_f32 v182, v28, v29
 v_exp_f32 v31, v119
 v_add_f32 v19, v19, v30
 s_nop 0
 v_add_f32 v19, v19, v31
 v_cvt_pk_bf16_f32 v183, v30, v31
 v_max3_f32 v34, v16, v17, v18
 v_add_f32 v34, v34, v19
 v_cmp_nlt_f32 vcc, v34, v20
 s_cbranch_vccnz L_slow
L_slow_ret:
 s_waitcnt lgkmcnt(11)
 v_mfma_f32_16x16x32_bf16 a[0:3], a[192:195], v[152:155], a[0:3]
 v_mov_b32 v34, v16
 v_mov_b32 v35, v17
 v_mfma_f32_16x16x32_bf16 a[0:3], a[196:199], v[156:159], a[0:3]
 ds_read_b64_tr_b16 a[222:223], v11 offset:45056
 v_mov_b32 v36, v18
 v_mfma_f32_16x16x32_bf16 a[4:7], a[192:195], v[160:163], a[4:7]
 v_mov_b32 v37, v19
 v_permlane32_swap_b32 v16, v34
 v_mfma_f32_16x16x32_bf16 a[4:7], a[196:199], v[164:167], a[4:7]
 v_permlane32_swap_b32 v17, v35
 v_permlane32_swap_b32 v18, v36
 v_mfma_f32_16x16x32_bf16 a[8:11], a[192:195], v[168:171], a[8:11]
 ds_read_b64_tr_b16 a[224:225], v12 offset:32768
 v_permlane32_swap_b32 v19, v37
 v_mfma_f32_16x16x32_bf16 a[8:11], a[196:199], v[172:175], a[8:11]
 ds_read_b64_tr_b16 a[226:227], v12 offset:36864
 v_add_f32 v16, v16, v34
 v_mfma_f32_16x16x32_bf16 a[12:15], a[192:195], v[176:179], a[12:15]
 v_add_f32 v17, v17, v35
 v_add_f32 v18, v18, v36
 v_mfma_f32_16x16x32_bf16 a[12:15], a[196:199], v[180:183], a[12:15]
 s_waitcnt lgkmcnt(10)
 v_add_f32 v19, v19, v37
 v_mov_b32 v34, v16
 v_mfma_f32_16x16x32_bf16 a[16:19], a[200:203], v[152:155], a[16:19]
 v_mov_b32 v35, v17
 v_mov_b32 v36, v18
 v_mfma_f32_16x16x32_bf16 a[16:19], a[204:207], v[156:159], a[16:19]
 ds_read_b64_tr_b16 a[228:229], v12 offset:40960
 v_mov_b32 v37, v19
 v_mfma_f32_16x16x32_bf16 a[20:23], a[200:203], v[160:163], a[20:23]
 v_permlane16_swap_b32 v16, v34
 v_permlane16_swap_b32 v17, v35
 v_mfma_f32_16x16x32_bf16 a[20:23], a[204:207], v[164:167], a[20:23]
 v_permlane16_swap_b32 v18, v36
 v_permlane16_swap_b32 v19, v37
 v_mfma_f32_16x16x32_bf16 a[24:27], a[200:203], v[168:171], a[24:27]
 ds_read_b64_tr_b16 a[230:231], v12 offset:45056
 v_add_f32 v16, v16, v34
 v_mfma_f32_16x16x32_bf16 a[24:27], a[204:207], v[172:175], a[24:27]
 ds_read_b64_tr_b16 a[232:233], v13 offset:32768
 v_add_f32 v17, v17, v35
 v_mfma_f32_16x16x32_bf16 a[28:31], a[200:203], v[176:179], a[28:31]
 v_add_f32 v18, v18, v36
 v_add_f32 v19, v19, v37
 v_mfma_f32_16x16x32_bf16 a[28:31], a[204:207], v[180:183], a[28:31]
 s_waitcnt lgkmcnt(9)
 v_rcp_f32 v16, v16
 v_mfma_f32_16x16x32_bf16 a[32:35], a[208:211], v[152:155], a[32:35]
 v_rcp_f32 v17, v17
 v_mfma_f32_16x16x32_bf16 a[32:35], a[212:215], v[156:159], a[32:35]
 ds_read_b64_tr_b16 a[234:235], v13 offset:36864
 v_mfma_f32_16x16x32_bf16 a[36:39], a[208:211], v[160:163], a[36:39]
 v_rcp_f32 v18, v18
 v_mfma_f32_16x16x32_bf16 a[36:39], a[212:215], v[164:167], a[36:39]
 v_rcp_f32 v19, v19
 v_mfma_f32_16x16x32_bf16 a[40:43], a[208:211], v[168:171], a[40:43]
 ds_read_b64_tr_b16 a[236:237], v13 offset:40960
 v_accvgpr_read_b32 v184, a0
 v_mfma_f32_16x16x32_bf16 a[40:43], a[212:215], v[172:175], a[40:43]
 ds_read_b64_tr_b16 a[238:239], v13 offset:45056
 v_accvgpr_read_b32 v185, a1
 v_mfma_f32_16x16x32_bf16 a[44:47], a[208:211], v[176:179], a[44:47]
 v_accvgpr_read_b32 v186, a2
 v_accvgpr_read_b32 v187, a3
 v_mfma_f32_16x16x32_bf16 a[44:47], a[212:215], v[180:183], a[44:47]
 s_waitcnt lgkmcnt(8)
 v_accvgpr_read_b32 v188, a16
 v_accvgpr_read_b32 v189, a17
 v_mfma_f32_16x16x32_bf16 a[48:51], a[216:219], v[152:155], a[48:51]
 v_accvgpr_read_b32 v190, a18
 v_accvgpr_read_b32 v191, a19
 v_mfma_f32_16x16x32_bf16 a[48:51], a[220:223], v[156:159], a[48:51]
 ds_read_b64_tr_b16 a[240:241], v14 offset:32768
 v_mul_f32 v184, v184, v16
 v_mfma_f32_16x16x32_bf16 a[52:55], a[216:219], v[160:163], a[52:55]
 v_mul_f32 v185, v185, v16
 v_mul_f32 v186, v186, v16
 v_mfma_f32_16x16x32_bf16 a[52:55], a[220:223], v[164:167], a[52:55]
 v_mul_f32 v187, v187, v16
 v_mul_f32 v188, v188, v16
 v_mfma_f32_16x16x32_bf16 a[56:59], a[216:219], v[168:171], a[56:59]
 ds_read_b64_tr_b16 a[242:243], v14 offset:36864
 v_mul_f32 v189, v189, v16
 v_mfma_f32_16x16x32_bf16 a[56:59], a[220:223], v[172:175], a[56:59]
 ds_read_b64_tr_b16 a[244:245], v14 offset:40960
 v_mul_f32 v190, v190, v16
 v_mfma_f32_16x16x32_bf16 a[60:63], a[216:219], v[176:179], a[60:63]
 v_mul_f32 v191, v191, v16
 v_cvt_pk_bf16_f32 v192, v184, v185
 v_mfma_f32_16x16x32_bf16 a[60:63], a[220:223], v[180:183], a[60:63]
 s_waitcnt lgkmcnt(7)
 v_cvt_pk_bf16_f32 v193, v186, v187
 v_cvt_pk_bf16_f32 v194, v188, v189
 v_mfma_f32_16x16x32_bf16 a[64:67], a[224:227], v[152:155], a[64:67]
 v_cvt_pk_bf16_f32 v195, v190, v191
 v_accvgpr_read_b32 v196, a4
 v_mfma_f32_16x16x32_bf16 a[64:67], a[228:231], v[156:159], a[64:67]
 s_mov_b32 s88, 8192
 ds_read_b64_tr_b16 a[246:247], v14 offset:45056
 v_accvgpr_read_b32 v197, a5
 v_mfma_f32_16x16x32_bf16 a[68:71], a[224:227], v[160:163], a[68:71]
 buffer_store_dwordx4 v[192:195], v2, s[28:31], s71 offen offset:0 sc1
 v_mfma_f32_16x16x32_bf16 a[68:71], a[228:231], v[164:167], a[68:71]
 v_accvgpr_read_b32 v198, a6
 v_accvgpr_read_b32 v199, a7
 v_mfma_f32_16x16x32_bf16 a[72:75], a[224:227], v[168:171], a[72:75]
 ds_read_b64_tr_b16 a[248:249], v15 offset:32768
 v_accvgpr_read_b32 v200, a20
 v_mfma_f32_16x16x32_bf16 a[72:75], a[228:231], v[172:175], a[72:75]
 ds_read_b64_tr_b16 a[250:251], v15 offset:36864
 v_accvgpr_read_b32 v201, a21
 v_mfma_f32_16x16x32_bf16 a[76:79], a[224:227], v[176:179], a[76:79]
 buffer_load_dwordx4 a[192:195], v2, s[20:23], s88 offen offset:0 sc1
 v_mfma_f32_16x16x32_bf16 a[76:79], a[228:231], v[180:183], a[76:79]
 s_waitcnt lgkmcnt(6)
 v_accvgpr_read_b32 v202, a22
 v_accvgpr_read_b32 v203, a23
 v_mfma_f32_16x16x32_bf16 a[80:83], a[232:235], v[152:155], a[80:83]
 v_mul_f32 v196, v196, v17
 v_mul_f32 v197, v197, v17
 v_mfma_f32_16x16x32_bf16 a[80:83], a[236:239], v[156:159], a[80:83]
 ds_read_b64_tr_b16 a[252:253], v15 offset:40960
 v_mul_f32 v198, v198, v17
 v_mfma_f32_16x16x32_bf16 a[84:87], a[232:235], v[160:163], a[84:87]
 buffer_load_dwordx4 a[196:199], v2, s[20:23], s88 offen offset:1024 sc1
 v_mfma_f32_16x16x32_bf16 a[84:87], a[236:239], v[164:167], a[84:87]
 v_mul_f32 v199, v199, v17
 v_mul_f32 v200, v200, v17
 v_mfma_f32_16x16x32_bf16 a[88:91], a[232:235], v[168:171], a[88:91]
 ds_read_b64_tr_b16 a[254:255], v15 offset:45056
 v_mul_f32 v201, v201, v17
 v_mfma_f32_16x16x32_bf16 a[88:91], a[236:239], v[172:175], a[88:91]
 buffer_load_dwordx4 a[200:203], v2, s[20:23], s88 offen offset:2048 sc1
 s_waitcnt vmcnt(38) lgkmcnt(0)
 s_barrier
 v_mfma_f32_16x16x32_bf16 a[92:95], a[232:235], v[176:179], a[92:95]
 ds_read_b64_tr_b16 v[56:57], v40 offset:0
 ds_read_b64_tr_b16 v[58:59], v40 offset:4608
 v_mfma_f32_16x16x32_bf16 a[92:95], a[236:239], v[180:183], a[92:95]
 ds_read_b64_tr_b16 v[60:61], v40 offset:9216
 ds_read_b64_tr_b16 v[62:63], v40 offset:13824
 v_mfma_f32_16x16x32_bf16 a[96:99], a[240:243], v[152:155], a[96:99]
 ds_read_b64_tr_b16 v[64:65], v40 offset:18432
 ds_read_b64_tr_b16 v[66:67], v40 offset:23040
 v_mfma_f32_16x16x32_bf16 a[96:99], a[244:247], v[156:159], a[96:99]
 ds_read_b64_tr_b16 v[68:69], v40 offset:27648
 ds_read_b64_tr_b16 v[70:71], v40 offset:32256
 v_mfma_f32_16x16x32_bf16 a[100:103], a[240:243], v[160:163], a[100:103]
 ds_read_b64_tr_b16 v[72:73], v40 offset:32
 ds_read_b64_tr_b16 v[74:75], v40 offset:4640
 v_mfma_f32_16x16x32_bf16 a[100:103], a[244:247], v[164:167], a[100:103]
 ds_read_b64_tr_b16 v[76:77], v40 offset:9248
 ds_read_b64_tr_b16 v[78:79], v40 offset:13856
 v_mfma_f32_16x16x32_bf16 a[104:107], a[240:243], v[168:171], a[104:107]
 ds_read_b64_tr_b16 v[80:81], v40 offset:18464
 ds_read_b64_tr_b16 v[82:83], v40 offset:23072
 v_mfma_f32_16x16x32_bf16 a[104:107], a[244:247], v[172:175], a[104:107]
 ds_read_b64_tr_b16 v[84:85], v40 offset:27680
 ds_read_b64_tr_b16 v[86:87], v40 offset:32288
 v_mfma_f32_16x16x32_bf16 a[108:111], a[240:243], v[176:179], a[108:111]
 buffer_load_dwordx4 a[204:207], v2, s[20:23], s88 offen offset:3072 sc1
 v_mfma_f32_16x16x32_bf16 a[108:111], a[244:247], v[180:183], a[108:111]
 v_mul_f32 v202, v202, v17
 v_mul_f32 v203, v203, v17
 v_mfma_f32_16x16x32_bf16 a[112:115], a[248:251], v[152:155], a[112:115]
 s_mov_b32 s89, 156928
 v_cvt_pk_bf16_f32 v204, v196, v197
 v_cvt_pk_bf16_f32 v205, v198, v199
 v_mfma_f32_16x16x32_bf16 a[112:115], a[252:255], v[156:159], a[112:115]
 buffer_load_dwordx4 a[208:211], v2, s[20:23], s89 offen offset:0 sc1
 v_mfma_f32_16x16x32_bf16 a[116:119], a[248:251], v[160:163], a[116:119]
 v_cvt_pk_bf16_f32 v206, v200, v201
 v_cvt_pk_bf16_f32 v207, v202, v203
 v_mfma_f32_16x16x32_bf16 a[116:119], a[252:255], v[164:167], a[116:119]
 v_accvgpr_read_b32 v208, a8
 v_accvgpr_read_b32 v209, a9
 v_mfma_f32_16x16x32_bf16 a[120:123], a[248:251], v[168:171], a[120:123]
 buffer_store_dwordx4 v[204:207], v2, s[28:31], s72 offen offset:0 sc1
 v_mfma_f32_16x16x32_bf16 a[120:123], a[252:255], v[172:175], a[120:123]
 v_accvgpr_read_b32 v210, a10
 v_accvgpr_read_b32 v211, a11
 v_mfma_f32_16x16x32_bf16 a[124:127], a[248:251], v[176:179], a[124:127]
 v_accvgpr_read_b32 v212, a24
 v_accvgpr_read_b32 v213, a25
 v_mfma_f32_16x16x32_bf16 a[124:127], a[252:255], v[180:183], a[124:127]
 buffer_load_dwordx4 a[212:215], v2, s[20:23], s89 offen offset:1024 sc1
 s_waitcnt vmcnt(25) lgkmcnt(8)
 v_mfma_f32_16x16x32_bf16 v[104:107], v[56:59], a[128:131], 0
 ds_read_b64_tr_b16 v[88:89], v40 offset:64
 ds_read_b64_tr_b16 v[90:91], v40 offset:4672
 v_accvgpr_read_b32 v214, a26
 v_accvgpr_read_b32 v215, a27
 v_mfma_f32_16x16x32_bf16 v[104:107], v[60:63], a[132:135], v[104:107]
 v_mul_f32 v208, v208, v18
 v_mul_f32 v209, v209, v18
 v_mul_f32 v210, v210, v18
 v_mul_f32 v211, v211, v18
 v_mfma_f32_16x16x32_bf16 v[104:107], v[64:67], a[136:139], v[104:107]
 ds_read_b64_tr_b16 v[92:93], v40 offset:9280
 ds_read_b64_tr_b16 v[94:95], v40 offset:13888
 buffer_load_dwordx4 a[216:219], v2, s[20:23], s89 offen offset:2048 sc1
 v_mfma_f32_16x16x32_bf16 v[104:107], v[68:71], a[140:143], v[104:107]
 v_mul_f32 v212, v212, v18
 v_mul_f32 v213, v213, v18
 v_mul_f32 v214, v214, v18
 v_mul_f32 v215, v215, v18
 v_mfma_f32_16x16x32_bf16 v[108:111], v[56:59], a[144:147], 0
 ds_read_b64_tr_b16 v[96:97], v40 offset:18496
 ds_read_b64_tr_b16 v[98:99], v40 offset:23104
 v_cvt_pk_bf16_f32 v216, v208, v209
 v_cvt_pk_bf16_f32 v217, v210, v211
 v_mfma_f32_16x16x32_bf16 v[108:111], v[60:63], a[148:151], v[108:111]
 buffer_load_dwordx4 a[220:223], v2, s[20:23], s89 offen offset:3072 sc1
 v_cvt_pk_bf16_f32 v218, v212, v213
 v_cvt_pk_bf16_f32 v219, v214, v215
 v_mfma_f32_16x16x32_bf16 v[108:111], v[64:67], a[152:155], v[108:111]
 s_mov_b32 s88, 12288
 ds_read_b64_tr_b16 v[100:101], v40 offset:27712
 ds_read_b64_tr_b16 v[102:103], v40 offset:32320
 v_accvgpr_read_b32 v220, a12
 v_accvgpr_read_b32 v221, a13
 v_mfma_f32_16x16x32_bf16 v[108:111], v[68:71], a[156:159], v[108:111]
 s_waitcnt lgkmcnt(8)
 v_accvgpr_read_b32 v222, a14
 v_accvgpr_read_b32 v223, a15
 v_accvgpr_read_b32 v224, a28
 v_accvgpr_read_b32 v225, a29
 v_mfma_f32_16x16x32_bf16 v[112:115], v[72:75], a[128:131], 0
 ds_read_b64_tr_b16 v[56:57], v40 offset:96
 ds_read_b64_tr_b16 v[58:59], v40 offset:4704
 buffer_store_dwordx4 v[216:219], v2, s[28:31], s73 offen offset:0 sc1
 v_mfma_f32_16x16x32_bf16 v[112:115], v[76:79], a[132:135], v[112:115]
 v_accvgpr_read_b32 v226, a30
 v_accvgpr_read_b32 v227, a31
 v_mul_f32 v220, v220, v19
 v_mul_f32 v221, v221, v19
 v_mfma_f32_16x16x32_bf16 v[112:115], v[80:83], a[136:139], v[112:115]
 ds_read_b64_tr_b16 v[60:61], v40 offset:9312
 ds_read_b64_tr_b16 v[62:63], v40 offset:13920
 v_mul_f32 v222, v222, v19
 v_mul_f32 v223, v223, v19
 v_mfma_f32_16x16x32_bf16 v[112:115], v[84:87], a[140:143], v[112:115]
 buffer_load_dwordx4 a[224:227], v2, s[20:23], s88 offen offset:0 sc1
 v_mul_f32 v224, v224, v19
 v_mul_f32 v225, v225, v19
 v_mfma_f32_16x16x32_bf16 v[116:119], v[72:75], a[144:147], 0
 ds_read_b64_tr_b16 v[64:65], v40 offset:18528
 ds_read_b64_tr_b16 v[66:67], v40 offset:23136
 v_mul_f32 v226, v226, v19
 v_mul_f32 v227, v227, v19
 v_mfma_f32_16x16x32_bf16 v[116:119], v[76:79], a[148:151], v[116:119]
 v_cvt_pk_bf16_f32 v228, v220, v221
 v_cvt_pk_bf16_f32 v229, v222, v223
 v_cvt_pk_bf16_f32 v230, v224, v225
 v_cvt_pk_bf16_f32 v231, v226, v227
 v_mfma_f32_16x16x32_bf16 v[116:119], v[80:83], a[152:155], v[116:119]
 ds_read_b64_tr_b16 v[68:69], v40 offset:27744
 ds_read_b64_tr_b16 v[70:71], v40 offset:32352
 buffer_store_dwordx4 v[228:231], v2, s[28:31], s74 offen offset:0 sc1
 v_mfma_f32_16x16x32_bf16 v[116:119], v[84:87], a[156:159], v[116:119]
 s_waitcnt lgkmcnt(8)
 v_accvgpr_read_b32 v184, a32
 v_accvgpr_read_b32 v185, a33
 v_accvgpr_read_b32 v186, a34
 v_accvgpr_read_b32 v187, a35
 v_mfma_f32_16x16x32_bf16 v[120:123], v[88:91], a[128:131], 0
 ds_read_b64_tr_b16 v[72:73], v40 offset:128
 ds_read_b64_tr_b16 v[74:75], v40 offset:4736
 v_accvgpr_read_b32 v188, a48
 v_accvgpr_read_b32 v189, a49
 v_mfma_f32_16x16x32_bf16 v[120:123], v[92:95], a[132:135], v[120:123]
 buffer_load_dwordx4 a[228:231], v2, s[20:23], s88 offen offset:1024 sc1
 v_accvgpr_read_b32 v190, a50
 v_accvgpr_read_b32 v191, a51
 v_mfma_f32_16x16x32_bf16 v[120:123], v[96:99], a[136:139], v[120:123]
 ds_read_b64_tr_b16 v[76:77], v40 offset:9344
 ds_read_b64_tr_b16 v[78:79], v40 offset:13952
 v_mul_f32 v184, v184, v16
 v_mul_f32 v185, v185, v16
 v_mfma_f32_16x16x32_bf16 v[120:123], v[100:103], a[140:143], v[120:123]
 v_mul_f32 v186, v186, v16
 v_mul_f32 v187, v187, v16
 v_mul_f32 v188, v188, v16
 v_mul_f32 v189, v189, v16
 v_mfma_f32_16x16x32_bf16 v[124:127], v[88:91], a[144:147], 0
 ds_read_b64_tr_b16 v[80:81], v40 offset:18560
 ds_read_b64_tr_b16 v[82:83], v40 offset:23168
 buffer_load_dwordx4 a[232:235], v2, s[20:23], s88 offen offset:2048 sc1
 v_mfma_f32_16x16x32_bf16 v[124:127], v[92:95], a[148:151], v[124:127]
 v_mul_f32 v190, v190, v16
 v_mul_f32 v191, v191, v16
 v_cvt_pk_bf16_f32 v192, v184, v185
 v_cvt_pk_bf16_f32 v193, v186, v187
 v_mfma_f32_16x16x32_bf16 v[124:127], v[96:99], a[152:155], v[124:127]
 ds_read_b64_tr_b16 v[84:85], v40 offset:27776
 ds_read_b64_tr_b16 v[86:87], v40 offset:32384
 v_cvt_pk_bf16_f32 v194, v188, v189
 v_cvt_pk_bf16_f32 v195, v190, v191
 v_mfma_f32_16x16x32_bf16 v[124:127], v[100:103], a[156:159], v[124:127]
 s_waitcnt lgkmcnt(8)
 buffer_store_dwordx4 v[192:195], v2, s[28:31], s71 offen offset:1024 sc1
 v_accvgpr_read_b32 v196, a36
 v_accvgpr_read_b32 v197, a37
 v_mfma_f32_16x16x32_bf16 v[128:131], v[56:59], a[128:131], 0
 ds_read_b64_tr_b16 v[88:89], v40 offset:160
 ds_read_b64_tr_b16 v[90:91], v40 offset:4768
 v_accvgpr_read_b32 v198, a38
 v_accvgpr_read_b32 v199, a39
 v_mfma_f32_16x16x32_bf16 v[128:131], v[60:63], a[132:135], v[128:131]
 v_accvgpr_read_b32 v200, a52
 v_accvgpr_read_b32 v201, a53
 v_accvgpr_read_b32 v202, a54
 v_accvgpr_read_b32 v203, a55
 v_mfma_f32_16x16x32_bf16 v[128:131], v[64:67], a[136:139], v[128:131]
 ds_read_b64_tr_b16 v[92:93], v40 offset:9376
 ds_read_b64_tr_b16 v[94:95], v40 offset:13984
 buffer_load_dwordx4 a[236:239], v2, s[20:23], s88 offen offset:3072 sc1
 v_mfma_f32_16x16x32_bf16 v[128:131], v[68:71], a[140:143], v[128:131]
 s_mov_b32 s89, 161024
 v_mul_f32 v196, v196, v17
 v_mul_f32 v197, v197, v17
 v_mul_f32 v198, v198, v17
 v_mul_f32 v199, v199, v17
 v_mfma_f32_16x16x32_bf16 v[132:135], v[56:59], a[144:147], 0
 ds_read_b64_tr_b16 v[96:97], v40 offset:18592
 ds_read_b64_tr_b16 v[98:99], v40 offset:23200
 v_mul_f32 v200, v200, v17
 v_mul_f32 v201, v201, v17
 v_mfma_f32_16x16x32_bf16 v[132:135], v[60:63], a[148:151], v[132:135]
 buffer_load_dwordx4 a[240:243], v2, s[20:23], s89 offen offset:0 sc1
 v_mul_f32 v202, v202, v17
 v_mul_f32 v203, v203, v17
 v_mfma_f32_16x16x32_bf16 v[132:135], v[64:67], a[152:155], v[132:135]
 ds_read_b64_tr_b16 v[100:101], v40 offset:27808
 ds_read_b64_tr_b16 v[102:103], v40 offset:32416
 v_cvt_pk_bf16_f32 v204, v196, v197
 v_cvt_pk_bf16_f32 v205, v198, v199
 v_mfma_f32_16x16x32_bf16 v[132:135], v[68:71], a[156:159], v[132:135]
 s_waitcnt lgkmcnt(8)
 v_cvt_pk_bf16_f32 v206, v200, v201
 v_cvt_pk_bf16_f32 v207, v202, v203
 v_accvgpr_read_b32 v208, a40
 v_accvgpr_read_b32 v209, a41
 v_mfma_f32_16x16x32_bf16 v[136:139], v[72:75], a[128:131], 0
 ds_read_b64_tr_b16 v[56:57], v40 offset:192
 ds_read_b64_tr_b16 v[58:59], v40 offset:4800
 buffer_store_dwordx4 v[204:207], v2, s[28:31], s72 offen offset:1024 sc1
 v_mfma_f32_16x16x32_bf16 v[136:139], v[76:79], a[132:135], v[136:139]
 v_accvgpr_read_b32 v210, a42
 v_accvgpr_read_b32 v211, a43
 v_accvgpr_read_b32 v212, a56
 v_accvgpr_read_b32 v213, a57
 v_mfma_f32_16x16x32_bf16 v[136:139], v[80:83], a[136:139], v[136:139]
 ds_read_b64_tr_b16 v[60:61], v40 offset:9408
 ds_read_b64_tr_b16 v[62:63], v40 offset:14016
 v_accvgpr_read_b32 v214, a58
 v_accvgpr_read_b32 v215, a59
 v_mfma_f32_16x16x32_bf16 v[136:139], v[84:87], a[140:143], v[136:139]
 buffer_load_dwordx4 a[244:247], v2, s[20:23], s89 offen offset:1024 sc1
 v_mul_f32 v208, v208, v18
 v_mul_f32 v209, v209, v18
 v_mfma_f32_16x16x32_bf16 v[140:143], v[72:75], a[144:147], 0
 ds_read_b64_tr_b16 v[64:65], v40 offset:18624
 ds_read_b64_tr_b16 v[66:67], v40 offset:23232
 v_mul_f32 v210, v210, v18
 v_mul_f32 v211, v211, v18
 v_mfma_f32_16x16x32_bf16 v[140:143], v[76:79], a[148:151], v[140:143]
 v_mul_f32 v212, v212, v18
 v_mul_f32 v213, v213, v18
 v_mul_f32 v214, v214, v18
 v_mul_f32 v215, v215, v18
 v_mfma_f32_16x16x32_bf16 v[140:143], v[80:83], a[152:155], v[140:143]
 ds_read_b64_tr_b16 v[68:69], v40 offset:27840
 ds_read_b64_tr_b16 v[70:71], v40 offset:32448
 buffer_load_dwordx4 a[248:251], v2, s[20:23], s89 offen offset:2048 sc1
 v_mfma_f32_16x16x32_bf16 v[140:143], v[84:87], a[156:159], v[140:143]
 s_waitcnt lgkmcnt(8)
 v_cvt_pk_bf16_f32 v216, v208, v209
 v_cvt_pk_bf16_f32 v217, v210, v211
 v_cvt_pk_bf16_f32 v218, v212, v213
 v_cvt_pk_bf16_f32 v219, v214, v215
 v_mfma_f32_16x16x32_bf16 v[144:147], v[88:91], a[128:131], 0
 ds_read_b64_tr_b16 v[72:73], v40 offset:224
 ds_read_b64_tr_b16 v[74:75], v40 offset:4832
 v_accvgpr_read_b32 v220, a44
 v_accvgpr_read_b32 v221, a45
 v_mfma_f32_16x16x32_bf16 v[144:147], v[92:95], a[132:135], v[144:147]
 buffer_store_dwordx4 v[216:219], v2, s[28:31], s73 offen offset:1024 sc1
 v_accvgpr_read_b32 v222, a46
 v_accvgpr_read_b32 v223, a47
 v_mfma_f32_16x16x32_bf16 v[144:147], v[96:99], a[136:139], v[144:147]
 ds_read_b64_tr_b16 v[76:77], v40 offset:9440
 ds_read_b64_tr_b16 v[78:79], v40 offset:14048
 v_accvgpr_read_b32 v224, a60
 v_accvgpr_read_b32 v225, a61
 v_mfma_f32_16x16x32_bf16 v[144:147], v[100:103], a[140:143], v[144:147]
 v_accvgpr_read_b32 v226, a62
 v_accvgpr_read_b32 v227, a63
 v_mul_f32 v220, v220, v19
 v_mul_f32 v221, v221, v19
 v_mfma_f32_16x16x32_bf16 v[148:151], v[88:91], a[144:147], 0
 ds_read_b64_tr_b16 v[80:81], v40 offset:18656
 ds_read_b64_tr_b16 v[82:83], v40 offset:23264
 buffer_load_dwordx4 a[252:255], v2, s[20:23], s89 offen offset:3072 sc1
 v_mfma_f32_16x16x32_bf16 v[148:151], v[92:95], a[148:151], v[148:151]
 s_mov_b32 s87, 110592
 v_mul_f32 v222, v222, v19
 v_mul_f32 v223, v223, v19
 v_mul_f32 v224, v224, v19
 v_mul_f32 v225, v225, v19
 v_mfma_f32_16x16x32_bf16 v[148:151], v[96:99], a[152:155], v[148:151]
 s_add_u32 m0, s60, 73728
 ds_read_b64_tr_b16 v[84:85], v40 offset:27872
 ds_read_b64_tr_b16 v[86:87], v40 offset:32480
 v_mul_f32 v226, v226, v19
 v_mul_f32 v227, v227, v19
 v_mfma_f32_16x16x32_bf16 v[148:151], v[100:103], a[156:159], v[148:151]
 s_waitcnt lgkmcnt(8)
 buffer_load_dwordx4 v2, s[12:15], s87 offen offset:0 sc1 lds
 v_cvt_pk_bf16_f32 v228, v220, v221
 v_cvt_pk_bf16_f32 v229, v222, v223
 v_mfma_f32_16x16x32_bf16 v[152:155], v[56:59], a[128:131], 0
 ds_read_b64_tr_b16 v[88:89], v40 offset:256
 ds_read_b64_tr_b16 v[90:91], v40 offset:4864
 v_cvt_pk_bf16_f32 v230, v224, v225
 v_cvt_pk_bf16_f32 v231, v226, v227
 v_mfma_f32_16x16x32_bf16 v[152:155], v[60:63], a[132:135], v[152:155]
 v_accvgpr_read_b32 v184, a64
 v_accvgpr_read_b32 v185, a65
 v_accvgpr_read_b32 v186, a66
 v_accvgpr_read_b32 v187, a67
 v_mfma_f32_16x16x32_bf16 v[152:155], v[64:67], a[136:139], v[152:155]
 ds_read_b64_tr_b16 v[92:93], v40 offset:9472
 ds_read_b64_tr_b16 v[94:95], v40 offset:14080
 buffer_store_dwordx4 v[228:231], v2, s[28:31], s74 offen offset:1024 sc1
 v_mfma_f32_16x16x32_bf16 v[152:155], v[68:71], a[140:143], v[152:155]
 v_accvgpr_read_b32 v188, a80
 v_accvgpr_read_b32 v189, a81
 v_accvgpr_read_b32 v190, a82
 v_accvgpr_read_b32 v191, a83
 v_mfma_f32_16x16x32_bf16 v[156:159], v[56:59], a[144:147], 0
 ds_read_b64_tr_b16 v[96:97], v40 offset:18688
 ds_read_b64_tr_b16 v[98:99], v40 offset:23296
 v_mul_f32 v184, v184, v16
 v_mul_f32 v185, v185, v16
 v_mfma_f32_16x16x32_bf16 v[156:159], v[60:63], a[148:151], v[156:159]
 buffer_load_dwordx4 v2, s[12:15], s87 offen offset:1024 sc1 lds
 v_mul_f32 v186, v186, v16
 v_mul_f32 v187, v187, v16
 v_mfma_f32_16x16x32_bf16 v[156:159], v[64:67], a[152:155], v[156:159]
 ds_read_b64_tr_b16 v[100:101], v40 offset:27904
 ds_read_b64_tr_b16 v[102:103], v40 offset:32512
 v_mul_f32 v188, v188, v16
 v_mul_f32 v189, v189, v16
 v_mfma_f32_16x16x32_bf16 v[156:159], v[68:71], a[156:159], v[156:159]
 s_waitcnt lgkmcnt(8)
 v_mul_f32 v190, v190, v16
 v_mul_f32 v191, v191, v16
 v_cvt_pk_bf16_f32 v192, v184, v185
 v_cvt_pk_bf16_f32 v193, v186, v187
 v_mfma_f32_16x16x32_bf16 v[160:163], v[72:75], a[128:131], 0
 buffer_load_dwordx4 v2, s[12:15], s87 offen offset:2048 sc1 lds
 v_cvt_pk_bf16_f32 v194, v188, v189
 v_cvt_pk_bf16_f32 v195, v190, v191
 v_mfma_f32_16x16x32_bf16 v[160:163], v[76:79], a[132:135], v[160:163]
 v_accvgpr_read_b32 v196, a68
 v_accvgpr_read_b32 v197, a69
 v_accvgpr_read_b32 v198, a70
 v_accvgpr_read_b32 v199, a71
 v_mfma_f32_16x16x32_bf16 v[160:163], v[80:83], a[136:139], v[160:163]
 s_waitcnt lgkmcnt(0)
 v_accvgpr_read_b32 v200, a84
 v_accvgpr_read_b32 v201, a85
 v_accvgpr_read_b32 v202, a86
 v_accvgpr_read_b32 v203, a87
 v_mfma_f32_16x16x32_bf16 v[160:163], v[84:87], a[140:143], v[160:163]
 s_barrier
 buffer_store_dwordx4 v[192:195], v2, s[28:31], s71 offen offset:2048 sc1
 v_mul_f32 v196, v196, v17
 v_mul_f32 v197, v197, v17
 v_mfma_f32_16x16x32_bf16 v[164:167], v[72:75], a[144:147], 0
 ds_read_b64_tr_b16 v[56:57], v41 offset:0
 ds_read_b64_tr_b16 v[58:59], v41 offset:4608
 v_mul_f32 v198, v198, v17
 v_mul_f32 v199, v199, v17
 v_mfma_f32_16x16x32_bf16 v[164:167], v[76:79], a[148:151], v[164:167]
 ds_read_b64_tr_b16 v[60:61], v41 offset:9216
 ds_read_b64_tr_b16 v[62:63], v41 offset:13824
 v_mul_f32 v200, v200, v17
 v_mul_f32 v201, v201, v17
 v_mfma_f32_16x16x32_bf16 v[164:167], v[80:83], a[152:155], v[164:167]
 ds_read_b64_tr_b16 v[64:65], v41 offset:18432
 ds_read_b64_tr_b16 v[66:67], v41 offset:23040
 buffer_load_dwordx4 v2, s[12:15], s87 offen offset:3072 sc1 lds
 v_mfma_f32_16x16x32_bf16 v[164:167], v[84:87], a[156:159], v[164:167]
 ds_read_b64_tr_b16 v[68:69], v41 offset:27648
 ds_read_b64_tr_b16 v[70:71], v41 offset:32256
 v_mul_f32 v202, v202, v17
 v_mul_f32 v203, v203, v17
 v_mfma_f32_16x16x32_bf16 v[168:171], v[88:91], a[128:131], 0
 s_mov_b32 s87, 114688
 ds_read_b64_tr_b16 v[72:73], v41 offset:32
 ds_read_b64_tr_b16 v[74:75], v41 offset:4640
 v_cvt_pk_bf16_f32 v204, v196, v197
 v_cvt_pk_bf16_f32 v205, v198, v199
 v_mfma_f32_16x16x32_bf16 v[168:171], v[92:95], a[132:135], v[168:171]
 s_add_u32 m0, s60, 77824
 v_cvt_pk_bf16_f32 v206, v200, v201
 v_cvt_pk_bf16_f32 v207, v202, v203
 v_accvgpr_read_b32 v208, a72
 v_accvgpr_read_b32 v209, a73
 v_mfma_f32_16x16x32_bf16 v[168:171], v[96:99], a[136:139], v[168:171]
 ds_read_b64_tr_b16 v[76:77], v41 offset:9248
 ds_read_b64_tr_b16 v[78:79], v41 offset:13856
 buffer_store_dwordx4 v[204:207], v2, s[28:31], s72 offen offset:2048 sc1
 v_mfma_f32_16x16x32_bf16 v[168:171], v[100:103], a[140:143], v[168:171]
 v_accvgpr_read_b32 v210, a74
 v_accvgpr_read_b32 v211, a75
 v_accvgpr_read_b32 v212, a88
 v_accvgpr_read_b32 v213, a89
 v_mfma_f32_16x16x32_bf16 v[172:175], v[88:91], a[144:147], 0
 ds_read_b64_tr_b16 v[80:81], v41 offset:18464
 ds_read_b64_tr_b16 v[82:83], v41 offset:23072
 v_accvgpr_read_b32 v214, a90
 v_accvgpr_read_b32 v215, a91
 v_mfma_f32_16x16x32_bf16 v[172:175], v[92:95], a[148:151], v[172:175]
 buffer_load_dwordx4 v2, s[12:15], s87 offen offset:0 sc1 lds
 v_mul_f32 v208, v208, v18
 v_mul_f32 v209, v209, v18
 v_mfma_f32_16x16x32_bf16 v[172:175], v[96:99], a[152:155], v[172:175]
 ds_read_b64_tr_b16 v[84:85], v41 offset:27680
 ds_read_b64_tr_b16 v[86:87], v41 offset:32288
 v_mul_f32 v210, v210, v18
 v_mul_f32 v211, v211, v18
 v_mfma_f32_16x16x32_bf16 v[172:175], v[100:103], a[156:159], v[172:175]
 s_waitcnt vmcnt(40) lgkmcnt(8)
 v_mul_f32 v212, v212, v18
 v_mul_f32 v213, v213, v18
 v_mul_f32 v214, v214, v18
 v_mul_f32 v215, v215, v18
 v_mfma_f32_16x16x32_bf16 v[104:107], v[56:59], a[160:163], v[104:107]
 ds_read_b64_tr_b16 v[88:89], v41 offset:64
 ds_read_b64_tr_b16 v[90:91], v41 offset:4672
 buffer_load_dwordx4 v2, s[12:15], s87 offen offset:1024 sc1 lds
 v_mfma_f32_16x16x32_bf16 v[104:107], v[60:63], a[164:167], v[104:107]
 v_cvt_pk_bf16_f32 v216, v208, v209
 v_cvt_pk_bf16_f32 v217, v210, v211
 v_cvt_pk_bf16_f32 v218, v212, v213
 v_cvt_pk_bf16_f32 v219, v214, v215
 v_mfma_f32_16x16x32_bf16 v[104:107], v[64:67], a[168:171], v[104:107]
 ds_read_b64_tr_b16 v[92:93], v41 offset:9280
 ds_read_b64_tr_b16 v[94:95], v41 offset:13888
 v_accvgpr_read_b32 v220, a76
 v_accvgpr_read_b32 v221, a77
 v_mfma_f32_16x16x32_bf16 v[104:107], v[68:71], a[172:175], v[104:107]
 buffer_store_dwordx4 v[216:219], v2, s[28:31], s73 offen offset:2048 sc1
 v_accvgpr_read_b32 v222, a78
 v_accvgpr_read_b32 v223, a79
 v_mfma_f32_16x16x32_bf16 v[108:111], v[56:59], a[176:179], v[108:111]
 ds_read_b64_tr_b16 v[96:97], v41 offset:18496
 ds_read_b64_tr_b16 v[98:99], v41 offset:23104
 v_accvgpr_read_b32 v224, a92
 v_accvgpr_read_b32 v225, a93
 v_mfma_f32_16x16x32_bf16 v[108:111], v[60:63], a[180:183], v[108:111]
 v_accvgpr_read_b32 v226, a94
 v_accvgpr_read_b32 v227, a95
 v_mul_f32 v220, v220, v19
 v_mul_f32 v221, v221, v19
 v_mfma_f32_16x16x32_bf16 v[108:111], v[64:67], a[184:187], v[108:111]
 ds_read_b64_tr_b16 v[100:101], v41 offset:27712
 ds_read_b64_tr_b16 v[102:103], v41 offset:32320
 buffer_load_dwordx4 v2, s[12:15], s87 offen offset:2048 sc1 lds
 v_mfma_f32_16x16x32_bf16 v[108:111], v[68:71], a[188:191], v[108:111]
 s_waitcnt lgkmcnt(8)
 v_mul_f32 v222, v222, v19
 v_mul_f32 v223, v223, v19
 v_mul_f32 v224, v224, v19
 v_mul_f32 v225, v225, v19
 v_mfma_f32_16x16x32_bf16 v[112:115], v[72:75], a[160:163], v[112:115]
 ds_read_b64_tr_b16 v[56:57], v41 offset:96
 ds_read_b64_tr_b16 v[58:59], v41 offset:4704
 v_mul_f32 v226, v226, v19
 v_mul_f32 v227, v227, v19
 v_mfma_f32_16x16x32_bf16 v[112:115], v[76:79], a[164:167], v[112:115]
 buffer_load_dwordx4 v2, s[12:15], s87 offen offset:3072 sc1 lds
 v_cvt_pk_bf16_f32 v228, v220, v221
 v_cvt_pk_bf16_f32 v229, v222, v223
 v_mfma_f32_16x16x32_bf16 v[112:115], v[80:83], a[168:171], v[112:115]
 s_mov_b32 s87, 118784
 ds_read_b64_tr_b16 v[60:61], v41 offset:9312
 ds_read_b64_tr_b16 v[62:63], v41 offset:13920
 v_cvt_pk_bf16_f32 v230, v224, v225
 v_cvt_pk_bf16_f32 v231, v226, v227
 v_mfma_f32_16x16x32_bf16 v[112:115], v[84:87], a[172:175], v[112:115]
 s_add_u32 m0, s60, 81920
 v_accvgpr_read_b32 v184, a96
 v_accvgpr_read_b32 v185, a97
 v_accvgpr_read_b32 v186, a98
 v_accvgpr_read_b32 v187, a99
 v_mfma_f32_16x16x32_bf16 v[116:119], v[72:75], a[176:179], v[116:119]
 ds_read_b64_tr_b16 v[64:65], v41 offset:18528
 ds_read_b64_tr_b16 v[66:67], v41 offset:23136
 buffer_store_dwordx4 v[228:231], v2, s[28:31], s74 offen offset:2048 sc1
 v_mfma_f32_16x16x32_bf16 v[116:119], v[76:79], a[180:183], v[116:119]
 v_accvgpr_read_b32 v188, a112
 v_accvgpr_read_b32 v189, a113
 v_accvgpr_read_b32 v190, a114
 v_accvgpr_read_b32 v191, a115
 v_mfma_f32_16x16x32_bf16 v[116:119], v[80:83], a[184:187], v[116:119]
 ds_read_b64_tr_b16 v[68:69], v41 offset:27744
 ds_read_b64_tr_b16 v[70:71], v41 offset:32352
 v_mul_f32 v184, v184, v16
 v_mul_f32 v185, v185, v16
 v_mfma_f32_16x16x32_bf16 v[116:119], v[84:87], a[188:191], v[116:119]
 s_waitcnt lgkmcnt(8)
 buffer_load_dwordx4 v2, s[12:15], s87 offen offset:0 sc1 lds
 v_mul_f32 v186, v186, v16
 v_mul_f32 v187, v187, v16
 v_mfma_f32_16x16x32_bf16 v[120:123], v[88:91], a[160:163], v[120:123]
 s_mov_b32 s88, 16384
 ds_read_b64_tr_b16 v[72:73], v41 offset:128
 ds_read_b64_tr_b16 v[74:75], v41 offset:4736
 v_mul_f32 v188, v188, v16
 v_mul_f32 v189, v189, v16
 v_mfma_f32_16x16x32_bf16 v[120:123], v[92:95], a[164:167], v[120:123]
 v_mul_f32 v190, v190, v16
 v_mul_f32 v191, v191, v16
 v_cvt_pk_bf16_f32 v192, v184, v185
 v_cvt_pk_bf16_f32 v193, v186, v187
 v_mfma_f32_16x16x32_bf16 v[120:123], v[96:99], a[168:171], v[120:123]
 ds_read_b64_tr_b16 v[76:77], v41 offset:9344
 ds_read_b64_tr_b16 v[78:79], v41 offset:13952
 buffer_load_dwordx4 a[128:131], v2, s[20:23], s88 offen offset:0 sc1
 v_mfma_f32_16x16x32_bf16 v[120:123], v[100:103], a[172:175], v[120:123]
 v_cvt_pk_bf16_f32 v194, v188, v189
 v_cvt_pk_bf16_f32 v195, v190, v191
 v_accvgpr_read_b32 v196, a100
 v_accvgpr_read_b32 v197, a101
 v_mfma_f32_16x16x32_bf16 v[124:127], v[88:91], a[176:179], v[124:127]
 ds_read_b64_tr_b16 v[80:81], v41 offset:18560
 ds_read_b64_tr_b16 v[82:83], v41 offset:23168
 v_accvgpr_read_b32 v198, a102
 v_accvgpr_read_b32 v199, a103
 v_mfma_f32_16x16x32_bf16 v[124:127], v[92:95], a[180:183], v[124:127]
 buffer_store_dwordx4 v[192:195], v2, s[28:31], s71 offen offset:3072 sc1
 v_accvgpr_read_b32 v200, a116
 v_accvgpr_read_b32 v201, a117
 v_mfma_f32_16x16x32_bf16 v[124:127], v[96:99], a[184:187], v[124:127]
 ds_read_b64_tr_b16 v[84:85], v41 offset:27776
 ds_read_b64_tr_b16 v[86:87], v41 offset:32384
 v_accvgpr_read_b32 v202, a118
 v_accvgpr_read_b32 v203, a119
 v_mfma_f32_16x16x32_bf16 v[124:127], v[100:103], a[188:191], v[124:127]
 s_waitcnt lgkmcnt(8)
 v_mul_f32 v196, v196, v17
 v_mul_f32 v197, v197, v17
 v_mul_f32 v198, v198, v17
 v_mul_f32 v199, v199, v17
 v_mfma_f32_16x16x32_bf16 v[128:131], v[56:59], a[160:163], v[128:131]
 ds_read_b64_tr_b16 v[88:89], v41 offset:160
 ds_read_b64_tr_b16 v[90:91], v41 offset:4768
 buffer_load_dwordx4 a[132:135], v2, s[20:23], s88 offen offset:1024 sc1
 v_mfma_f32_16x16x32_bf16 v[128:131], v[60:63], a[164:167], v[128:131]
 v_mul_f32 v200, v200, v17
 v_mul_f32 v201, v201, v17
 v_mul_f32 v202, v202, v17
 v_mul_f32 v203, v203, v17
 v_mfma_f32_16x16x32_bf16 v[128:131], v[64:67], a[168:171], v[128:131]
 ds_read_b64_tr_b16 v[92:93], v41 offset:9376
 ds_read_b64_tr_b16 v[94:95], v41 offset:13984
 v_cvt_pk_bf16_f32 v204, v196, v197
 v_cvt_pk_bf16_f32 v205, v198, v199
 v_mfma_f32_16x16x32_bf16 v[128:131], v[68:71], a[172:175], v[128:131]
 buffer_load_dwordx4 a[136:139], v2, s[20:23], s88 offen offset:2048 sc1
 v_cvt_pk_bf16_f32 v206, v200, v201
 v_cvt_pk_bf16_f32 v207, v202, v203
 v_mfma_f32_16x16x32_bf16 v[132:135], v[56:59], a[176:179], v[132:135]
 ds_read_b64_tr_b16 v[96:97], v41 offset:18592
 ds_read_b64_tr_b16 v[98:99], v41 offset:23200
 v_accvgpr_read_b32 v208, a104
 v_accvgpr_read_b32 v209, a105
 v_mfma_f32_16x16x32_bf16 v[132:135], v[60:63], a[180:183], v[132:135]
 v_accvgpr_read_b32 v210, a106
 v_accvgpr_read_b32 v211, a107
 v_accvgpr_read_b32 v212, a120
 v_accvgpr_read_b32 v213, a121
 v_mfma_f32_16x16x32_bf16 v[132:135], v[64:67], a[184:187], v[132:135]
 ds_read_b64_tr_b16 v[100:101], v41 offset:27808
 ds_read_b64_tr_b16 v[102:103], v41 offset:32416
 buffer_store_dwordx4 v[204:207], v2, s[28:31], s72 offen offset:3072 sc1
 v_mfma_f32_16x16x32_bf16 v[132:135], v[68:71], a[188:191], v[132:135]
 s_waitcnt lgkmcnt(8)
 v_accvgpr_read_b32 v214, a122
 v_accvgpr_read_b32 v215, a123
 v_mul_f32 v208, v208, v18
 v_mul_f32 v209, v209, v18
 v_mfma_f32_16x16x32_bf16 v[136:139], v[72:75], a[160:163], v[136:139]
 ds_read_b64_tr_b16 v[56:57], v41 offset:192
 ds_read_b64_tr_b16 v[58:59], v41 offset:4800
 v_mul_f32 v210, v210, v18
 v_mul_f32 v211, v211, v18
 v_mfma_f32_16x16x32_bf16 v[136:139], v[76:79], a[164:167], v[136:139]
 buffer_load_dwordx4 a[140:143], v2, s[20:23], s88 offen offset:3072 sc1
 v_mul_f32 v212, v212, v18
 v_mul_f32 v213, v213, v18
 v_mfma_f32_16x16x32_bf16 v[136:139], v[80:83], a[168:171], v[136:139]
 s_mov_b32 s89, 165120
 ds_read_b64_tr_b16 v[60:61], v41 offset:9408
 ds_read_b64_tr_b16 v[62:63], v41 offset:14016
 v_mul_f32 v214, v214, v18
 v_mul_f32 v215, v215, v18
 v_mfma_f32_16x16x32_bf16 v[136:139], v[84:87], a[172:175], v[136:139]
 v_cvt_pk_bf16_f32 v216, v208, v209
 v_cvt_pk_bf16_f32 v217, v210, v211
 v_cvt_pk_bf16_f32 v218, v212, v213
 v_cvt_pk_bf16_f32 v219, v214, v215
 v_mfma_f32_16x16x32_bf16 v[140:143], v[72:75], a[176:179], v[140:143]
 ds_read_b64_tr_b16 v[64:65], v41 offset:18624
 ds_read_b64_tr_b16 v[66:67], v41 offset:23232
 buffer_store_dwordx4 v[216:219], v2, s[28:31], s73 offen offset:3072 sc1
 v_mfma_f32_16x16x32_bf16 v[140:143], v[76:79], a[180:183], v[140:143]
 v_accvgpr_read_b32 v220, a108
 v_accvgpr_read_b32 v221, a109
 v_accvgpr_read_b32 v222, a110
 v_accvgpr_read_b32 v223, a111
 v_mfma_f32_16x16x32_bf16 v[140:143], v[80:83], a[184:187], v[140:143]
 ds_read_b64_tr_b16 v[68:69], v41 offset:27840
 ds_read_b64_tr_b16 v[70:71], v41 offset:32448
 v_accvgpr_read_b32 v224, a124
 v_accvgpr_read_b32 v225, a125
 v_mfma_f32_16x16x32_bf16 v[140:143], v[84:87], a[188:191], v[140:143]
 s_waitcnt lgkmcnt(8)
 buffer_load_dwordx4 a[144:147], v2, s[20:23], s89 offen offset:0 sc1
 v_accvgpr_read_b32 v226, a126
 v_accvgpr_read_b32 v227, a127
 v_mfma_f32_16x16x32_bf16 v[144:147], v[88:91], a[160:163], v[144:147]
 ds_read_b64_tr_b16 v[72:73], v41 offset:224
 ds_read_b64_tr_b16 v[74:75], v41 offset:4832
 v_mul_f32 v220, v220, v19
 v_mul_f32 v221, v221, v19
 v_mfma_f32_16x16x32_bf16 v[144:147], v[92:95], a[164:167], v[144:147]
 v_mul_f32 v222, v222, v19
 v_mul_f32 v223, v223, v19
 v_mul_f32 v224, v224, v19
 v_mul_f32 v225, v225, v19
 v_mfma_f32_16x16x32_bf16 v[144:147], v[96:99], a[168:171], v[144:147]
 ds_read_b64_tr_b16 v[76:77], v41 offset:9440
 ds_read_b64_tr_b16 v[78:79], v41 offset:14048
 buffer_load_dwordx4 a[148:151], v2, s[20:23], s89 offen offset:1024 sc1
 v_mfma_f32_16x16x32_bf16 v[144:147], v[100:103], a[172:175], v[144:147]
 v_mul_f32 v226, v226, v19
 v_mul_f32 v227, v227, v19
 v_cvt_pk_bf16_f32 v228, v220, v221
 v_cvt_pk_bf16_f32 v229, v222, v223
 v_mfma_f32_16x16x32_bf16 v[148:151], v[88:91], a[176:179], v[148:151]
 ds_read_b64_tr_b16 v[80:81], v41 offset:18656
 ds_read_b64_tr_b16 v[82:83], v41 offset:23264
 v_cvt_pk_bf16_f32 v230, v224, v225
 v_cvt_pk_bf16_f32 v231, v226, v227
 v_mfma_f32_16x16x32_bf16 v[148:151], v[92:95], a[180:183], v[148:151]
 buffer_store_dwordx4 v[228:231], v2, s[28:31], s74 offen offset:3072 sc1
 v_mfma_f32_16x16x32_bf16 v[148:151], v[96:99], a[184:187], v[148:151]
 ds_read_b64_tr_b16 v[84:85], v41 offset:27872
 ds_read_b64_tr_b16 v[86:87], v41 offset:32480
 v_mfma_f32_16x16x32_bf16 v[148:151], v[100:103], a[188:191], v[148:151]
 s_waitcnt lgkmcnt(8)
 v_mfma_f32_16x16x32_bf16 v[152:155], v[56:59], a[160:163], v[152:155]
 ds_read_b64_tr_b16 v[88:89], v41 offset:256
 ds_read_b64_tr_b16 v[90:91], v41 offset:4864
 buffer_load_dwordx4 a[152:155], v2, s[20:23], s89 offen offset:2048 sc1
 v_mfma_f32_16x16x32_bf16 v[152:155], v[60:63], a[164:167], v[152:155]
 v_mfma_f32_16x16x32_bf16 v[152:155], v[64:67], a[168:171], v[152:155]
 ds_read_b64_tr_b16 v[92:93], v41 offset:9472
 ds_read_b64_tr_b16 v[94:95], v41 offset:14080
 v_mfma_f32_16x16x32_bf16 v[152:155], v[68:71], a[172:175], v[152:155]
 buffer_load_dwordx4 a[156:159], v2, s[20:23], s89 offen offset:3072 sc1
 v_mfma_f32_16x16x32_bf16 v[156:159], v[56:59], a[176:179], v[156:159]
 s_mov_b32 s87, 147456
 ds_read_b64_tr_b16 v[96:97], v41 offset:18688
 ds_read_b64_tr_b16 v[98:99], v41 offset:23296
 v_mfma_f32_16x16x32_bf16 v[156:159], v[60:63], a[180:183], v[156:159]
 s_add_u32 m0, s60, 0
 v_mfma_f32_16x16x32_bf16 v[156:159], v[64:67], a[184:187], v[156:159]
 ds_read_b64_tr_b16 v[100:101], v41 offset:27904
 ds_read_b64_tr_b16 v[102:103], v41 offset:32512
 buffer_load_dwordx4 v2, s[12:15], s87 offen offset:0 sc1 lds
 v_mfma_f32_16x16x32_bf16 v[156:159], v[68:71], a[188:191], v[156:159]
 s_waitcnt lgkmcnt(8)
 v_mfma_f32_16x16x32_bf16 v[160:163], v[72:75], a[160:163], v[160:163]
 v_mfma_f32_16x16x32_bf16 v[160:163], v[76:79], a[164:167], v[160:163]
 buffer_load_dwordx4 v2, s[12:15], s87 offen offset:1024 sc1 lds
 v_mfma_f32_16x16x32_bf16 v[160:163], v[80:83], a[168:171], v[160:163]
 s_waitcnt vmcnt(51) lgkmcnt(0)
 v_mfma_f32_16x16x32_bf16 v[160:163], v[84:87], a[172:175], v[160:163]
 s_barrier
 v_mfma_f32_16x16x32_bf16 v[164:167], v[72:75], a[176:179], v[164:167]
 ds_read_b64_tr_b16 v[56:57], v42 offset:0
 ds_read_b64_tr_b16 v[58:59], v42 offset:4608
 buffer_load_dwordx4 v2, s[12:15], s87 offen offset:2048 sc1 lds
 v_mfma_f32_16x16x32_bf16 v[164:167], v[76:79], a[180:183], v[164:167]
 ds_read_b64_tr_b16 v[60:61], v42 offset:9216
 ds_read_b64_tr_b16 v[62:63], v42 offset:13824
 v_mfma_f32_16x16x32_bf16 v[164:167], v[80:83], a[184:187], v[164:167]
 ds_read_b64_tr_b16 v[64:65], v42 offset:18432
 ds_read_b64_tr_b16 v[66:67], v42 offset:23040
 v_mfma_f32_16x16x32_bf16 v[164:167], v[84:87], a[188:191], v[164:167]
 ds_read_b64_tr_b16 v[68:69], v42 offset:27648
 ds_read_b64_tr_b16 v[70:71], v42 offset:32256
 buffer_load_dwordx4 v2, s[12:15], s87 offen offset:3072 sc1 lds
 v_mfma_f32_16x16x32_bf16 v[168:171], v[88:91], a[160:163], v[168:171]
 s_mov_b32 s87, 151552
 ds_read_b64_tr_b16 v[72:73], v42 offset:32
 ds_read_b64_tr_b16 v[74:75], v42 offset:4640
 v_mfma_f32_16x16x32_bf16 v[168:171], v[92:95], a[164:167], v[168:171]
 s_add_u32 m0, s60, 4096
 v_mfma_f32_16x16x32_bf16 v[168:171], v[96:99], a[168:171], v[168:171]
 ds_read_b64_tr_b16 v[76:77], v42 offset:9248
 ds_read_b64_tr_b16 v[78:79], v42 offset:13856
 buffer_load_dwordx4 v2, s[12:15], s87 offen offset:0 sc1 lds
 v_mfma_f32_16x16x32_bf16 v[168:171], v[100:103], a[172:175], v[168:171]
 v_mfma_f32_16x16x32_bf16 v[172:175], v[88:91], a[176:179], v[172:175]
 ds_read_b64_tr_b16 v[80:81], v42 offset:18464
 ds_read_b64_tr_b16 v[82:83], v42 offset:23072
 v_mfma_f32_16x16x32_bf16 v[172:175], v[92:95], a[180:183], v[172:175]
 buffer_load_dwordx4 v2, s[12:15], s87 offen offset:1024 sc1 lds
 v_mfma_f32_16x16x32_bf16 v[172:175], v[96:99], a[184:187], v[172:175]
 ds_read_b64_tr_b16 v[84:85], v42 offset:27680
 ds_read_b64_tr_b16 v[86:87], v42 offset:32288
 v_mfma_f32_16x16x32_bf16 v[172:175], v[100:103], a[188:191], v[172:175]
 s_waitcnt vmcnt(45) lgkmcnt(8)
 v_mfma_f32_16x16x32_bf16 v[104:107], v[56:59], a[192:195], v[104:107]
 ds_read_b64_tr_b16 v[88:89], v42 offset:64
 ds_read_b64_tr_b16 v[90:91], v42 offset:4672
 buffer_load_dwordx4 v2, s[12:15], s87 offen offset:2048 sc1 lds
 v_mfma_f32_16x16x32_bf16 v[104:107], v[60:63], a[196:199], v[104:107]
 v_mfma_f32_16x16x32_bf16 v[104:107], v[64:67], a[200:203], v[104:107]
 ds_read_b64_tr_b16 v[92:93], v42 offset:9280
 ds_read_b64_tr_b16 v[94:95], v42 offset:13888
 v_mfma_f32_16x16x32_bf16 v[104:107], v[68:71], a[204:207], v[104:107]
 buffer_load_dwordx4 v2, s[12:15], s87 offen offset:3072 sc1 lds
 v_mfma_f32_16x16x32_bf16 v[108:111], v[56:59], a[208:211], v[108:111]
 s_mov_b32 s87, 155648
 ds_read_b64_tr_b16 v[96:97], v42 offset:18496
 ds_read_b64_tr_b16 v[98:99], v42 offset:23104
 v_mfma_f32_16x16x32_bf16 v[108:111], v[60:63], a[212:215], v[108:111]
 s_add_u32 m0, s60, 8192
 v_mfma_f32_16x16x32_bf16 v[108:111], v[64:67], a[216:219], v[108:111]
 ds_read_b64_tr_b16 v[100:101], v42 offset:27712
 ds_read_b64_tr_b16 v[102:103], v42 offset:32320
 buffer_load_dwordx4 v2, s[12:15], s87 offen offset:0 sc1 lds
 v_mfma_f32_16x16x32_bf16 v[108:111], v[68:71], a[220:223], v[108:111]
 s_waitcnt lgkmcnt(8)
 v_mfma_f32_16x16x32_bf16 v[112:115], v[72:75], a[192:195], v[112:115]
 s_mov_b32 s88, 20480
 ds_read_b64_tr_b16 v[56:57], v42 offset:96
 ds_read_b64_tr_b16 v[58:59], v42 offset:4704
 v_mfma_f32_16x16x32_bf16 v[112:115], v[76:79], a[196:199], v[112:115]
 buffer_load_dwordx4 a[160:163], v2, s[20:23], s88 offen offset:0 sc1
 v_mfma_f32_16x16x32_bf16 v[112:115], v[80:83], a[200:203], v[112:115]
 ds_read_b64_tr_b16 v[60:61], v42 offset:9312
 ds_read_b64_tr_b16 v[62:63], v42 offset:13920
 v_mfma_f32_16x16x32_bf16 v[112:115], v[84:87], a[204:207], v[112:115]
 v_mfma_f32_16x16x32_bf16 v[116:119], v[72:75], a[208:211], v[116:119]
 ds_read_b64_tr_b16 v[64:65], v42 offset:18528
 ds_read_b64_tr_b16 v[66:67], v42 offset:23136
 buffer_load_dwordx4 a[164:167], v2, s[20:23], s88 offen offset:1024 sc1
 v_mfma_f32_16x16x32_bf16 v[116:119], v[76:79], a[212:215], v[116:119]
 v_mfma_f32_16x16x32_bf16 v[116:119], v[80:83], a[216:219], v[116:119]
 ds_read_b64_tr_b16 v[68:69], v42 offset:27744
 ds_read_b64_tr_b16 v[70:71], v42 offset:32352
 v_mfma_f32_16x16x32_bf16 v[116:119], v[84:87], a[220:223], v[116:119]
 s_waitcnt lgkmcnt(8)
 buffer_load_dwordx4 a[168:171], v2, s[20:23], s88 offen offset:2048 sc1
 v_mfma_f32_16x16x32_bf16 v[120:123], v[88:91], a[192:195], v[120:123]
 ds_read_b64_tr_b16 v[72:73], v42 offset:128
 ds_read_b64_tr_b16 v[74:75], v42 offset:4736
 v_mfma_f32_16x16x32_bf16 v[120:123], v[92:95], a[196:199], v[120:123]
 v_mfma_f32_16x16x32_bf16 v[120:123], v[96:99], a[200:203], v[120:123]
 ds_read_b64_tr_b16 v[76:77], v42 offset:9344
 ds_read_b64_tr_b16 v[78:79], v42 offset:13952
 buffer_load_dwordx4 a[172:175], v2, s[20:23], s88 offen offset:3072 sc1
 v_mfma_f32_16x16x32_bf16 v[120:123], v[100:103], a[204:207], v[120:123]
 s_mov_b32 s89, 169216
 v_mfma_f32_16x16x32_bf16 v[124:127], v[88:91], a[208:211], v[124:127]
 ds_read_b64_tr_b16 v[80:81], v42 offset:18560
 ds_read_b64_tr_b16 v[82:83], v42 offset:23168
 v_mfma_f32_16x16x32_bf16 v[124:127], v[92:95], a[212:215], v[124:127]
 buffer_load_dwordx4 a[176:179], v2, s[20:23], s89 offen offset:0 sc1
 v_mfma_f32_16x16x32_bf16 v[124:127], v[96:99], a[216:219], v[124:127]
 ds_read_b64_tr_b16 v[84:85], v42 offset:27776
 ds_read_b64_tr_b16 v[86:87], v42 offset:32384
 v_mfma_f32_16x16x32_bf16 v[124:127], v[100:103], a[220:223], v[124:127]
 s_waitcnt lgkmcnt(8)
 v_mfma_f32_16x16x32_bf16 v[128:131], v[56:59], a[192:195], v[128:131]
 ds_read_b64_tr_b16 v[88:89], v42 offset:160
 ds_read_b64_tr_b16 v[90:91], v42 offset:4768
 buffer_load_dwordx4 a[180:183], v2, s[20:23], s89 offen offset:1024 sc1
 v_mfma_f32_16x16x32_bf16 v[128:131], v[60:63], a[196:199], v[128:131]
 v_mfma_f32_16x16x32_bf16 v[128:131], v[64:67], a[200:203], v[128:131]
 ds_read_b64_tr_b16 v[92:93], v42 offset:9376
 ds_read_b64_tr_b16 v[94:95], v42 offset:13984
 v_mfma_f32_16x16x32_bf16 v[128:131], v[68:71], a[204:207], v[128:131]
 buffer_load_dwordx4 a[184:187], v2, s[20:23], s89 offen offset:2048 sc1
 v_mfma_f32_16x16x32_bf16 v[132:135], v[56:59], a[208:211], v[132:135]
 ds_read_b64_tr_b16 v[96:97], v42 offset:18592
 ds_read_b64_tr_b16 v[98:99], v42 offset:23200
 v_mfma_f32_16x16x32_bf16 v[132:135], v[60:63], a[212:215], v[132:135]
 v_mfma_f32_16x16x32_bf16 v[132:135], v[64:67], a[216:219], v[132:135]
 ds_read_b64_tr_b16 v[100:101], v42 offset:27808
 ds_read_b64_tr_b16 v[102:103], v42 offset:32416
 buffer_load_dwordx4 a[188:191], v2, s[20:23], s89 offen offset:3072 sc1
 v_mfma_f32_16x16x32_bf16 v[132:135], v[68:71], a[220:223], v[132:135]
 s_waitcnt lgkmcnt(8)
 v_mfma_f32_16x16x32_bf16 v[136:139], v[72:75], a[192:195], v[136:139]
 s_mov_b32 s87, 184320
 ds_read_b64_tr_b16 v[56:57], v42 offset:192
 ds_read_b64_tr_b16 v[58:59], v42 offset:4800
 v_mfma_f32_16x16x32_bf16 v[136:139], v[76:79], a[196:199], v[136:139]
 s_add_u32 m0, s60, 126976
 v_mfma_f32_16x16x32_bf16 v[136:139], v[80:83], a[200:203], v[136:139]
 ds_read_b64_tr_b16 v[60:61], v42 offset:9408
 ds_read_b64_tr_b16 v[62:63], v42 offset:14016
 buffer_load_dwordx4 v2, s[12:15], s87 offen offset:0 sc1 lds
 v_mfma_f32_16x16x32_bf16 v[136:139], v[84:87], a[204:207], v[136:139]
 v_mfma_f32_16x16x32_bf16 v[140:143], v[72:75], a[208:211], v[140:143]
 ds_read_b64_tr_b16 v[64:65], v42 offset:18624
 ds_read_b64_tr_b16 v[66:67], v42 offset:23232
 v_mfma_f32_16x16x32_bf16 v[140:143], v[76:79], a[212:215], v[140:143]
 buffer_load_dwordx4 v2, s[12:15], s87 offen offset:1024 sc1 lds
 v_mfma_f32_16x16x32_bf16 v[140:143], v[80:83], a[216:219], v[140:143]
 ds_read_b64_tr_b16 v[68:69], v42 offset:27840
 ds_read_b64_tr_b16 v[70:71], v42 offset:32448
 v_mfma_f32_16x16x32_bf16 v[140:143], v[84:87], a[220:223], v[140:143]
 s_waitcnt lgkmcnt(8)
 v_mfma_f32_16x16x32_bf16 v[144:147], v[88:91], a[192:195], v[144:147]
 ds_read_b64_tr_b16 v[72:73], v42 offset:224
 ds_read_b64_tr_b16 v[74:75], v42 offset:4832
 buffer_load_dwordx4 v2, s[12:15], s87 offen offset:2048 sc1 lds
 v_mfma_f32_16x16x32_bf16 v[144:147], v[92:95], a[196:199], v[144:147]
 v_mfma_f32_16x16x32_bf16 v[144:147], v[96:99], a[200:203], v[144:147]
 ds_read_b64_tr_b16 v[76:77], v42 offset:9440
 ds_read_b64_tr_b16 v[78:79], v42 offset:14048
 v_mfma_f32_16x16x32_bf16 v[144:147], v[100:103], a[204:207], v[144:147]
 buffer_load_dwordx4 v2, s[12:15], s87 offen offset:3072 sc1 lds
 v_mfma_f32_16x16x32_bf16 v[148:151], v[88:91], a[208:211], v[148:151]
 s_mov_b32 s87, 188416
 ds_read_b64_tr_b16 v[80:81], v42 offset:18656
 ds_read_b64_tr_b16 v[82:83], v42 offset:23264
 v_mfma_f32_16x16x32_bf16 v[148:151], v[92:95], a[212:215], v[148:151]
 s_add_u32 m0, s60, 131072
 v_mfma_f32_16x16x32_bf16 v[148:151], v[96:99], a[216:219], v[148:151]
 ds_read_b64_tr_b16 v[84:85], v42 offset:27872
 ds_read_b64_tr_b16 v[86:87], v42 offset:32480
 buffer_load_dwordx4 v2, s[12:15], s87 offen offset:0 sc1 lds
 v_mfma_f32_16x16x32_bf16 v[148:151], v[100:103], a[220:223], v[148:151]
 s_waitcnt lgkmcnt(8)
 v_mfma_f32_16x16x32_bf16 v[152:155], v[56:59], a[192:195], v[152:155]
 ds_read_b64_tr_b16 v[88:89], v42 offset:256
 ds_read_b64_tr_b16 v[90:91], v42 offset:4864
 v_mfma_f32_16x16x32_bf16 v[152:155], v[60:63], a[196:199], v[152:155]
 buffer_load_dwordx4 v2, s[12:15], s87 offen offset:1024 sc1 lds
 v_mfma_f32_16x16x32_bf16 v[152:155], v[64:67], a[200:203], v[152:155]
 ds_read_b64_tr_b16 v[92:93], v42 offset:9472
 ds_read_b64_tr_b16 v[94:95], v42 offset:14080
 v_mfma_f32_16x16x32_bf16 v[152:155], v[68:71], a[204:207], v[152:155]
 v_mfma_f32_16x16x32_bf16 v[156:159], v[56:59], a[208:211], v[156:159]
 ds_read_b64_tr_b16 v[96:97], v42 offset:18688
 ds_read_b64_tr_b16 v[98:99], v42 offset:23296
 buffer_load_dwordx4 v2, s[12:15], s87 offen offset:2048 sc1 lds
 v_mfma_f32_16x16x32_bf16 v[156:159], v[60:63], a[212:215], v[156:159]
 v_mfma_f32_16x16x32_bf16 v[156:159], v[64:67], a[216:219], v[156:159]
 ds_read_b64_tr_b16 v[100:101], v42 offset:27904
 ds_read_b64_tr_b16 v[102:103], v42 offset:32512
 v_mfma_f32_16x16x32_bf16 v[156:159], v[68:71], a[220:223], v[156:159]
 s_waitcnt lgkmcnt(8)
 buffer_load_dwordx4 v2, s[12:15], s87 offen offset:3072 sc1 lds
 v_mfma_f32_16x16x32_bf16 v[160:163], v[72:75], a[192:195], v[160:163]
 s_mov_b32 s87, 192512
 v_mfma_f32_16x16x32_bf16 v[160:163], v[76:79], a[196:199], v[160:163]
 s_add_u32 m0, s60, 135168
 v_mfma_f32_16x16x32_bf16 v[160:163], v[80:83], a[200:203], v[160:163]
 s_waitcnt vmcnt(37) lgkmcnt(0)
 buffer_load_dwordx4 v2, s[12:15], s87 offen offset:0 sc1 lds
 v_mfma_f32_16x16x32_bf16 v[160:163], v[84:87], a[204:207], v[160:163]
 s_barrier
 v_mfma_f32_16x16x32_bf16 v[164:167], v[72:75], a[208:211], v[164:167]
 ds_read_b64_tr_b16 v[56:57], v43 offset:0
 ds_read_b64_tr_b16 v[58:59], v43 offset:4608
 v_mfma_f32_16x16x32_bf16 v[164:167], v[76:79], a[212:215], v[164:167]
 ds_read_b64_tr_b16 v[60:61], v43 offset:9216
 ds_read_b64_tr_b16 v[62:63], v43 offset:13824
 v_mfma_f32_16x16x32_bf16 v[164:167], v[80:83], a[216:219], v[164:167]
 ds_read_b64_tr_b16 v[64:65], v43 offset:18432
 ds_read_b64_tr_b16 v[66:67], v43 offset:23040
 v_mfma_f32_16x16x32_bf16 v[164:167], v[84:87], a[220:223], v[164:167]
 ds_read_b64_tr_b16 v[68:69], v43 offset:27648
 ds_read_b64_tr_b16 v[70:71], v43 offset:32256
 v_mfma_f32_16x16x32_bf16 v[168:171], v[88:91], a[192:195], v[168:171]
 ds_read_b64_tr_b16 v[72:73], v43 offset:32
 ds_read_b64_tr_b16 v[74:75], v43 offset:4640
 v_mfma_f32_16x16x32_bf16 v[168:171], v[92:95], a[196:199], v[168:171]
 v_mfma_f32_16x16x32_bf16 v[168:171], v[96:99], a[200:203], v[168:171]
 ds_read_b64_tr_b16 v[76:77], v43 offset:9248
 ds_read_b64_tr_b16 v[78:79], v43 offset:13856
 v_mfma_f32_16x16x32_bf16 v[168:171], v[100:103], a[204:207], v[168:171]
 v_mfma_f32_16x16x32_bf16 v[172:175], v[88:91], a[208:211], v[172:175]
 ds_read_b64_tr_b16 v[80:81], v43 offset:18464
 ds_read_b64_tr_b16 v[82:83], v43 offset:23072
 v_mfma_f32_16x16x32_bf16 v[172:175], v[92:95], a[212:215], v[172:175]
 v_mfma_f32_16x16x32_bf16 v[172:175], v[96:99], a[216:219], v[172:175]
 ds_read_b64_tr_b16 v[84:85], v43 offset:27680
 ds_read_b64_tr_b16 v[86:87], v43 offset:32288
 v_mfma_f32_16x16x32_bf16 v[172:175], v[100:103], a[220:223], v[172:175]
 s_waitcnt lgkmcnt(8)
 v_mfma_f32_16x16x32_bf16 v[104:107], v[56:59], a[224:227], v[104:107]
 s_mov_b32 s88, 24576
 ds_read_b64_tr_b16 v[88:89], v43 offset:64
 ds_read_b64_tr_b16 v[90:91], v43 offset:4672
 v_mfma_f32_16x16x32_bf16 v[104:107], v[60:63], a[228:231], v[104:107]
 buffer_load_dwordx4 a[192:195], v2, s[20:23], s88 offen offset:0 sc1
 v_mfma_f32_16x16x32_bf16 v[104:107], v[64:67], a[232:235], v[104:107]
 ds_read_b64_tr_b16 v[92:93], v43 offset:9280
 ds_read_b64_tr_b16 v[94:95], v43 offset:13888
 v_mfma_f32_16x16x32_bf16 v[104:107], v[68:71], a[236:239], v[104:107]
 v_and_b32 v34, 15, v3
 v_mul_u32_u24 v34, 1152, v34
 v_mfma_f32_16x16x32_bf16 v[108:111], v[56:59], a[240:243], v[108:111]
 ds_read_b64_tr_b16 v[96:97], v43 offset:18496
 ds_read_b64_tr_b16 v[98:99], v43 offset:23104
 v_mfma_f32_16x16x32_bf16 v[108:111], v[60:63], a[244:247], v[108:111]
 buffer_load_dwordx4 a[196:199], v2, s[20:23], s88 offen offset:1024 sc1
 v_mfma_f32_16x16x32_bf16 v[108:111], v[64:67], a[248:251], v[108:111]
 ds_read_b64_tr_b16 v[100:101], v43 offset:27712
 ds_read_b64_tr_b16 v[102:103], v43 offset:32320
 v_mfma_f32_16x16x32_bf16 v[108:111], v[68:71], a[252:255], v[108:111]
 s_waitcnt lgkmcnt(8)
 v_lshrrev_b32 v35, 4, v3
 v_lshl_add_u32 v39, v35, 3, v34
 v_mfma_f32_16x16x32_bf16 v[112:115], v[72:75], a[224:227], v[112:115]
 ds_read_b64_tr_b16 v[56:57], v43 offset:96
 ds_read_b64_tr_b16 v[58:59], v43 offset:4704
 v_mfma_f32_16x16x32_bf16 v[112:115], v[76:79], a[228:231], v[112:115]
 buffer_load_dwordx4 a[200:203], v2, s[20:23], s88 offen offset:2048 sc1
 v_mfma_f32_16x16x32_bf16 v[112:115], v[80:83], a[232:235], v[112:115]
 ds_read_b64_tr_b16 v[60:61], v43 offset:9312
 ds_read_b64_tr_b16 v[62:63], v43 offset:13920
 v_mfma_f32_16x16x32_bf16 v[112:115], v[84:87], a[236:239], v[112:115]
 v_mfma_f32_16x16x32_bf16 v[116:119], v[72:75], a[240:243], v[116:119]
 ds_read_b64_tr_b16 v[64:65], v43 offset:18528
 ds_read_b64_tr_b16 v[66:67], v43 offset:23136
 v_mfma_f32_16x16x32_bf16 v[116:119], v[76:79], a[244:247], v[116:119]
 buffer_load_dwordx4 a[204:207], v2, s[20:23], s88 offen offset:3072 sc1
 v_mfma_f32_16x16x32_bf16 v[116:119], v[80:83], a[248:251], v[116:119]
 s_mov_b32 s89, 173312
 ds_read_b64_tr_b16 v[68:69], v43 offset:27744
 ds_read_b64_tr_b16 v[70:71], v43 offset:32352
 v_mfma_f32_16x16x32_bf16 v[116:119], v[84:87], a[252:255], v[116:119]
 s_waitcnt lgkmcnt(8)
 v_mfma_f32_16x16x32_bf16 v[120:123], v[88:91], a[224:227], v[120:123]
 ds_read_b64_tr_b16 v[72:73], v43 offset:128
 ds_read_b64_tr_b16 v[74:75], v43 offset:4736
 v_mfma_f32_16x16x32_bf16 v[120:123], v[92:95], a[228:231], v[120:123]
 buffer_load_dwordx4 a[208:211], v2, s[20:23], s89 offen offset:0 sc1
 v_mfma_f32_16x16x32_bf16 v[120:123], v[96:99], a[232:235], v[120:123]
 ds_read_b64_tr_b16 v[76:77], v43 offset:9344
 ds_read_b64_tr_b16 v[78:79], v43 offset:13952
 v_mfma_f32_16x16x32_bf16 v[120:123], v[100:103], a[236:239], v[120:123]
 v_mfma_f32_16x16x32_bf16 v[124:127], v[88:91], a[240:243], v[124:127]
 ds_read_b64_tr_b16 v[80:81], v43 offset:18560
 ds_read_b64_tr_b16 v[82:83], v43 offset:23168
 v_mfma_f32_16x16x32_bf16 v[124:127], v[92:95], a[244:247], v[124:127]
 buffer_load_dwordx4 a[212:215], v2, s[20:23], s89 offen offset:1024 sc1
 v_mfma_f32_16x16x32_bf16 v[124:127], v[96:99], a[248:251], v[124:127]
 ds_read_b64_tr_b16 v[84:85], v43 offset:27776
 ds_read_b64_tr_b16 v[86:87], v43 offset:32384
 v_mfma_f32_16x16x32_bf16 v[124:127], v[100:103], a[252:255], v[124:127]
 s_waitcnt lgkmcnt(8)
 v_mfma_f32_16x16x32_bf16 v[128:131], v[56:59], a[224:227], v[128:131]
 ds_read_b64_tr_b16 v[88:89], v43 offset:160
 ds_read_b64_tr_b16 v[90:91], v43 offset:4768
 v_mfma_f32_16x16x32_bf16 v[128:131], v[60:63], a[228:231], v[128:131]
 buffer_load_dwordx4 a[216:219], v2, s[20:23], s89 offen offset:2048 sc1
 v_mfma_f32_16x16x32_bf16 v[128:131], v[64:67], a[232:235], v[128:131]
 ds_read_b64_tr_b16 v[92:93], v43 offset:9376
 ds_read_b64_tr_b16 v[94:95], v43 offset:13984
 v_mfma_f32_16x16x32_bf16 v[128:131], v[68:71], a[236:239], v[128:131]
 v_mfma_f32_16x16x32_bf16 v[132:135], v[56:59], a[240:243], v[132:135]
 ds_read_b64_tr_b16 v[96:97], v43 offset:18592
 ds_read_b64_tr_b16 v[98:99], v43 offset:23200
 v_mfma_f32_16x16x32_bf16 v[132:135], v[60:63], a[244:247], v[132:135]
 buffer_load_dwordx4 a[220:223], v2, s[20:23], s89 offen offset:3072 sc1
 v_mfma_f32_16x16x32_bf16 v[132:135], v[64:67], a[248:251], v[132:135]
 s_mov_b32 s87, 221184
 ds_read_b64_tr_b16 v[100:101], v43 offset:27808
 ds_read_b64_tr_b16 v[102:103], v43 offset:32416
 v_mfma_f32_16x16x32_bf16 v[132:135], v[68:71], a[252:255], v[132:135]
 s_waitcnt lgkmcnt(8)
 v_mfma_f32_16x16x32_bf16 v[136:139], v[72:75], a[224:227], v[136:139]
 s_add_u32 m0, s60, 36864
 ds_read_b64_tr_b16 v[56:57], v43 offset:192
 ds_read_b64_tr_b16 v[58:59], v43 offset:4800
 v_mfma_f32_16x16x32_bf16 v[136:139], v[76:79], a[228:231], v[136:139]
 buffer_load_dwordx4 v2, s[12:15], s87 offen offset:0 sc1 lds
 v_mfma_f32_16x16x32_bf16 v[136:139], v[80:83], a[232:235], v[136:139]
 ds_read_b64_tr_b16 v[60:61], v43 offset:9408
 ds_read_b64_tr_b16 v[62:63], v43 offset:14016
 v_mfma_f32_16x16x32_bf16 v[136:139], v[84:87], a[236:239], v[136:139]
 v_mfma_f32_16x16x32_bf16 v[140:143], v[72:75], a[240:243], v[140:143]
 ds_read_b64_tr_b16 v[64:65], v43 offset:18624
 ds_read_b64_tr_b16 v[66:67], v43 offset:23232
 v_mfma_f32_16x16x32_bf16 v[140:143], v[76:79], a[244:247], v[140:143]
 buffer_load_dwordx4 v2, s[12:15], s87 offen offset:1024 sc1 lds
 v_mfma_f32_16x16x32_bf16 v[140:143], v[80:83], a[248:251], v[140:143]
 ds_read_b64_tr_b16 v[68:69], v43 offset:27840
 ds_read_b64_tr_b16 v[70:71], v43 offset:32448
 v_mfma_f32_16x16x32_bf16 v[140:143], v[84:87], a[252:255], v[140:143]
 s_waitcnt lgkmcnt(8)
 v_mfma_f32_16x16x32_bf16 v[144:147], v[88:91], a[224:227], v[144:147]
 ds_read_b64_tr_b16 v[72:73], v43 offset:224
 ds_read_b64_tr_b16 v[74:75], v43 offset:4832
 v_mfma_f32_16x16x32_bf16 v[144:147], v[92:95], a[228:231], v[144:147]
 buffer_load_dwordx4 v2, s[12:15], s87 offen offset:2048 sc1 lds
 v_mfma_f32_16x16x32_bf16 v[144:147], v[96:99], a[232:235], v[144:147]
 ds_read_b64_tr_b16 v[76:77], v43 offset:9440
 ds_read_b64_tr_b16 v[78:79], v43 offset:14048
 v_mfma_f32_16x16x32_bf16 v[144:147], v[100:103], a[236:239], v[144:147]
 v_mfma_f32_16x16x32_bf16 v[148:151], v[88:91], a[240:243], v[148:151]
 ds_read_b64_tr_b16 v[80:81], v43 offset:18656
 ds_read_b64_tr_b16 v[82:83], v43 offset:23264
 v_mfma_f32_16x16x32_bf16 v[148:151], v[92:95], a[244:247], v[148:151]
 buffer_load_dwordx4 v2, s[12:15], s87 offen offset:3072 sc1 lds
 v_mfma_f32_16x16x32_bf16 v[148:151], v[96:99], a[248:251], v[148:151]
 s_mov_b32 s87, 225280
 ds_read_b64_tr_b16 v[84:85], v43 offset:27872
 ds_read_b64_tr_b16 v[86:87], v43 offset:32480
 v_mfma_f32_16x16x32_bf16 v[148:151], v[100:103], a[252:255], v[148:151]
 s_waitcnt lgkmcnt(8)
 v_mfma_f32_16x16x32_bf16 v[152:155], v[56:59], a[224:227], v[152:155]
 s_add_u32 m0, s60, 40960
 ds_read_b64_tr_b16 v[88:89], v43 offset:256
 ds_read_b64_tr_b16 v[90:91], v43 offset:4864
 v_mfma_f32_16x16x32_bf16 v[152:155], v[60:63], a[228:231], v[152:155]
 buffer_load_dwordx4 v2, s[12:15], s87 offen offset:0 sc1 lds
 v_mfma_f32_16x16x32_bf16 v[152:155], v[64:67], a[232:235], v[152:155]
 ds_read_b64_tr_b16 v[92:93], v43 offset:9472
 ds_read_b64_tr_b16 v[94:95], v43 offset:14080
 v_mfma_f32_16x16x32_bf16 v[152:155], v[68:71], a[236:239], v[152:155]
 v_mfma_f32_16x16x32_bf16 v[156:159], v[56:59], a[240:243], v[156:159]
 ds_read_b64_tr_b16 v[96:97], v43 offset:18688
 ds_read_b64_tr_b16 v[98:99], v43 offset:23296
 v_mfma_f32_16x16x32_bf16 v[156:159], v[60:63], a[244:247], v[156:159]
 buffer_load_dwordx4 v2, s[12:15], s87 offen offset:1024 sc1 lds
 v_mfma_f32_16x16x32_bf16 v[156:159], v[64:67], a[248:251], v[156:159]
 ds_read_b64_tr_b16 v[100:101], v43 offset:27904
 ds_read_b64_tr_b16 v[102:103], v43 offset:32512
 v_mfma_f32_16x16x32_bf16 v[156:159], v[68:71], a[252:255], v[156:159]
 s_waitcnt lgkmcnt(8)
 v_mfma_f32_16x16x32_bf16 v[160:163], v[72:75], a[224:227], v[160:163]
 v_mfma_f32_16x16x32_bf16 v[160:163], v[76:79], a[228:231], v[160:163]
 buffer_load_dwordx4 v2, s[12:15], s87 offen offset:2048 sc1 lds
 v_mfma_f32_16x16x32_bf16 v[160:163], v[80:83], a[232:235], v[160:163]
 s_waitcnt vmcnt(32) lgkmcnt(0)
 v_mfma_f32_16x16x32_bf16 v[160:163], v[84:87], a[236:239], v[160:163]
 s_barrier
 v_mfma_f32_16x16x32_bf16 v[164:167], v[72:75], a[240:243], v[164:167]
 ds_read_b64_tr_b16 v[56:57], v40 offset:0
 ds_read_b64_tr_b16 v[58:59], v40 offset:4608
 v_mfma_f32_16x16x32_bf16 v[164:167], v[76:79], a[244:247], v[164:167]
 ds_read_b64_tr_b16 v[60:61], v40 offset:9216
 ds_read_b64_tr_b16 v[62:63], v40 offset:13824
 v_mfma_f32_16x16x32_bf16 v[164:167], v[80:83], a[248:251], v[164:167]
 ds_read_b64_tr_b16 v[64:65], v40 offset:18432
 ds_read_b64_tr_b16 v[66:67], v40 offset:23040
 v_mfma_f32_16x16x32_bf16 v[164:167], v[84:87], a[252:255], v[164:167]
 ds_read_b64_tr_b16 v[68:69], v40 offset:27648
 ds_read_b64_tr_b16 v[70:71], v40 offset:32256
 v_mfma_f32_16x16x32_bf16 v[168:171], v[88:91], a[224:227], v[168:171]
 ds_read_b64_tr_b16 v[72:73], v40 offset:32
 ds_read_b64_tr_b16 v[74:75], v40 offset:4640
 v_mfma_f32_16x16x32_bf16 v[168:171], v[92:95], a[228:231], v[168:171]
 buffer_store_dword v253, v252, s[32:35], s65 offen sc1
 v_mfma_f32_16x16x32_bf16 v[168:171], v[96:99], a[232:235], v[168:171]
 ds_read_b64_tr_b16 v[76:77], v40 offset:9248
 ds_read_b64_tr_b16 v[78:79], v40 offset:13856
 v_mfma_f32_16x16x32_bf16 v[168:171], v[100:103], a[236:239], v[168:171]
 v_mfma_f32_16x16x32_bf16 v[172:175], v[88:91], a[240:243], v[172:175]
 ds_read_b64_tr_b16 v[80:81], v40 offset:18464
 ds_read_b64_tr_b16 v[82:83], v40 offset:23072
 v_mfma_f32_16x16x32_bf16 v[172:175], v[92:95], a[244:247], v[172:175]
 buffer_load_dwordx4 v2, s[12:15], s87 offen offset:3072 sc1 lds
 v_mfma_f32_16x16x32_bf16 v[172:175], v[96:99], a[248:251], v[172:175]
 s_mov_b32 s87, 229376
 ds_read_b64_tr_b16 v[84:85], v40 offset:27680
 ds_read_b64_tr_b16 v[86:87], v40 offset:32288
 v_mfma_f32_16x16x32_bf16 v[172:175], v[100:103], a[252:255], v[172:175]
 s_waitcnt lgkmcnt(8)
 v_mfma_f32_16x16x32_bf16 v[104:107], v[56:59], a[128:131], v[104:107]
 s_add_u32 m0, s60, 45056
 ds_read_b64_tr_b16 v[88:89], v40 offset:64
 ds_read_b64_tr_b16 v[90:91], v40 offset:4672
 v_mfma_f32_16x16x32_bf16 v[104:107], v[60:63], a[132:135], v[104:107]
 buffer_load_dwordx4 v2, s[12:15], s87 offen offset:0 sc1 lds
 v_mfma_f32_16x16x32_bf16 v[104:107], v[64:67], a[136:139], v[104:107]
 s_mov_b32 s88, 28672
 ds_read_b64_tr_b16 v[92:93], v40 offset:9280
 ds_read_b64_tr_b16 v[94:95], v40 offset:13888
 v_mfma_f32_16x16x32_bf16 v[104:107], v[68:71], a[140:143], v[104:107]
 v_mfma_f32_16x16x32_bf16 v[108:111], v[56:59], a[144:147], v[108:111]
 ds_read_b64_tr_b16 v[96:97], v40 offset:18496
 ds_read_b64_tr_b16 v[98:99], v40 offset:23104
 v_mfma_f32_16x16x32_bf16 v[108:111], v[60:63], a[148:151], v[108:111]
 buffer_load_dwordx4 a[224:227], v2, s[20:23], s88 offen offset:0 sc1
 v_mfma_f32_16x16x32_bf16 v[108:111], v[64:67], a[152:155], v[108:111]
 ds_read_b64_tr_b16 v[100:101], v40 offset:27712
 ds_read_b64_tr_b16 v[102:103], v40 offset:32320
 v_mfma_f32_16x16x32_bf16 v[108:111], v[68:71], a[156:159], v[108:111]
 s_waitcnt lgkmcnt(8)
 v_mfma_f32_16x16x32_bf16 v[112:115], v[72:75], a[128:131], v[112:115]
 ds_read_b64_tr_b16 v[56:57], v40 offset:96
 ds_read_b64_tr_b16 v[58:59], v40 offset:4704
 v_mfma_f32_16x16x32_bf16 v[112:115], v[76:79], a[132:135], v[112:115]
 buffer_load_dwordx4 a[228:231], v2, s[20:23], s88 offen offset:1024 sc1
 v_mfma_f32_16x16x32_bf16 v[112:115], v[80:83], a[136:139], v[112:115]
 ds_read_b64_tr_b16 v[60:61], v40 offset:9312
 ds_read_b64_tr_b16 v[62:63], v40 offset:13920
 v_mfma_f32_16x16x32_bf16 v[112:115], v[84:87], a[140:143], v[112:115]
 v_mfma_f32_16x16x32_bf16 v[116:119], v[72:75], a[144:147], v[116:119]
 ds_read_b64_tr_b16 v[64:65], v40 offset:18528
 ds_read_b64_tr_b16 v[66:67], v40 offset:23136
 v_mfma_f32_16x16x32_bf16 v[116:119], v[76:79], a[148:151], v[116:119]
 buffer_load_dwordx4 a[232:235], v2, s[20:23], s88 offen offset:2048 sc1
 v_mfma_f32_16x16x32_bf16 v[116:119], v[80:83], a[152:155], v[116:119]
 ds_read_b64_tr_b16 v[68:69], v40 offset:27744
 ds_read_b64_tr_b16 v[70:71], v40 offset:32352
 v_mfma_f32_16x16x32_bf16 v[116:119], v[84:87], a[156:159], v[116:119]
 s_waitcnt lgkmcnt(8)
 v_mfma_f32_16x16x32_bf16 v[120:123], v[88:91], a[128:131], v[120:123]
 ds_read_b64_tr_b16 v[72:73], v40 offset:128
 ds_read_b64_tr_b16 v[74:75], v40 offset:4736
 v_mfma_f32_16x16x32_bf16 v[120:123], v[92:95], a[132:135], v[120:123]
 buffer_load_dwordx4 a[236:239], v2, s[20:23], s88 offen offset:3072 sc1
 v_mfma_f32_16x16x32_bf16 v[120:123], v[96:99], a[136:139], v[120:123]
 s_mov_b32 s89, 177408
 ds_read_b64_tr_b16 v[76:77], v40 offset:9344
 ds_read_b64_tr_b16 v[78:79], v40 offset:13952
 v_mfma_f32_16x16x32_bf16 v[120:123], v[100:103], a[140:143], v[120:123]
 v_mfma_f32_16x16x32_bf16 v[124:127], v[88:91], a[144:147], v[124:127]
 ds_read_b64_tr_b16 v[80:81], v40 offset:18560
 ds_read_b64_tr_b16 v[82:83], v40 offset:23168
 v_mfma_f32_16x16x32_bf16 v[124:127], v[92:95], a[148:151], v[124:127]
 buffer_load_dwordx4 a[240:243], v2, s[20:23], s89 offen offset:0 sc1
 v_mfma_f32_16x16x32_bf16 v[124:127], v[96:99], a[152:155], v[124:127]
 ds_read_b64_tr_b16 v[84:85], v40 offset:27776
 ds_read_b64_tr_b16 v[86:87], v40 offset:32384
 v_mfma_f32_16x16x32_bf16 v[124:127], v[100:103], a[156:159], v[124:127]
 s_waitcnt lgkmcnt(8)
 v_mfma_f32_16x16x32_bf16 v[128:131], v[56:59], a[128:131], v[128:131]
 ds_read_b64_tr_b16 v[88:89], v40 offset:160
 ds_read_b64_tr_b16 v[90:91], v40 offset:4768
 v_mfma_f32_16x16x32_bf16 v[128:131], v[60:63], a[132:135], v[128:131]
 buffer_load_dwordx4 a[244:247], v2, s[20:23], s89 offen offset:1024 sc1
 v_mfma_f32_16x16x32_bf16 v[128:131], v[64:67], a[136:139], v[128:131]
 ds_read_b64_tr_b16 v[92:93], v40 offset:9376
 ds_read_b64_tr_b16 v[94:95], v40 offset:13984
 v_mfma_f32_16x16x32_bf16 v[128:131], v[68:71], a[140:143], v[128:131]
 v_mfma_f32_16x16x32_bf16 v[132:135], v[56:59], a[144:147], v[132:135]
 ds_read_b64_tr_b16 v[96:97], v40 offset:18592
 ds_read_b64_tr_b16 v[98:99], v40 offset:23200
 v_mfma_f32_16x16x32_bf16 v[132:135], v[60:63], a[148:151], v[132:135]
 buffer_load_dwordx4 a[248:251], v2, s[20:23], s89 offen offset:2048 sc1
 v_mfma_f32_16x16x32_bf16 v[132:135], v[64:67], a[152:155], v[132:135]
 ds_read_b64_tr_b16 v[100:101], v40 offset:27808
 ds_read_b64_tr_b16 v[102:103], v40 offset:32416
 v_mfma_f32_16x16x32_bf16 v[132:135], v[68:71], a[156:159], v[132:135]
 s_waitcnt lgkmcnt(8)
 v_mfma_f32_16x16x32_bf16 v[136:139], v[72:75], a[128:131], v[136:139]
 ds_read_b64_tr_b16 v[56:57], v40 offset:192
 ds_read_b64_tr_b16 v[58:59], v40 offset:4800
 v_mfma_f32_16x16x32_bf16 v[136:139], v[76:79], a[132:135], v[136:139]
 buffer_load_dwordx4 a[252:255], v2, s[20:23], s89 offen offset:3072 sc1
 v_mfma_f32_16x16x32_bf16 v[136:139], v[80:83], a[136:139], v[136:139]
 s_mov_b32 s87, 258048
 ds_read_b64_tr_b16 v[60:61], v40 offset:9408
 ds_read_b64_tr_b16 v[62:63], v40 offset:14016
 v_mfma_f32_16x16x32_bf16 v[136:139], v[84:87], a[140:143], v[136:139]
 s_add_u32 m0, s60, 73728
 v_mfma_f32_16x16x32_bf16 v[140:143], v[72:75], a[144:147], v[140:143]
 ds_read_b64_tr_b16 v[64:65], v40 offset:18624
 ds_read_b64_tr_b16 v[66:67], v40 offset:23232
 v_mfma_f32_16x16x32_bf16 v[140:143], v[76:79], a[148:151], v[140:143]
 buffer_load_dwordx4 v2, s[12:15], s87 offen offset:0 sc1 lds
 v_mfma_f32_16x16x32_bf16 v[140:143], v[80:83], a[152:155], v[140:143]
 ds_read_b64_tr_b16 v[68:69], v40 offset:27840
 ds_read_b64_tr_b16 v[70:71], v40 offset:32448
 v_mfma_f32_16x16x32_bf16 v[140:143], v[84:87], a[156:159], v[140:143]
 s_waitcnt lgkmcnt(8)
 v_mfma_f32_16x16x32_bf16 v[144:147], v[88:91], a[128:131], v[144:147]
 ds_read_b64_tr_b16 v[72:73], v40 offset:224
 ds_read_b64_tr_b16 v[74:75], v40 offset:4832
 v_mfma_f32_16x16x32_bf16 v[144:147], v[92:95], a[132:135], v[144:147]
 buffer_load_dwordx4 v2, s[12:15], s87 offen offset:1024 sc1 lds
 v_mfma_f32_16x16x32_bf16 v[144:147], v[96:99], a[136:139], v[144:147]
 ds_read_b64_tr_b16 v[76:77], v40 offset:9440
 ds_read_b64_tr_b16 v[78:79], v40 offset:14048
 v_mfma_f32_16x16x32_bf16 v[144:147], v[100:103], a[140:143], v[144:147]
 v_mfma_f32_16x16x32_bf16 v[148:151], v[88:91], a[144:147], v[148:151]
 ds_read_b64_tr_b16 v[80:81], v40 offset:18656
 ds_read_b64_tr_b16 v[82:83], v40 offset:23264
 v_mfma_f32_16x16x32_bf16 v[148:151], v[92:95], a[148:151], v[148:151]
 buffer_load_dwordx4 v2, s[12:15], s87 offen offset:2048 sc1 lds
 v_mfma_f32_16x16x32_bf16 v[148:151], v[96:99], a[152:155], v[148:151]
 ds_read_b64_tr_b16 v[84:85], v40 offset:27872
 ds_read_b64_tr_b16 v[86:87], v40 offset:32480
 v_mfma_f32_16x16x32_bf16 v[148:151], v[100:103], a[156:159], v[148:151]
 s_waitcnt lgkmcnt(8)
 v_mfma_f32_16x16x32_bf16 v[152:155], v[56:59], a[128:131], v[152:155]
 ds_read_b64_tr_b16 v[88:89], v40 offset:256
 ds_read_b64_tr_b16 v[90:91], v40 offset:4864
 v_mfma_f32_16x16x32_bf16 v[152:155], v[60:63], a[132:135], v[152:155]
 buffer_load_dwordx4 v2, s[12:15], s87 offen offset:3072 sc1 lds
 v_mfma_f32_16x16x32_bf16 v[152:155], v[64:67], a[136:139], v[152:155]
 s_mov_b32 s87, 262144
 ds_read_b64_tr_b16 v[92:93], v40 offset:9472
 ds_read_b64_tr_b16 v[94:95], v40 offset:14080
 v_mfma_f32_16x16x32_bf16 v[152:155], v[68:71], a[140:143], v[152:155]
 s_add_u32 m0, s60, 77824
 v_mfma_f32_16x16x32_bf16 v[156:159], v[56:59], a[144:147], v[156:159]
 ds_read_b64_tr_b16 v[96:97], v40 offset:18688
 ds_read_b64_tr_b16 v[98:99], v40 offset:23296
 v_mfma_f32_16x16x32_bf16 v[156:159], v[60:63], a[148:151], v[156:159]
 buffer_load_dwordx4 v2, s[12:15], s87 offen offset:0 sc1 lds
 v_mfma_f32_16x16x32_bf16 v[156:159], v[64:67], a[152:155], v[156:159]
 ds_read_b64_tr_b16 v[100:101], v40 offset:27904
 ds_read_b64_tr_b16 v[102:103], v40 offset:32512
 v_mfma_f32_16x16x32_bf16 v[156:159], v[68:71], a[156:159], v[156:159]
 s_waitcnt lgkmcnt(8)
 v_mfma_f32_16x16x32_bf16 v[160:163], v[72:75], a[128:131], v[160:163]
 v_mfma_f32_16x16x32_bf16 v[160:163], v[76:79], a[132:135], v[160:163]
 buffer_load_dwordx4 v2, s[12:15], s87 offen offset:1024 sc1 lds
 v_mfma_f32_16x16x32_bf16 v[160:163], v[80:83], a[136:139], v[160:163]
 s_waitcnt vmcnt(32) lgkmcnt(0)
 v_mfma_f32_16x16x32_bf16 v[160:163], v[84:87], a[140:143], v[160:163]
 s_barrier
 v_mfma_f32_16x16x32_bf16 v[164:167], v[72:75], a[144:147], v[164:167]
 ds_read_b64_tr_b16 v[56:57], v41 offset:0
 ds_read_b64_tr_b16 v[58:59], v41 offset:4608
 v_mfma_f32_16x16x32_bf16 v[164:167], v[76:79], a[148:151], v[164:167]
 ds_read_b64_tr_b16 v[60:61], v41 offset:9216
 ds_read_b64_tr_b16 v[62:63], v41 offset:13824
 v_mfma_f32_16x16x32_bf16 v[164:167], v[80:83], a[152:155], v[164:167]
 ds_read_b64_tr_b16 v[64:65], v41 offset:18432
 ds_read_b64_tr_b16 v[66:67], v41 offset:23040
 v_mfma_f32_16x16x32_bf16 v[164:167], v[84:87], a[156:159], v[164:167]
 ds_read_b64_tr_b16 v[68:69], v41 offset:27648
 ds_read_b64_tr_b16 v[70:71], v41 offset:32256
 v_mfma_f32_16x16x32_bf16 v[168:171], v[88:91], a[128:131], v[168:171]
 ds_read_b64_tr_b16 v[72:73], v41 offset:32
 ds_read_b64_tr_b16 v[74:75], v41 offset:4640
 v_mfma_f32_16x16x32_bf16 v[168:171], v[92:95], a[132:135], v[168:171]
 buffer_load_dwordx4 v2, s[12:15], s87 offen offset:2048 sc1 lds
 v_mfma_f32_16x16x32_bf16 v[168:171], v[96:99], a[136:139], v[168:171]
 ds_read_b64_tr_b16 v[76:77], v41 offset:9248
 ds_read_b64_tr_b16 v[78:79], v41 offset:13856
 v_mfma_f32_16x16x32_bf16 v[168:171], v[100:103], a[140:143], v[168:171]
 v_mfma_f32_16x16x32_bf16 v[172:175], v[88:91], a[144:147], v[172:175]
 ds_read_b64_tr_b16 v[80:81], v41 offset:18464
 ds_read_b64_tr_b16 v[82:83], v41 offset:23072
 v_mfma_f32_16x16x32_bf16 v[172:175], v[92:95], a[148:151], v[172:175]
 buffer_load_dwordx4 v2, s[12:15], s87 offen offset:3072 sc1 lds
 v_mfma_f32_16x16x32_bf16 v[172:175], v[96:99], a[152:155], v[172:175]
 s_mov_b32 s87, 266240
 ds_read_b64_tr_b16 v[84:85], v41 offset:27680
 ds_read_b64_tr_b16 v[86:87], v41 offset:32288
 v_mfma_f32_16x16x32_bf16 v[172:175], v[100:103], a[156:159], v[172:175]
 s_waitcnt lgkmcnt(8)
 v_mfma_f32_16x16x32_bf16 v[104:107], v[56:59], a[160:163], v[104:107]
 s_add_u32 m0, s60, 81920
 ds_read_b64_tr_b16 v[88:89], v41 offset:64
 ds_read_b64_tr_b16 v[90:91], v41 offset:4672
 v_mfma_f32_16x16x32_bf16 v[104:107], v[60:63], a[164:167], v[104:107]
 buffer_load_dwordx4 v2, s[12:15], s87 offen offset:0 sc1 lds
 v_mfma_f32_16x16x32_bf16 v[104:107], v[64:67], a[168:171], v[104:107]
 s_mov_b32 s88, 32768
 ds_read_b64_tr_b16 v[92:93], v41 offset:9280
 ds_read_b64_tr_b16 v[94:95], v41 offset:13888
 v_mfma_f32_16x16x32_bf16 v[104:107], v[68:71], a[172:175], v[104:107]
 v_mfma_f32_16x16x32_bf16 v[108:111], v[56:59], a[176:179], v[108:111]
 ds_read_b64_tr_b16 v[96:97], v41 offset:18496
 ds_read_b64_tr_b16 v[98:99], v41 offset:23104
 v_mfma_f32_16x16x32_bf16 v[108:111], v[60:63], a[180:183], v[108:111]
 buffer_load_dwordx4 a[128:131], v2, s[20:23], s88 offen offset:0 sc1
 v_mfma_f32_16x16x32_bf16 v[108:111], v[64:67], a[184:187], v[108:111]
 ds_read_b64_tr_b16 v[100:101], v41 offset:27712
 ds_read_b64_tr_b16 v[102:103], v41 offset:32320
 v_mfma_f32_16x16x32_bf16 v[108:111], v[68:71], a[188:191], v[108:111]
 s_waitcnt lgkmcnt(8)
 v_mfma_f32_16x16x32_bf16 v[112:115], v[72:75], a[160:163], v[112:115]
 ds_read_b64_tr_b16 v[56:57], v41 offset:96
 ds_read_b64_tr_b16 v[58:59], v41 offset:4704
 v_mfma_f32_16x16x32_bf16 v[112:115], v[76:79], a[164:167], v[112:115]
 buffer_load_dwordx4 a[132:135], v2, s[20:23], s88 offen offset:1024 sc1
 v_mfma_f32_16x16x32_bf16 v[112:115], v[80:83], a[168:171], v[112:115]
 ds_read_b64_tr_b16 v[60:61], v41 offset:9312
 ds_read_b64_tr_b16 v[62:63], v41 offset:13920
 v_mfma_f32_16x16x32_bf16 v[112:115], v[84:87], a[172:175], v[112:115]
 v_mfma_f32_16x16x32_bf16 v[116:119], v[72:75], a[176:179], v[116:119]
 ds_read_b64_tr_b16 v[64:65], v41 offset:18528
 ds_read_b64_tr_b16 v[66:67], v41 offset:23136
 v_mfma_f32_16x16x32_bf16 v[116:119], v[76:79], a[180:183], v[116:119]
 buffer_load_dwordx4 a[136:139], v2, s[20:23], s88 offen offset:2048 sc1
 v_mfma_f32_16x16x32_bf16 v[116:119], v[80:83], a[184:187], v[116:119]
 ds_read_b64_tr_b16 v[68:69], v41 offset:27744
 ds_read_b64_tr_b16 v[70:71], v41 offset:32352
 v_mfma_f32_16x16x32_bf16 v[116:119], v[84:87], a[188:191], v[116:119]
 s_waitcnt lgkmcnt(8)
 v_mfma_f32_16x16x32_bf16 v[120:123], v[88:91], a[160:163], v[120:123]
 ds_read_b64_tr_b16 v[72:73], v41 offset:128
 ds_read_b64_tr_b16 v[74:75], v41 offset:4736
 v_mfma_f32_16x16x32_bf16 v[120:123], v[92:95], a[164:167], v[120:123]
 buffer_load_dwordx4 a[140:143], v2, s[20:23], s88 offen offset:3072 sc1
 v_mfma_f32_16x16x32_bf16 v[120:123], v[96:99], a[168:171], v[120:123]
 s_mov_b32 s89, 181504
 ds_read_b64_tr_b16 v[76:77], v41 offset:9344
 ds_read_b64_tr_b16 v[78:79], v41 offset:13952
 v_mfma_f32_16x16x32_bf16 v[120:123], v[100:103], a[172:175], v[120:123]
 v_mfma_f32_16x16x32_bf16 v[124:127], v[88:91], a[176:179], v[124:127]
 ds_read_b64_tr_b16 v[80:81], v41 offset:18560
 ds_read_b64_tr_b16 v[82:83], v41 offset:23168
 v_mfma_f32_16x16x32_bf16 v[124:127], v[92:95], a[180:183], v[124:127]
 buffer_load_dwordx4 a[144:147], v2, s[20:23], s89 offen offset:0 sc1
 v_mfma_f32_16x16x32_bf16 v[124:127], v[96:99], a[184:187], v[124:127]
 ds_read_b64_tr_b16 v[84:85], v41 offset:27776
 ds_read_b64_tr_b16 v[86:87], v41 offset:32384
 v_mfma_f32_16x16x32_bf16 v[124:127], v[100:103], a[188:191], v[124:127]
 s_waitcnt lgkmcnt(8)
 v_mfma_f32_16x16x32_bf16 v[128:131], v[56:59], a[160:163], v[128:131]
 ds_read_b64_tr_b16 v[88:89], v41 offset:160
 ds_read_b64_tr_b16 v[90:91], v41 offset:4768
 v_mfma_f32_16x16x32_bf16 v[128:131], v[60:63], a[164:167], v[128:131]
 buffer_load_dwordx4 a[148:151], v2, s[20:23], s89 offen offset:1024 sc1
 v_mfma_f32_16x16x32_bf16 v[128:131], v[64:67], a[168:171], v[128:131]
 ds_read_b64_tr_b16 v[92:93], v41 offset:9376
 ds_read_b64_tr_b16 v[94:95], v41 offset:13984
 v_mfma_f32_16x16x32_bf16 v[128:131], v[68:71], a[172:175], v[128:131]
 v_mfma_f32_16x16x32_bf16 v[132:135], v[56:59], a[176:179], v[132:135]
 ds_read_b64_tr_b16 v[96:97], v41 offset:18592
 ds_read_b64_tr_b16 v[98:99], v41 offset:23200
 v_mfma_f32_16x16x32_bf16 v[132:135], v[60:63], a[180:183], v[132:135]
 buffer_load_dwordx4 a[152:155], v2, s[20:23], s89 offen offset:2048 sc1
 v_mfma_f32_16x16x32_bf16 v[132:135], v[64:67], a[184:187], v[132:135]
 ds_read_b64_tr_b16 v[100:101], v41 offset:27808
 ds_read_b64_tr_b16 v[102:103], v41 offset:32416
 v_mfma_f32_16x16x32_bf16 v[132:135], v[68:71], a[188:191], v[132:135]
 s_waitcnt lgkmcnt(8)
 v_mfma_f32_16x16x32_bf16 v[136:139], v[72:75], a[160:163], v[136:139]
 ds_read_b64_tr_b16 v[56:57], v41 offset:192
 ds_read_b64_tr_b16 v[58:59], v41 offset:4800
 v_mfma_f32_16x16x32_bf16 v[136:139], v[76:79], a[164:167], v[136:139]
 buffer_load_dwordx4 a[156:159], v2, s[20:23], s89 offen offset:3072 sc1
 v_mfma_f32_16x16x32_bf16 v[136:139], v[80:83], a[168:171], v[136:139]
 s_mov_b32 s87, 294912
 ds_read_b64_tr_b16 v[60:61], v41 offset:9408
 ds_read_b64_tr_b16 v[62:63], v41 offset:14016
 v_mfma_f32_16x16x32_bf16 v[136:139], v[84:87], a[172:175], v[136:139]
 s_add_u32 m0, s60, 0
 v_mfma_f32_16x16x32_bf16 v[140:143], v[72:75], a[176:179], v[140:143]
 ds_read_b64_tr_b16 v[64:65], v41 offset:18624
 ds_read_b64_tr_b16 v[66:67], v41 offset:23232
 v_mfma_f32_16x16x32_bf16 v[140:143], v[76:79], a[180:183], v[140:143]
 buffer_load_dwordx4 v2, s[12:15], s87 offen offset:0 sc1 lds
 v_mfma_f32_16x16x32_bf16 v[140:143], v[80:83], a[184:187], v[140:143]
 ds_read_b64_tr_b16 v[68:69], v41 offset:27840
 ds_read_b64_tr_b16 v[70:71], v41 offset:32448
 v_mfma_f32_16x16x32_bf16 v[140:143], v[84:87], a[188:191], v[140:143]
 s_waitcnt lgkmcnt(8)
 v_mfma_f32_16x16x32_bf16 v[144:147], v[88:91], a[160:163], v[144:147]
 ds_read_b64_tr_b16 v[72:73], v41 offset:224
 ds_read_b64_tr_b16 v[74:75], v41 offset:4832
 v_mfma_f32_16x16x32_bf16 v[144:147], v[92:95], a[164:167], v[144:147]
 buffer_load_dwordx4 v2, s[12:15], s87 offen offset:1024 sc1 lds
 v_mfma_f32_16x16x32_bf16 v[144:147], v[96:99], a[168:171], v[144:147]
 ds_read_b64_tr_b16 v[76:77], v41 offset:9440
 ds_read_b64_tr_b16 v[78:79], v41 offset:14048
 v_mfma_f32_16x16x32_bf16 v[144:147], v[100:103], a[172:175], v[144:147]
 v_mfma_f32_16x16x32_bf16 v[148:151], v[88:91], a[176:179], v[148:151]
 ds_read_b64_tr_b16 v[80:81], v41 offset:18656
 ds_read_b64_tr_b16 v[82:83], v41 offset:23264
 v_mfma_f32_16x16x32_bf16 v[148:151], v[92:95], a[180:183], v[148:151]
 buffer_load_dwordx4 v2, s[12:15], s87 offen offset:2048 sc1 lds
 v_mfma_f32_16x16x32_bf16 v[148:151], v[96:99], a[184:187], v[148:151]
 ds_read_b64_tr_b16 v[84:85], v41 offset:27872
 ds_read_b64_tr_b16 v[86:87], v41 offset:32480
 v_mfma_f32_16x16x32_bf16 v[148:151], v[100:103], a[188:191], v[148:151]
 s_waitcnt lgkmcnt(8)
 v_mfma_f32_16x16x32_bf16 v[152:155], v[56:59], a[160:163], v[152:155]
 ds_read_b64_tr_b16 v[88:89], v41 offset:256
 ds_read_b64_tr_b16 v[90:91], v41 offset:4864
 v_mfma_f32_16x16x32_bf16 v[152:155], v[60:63], a[164:167], v[152:155]
 buffer_load_dwordx4 v2, s[12:15], s87 offen offset:3072 sc1 lds
 v_mfma_f32_16x16x32_bf16 v[152:155], v[64:67], a[168:171], v[152:155]
 s_mov_b32 s87, 299008
 ds_read_b64_tr_b16 v[92:93], v41 offset:9472
 ds_read_b64_tr_b16 v[94:95], v41 offset:14080
 v_mfma_f32_16x16x32_bf16 v[152:155], v[68:71], a[172:175], v[152:155]
 s_add_u32 m0, s60, 4096
 v_mfma_f32_16x16x32_bf16 v[156:159], v[56:59], a[176:179], v[156:159]
 ds_read_b64_tr_b16 v[96:97], v41 offset:18688
 ds_read_b64_tr_b16 v[98:99], v41 offset:23296
 v_mfma_f32_16x16x32_bf16 v[156:159], v[60:63], a[180:183], v[156:159]
 buffer_load_dwordx4 v2, s[12:15], s87 offen offset:0 sc1 lds
 v_mfma_f32_16x16x32_bf16 v[156:159], v[64:67], a[184:187], v[156:159]
 ds_read_b64_tr_b16 v[100:101], v41 offset:27904
 ds_read_b64_tr_b16 v[102:103], v41 offset:32512
 v_mfma_f32_16x16x32_bf16 v[156:159], v[68:71], a[188:191], v[156:159]
 s_waitcnt lgkmcnt(8)
 v_mfma_f32_16x16x32_bf16 v[160:163], v[72:75], a[160:163], v[160:163]
 v_mfma_f32_16x16x32_bf16 v[160:163], v[76:79], a[164:167], v[160:163]
 buffer_load_dwordx4 v2, s[12:15], s87 offen offset:1024 sc1 lds
 v_mfma_f32_16x16x32_bf16 v[160:163], v[80:83], a[168:171], v[160:163]
 s_waitcnt vmcnt(31) lgkmcnt(0)
 v_mfma_f32_16x16x32_bf16 v[160:163], v[84:87], a[172:175], v[160:163]
 s_barrier
 v_mfma_f32_16x16x32_bf16 v[164:167], v[72:75], a[176:179], v[164:167]
 ds_read_b64_tr_b16 v[56:57], v42 offset:0
 ds_read_b64_tr_b16 v[58:59], v42 offset:4608
 v_mfma_f32_16x16x32_bf16 v[164:167], v[76:79], a[180:183], v[164:167]
 ds_read_b64_tr_b16 v[60:61], v42 offset:9216
 ds_read_b64_tr_b16 v[62:63], v42 offset:13824
 v_mfma_f32_16x16x32_bf16 v[164:167], v[80:83], a[184:187], v[164:167]
 ds_read_b64_tr_b16 v[64:65], v42 offset:18432
 ds_read_b64_tr_b16 v[66:67], v42 offset:23040
 v_mfma_f32_16x16x32_bf16 v[164:167], v[84:87], a[188:191], v[164:167]
 ds_read_b64_tr_b16 v[68:69], v42 offset:27648
 ds_read_b64_tr_b16 v[70:71], v42 offset:32256
 v_mfma_f32_16x16x32_bf16 v[168:171], v[88:91], a[160:163], v[168:171]
 ds_read_b64_tr_b16 v[72:73], v42 offset:32
 ds_read_b64_tr_b16 v[74:75], v42 offset:4640
 v_mfma_f32_16x16x32_bf16 v[168:171], v[92:95], a[164:167], v[168:171]
 buffer_load_dwordx4 v2, s[12:15], s87 offen offset:2048 sc1 lds
 v_mfma_f32_16x16x32_bf16 v[168:171], v[96:99], a[168:171], v[168:171]
 ds_read_b64_tr_b16 v[76:77], v42 offset:9248
 ds_read_b64_tr_b16 v[78:79], v42 offset:13856
 v_mfma_f32_16x16x32_bf16 v[168:171], v[100:103], a[172:175], v[168:171]
 v_mfma_f32_16x16x32_bf16 v[172:175], v[88:91], a[176:179], v[172:175]
 ds_read_b64_tr_b16 v[80:81], v42 offset:18464
 ds_read_b64_tr_b16 v[82:83], v42 offset:23072
 v_mfma_f32_16x16x32_bf16 v[172:175], v[92:95], a[180:183], v[172:175]
 buffer_load_dwordx4 v2, s[12:15], s87 offen offset:3072 sc1 lds
 v_mfma_f32_16x16x32_bf16 v[172:175], v[96:99], a[184:187], v[172:175]
 s_mov_b32 s87, 303104
 ds_read_b64_tr_b16 v[84:85], v42 offset:27680
 ds_read_b64_tr_b16 v[86:87], v42 offset:32288
 v_mfma_f32_16x16x32_bf16 v[172:175], v[100:103], a[188:191], v[172:175]
 s_waitcnt lgkmcnt(8)
 v_mfma_f32_16x16x32_bf16 v[104:107], v[56:59], a[192:195], v[104:107]
 s_add_u32 m0, s60, 8192
 ds_read_b64_tr_b16 v[88:89], v42 offset:64
 ds_read_b64_tr_b16 v[90:91], v42 offset:4672
 v_mfma_f32_16x16x32_bf16 v[104:107], v[60:63], a[196:199], v[104:107]
 buffer_load_dword v255, v250, s[32:35], s66 offen sc1
 v_mfma_f32_16x16x32_bf16 v[104:107], v[64:67], a[200:203], v[104:107]
 ds_read_b64_tr_b16 v[92:93], v42 offset:9280
 ds_read_b64_tr_b16 v[94:95], v42 offset:13888
 v_mfma_f32_16x16x32_bf16 v[104:107], v[68:71], a[204:207], v[104:107]
 v_mfma_f32_16x16x32_bf16 v[108:111], v[56:59], a[208:211], v[108:111]
 ds_read_b64_tr_b16 v[96:97], v42 offset:18496
 ds_read_b64_tr_b16 v[98:99], v42 offset:23104
 v_mfma_f32_16x16x32_bf16 v[108:111], v[60:63], a[212:215], v[108:111]
 buffer_load_dwordx4 v2, s[12:15], s87 offen offset:0 sc1 lds
 v_mfma_f32_16x16x32_bf16 v[108:111], v[64:67], a[216:219], v[108:111]
 ds_read_b64_tr_b16 v[100:101], v42 offset:27712
 ds_read_b64_tr_b16 v[102:103], v42 offset:32320
 v_mfma_f32_16x16x32_bf16 v[108:111], v[68:71], a[220:223], v[108:111]
 s_waitcnt lgkmcnt(8)
 v_mfma_f32_16x16x32_bf16 v[112:115], v[72:75], a[192:195], v[112:115]
 ds_read_b64_tr_b16 v[56:57], v42 offset:96
 ds_read_b64_tr_b16 v[58:59], v42 offset:4704
 v_mfma_f32_16x16x32_bf16 v[112:115], v[76:79], a[196:199], v[112:115]
 buffer_load_dwordx2 v[44:45], v39, s[44:47], s75 offen offset:0
 v_mfma_f32_16x16x32_bf16 v[112:115], v[80:83], a[200:203], v[112:115]
 ds_read_b64_tr_b16 v[60:61], v42 offset:9312
 ds_read_b64_tr_b16 v[62:63], v42 offset:13920
 v_mfma_f32_16x16x32_bf16 v[112:115], v[84:87], a[204:207], v[112:115]
 v_mfma_f32_16x16x32_bf16 v[116:119], v[72:75], a[208:211], v[116:119]
 ds_read_b64_tr_b16 v[64:65], v42 offset:18528
 ds_read_b64_tr_b16 v[66:67], v42 offset:23136
 v_mfma_f32_16x16x32_bf16 v[116:119], v[76:79], a[212:215], v[116:119]
 buffer_load_dwordx2 v[46:47], v39, s[44:47], s76 offen offset:0
 v_mfma_f32_16x16x32_bf16 v[116:119], v[80:83], a[216:219], v[116:119]
 ds_read_b64_tr_b16 v[68:69], v42 offset:27744
 ds_read_b64_tr_b16 v[70:71], v42 offset:32352
 v_mfma_f32_16x16x32_bf16 v[116:119], v[84:87], a[220:223], v[116:119]
 s_waitcnt lgkmcnt(8)
 v_mfma_f32_16x16x32_bf16 v[120:123], v[88:91], a[192:195], v[120:123]
 ds_read_b64_tr_b16 v[72:73], v42 offset:128
 ds_read_b64_tr_b16 v[74:75], v42 offset:4736
 v_mfma_f32_16x16x32_bf16 v[120:123], v[92:95], a[196:199], v[120:123]
 buffer_load_dwordx2 v[48:49], v39, s[44:47], s75 offen offset:128
 v_mfma_f32_16x16x32_bf16 v[120:123], v[96:99], a[200:203], v[120:123]
 ds_read_b64_tr_b16 v[76:77], v42 offset:9344
 ds_read_b64_tr_b16 v[78:79], v42 offset:13952
 v_mfma_f32_16x16x32_bf16 v[120:123], v[100:103], a[204:207], v[120:123]
 v_mfma_f32_16x16x32_bf16 v[124:127], v[88:91], a[208:211], v[124:127]
 ds_read_b64_tr_b16 v[80:81], v42 offset:18560
 ds_read_b64_tr_b16 v[82:83], v42 offset:23168
 v_mfma_f32_16x16x32_bf16 v[124:127], v[92:95], a[212:215], v[124:127]
 buffer_load_dwordx2 v[50:51], v39, s[44:47], s76 offen offset:128
 v_mfma_f32_16x16x32_bf16 v[124:127], v[96:99], a[216:219], v[124:127]
 ds_read_b64_tr_b16 v[84:85], v42 offset:27776
 ds_read_b64_tr_b16 v[86:87], v42 offset:32384
 v_mfma_f32_16x16x32_bf16 v[124:127], v[100:103], a[220:223], v[124:127]
 s_waitcnt lgkmcnt(8)
 v_mfma_f32_16x16x32_bf16 v[128:131], v[56:59], a[192:195], v[128:131]
 ds_read_b64_tr_b16 v[88:89], v42 offset:160
 ds_read_b64_tr_b16 v[90:91], v42 offset:4768
 v_mfma_f32_16x16x32_bf16 v[128:131], v[60:63], a[196:199], v[128:131]
 buffer_load_dwordx2 v[52:53], v39, s[44:47], s77 offen offset:256
 v_mfma_f32_16x16x32_bf16 v[128:131], v[64:67], a[200:203], v[128:131]
 ds_read_b64_tr_b16 v[92:93], v42 offset:9376
 ds_read_b64_tr_b16 v[94:95], v42 offset:13984
 v_mfma_f32_16x16x32_bf16 v[128:131], v[68:71], a[204:207], v[128:131]
 v_mfma_f32_16x16x32_bf16 v[132:135], v[56:59], a[208:211], v[132:135]
 ds_read_b64_tr_b16 v[96:97], v42 offset:18592
 ds_read_b64_tr_b16 v[98:99], v42 offset:23200
 v_mfma_f32_16x16x32_bf16 v[132:135], v[60:63], a[212:215], v[132:135]
 buffer_load_dwordx2 v[54:55], v39, s[44:47], s78 offen offset:256
 v_mfma_f32_16x16x32_bf16 v[132:135], v[64:67], a[216:219], v[132:135]
 s_mov_b32 s87, 331776
 ds_read_b64_tr_b16 v[100:101], v42 offset:27808
 ds_read_b64_tr_b16 v[102:103], v42 offset:32416
 v_mfma_f32_16x16x32_bf16 v[132:135], v[68:71], a[220:223], v[132:135]
 s_waitcnt lgkmcnt(8)
 v_mfma_f32_16x16x32_bf16 v[136:139], v[72:75], a[192:195], v[136:139]
 s_add_u32 m0, s60, 126976
 ds_read_b64_tr_b16 v[56:57], v42 offset:192
 ds_read_b64_tr_b16 v[58:59], v42 offset:4800
 v_mfma_f32_16x16x32_bf16 v[136:139], v[76:79], a[196:199], v[136:139]
 buffer_load_dwordx4 v2, s[12:15], s87 offen offset:0 sc1 lds
 v_mfma_f32_16x16x32_bf16 v[136:139], v[80:83], a[200:203], v[136:139]
 ds_read_b64_tr_b16 v[60:61], v42 offset:9408
 ds_read_b64_tr_b16 v[62:63], v42 offset:14016
 v_mfma_f32_16x16x32_bf16 v[136:139], v[84:87], a[204:207], v[136:139]
 v_mfma_f32_16x16x32_bf16 v[140:143], v[72:75], a[208:211], v[140:143]
 ds_read_b64_tr_b16 v[64:65], v42 offset:18624
 ds_read_b64_tr_b16 v[66:67], v42 offset:23232
 v_mfma_f32_16x16x32_bf16 v[140:143], v[76:79], a[212:215], v[140:143]
 buffer_load_dwordx4 v2, s[12:15], s87 offen offset:1024 sc1 lds
 v_mfma_f32_16x16x32_bf16 v[140:143], v[80:83], a[216:219], v[140:143]
 ds_read_b64_tr_b16 v[68:69], v42 offset:27840
 ds_read_b64_tr_b16 v[70:71], v42 offset:32448
 v_mfma_f32_16x16x32_bf16 v[140:143], v[84:87], a[220:223], v[140:143]
 s_waitcnt lgkmcnt(8)
 v_mfma_f32_16x16x32_bf16 v[144:147], v[88:91], a[192:195], v[144:147]
 ds_read_b64_tr_b16 v[72:73], v42 offset:224
 ds_read_b64_tr_b16 v[74:75], v42 offset:4832
 v_mfma_f32_16x16x32_bf16 v[144:147], v[92:95], a[196:199], v[144:147]
 buffer_load_dwordx4 v2, s[12:15], s87 offen offset:2048 sc1 lds
 v_mfma_f32_16x16x32_bf16 v[144:147], v[96:99], a[200:203], v[144:147]
 ds_read_b64_tr_b16 v[76:77], v42 offset:9440
 ds_read_b64_tr_b16 v[78:79], v42 offset:14048
 v_mfma_f32_16x16x32_bf16 v[144:147], v[100:103], a[204:207], v[144:147]
 v_mfma_f32_16x16x32_bf16 v[148:151], v[88:91], a[208:211], v[148:151]
 ds_read_b64_tr_b16 v[80:81], v42 offset:18656
 ds_read_b64_tr_b16 v[82:83], v42 offset:23264
 v_mfma_f32_16x16x32_bf16 v[148:151], v[92:95], a[212:215], v[148:151]
 buffer_load_dwordx4 v2, s[12:15], s87 offen offset:3072 sc1 lds
 v_mfma_f32_16x16x32_bf16 v[148:151], v[96:99], a[216:219], v[148:151]
 s_mov_b32 s87, 335872
 ds_read_b64_tr_b16 v[84:85], v42 offset:27872
 ds_read_b64_tr_b16 v[86:87], v42 offset:32480
 v_mfma_f32_16x16x32_bf16 v[148:151], v[100:103], a[220:223], v[148:151]
 s_waitcnt lgkmcnt(8)
 v_mfma_f32_16x16x32_bf16 v[152:155], v[56:59], a[192:195], v[152:155]
 s_add_u32 m0, s60, 131072
 ds_read_b64_tr_b16 v[88:89], v42 offset:256
 ds_read_b64_tr_b16 v[90:91], v42 offset:4864
 v_mfma_f32_16x16x32_bf16 v[152:155], v[60:63], a[196:199], v[152:155]
 buffer_load_dwordx4 v2, s[12:15], s87 offen offset:0 sc1 lds
 v_mfma_f32_16x16x32_bf16 v[152:155], v[64:67], a[200:203], v[152:155]
 ds_read_b64_tr_b16 v[92:93], v42 offset:9472
 ds_read_b64_tr_b16 v[94:95], v42 offset:14080
 v_mfma_f32_16x16x32_bf16 v[152:155], v[68:71], a[204:207], v[152:155]
 v_mfma_f32_16x16x32_bf16 v[156:159], v[56:59], a[208:211], v[156:159]
 ds_read_b64_tr_b16 v[96:97], v42 offset:18688
 ds_read_b64_tr_b16 v[98:99], v42 offset:23296
 v_mfma_f32_16x16x32_bf16 v[156:159], v[60:63], a[212:215], v[156:159]
 buffer_load_dwordx4 v2, s[12:15], s87 offen offset:1024 sc1 lds
 v_mfma_f32_16x16x32_bf16 v[156:159], v[64:67], a[216:219], v[156:159]
 ds_read_b64_tr_b16 v[100:101], v42 offset:27904
 ds_read_b64_tr_b16 v[102:103], v42 offset:32512
 v_mfma_f32_16x16x32_bf16 v[156:159], v[68:71], a[220:223], v[156:159]
 s_waitcnt lgkmcnt(8)
 v_mfma_f32_16x16x32_bf16 v[160:163], v[72:75], a[192:195], v[160:163]
 v_mfma_f32_16x16x32_bf16 v[160:163], v[76:79], a[196:199], v[160:163]
 buffer_load_dwordx4 v2, s[12:15], s87 offen offset:2048 sc1 lds
 v_mfma_f32_16x16x32_bf16 v[160:163], v[80:83], a[200:203], v[160:163]
 s_waitcnt vmcnt(31) lgkmcnt(0)
 v_mfma_f32_16x16x32_bf16 v[160:163], v[84:87], a[204:207], v[160:163]
 s_barrier
 v_mfma_f32_16x16x32_bf16 v[164:167], v[72:75], a[208:211], v[164:167]
 ds_read_b64_tr_b16 v[56:57], v43 offset:0
 ds_read_b64_tr_b16 v[58:59], v43 offset:4608
 v_mfma_f32_16x16x32_bf16 v[164:167], v[76:79], a[212:215], v[164:167]
 ds_read_b64_tr_b16 v[60:61], v43 offset:9216
 ds_read_b64_tr_b16 v[62:63], v43 offset:13824
 v_mfma_f32_16x16x32_bf16 v[164:167], v[80:83], a[216:219], v[164:167]
 ds_read_b64_tr_b16 v[64:65], v43 offset:18432
 ds_read_b64_tr_b16 v[66:67], v43 offset:23040
 v_mfma_f32_16x16x32_bf16 v[164:167], v[84:87], a[220:223], v[164:167]
 ds_read_b64_tr_b16 v[68:69], v43 offset:27648
 ds_read_b64_tr_b16 v[70:71], v43 offset:32256
 v_mfma_f32_16x16x32_bf16 v[168:171], v[88:91], a[192:195], v[168:171]
 ds_read_b64_tr_b16 v[72:73], v43 offset:32
 ds_read_b64_tr_b16 v[74:75], v43 offset:4640
 v_mfma_f32_16x16x32_bf16 v[168:171], v[92:95], a[196:199], v[168:171]
 buffer_load_dwordx4 v2, s[12:15], s87 offen offset:3072 sc1 lds
 v_mfma_f32_16x16x32_bf16 v[168:171], v[96:99], a[200:203], v[168:171]
 s_mov_b32 s87, 339968
 ds_read_b64_tr_b16 v[76:77], v43 offset:9248
 ds_read_b64_tr_b16 v[78:79], v43 offset:13856
 v_mfma_f32_16x16x32_bf16 v[168:171], v[100:103], a[204:207], v[168:171]
 s_add_u32 m0, s60, 135168
 v_mfma_f32_16x16x32_bf16 v[172:175], v[88:91], a[208:211], v[172:175]
 ds_read_b64_tr_b16 v[80:81], v43 offset:18464
 ds_read_b64_tr_b16 v[82:83], v43 offset:23072
 v_mfma_f32_16x16x32_bf16 v[172:175], v[92:95], a[212:215], v[172:175]
 buffer_load_dwordx4 v2, s[12:15], s87 offen offset:0 sc1 lds
 v_mfma_f32_16x16x32_bf16 v[172:175], v[96:99], a[216:219], v[172:175]
 ds_read_b64_tr_b16 v[84:85], v43 offset:27680
 ds_read_b64_tr_b16 v[86:87], v43 offset:32288
 v_mfma_f32_16x16x32_bf16 v[172:175], v[100:103], a[220:223], v[172:175]
 s_waitcnt lgkmcnt(8)
 s_waitcnt vmcnt(16)
 v_cmp_ne_u32 vcc, s54, v255
 s_cbranch_vccnz L_spin_o
L_ok_o:
 v_mfma_f32_16x16x32_bf16 v[104:107], v[56:59], a[224:227], v[104:107]
 s_mov_b32 s88, 0
 ds_read_b64_tr_b16 v[88:89], v43 offset:64
 ds_read_b64_tr_b16 v[90:91], v43 offset:4672
 v_mfma_f32_16x16x32_bf16 v[104:107], v[60:63], a[228:231], v[104:107]
 buffer_load_dwordx4 a[160:163], v2, s[24:27], s88 offen offset:0 sc1
 v_mfma_f32_16x16x32_bf16 v[104:107], v[64:67], a[232:235], v[104:107]
 ds_read_b64_tr_b16 v[92:93], v43 offset:9280
 ds_read_b64_tr_b16 v[94:95], v43 offset:13888
 v_mfma_f32_16x16x32_bf16 v[104:107], v[68:71], a[236:239], v[104:107]
 v_mfma_f32_16x16x32_bf16 v[108:111], v[56:59], a[240:243], v[108:111]
 ds_read_b64_tr_b16 v[96:97], v43 offset:18496
 ds_read_b64_tr_b16 v[98:99], v43 offset:23104
 v_mfma_f32_16x16x32_bf16 v[108:111], v[60:63], a[244:247], v[108:111]
 buffer_load_dwordx4 a[164:167], v2, s[24:27], s88 offen offset:1024 sc1
 v_mfma_f32_16x16x32_bf16 v[108:111], v[64:67], a[248:251], v[108:111]
 ds_read_b64_tr_b16 v[100:101], v43 offset:27712
 ds_read_b64_tr_b16 v[102:103], v43 offset:32320
 v_mfma_f32_16x16x32_bf16 v[108:111], v[68:71], a[252:255], v[108:111]
 s_waitcnt lgkmcnt(8)
 v_mfma_f32_16x16x32_bf16 v[112:115], v[72:75], a[224:227], v[112:115]
 ds_read_b64_tr_b16 v[56:57], v43 offset:96
 ds_read_b64_tr_b16 v[58:59], v43 offset:4704
 v_mfma_f32_16x16x32_bf16 v[112:115], v[76:79], a[228:231], v[112:115]
 buffer_load_dwordx4 a[168:171], v2, s[24:27], s88 offen offset:2048 sc1
 v_mfma_f32_16x16x32_bf16 v[112:115], v[80:83], a[232:235], v[112:115]
 ds_read_b64_tr_b16 v[60:61], v43 offset:9312
 ds_read_b64_tr_b16 v[62:63], v43 offset:13920
 v_mfma_f32_16x16x32_bf16 v[112:115], v[84:87], a[236:239], v[112:115]
 v_mfma_f32_16x16x32_bf16 v[116:119], v[72:75], a[240:243], v[116:119]
 ds_read_b64_tr_b16 v[64:65], v43 offset:18528
 ds_read_b64_tr_b16 v[66:67], v43 offset:23136
 v_mfma_f32_16x16x32_bf16 v[116:119], v[76:79], a[244:247], v[116:119]
 buffer_load_dwordx4 a[172:175], v2, s[24:27], s88 offen offset:3072 sc1
 v_mfma_f32_16x16x32_bf16 v[116:119], v[80:83], a[248:251], v[116:119]
 s_mov_b32 s89, 132352
 ds_read_b64_tr_b16 v[68:69], v43 offset:27744
 ds_read_b64_tr_b16 v[70:71], v43 offset:32352
 v_mfma_f32_16x16x32_bf16 v[116:119], v[84:87], a[252:255], v[116:119]
 s_waitcnt lgkmcnt(8)
 v_mfma_f32_16x16x32_bf16 v[120:123], v[88:91], a[224:227], v[120:123]
 ds_read_b64_tr_b16 v[72:73], v43 offset:128
 ds_read_b64_tr_b16 v[74:75], v43 offset:4736
 v_mfma_f32_16x16x32_bf16 v[120:123], v[92:95], a[228:231], v[120:123]
 buffer_load_dwordx4 a[176:179], v2, s[24:27], s89 offen offset:0 sc1
 v_mfma_f32_16x16x32_bf16 v[120:123], v[96:99], a[232:235], v[120:123]
 ds_read_b64_tr_b16 v[76:77], v43 offset:9344
 ds_read_b64_tr_b16 v[78:79], v43 offset:13952
 v_mfma_f32_16x16x32_bf16 v[120:123], v[100:103], a[236:239], v[120:123]
 v_mfma_f32_16x16x32_bf16 v[124:127], v[88:91], a[240:243], v[124:127]
 ds_read_b64_tr_b16 v[80:81], v43 offset:18560
 ds_read_b64_tr_b16 v[82:83], v43 offset:23168
 v_mfma_f32_16x16x32_bf16 v[124:127], v[92:95], a[244:247], v[124:127]
 buffer_load_dwordx4 a[180:183], v2, s[24:27], s89 offen offset:1024 sc1
 v_mfma_f32_16x16x32_bf16 v[124:127], v[96:99], a[248:251], v[124:127]
 ds_read_b64_tr_b16 v[84:85], v43 offset:27776
 ds_read_b64_tr_b16 v[86:87], v43 offset:32384
 v_mfma_f32_16x16x32_bf16 v[124:127], v[100:103], a[252:255], v[124:127]
 s_waitcnt lgkmcnt(8)
 v_mfma_f32_16x16x32_bf16 v[128:131], v[56:59], a[224:227], v[128:131]
 ds_read_b64_tr_b16 v[88:89], v43 offset:160
 ds_read_b64_tr_b16 v[90:91], v43 offset:4768
 v_mfma_f32_16x16x32_bf16 v[128:131], v[60:63], a[228:231], v[128:131]
 buffer_load_dwordx4 a[184:187], v2, s[24:27], s89 offen offset:2048 sc1
 v_mfma_f32_16x16x32_bf16 v[128:131], v[64:67], a[232:235], v[128:131]
 ds_read_b64_tr_b16 v[92:93], v43 offset:9376
 ds_read_b64_tr_b16 v[94:95], v43 offset:13984
 v_mfma_f32_16x16x32_bf16 v[128:131], v[68:71], a[236:239], v[128:131]
 v_mfma_f32_16x16x32_bf16 v[132:135], v[56:59], a[240:243], v[132:135]
 ds_read_b64_tr_b16 v[96:97], v43 offset:18592
 ds_read_b64_tr_b16 v[98:99], v43 offset:23200
 v_mfma_f32_16x16x32_bf16 v[132:135], v[60:63], a[244:247], v[132:135]
 buffer_load_dwordx4 a[188:191], v2, s[24:27], s89 offen offset:3072 sc1
 v_mfma_f32_16x16x32_bf16 v[132:135], v[64:67], a[248:251], v[132:135]
 s_mov_b32 s88, 4096
 ds_read_b64_tr_b16 v[100:101], v43 offset:27808
 ds_read_b64_tr_b16 v[102:103], v43 offset:32416
 v_mfma_f32_16x16x32_bf16 v[132:135], v[68:71], a[252:255], v[132:135]
 s_waitcnt lgkmcnt(8)
 v_mfma_f32_16x16x32_bf16 v[136:139], v[72:75], a[224:227], v[136:139]
 ds_read_b64_tr_b16 v[56:57], v43 offset:192
 ds_read_b64_tr_b16 v[58:59], v43 offset:4800
 v_mfma_f32_16x16x32_bf16 v[136:139], v[76:79], a[228:231], v[136:139]
 buffer_load_dwordx4 a[192:195], v2, s[24:27], s88 offen offset:0 sc1
 v_mfma_f32_16x16x32_bf16 v[136:139], v[80:83], a[232:235], v[136:139]
 ds_read_b64_tr_b16 v[60:61], v43 offset:9408
 ds_read_b64_tr_b16 v[62:63], v43 offset:14016
 v_mfma_f32_16x16x32_bf16 v[136:139], v[84:87], a[236:239], v[136:139]
 v_mfma_f32_16x16x32_bf16 v[140:143], v[72:75], a[240:243], v[140:143]
 ds_read_b64_tr_b16 v[64:65], v43 offset:18624
 ds_read_b64_tr_b16 v[66:67], v43 offset:23232
 v_mfma_f32_16x16x32_bf16 v[140:143], v[76:79], a[244:247], v[140:143]
 buffer_load_dwordx4 a[196:199], v2, s[24:27], s88 offen offset:1024 sc1
 v_mfma_f32_16x16x32_bf16 v[140:143], v[80:83], a[248:251], v[140:143]
 ds_read_b64_tr_b16 v[68:69], v43 offset:27840
 ds_read_b64_tr_b16 v[70:71], v43 offset:32448
 v_mfma_f32_16x16x32_bf16 v[140:143], v[84:87], a[252:255], v[140:143]
 s_waitcnt lgkmcnt(8)
 v_mfma_f32_16x16x32_bf16 v[144:147], v[88:91], a[224:227], v[144:147]
 ds_read_b64_tr_b16 v[72:73], v43 offset:224
 ds_read_b64_tr_b16 v[74:75], v43 offset:4832
 v_mfma_f32_16x16x32_bf16 v[144:147], v[92:95], a[228:231], v[144:147]
 buffer_load_dwordx4 a[200:203], v2, s[24:27], s88 offen offset:2048 sc1
 v_mfma_f32_16x16x32_bf16 v[144:147], v[96:99], a[232:235], v[144:147]
 ds_read_b64_tr_b16 v[76:77], v43 offset:9440
 ds_read_b64_tr_b16 v[78:79], v43 offset:14048
 v_mfma_f32_16x16x32_bf16 v[144:147], v[100:103], a[236:239], v[144:147]
 v_mfma_f32_16x16x32_bf16 v[148:151], v[88:91], a[240:243], v[148:151]
 ds_read_b64_tr_b16 v[80:81], v43 offset:18656
 ds_read_b64_tr_b16 v[82:83], v43 offset:23264
 v_mfma_f32_16x16x32_bf16 v[148:151], v[92:95], a[244:247], v[148:151]
 buffer_load_dwordx4 a[204:207], v2, s[24:27], s88 offen offset:3072 sc1
 v_mfma_f32_16x16x32_bf16 v[148:151], v[96:99], a[248:251], v[148:151]
 s_mov_b32 s89, 136448
 ds_read_b64_tr_b16 v[84:85], v43 offset:27872
 ds_read_b64_tr_b16 v[86:87], v43 offset:32480
 v_mfma_f32_16x16x32_bf16 v[148:151], v[100:103], a[252:255], v[148:151]
 s_waitcnt lgkmcnt(8)
 v_mfma_f32_16x16x32_bf16 v[152:155], v[56:59], a[224:227], v[152:155]
 ds_read_b64_tr_b16 v[88:89], v43 offset:256
 ds_read_b64_tr_b16 v[90:91], v43 offset:4864
 v_mfma_f32_16x16x32_bf16 v[152:155], v[60:63], a[228:231], v[152:155]
 buffer_load_dwordx4 a[208:211], v2, s[24:27], s89 offen offset:0 sc1
 v_mfma_f32_16x16x32_bf16 v[152:155], v[64:67], a[232:235], v[152:155]
 ds_read_b64_tr_b16 v[92:93], v43 offset:9472
 ds_read_b64_tr_b16 v[94:95], v43 offset:14080
 v_mfma_f32_16x16x32_bf16 v[152:155], v[68:71], a[236:239], v[152:155]
 v_mfma_f32_16x16x32_bf16 v[156:159], v[56:59], a[240:243], v[156:159]
 ds_read_b64_tr_b16 v[96:97], v43 offset:18688
 ds_read_b64_tr_b16 v[98:99], v43 offset:23296
 v_mfma_f32_16x16x32_bf16 v[156:159], v[60:63], a[244:247], v[156:159]
 buffer_load_dwordx4 a[212:215], v2, s[24:27], s89 offen offset:1024 sc1
 v_mfma_f32_16x16x32_bf16 v[156:159], v[64:67], a[248:251], v[156:159]
 ds_read_b64_tr_b16 v[100:101], v43 offset:27904
 ds_read_b64_tr_b16 v[102:103], v43 offset:32512
 v_mfma_f32_16x16x32_bf16 v[156:159], v[68:71], a[252:255], v[156:159]
 s_waitcnt lgkmcnt(8)
 v_mfma_f32_16x16x32_bf16 v[160:163], v[72:75], a[224:227], v[160:163]
 v_mfma_f32_16x16x32_bf16 v[160:163], v[76:79], a[228:231], v[160:163]
 buffer_load_dwordx4 a[216:219], v2, s[24:27], s89 offen offset:2048 sc1
 v_mfma_f32_16x16x32_bf16 v[160:163], v[80:83], a[232:235], v[160:163]
 s_waitcnt vmcnt(30) lgkmcnt(0)
 v_mfma_f32_16x16x32_bf16 v[160:163], v[84:87], a[236:239], v[160:163]
 s_barrier
 v_mfma_f32_16x16x32_bf16 v[164:167], v[72:75], a[240:243], v[164:167]
 ds_read_b64_tr_b16 v[56:57], v40 offset:0
 ds_read_b64_tr_b16 v[58:59], v40 offset:4608
 v_mfma_f32_16x16x32_bf16 v[164:167], v[76:79], a[244:247], v[164:167]
 ds_read_b64_tr_b16 v[60:61], v40 offset:9216
 ds_read_b64_tr_b16 v[62:63], v40 offset:13824
 v_mfma_f32_16x16x32_bf16 v[164:167], v[80:83], a[248:251], v[164:167]
 ds_read_b64_tr_b16 v[64:65], v40 offset:18432
 ds_read_b64_tr_b16 v[66:67], v40 offset:23040
 v_mfma_f32_16x16x32_bf16 v[164:167], v[84:87], a[252:255], v[164:167]
 ds_read_b64_tr_b16 v[68:69], v40 offset:27648
 ds_read_b64_tr_b16 v[70:71], v40 offset:32256
 v_mfma_f32_16x16x32_bf16 v[168:171], v[88:91], a[224:227], v[168:171]
 ds_read_b64_tr_b16 v[72:73], v40 offset:32
 ds_read_b64_tr_b16 v[74:75], v40 offset:4640
 v_mfma_f32_16x16x32_bf16 v[168:171], v[92:95], a[228:231], v[168:171]
 buffer_load_dwordx4 a[220:223], v2, s[24:27], s89 offen offset:3072 sc1
 v_mfma_f32_16x16x32_bf16 v[168:171], v[96:99], a[232:235], v[168:171]
 s_mov_b32 s87, 368640
 ds_read_b64_tr_b16 v[76:77], v40 offset:9248
 ds_read_b64_tr_b16 v[78:79], v40 offset:13856
 v_mfma_f32_16x16x32_bf16 v[168:171], v[100:103], a[236:239], v[168:171]
 s_add_u32 m0, s60, 36864
 v_mfma_f32_16x16x32_bf16 v[172:175], v[88:91], a[240:243], v[172:175]
 ds_read_b64_tr_b16 v[80:81], v40 offset:18464
 ds_read_b64_tr_b16 v[82:83], v40 offset:23072
 v_mfma_f32_16x16x32_bf16 v[172:175], v[92:95], a[244:247], v[172:175]
 buffer_load_dwordx4 v2, s[12:15], s87 offen offset:0 sc1 lds
 v_mfma_f32_16x16x32_bf16 v[172:175], v[96:99], a[248:251], v[172:175]
 ds_read_b64_tr_b16 v[84:85], v40 offset:27680
 ds_read_b64_tr_b16 v[86:87], v40 offset:32288
 v_mfma_f32_16x16x32_bf16 v[172:175], v[100:103], a[252:255], v[172:175]
 s_waitcnt lgkmcnt(8)
 v_mfma_f32_16x16x32_bf16 v[104:107], v[56:59], a[128:131], v[104:107]
 ds_read_b64_tr_b16 v[88:89], v40 offset:64
 ds_read_b64_tr_b16 v[90:91], v40 offset:4672
 v_mfma_f32_16x16x32_bf16 v[104:107], v[60:63], a[132:135], v[104:107]
 buffer_load_dwordx4 v2, s[12:15], s87 offen offset:1024 sc1 lds
 v_mfma_f32_16x16x32_bf16 v[104:107], v[64:67], a[136:139], v[104:107]
 ds_read_b64_tr_b16 v[92:93], v40 offset:9280
 ds_read_b64_tr_b16 v[94:95], v40 offset:13888
 v_mfma_f32_16x16x32_bf16 v[104:107], v[68:71], a[140:143], v[104:107]
 v_mfma_f32_16x16x32_bf16 v[108:111], v[56:59], a[144:147], v[108:111]
 ds_read_b64_tr_b16 v[96:97], v40 offset:18496
 ds_read_b64_tr_b16 v[98:99], v40 offset:23104
 v_mfma_f32_16x16x32_bf16 v[108:111], v[60:63], a[148:151], v[108:111]
 buffer_load_dwordx4 v2, s[12:15], s87 offen offset:2048 sc1 lds
 v_mfma_f32_16x16x32_bf16 v[108:111], v[64:67], a[152:155], v[108:111]
 ds_read_b64_tr_b16 v[100:101], v40 offset:27712
 ds_read_b64_tr_b16 v[102:103], v40 offset:32320
 v_mfma_f32_16x16x32_bf16 v[108:111], v[68:71], a[156:159], v[108:111]
 s_waitcnt lgkmcnt(8)
 v_mfma_f32_16x16x32_bf16 v[112:115], v[72:75], a[128:131], v[112:115]
 ds_read_b64_tr_b16 v[56:57], v40 offset:96
 ds_read_b64_tr_b16 v[58:59], v40 offset:4704
 v_mfma_f32_16x16x32_bf16 v[112:115], v[76:79], a[132:135], v[112:115]
 buffer_load_dwordx4 v2, s[12:15], s87 offen offset:3072 sc1 lds
 v_mfma_f32_16x16x32_bf16 v[112:115], v[80:83], a[136:139], v[112:115]
 s_mov_b32 s87, 372736
 ds_read_b64_tr_b16 v[60:61], v40 offset:9312
 ds_read_b64_tr_b16 v[62:63], v40 offset:13920
 v_mfma_f32_16x16x32_bf16 v[112:115], v[84:87], a[140:143], v[112:115]
 s_add_u32 m0, s60, 40960
 v_mfma_f32_16x16x32_bf16 v[116:119], v[72:75], a[144:147], v[116:119]
 ds_read_b64_tr_b16 v[64:65], v40 offset:18528
 ds_read_b64_tr_b16 v[66:67], v40 offset:23136
 v_mfma_f32_16x16x32_bf16 v[116:119], v[76:79], a[148:151], v[116:119]
 buffer_load_dwordx4 v2, s[12:15], s87 offen offset:0 sc1 lds
 v_mfma_f32_16x16x32_bf16 v[116:119], v[80:83], a[152:155], v[116:119]
 ds_read_b64_tr_b16 v[68:69], v40 offset:27744
 ds_read_b64_tr_b16 v[70:71], v40 offset:32352
 v_mfma_f32_16x16x32_bf16 v[116:119], v[84:87], a[156:159], v[116:119]
 s_waitcnt lgkmcnt(8)
 v_mfma_f32_16x16x32_bf16 v[120:123], v[88:91], a[128:131], v[120:123]
 ds_read_b64_tr_b16 v[72:73], v40 offset:128
 ds_read_b64_tr_b16 v[74:75], v40 offset:4736
 v_mfma_f32_16x16x32_bf16 v[120:123], v[92:95], a[132:135], v[120:123]
 buffer_load_dwordx4 v2, s[12:15], s87 offen offset:1024 sc1 lds
 v_mfma_f32_16x16x32_bf16 v[120:123], v[96:99], a[136:139], v[120:123]
 ds_read_b64_tr_b16 v[76:77], v40 offset:9344
 ds_read_b64_tr_b16 v[78:79], v40 offset:13952
 v_mfma_f32_16x16x32_bf16 v[120:123], v[100:103], a[140:143], v[120:123]
 v_mfma_f32_16x16x32_bf16 v[124:127], v[88:91], a[144:147], v[124:127]
 ds_read_b64_tr_b16 v[80:81], v40 offset:18560
 ds_read_b64_tr_b16 v[82:83], v40 offset:23168
 v_mfma_f32_16x16x32_bf16 v[124:127], v[92:95], a[148:151], v[124:127]
 buffer_load_dwordx4 v2, s[12:15], s87 offen offset:2048 sc1 lds
 v_mfma_f32_16x16x32_bf16 v[124:127], v[96:99], a[152:155], v[124:127]
 ds_read_b64_tr_b16 v[84:85], v40 offset:27776
 ds_read_b64_tr_b16 v[86:87], v40 offset:32384
 v_mfma_f32_16x16x32_bf16 v[124:127], v[100:103], a[156:159], v[124:127]
 s_waitcnt lgkmcnt(8)
 v_mfma_f32_16x16x32_bf16 v[128:131], v[56:59], a[128:131], v[128:131]
 ds_read_b64_tr_b16 v[88:89], v40 offset:160
 ds_read_b64_tr_b16 v[90:91], v40 offset:4768
 v_mfma_f32_16x16x32_bf16 v[128:131], v[60:63], a[132:135], v[128:131]
 buffer_load_dwordx4 v2, s[12:15], s87 offen offset:3072 sc1 lds
 v_mfma_f32_16x16x32_bf16 v[128:131], v[64:67], a[136:139], v[128:131]
 s_mov_b32 s87, 376832
 ds_read_b64_tr_b16 v[92:93], v40 offset:9376
 ds_read_b64_tr_b16 v[94:95], v40 offset:13984
 v_mfma_f32_16x16x32_bf16 v[128:131], v[68:71], a[140:143], v[128:131]
 s_add_u32 m0, s60, 45056
 v_mfma_f32_16x16x32_bf16 v[132:135], v[56:59], a[144:147], v[132:135]
 ds_read_b64_tr_b16 v[96:97], v40 offset:18592
 ds_read_b64_tr_b16 v[98:99], v40 offset:23200
 v_mfma_f32_16x16x32_bf16 v[132:135], v[60:63], a[148:151], v[132:135]
 buffer_load_dwordx4 v2, s[12:15], s87 offen offset:0 sc1 lds
 v_mfma_f32_16x16x32_bf16 v[132:135], v[64:67], a[152:155], v[132:135]
 s_mov_b32 s88, 8192
 ds_read_b64_tr_b16 v[100:101], v40 offset:27808
 ds_read_b64_tr_b16 v[102:103], v40 offset:32416
 v_mfma_f32_16x16x32_bf16 v[132:135], v[68:71], a[156:159], v[132:135]
 s_waitcnt lgkmcnt(8)
 v_mfma_f32_16x16x32_bf16 v[136:139], v[72:75], a[128:131], v[136:139]
 ds_read_b64_tr_b16 v[56:57], v40 offset:192
 ds_read_b64_tr_b16 v[58:59], v40 offset:4800
 v_mfma_f32_16x16x32_bf16 v[136:139], v[76:79], a[132:135], v[136:139]
 buffer_load_dwordx4 a[224:227], v2, s[24:27], s88 offen offset:0 sc1
 v_mfma_f32_16x16x32_bf16 v[136:139], v[80:83], a[136:139], v[136:139]
 ds_read_b64_tr_b16 v[60:61], v40 offset:9408
 ds_read_b64_tr_b16 v[62:63], v40 offset:14016
 v_mfma_f32_16x16x32_bf16 v[136:139], v[84:87], a[140:143], v[136:139]
 v_mfma_f32_16x16x32_bf16 v[140:143], v[72:75], a[144:147], v[140:143]
 ds_read_b64_tr_b16 v[64:65], v40 offset:18624
 ds_read_b64_tr_b16 v[66:67], v40 offset:23232
 v_mfma_f32_16x16x32_bf16 v[140:143], v[76:79], a[148:151], v[140:143]
 buffer_load_dwordx4 a[228:231], v2, s[24:27], s88 offen offset:1024 sc1
 v_mfma_f32_16x16x32_bf16 v[140:143], v[80:83], a[152:155], v[140:143]
 ds_read_b64_tr_b16 v[68:69], v40 offset:27840
 ds_read_b64_tr_b16 v[70:71], v40 offset:32448
 v_mfma_f32_16x16x32_bf16 v[140:143], v[84:87], a[156:159], v[140:143]
 s_waitcnt lgkmcnt(8)
 v_mfma_f32_16x16x32_bf16 v[144:147], v[88:91], a[128:131], v[144:147]
 ds_read_b64_tr_b16 v[72:73], v40 offset:224
 ds_read_b64_tr_b16 v[74:75], v40 offset:4832
 v_mfma_f32_16x16x32_bf16 v[144:147], v[92:95], a[132:135], v[144:147]
 buffer_load_dwordx4 a[232:235], v2, s[24:27], s88 offen offset:2048 sc1
 v_mfma_f32_16x16x32_bf16 v[144:147], v[96:99], a[136:139], v[144:147]
 ds_read_b64_tr_b16 v[76:77], v40 offset:9440
 ds_read_b64_tr_b16 v[78:79], v40 offset:14048
 v_mfma_f32_16x16x32_bf16 v[144:147], v[100:103], a[140:143], v[144:147]
 v_mfma_f32_16x16x32_bf16 v[148:151], v[88:91], a[144:147], v[148:151]
 ds_read_b64_tr_b16 v[80:81], v40 offset:18656
 ds_read_b64_tr_b16 v[82:83], v40 offset:23264
 v_mfma_f32_16x16x32_bf16 v[148:151], v[92:95], a[148:151], v[148:151]
 buffer_load_dwordx4 a[236:239], v2, s[24:27], s88 offen offset:3072 sc1
 v_mfma_f32_16x16x32_bf16 v[148:151], v[96:99], a[152:155], v[148:151]
 s_mov_b32 s89, 140544
 ds_read_b64_tr_b16 v[84:85], v40 offset:27872
 ds_read_b64_tr_b16 v[86:87], v40 offset:32480
 v_mfma_f32_16x16x32_bf16 v[148:151], v[100:103], a[156:159], v[148:151]
 s_waitcnt lgkmcnt(8)
 v_mfma_f32_16x16x32_bf16 v[152:155], v[56:59], a[128:131], v[152:155]
 ds_read_b64_tr_b16 v[88:89], v40 offset:256
 ds_read_b64_tr_b16 v[90:91], v40 offset:4864
 v_mfma_f32_16x16x32_bf16 v[152:155], v[60:63], a[132:135], v[152:155]
 buffer_load_dwordx4 a[240:243], v2, s[24:27], s89 offen offset:0 sc1
 v_mfma_f32_16x16x32_bf16 v[152:155], v[64:67], a[136:139], v[152:155]
 ds_read_b64_tr_b16 v[92:93], v40 offset:9472
 ds_read_b64_tr_b16 v[94:95], v40 offset:14080
 v_mfma_f32_16x16x32_bf16 v[152:155], v[68:71], a[140:143], v[152:155]
 v_mfma_f32_16x16x32_bf16 v[156:159], v[56:59], a[144:147], v[156:159]
 ds_read_b64_tr_b16 v[96:97], v40 offset:18688
 ds_read_b64_tr_b16 v[98:99], v40 offset:23296
 v_mfma_f32_16x16x32_bf16 v[156:159], v[60:63], a[148:151], v[156:159]
 buffer_load_dwordx4 a[244:247], v2, s[24:27], s89 offen offset:1024 sc1
 v_mfma_f32_16x16x32_bf16 v[156:159], v[64:67], a[152:155], v[156:159]
 ds_read_b64_tr_b16 v[100:101], v40 offset:27904
 ds_read_b64_tr_b16 v[102:103], v40 offset:32512
 v_mfma_f32_16x16x32_bf16 v[156:159], v[68:71], a[156:159], v[156:159]
 s_waitcnt lgkmcnt(8)
 v_mfma_f32_16x16x32_bf16 v[160:163], v[72:75], a[128:131], v[160:163]
 v_mfma_f32_16x16x32_bf16 v[160:163], v[76:79], a[132:135], v[160:163]
 buffer_load_dwordx4 a[248:251], v2, s[24:27], s89 offen offset:2048 sc1
 v_mfma_f32_16x16x32_bf16 v[160:163], v[80:83], a[136:139], v[160:163]
 s_waitcnt vmcnt(32) lgkmcnt(0)
 v_mfma_f32_16x16x32_bf16 v[160:163], v[84:87], a[140:143], v[160:163]
 s_barrier
 v_mfma_f32_16x16x32_bf16 v[164:167], v[72:75], a[144:147], v[164:167]
 ds_read_b64_tr_b16 v[56:57], v41 offset:0
 ds_read_b64_tr_b16 v[58:59], v41 offset:4608
 v_mfma_f32_16x16x32_bf16 v[164:167], v[76:79], a[148:151], v[164:167]
 ds_read_b64_tr_b16 v[60:61], v41 offset:9216
 ds_read_b64_tr_b16 v[62:63], v41 offset:13824
 v_mfma_f32_16x16x32_bf16 v[164:167], v[80:83], a[152:155], v[164:167]
 ds_read_b64_tr_b16 v[64:65], v41 offset:18432
 ds_read_b64_tr_b16 v[66:67], v41 offset:23040
 v_mfma_f32_16x16x32_bf16 v[164:167], v[84:87], a[156:159], v[164:167]
 ds_read_b64_tr_b16 v[68:69], v41 offset:27648
 ds_read_b64_tr_b16 v[70:71], v41 offset:32256
 v_mfma_f32_16x16x32_bf16 v[168:171], v[88:91], a[128:131], v[168:171]
 ds_read_b64_tr_b16 v[72:73], v41 offset:32
 ds_read_b64_tr_b16 v[74:75], v41 offset:4640
 v_mfma_f32_16x16x32_bf16 v[168:171], v[92:95], a[132:135], v[168:171]
 buffer_load_dwordx4 a[252:255], v2, s[24:27], s89 offen offset:3072 sc1
 v_mfma_f32_16x16x32_bf16 v[168:171], v[96:99], a[136:139], v[168:171]
 s_mov_b32 s87, 405504
 ds_read_b64_tr_b16 v[76:77], v41 offset:9248
 ds_read_b64_tr_b16 v[78:79], v41 offset:13856
 v_mfma_f32_16x16x32_bf16 v[168:171], v[100:103], a[140:143], v[168:171]
 s_add_u32 m0, s60, 73728
 v_mfma_f32_16x16x32_bf16 v[172:175], v[88:91], a[144:147], v[172:175]
 ds_read_b64_tr_b16 v[80:81], v41 offset:18464
 ds_read_b64_tr_b16 v[82:83], v41 offset:23072
 v_mfma_f32_16x16x32_bf16 v[172:175], v[92:95], a[148:151], v[172:175]
 buffer_load_dwordx4 v2, s[12:15], s87 offen offset:0 sc1 lds
 v_mfma_f32_16x16x32_bf16 v[172:175], v[96:99], a[152:155], v[172:175]
 ds_read_b64_tr_b16 v[84:85], v41 offset:27680
 ds_read_b64_tr_b16 v[86:87], v41 offset:32288
 v_mfma_f32_16x16x32_bf16 v[172:175], v[100:103], a[156:159], v[172:175]
 s_waitcnt vmcnt(26) lgkmcnt(8)
 v_mfma_f32_16x16x32_bf16 v[176:179], v[56:59], a[160:163], 0
 s_mov_b32 s79, 9437184
 ds_read_b64_tr_b16 v[88:89], v41 offset:64
 ds_read_b64_tr_b16 v[90:91], v41 offset:4672
 v_cvt_pk_bf16_f32 v4, v104, v105
 v_mfma_f32_16x16x32_bf16 v[176:179], v[60:63], a[164:167], v[176:179]
 buffer_load_dwordx4 v2, s[12:15], s87 offen offset:1024 sc1 lds
 v_cvt_pk_bf16_f32 v5, v106, v107
 v_mfma_f32_16x16x32_bf16 v[176:179], v[64:67], a[168:171], v[176:179]
 ds_read_b64_tr_b16 v[92:93], v41 offset:9280
 ds_read_b64_tr_b16 v[94:95], v41 offset:13888
 v_cvt_pk_bf16_f32 v6, v108, v109
 v_mfma_f32_16x16x32_bf16 v[176:179], v[68:71], a[172:175], v[176:179]
 v_cvt_pk_bf16_f32 v7, v110, v111
 v_cvt_pk_bf16_f32 v8, v112, v113
 v_cvt_pk_bf16_f32 v9, v114, v115
 v_mfma_f32_16x16x32_bf16 v[180:183], v[56:59], a[176:179], 0
 ds_read_b64_tr_b16 v[96:97], v41 offset:18496
 ds_read_b64_tr_b16 v[98:99], v41 offset:23104
 v_cvt_pk_bf16_f32 v10, v116, v117
 v_mfma_f32_16x16x32_bf16 v[180:183], v[60:63], a[180:183], v[180:183]
 buffer_store_dwordx4 v[4:7], v2, s[36:39], s79 offen offset:0 sc1
 v_cvt_pk_bf16_f32 v11, v118, v119
 v_mfma_f32_16x16x32_bf16 v[180:183], v[64:67], a[184:187], v[180:183]
 ds_read_b64_tr_b16 v[100:101], v41 offset:27712
 ds_read_b64_tr_b16 v[102:103], v41 offset:32320
 v_cvt_pk_bf16_f32 v12, v120, v121
 v_mfma_f32_16x16x32_bf16 v[180:183], v[68:71], a[188:191], v[180:183]
 s_waitcnt lgkmcnt(8)
 v_cvt_pk_bf16_f32 v13, v122, v123
 v_cvt_pk_bf16_f32 v14, v124, v125
 v_cvt_pk_bf16_f32 v15, v126, v127
 v_mfma_f32_16x16x32_bf16 v[184:187], v[72:75], a[160:163], 0
 ds_read_b64_tr_b16 v[56:57], v41 offset:96
 ds_read_b64_tr_b16 v[58:59], v41 offset:4704
 v_mfma_f32_16x16x32_bf16 v[184:187], v[76:79], a[164:167], v[184:187]
 buffer_store_dwordx4 v[8:11], v2, s[36:39], s79 offen offset:1024 sc1
 v_cvt_pk_bf16_f32 v4, v128, v129
 v_mfma_f32_16x16x32_bf16 v[184:187], v[80:83], a[168:171], v[184:187]
 ds_read_b64_tr_b16 v[60:61], v41 offset:9312
 ds_read_b64_tr_b16 v[62:63], v41 offset:13920
 v_cvt_pk_bf16_f32 v5, v130, v131
 v_mfma_f32_16x16x32_bf16 v[184:187], v[84:87], a[172:175], v[184:187]
 v_cvt_pk_bf16_f32 v6, v132, v133
 v_cvt_pk_bf16_f32 v7, v134, v135
 v_mfma_f32_16x16x32_bf16 v[188:191], v[72:75], a[176:179], 0
 ds_read_b64_tr_b16 v[64:65], v41 offset:18528
 ds_read_b64_tr_b16 v[66:67], v41 offset:23136
 v_mfma_f32_16x16x32_bf16 v[188:191], v[76:79], a[180:183], v[188:191]
 s_mov_b32 s80, 9441280
 buffer_store_dwordx4 v[12:15], v2, s[36:39], s79 offen offset:2048 sc1
 v_cvt_pk_bf16_f32 v8, v136, v137
 v_mfma_f32_16x16x32_bf16 v[188:191], v[80:83], a[184:187], v[188:191]
 ds_read_b64_tr_b16 v[68:69], v41 offset:27744
 ds_read_b64_tr_b16 v[70:71], v41 offset:32352
 v_cvt_pk_bf16_f32 v9, v138, v139
 v_mfma_f32_16x16x32_bf16 v[188:191], v[84:87], a[188:191], v[188:191]
 s_waitcnt lgkmcnt(8)
 v_cvt_pk_bf16_f32 v10, v140, v141
 v_cvt_pk_bf16_f32 v11, v142, v143
 v_mfma_f32_16x16x32_bf16 v[192:195], v[88:91], a[160:163], 0
 ds_read_b64_tr_b16 v[72:73], v41 offset:128
 ds_read_b64_tr_b16 v[74:75], v41 offset:4736
 v_mfma_f32_16x16x32_bf16 v[192:195], v[92:95], a[164:167], v[192:195]
 buffer_store_dwordx4 v[4:7], v2, s[36:39], s79 offen offset:3072 sc1
 v_cvt_pk_bf16_f32 v12, v144, v145
 v_mfma_f32_16x16x32_bf16 v[192:195], v[96:99], a[168:171], v[192:195]
 ds_read_b64_tr_b16 v[76:77], v41 offset:9344
 ds_read_b64_tr_b16 v[78:79], v41 offset:13952
 v_cvt_pk_bf16_f32 v13, v146, v147
 v_mfma_f32_16x16x32_bf16 v[192:195], v[100:103], a[172:175], v[192:195]
 v_cvt_pk_bf16_f32 v14, v148, v149
 v_cvt_pk_bf16_f32 v15, v150, v151
 v_mfma_f32_16x16x32_bf16 v[196:199], v[88:91], a[176:179], 0
 ds_read_b64_tr_b16 v[80:81], v41 offset:18560
 ds_read_b64_tr_b16 v[82:83], v41 offset:23168
 v_mfma_f32_16x16x32_bf16 v[196:199], v[92:95], a[180:183], v[196:199]
 buffer_store_dwordx4 v[8:11], v2, s[36:39], s80 offen offset:0 sc1
 v_mfma_f32_16x16x32_bf16 v[196:199], v[96:99], a[184:187], v[196:199]
 ds_read_b64_tr_b16 v[84:85], v41 offset:27776
 ds_read_b64_tr_b16 v[86:87], v41 offset:32384
 v_mfma_f32_16x16x32_bf16 v[196:199], v[100:103], a[188:191], v[196:199]
 s_waitcnt lgkmcnt(8)
 v_mfma_f32_16x16x32_bf16 v[200:203], v[56:59], a[160:163], 0
 ds_read_b64_tr_b16 v[88:89], v41 offset:160
 ds_read_b64_tr_b16 v[90:91], v41 offset:4768
 v_mfma_f32_16x16x32_bf16 v[200:203], v[60:63], a[164:167], v[200:203]
 buffer_store_dwordx4 v[12:15], v2, s[36:39], s80 offen offset:1024 sc1
 v_mfma_f32_16x16x32_bf16 v[200:203], v[64:67], a[168:171], v[200:203]
 ds_read_b64_tr_b16 v[92:93], v41 offset:9376
 ds_read_b64_tr_b16 v[94:95], v41 offset:13984
 v_mfma_f32_16x16x32_bf16 v[200:203], v[68:71], a[172:175], v[200:203]
 v_mfma_f32_16x16x32_bf16 v[204:207], v[56:59], a[176:179], 0
 ds_read_b64_tr_b16 v[96:97], v41 offset:18592
 ds_read_b64_tr_b16 v[98:99], v41 offset:23200
 v_mfma_f32_16x16x32_bf16 v[204:207], v[60:63], a[180:183], v[204:207]
 buffer_load_dwordx4 v2, s[12:15], s87 offen offset:2048 sc1 lds
 v_mfma_f32_16x16x32_bf16 v[204:207], v[64:67], a[184:187], v[204:207]
 ds_read_b64_tr_b16 v[100:101], v41 offset:27808
 ds_read_b64_tr_b16 v[102:103], v41 offset:32416
 v_mfma_f32_16x16x32_bf16 v[204:207], v[68:71], a[188:191], v[204:207]
 s_waitcnt lgkmcnt(8)
 v_mfma_f32_16x16x32_bf16 v[208:211], v[72:75], a[160:163], 0
 ds_read_b64_tr_b16 v[56:57], v41 offset:192
 ds_read_b64_tr_b16 v[58:59], v41 offset:4800
 v_mfma_f32_16x16x32_bf16 v[208:211], v[76:79], a[164:167], v[208:211]
 buffer_load_dwordx4 v2, s[12:15], s87 offen offset:3072 sc1 lds
 v_mfma_f32_16x16x32_bf16 v[208:211], v[80:83], a[168:171], v[208:211]
 s_mov_b32 s87, 409600
 ds_read_b64_tr_b16 v[60:61], v41 offset:9408
 ds_read_b64_tr_b16 v[62:63], v41 offset:14016
 v_mfma_f32_16x16x32_bf16 v[208:211], v[84:87], a[172:175], v[208:211]
 s_add_u32 m0, s60, 77824
 v_mfma_f32_16x16x32_bf16 v[212:215], v[72:75], a[176:179], 0
 ds_read_b64_tr_b16 v[64:65], v41 offset:18624
 ds_read_b64_tr_b16 v[66:67], v41 offset:23232
 v_mfma_f32_16x16x32_bf16 v[212:215], v[76:79], a[180:183], v[212:215]
 buffer_load_dwordx4 v2, s[12:15], s87 offen offset:0 sc1 lds
 v_mfma_f32_16x16x32_bf16 v[212:215], v[80:83], a[184:187], v[212:215]
 ds_read_b64_tr_b16 v[68:69], v41 offset:27840
 ds_read_b64_tr_b16 v[70:71], v41 offset:32448
 v_mfma_f32_16x16x32_bf16 v[212:215], v[84:87], a[188:191], v[212:215]
 s_waitcnt lgkmcnt(8)
 v_mfma_f32_16x16x32_bf16 v[216:219], v[88:91], a[160:163], 0
 ds_read_b64_tr_b16 v[72:73], v41 offset:224
 ds_read_b64_tr_b16 v[74:75], v41 offset:4832
 v_mfma_f32_16x16x32_bf16 v[216:219], v[92:95], a[164:167], v[216:219]
 buffer_load_dwordx4 v2, s[12:15], s87 offen offset:1024 sc1 lds
 v_mfma_f32_16x16x32_bf16 v[216:219], v[96:99], a[168:171], v[216:219]
 ds_read_b64_tr_b16 v[76:77], v41 offset:9440
 ds_read_b64_tr_b16 v[78:79], v41 offset:14048
 v_mfma_f32_16x16x32_bf16 v[216:219], v[100:103], a[172:175], v[216:219]
 v_mfma_f32_16x16x32_bf16 v[220:223], v[88:91], a[176:179], 0
 ds_read_b64_tr_b16 v[80:81], v41 offset:18656
 ds_read_b64_tr_b16 v[82:83], v41 offset:23264
 v_mfma_f32_16x16x32_bf16 v[220:223], v[92:95], a[180:183], v[220:223]
 buffer_load_dwordx4 v2, s[12:15], s87 offen offset:2048 sc1 lds
 v_mfma_f32_16x16x32_bf16 v[220:223], v[96:99], a[184:187], v[220:223]
 ds_read_b64_tr_b16 v[84:85], v41 offset:27872
 ds_read_b64_tr_b16 v[86:87], v41 offset:32480
 v_mfma_f32_16x16x32_bf16 v[220:223], v[100:103], a[188:191], v[220:223]
 s_waitcnt lgkmcnt(8)
 v_mfma_f32_16x16x32_bf16 v[224:227], v[56:59], a[160:163], 0
 ds_read_b64_tr_b16 v[88:89], v41 offset:256
 ds_read_b64_tr_b16 v[90:91], v41 offset:4864
 v_mfma_f32_16x16x32_bf16 v[224:227], v[60:63], a[164:167], v[224:227]
 buffer_load_dwordx4 v2, s[12:15], s87 offen offset:3072 sc1 lds
 v_mfma_f32_16x16x32_bf16 v[224:227], v[64:67], a[168:171], v[224:227]
 s_mov_b32 s87, 413696
 ds_read_b64_tr_b16 v[92:93], v41 offset:9472
 ds_read_b64_tr_b16 v[94:95], v41 offset:14080
 v_mfma_f32_16x16x32_bf16 v[224:227], v[68:71], a[172:175], v[224:227]
 s_add_u32 m0, s60, 81920
 v_mfma_f32_16x16x32_bf16 v[228:231], v[56:59], a[176:179], 0
 ds_read_b64_tr_b16 v[96:97], v41 offset:18688
 ds_read_b64_tr_b16 v[98:99], v41 offset:23296
 v_mfma_f32_16x16x32_bf16 v[228:231], v[60:63], a[180:183], v[228:231]
 buffer_load_dwordx4 v2, s[12:15], s87 offen offset:0 sc1 lds
 v_mfma_f32_16x16x32_bf16 v[228:231], v[64:67], a[184:187], v[228:231]
 ds_read_b64_tr_b16 v[100:101], v41 offset:27904
 ds_read_b64_tr_b16 v[102:103], v41 offset:32512
 v_mfma_f32_16x16x32_bf16 v[228:231], v[68:71], a[188:191], v[228:231]
 s_waitcnt lgkmcnt(8)
 v_mfma_f32_16x16x32_bf16 v[232:235], v[72:75], a[160:163], 0
 v_mfma_f32_16x16x32_bf16 v[232:235], v[76:79], a[164:167], v[232:235]
 v_mfma_f32_16x16x32_bf16 v[232:235], v[80:83], a[168:171], v[232:235]
 s_waitcnt vmcnt(23) lgkmcnt(0)
 v_mfma_f32_16x16x32_bf16 v[232:235], v[84:87], a[172:175], v[232:235]
 s_barrier
 v_mfma_f32_16x16x32_bf16 v[236:239], v[72:75], a[176:179], 0
 ds_read_b64_tr_b16 v[56:57], v42 offset:0
 ds_read_b64_tr_b16 v[58:59], v42 offset:4608
 v_mfma_f32_16x16x32_bf16 v[236:239], v[76:79], a[180:183], v[236:239]
 ds_read_b64_tr_b16 v[60:61], v42 offset:9216
 ds_read_b64_tr_b16 v[62:63], v42 offset:13824
 v_mfma_f32_16x16x32_bf16 v[236:239], v[80:83], a[184:187], v[236:239]
 ds_read_b64_tr_b16 v[64:65], v42 offset:18432
 ds_read_b64_tr_b16 v[66:67], v42 offset:23040
 v_mfma_f32_16x16x32_bf16 v[236:239], v[84:87], a[188:191], v[236:239]
 ds_read_b64_tr_b16 v[68:69], v42 offset:27648
 ds_read_b64_tr_b16 v[70:71], v42 offset:32256
 v_mfma_f32_16x16x32_bf16 v[240:243], v[88:91], a[160:163], 0
 ds_read_b64_tr_b16 v[72:73], v42 offset:32
 ds_read_b64_tr_b16 v[74:75], v42 offset:4640
 v_mfma_f32_16x16x32_bf16 v[240:243], v[92:95], a[164:167], v[240:243]
 v_mfma_f32_16x16x32_bf16 v[240:243], v[96:99], a[168:171], v[240:243]
 ds_read_b64_tr_b16 v[76:77], v42 offset:9248
 ds_read_b64_tr_b16 v[78:79], v42 offset:13856
 v_mfma_f32_16x16x32_bf16 v[240:243], v[100:103], a[172:175], v[240:243]
 v_mfma_f32_16x16x32_bf16 v[244:247], v[88:91], a[176:179], 0
 ds_read_b64_tr_b16 v[80:81], v42 offset:18464
 ds_read_b64_tr_b16 v[82:83], v42 offset:23072
 v_mfma_f32_16x16x32_bf16 v[244:247], v[92:95], a[180:183], v[244:247]
 v_mfma_f32_16x16x32_bf16 v[244:247], v[96:99], a[184:187], v[244:247]
 ds_read_b64_tr_b16 v[84:85], v42 offset:27680
 ds_read_b64_tr_b16 v[86:87], v42 offset:32288
 v_mfma_f32_16x16x32_bf16 v[244:247], v[100:103], a[188:191], v[244:247]
 s_waitcnt lgkmcnt(8)
 v_mfma_f32_16x16x32_bf16 v[176:179], v[56:59], a[192:195], v[176:179]
 s_mov_b32 s87, 442368
 ds_read_b64_tr_b16 v[88:89], v42 offset:64
 ds_read_b64_tr_b16 v[90:91], v42 offset:4672
 v_cvt_pk_bf16_f32 v4, v152, v153
 v_mfma_f32_16x16x32_bf16 v[176:179], v[60:63], a[196:199], v[176:179]
 s_add_u32 m0, s60, 0
 buffer_load_dword v255, v254, s[32:35], s66 offen sc1
 v_cvt_pk_bf16_f32 v5, v154, v155
 v_mfma_f32_16x16x32_bf16 v[176:179], v[64:67], a[200:203], v[176:179]
 ds_read_b64_tr_b16 v[92:93], v42 offset:9280
 ds_read_b64_tr_b16 v[94:95], v42 offset:13888
 v_cvt_pk_bf16_f32 v6, v156, v157
 v_mfma_f32_16x16x32_bf16 v[176:179], v[68:71], a[204:207], v[176:179]
 v_cvt_pk_bf16_f32 v7, v158, v159
 v_cvt_pk_bf16_f32 v8, v160, v161
 v_cvt_pk_bf16_f32 v9, v162, v163
 v_mfma_f32_16x16x32_bf16 v[180:183], v[56:59], a[208:211], v[180:183]
 ds_read_b64_tr_b16 v[96:97], v42 offset:18496
 ds_read_b64_tr_b16 v[98:99], v42 offset:23104
 v_cvt_pk_bf16_f32 v10, v164, v165
 v_mfma_f32_16x16x32_bf16 v[180:183], v[60:63], a[212:215], v[180:183]
 buffer_store_dwordx4 v[4:7], v2, s[36:39], s80 offen offset:2048 sc1
 v_cvt_pk_bf16_f32 v11, v166, v167
 v_mfma_f32_16x16x32_bf16 v[180:183], v[64:67], a[216:219], v[180:183]
 s_mov_b32 s81, 9445376
 ds_read_b64_tr_b16 v[100:101], v42 offset:27712
 ds_read_b64_tr_b16 v[102:103], v42 offset:32320
 v_cvt_pk_bf16_f32 v12, v168, v169
 v_mfma_f32_16x16x32_bf16 v[180:183], v[68:71], a[220:223], v[180:183]
 s_waitcnt lgkmcnt(8)
 v_cvt_pk_bf16_f32 v13, v170, v171
 v_cvt_pk_bf16_f32 v14, v172, v173
 v_cvt_pk_bf16_f32 v15, v174, v175
 v_mfma_f32_16x16x32_bf16 v[184:187], v[72:75], a[192:195], v[184:187]
 ds_read_b64_tr_b16 v[56:57], v42 offset:96
 ds_read_b64_tr_b16 v[58:59], v42 offset:4704
 v_mfma_f32_16x16x32_bf16 v[184:187], v[76:79], a[196:199], v[184:187]
 buffer_store_dwordx4 v[8:11], v2, s[36:39], s80 offen offset:3072 sc1
 v_mfma_f32_16x16x32_bf16 v[184:187], v[80:83], a[200:203], v[184:187]
 ds_read_b64_tr_b16 v[60:61], v42 offset:9312
 ds_read_b64_tr_b16 v[62:63], v42 offset:13920
 v_mfma_f32_16x16x32_bf16 v[184:187], v[84:87], a[204:207], v[184:187]
 v_mfma_f32_16x16x32_bf16 v[188:191], v[72:75], a[208:211], v[188:191]
 ds_read_b64_tr_b16 v[64:65], v42 offset:18528
 ds_read_b64_tr_b16 v[66:67], v42 offset:23136
 v_mfma_f32_16x16x32_bf16 v[188:191], v[76:79], a[212:215], v[188:191]
 buffer_store_dwordx4 v[12:15], v2, s[36:39], s81 offen offset:0 sc1
 v_mfma_f32_16x16x32_bf16 v[188:191], v[80:83], a[216:219], v[188:191]
 ds_read_b64_tr_b16 v[68:69], v42 offset:27744
 ds_read_b64_tr_b16 v[70:71], v42 offset:32352
 v_mfma_f32_16x16x32_bf16 v[188:191], v[84:87], a[220:223], v[188:191]
 s_waitcnt lgkmcnt(8)
 v_mfma_f32_16x16x32_bf16 v[192:195], v[88:91], a[192:195], v[192:195]
 ds_read_b64_tr_b16 v[72:73], v42 offset:128
 ds_read_b64_tr_b16 v[74:75], v42 offset:4736
 v_mfma_f32_16x16x32_bf16 v[192:195], v[92:95], a[196:199], v[192:195]
 buffer_load_dwordx4 v2, s[12:15], s87 offen offset:0 sc1 lds
 v_mfma_f32_16x16x32_bf16 v[192:195], v[96:99], a[200:203], v[192:195]
 ds_read_b64_tr_b16 v[76:77], v42 offset:9344
 ds_read_b64_tr_b16 v[78:79], v42 offset:13952
 v_mfma_f32_16x16x32_bf16 v[192:195], v[100:103], a[204:207], v[192:195]
 v_mfma_f32_16x16x32_bf16 v[196:199], v[88:91], a[208:211], v[196:199]
 ds_read_b64_tr_b16 v[80:81], v42 offset:18560
 ds_read_b64_tr_b16 v[82:83], v42 offset:23168
 v_mfma_f32_16x16x32_bf16 v[196:199], v[92:95], a[212:215], v[196:199]
 buffer_load_dwordx4 v2, s[12:15], s87 offen offset:1024 sc1 lds
 v_mfma_f32_16x16x32_bf16 v[196:199], v[96:99], a[216:219], v[196:199]
 ds_read_b64_tr_b16 v[84:85], v42 offset:27776
 ds_read_b64_tr_b16 v[86:87], v42 offset:32384
 v_mfma_f32_16x16x32_bf16 v[196:199], v[100:103], a[220:223], v[196:199]
 s_waitcnt lgkmcnt(8)
 v_mfma_f32_16x16x32_bf16 v[200:203], v[56:59], a[192:195], v[200:203]
 ds_read_b64_tr_b16 v[88:89], v42 offset:160
 ds_read_b64_tr_b16 v[90:91], v42 offset:4768
 v_mfma_f32_16x16x32_bf16 v[200:203], v[60:63], a[196:199], v[200:203]
 buffer_load_dwordx4 v2, s[12:15], s87 offen offset:2048 sc1 lds
 v_mfma_f32_16x16x32_bf16 v[200:203], v[64:67], a[200:203], v[200:203]
 ds_read_b64_tr_b16 v[92:93], v42 offset:9376
 ds_read_b64_tr_b16 v[94:95], v42 offset:13984
 v_mfma_f32_16x16x32_bf16 v[200:203], v[68:71], a[204:207], v[200:203]
 v_mfma_f32_16x16x32_bf16 v[204:207], v[56:59], a[208:211], v[204:207]
 ds_read_b64_tr_b16 v[96:97], v42 offset:18592
 ds_read_b64_tr_b16 v[98:99], v42 offset:23200
 v_mfma_f32_16x16x32_bf16 v[204:207], v[60:63], a[212:215], v[204:207]
 buffer_load_dwordx4 v2, s[12:15], s87 offen offset:3072 sc1 lds
 v_mfma_f32_16x16x32_bf16 v[204:207], v[64:67], a[216:219], v[204:207]
 s_mov_b32 s87, 446464
 ds_read_b64_tr_b16 v[100:101], v42 offset:27808
 ds_read_b64_tr_b16 v[102:103], v42 offset:32416
 v_mfma_f32_16x16x32_bf16 v[204:207], v[68:71], a[220:223], v[204:207]
 s_waitcnt lgkmcnt(8)
 v_mfma_f32_16x16x32_bf16 v[208:211], v[72:75], a[192:195], v[208:211]
 s_add_u32 m0, s60, 4096
 ds_read_b64_tr_b16 v[56:57], v42 offset:192
 ds_read_b64_tr_b16 v[58:59], v42 offset:4800
 v_mfma_f32_16x16x32_bf16 v[208:211], v[76:79], a[196:199], v[208:211]
 buffer_load_dwordx4 v2, s[12:15], s87 offen offset:0 sc1 lds
 v_mfma_f32_16x16x32_bf16 v[208:211], v[80:83], a[200:203], v[208:211]
 ds_read_b64_tr_b16 v[60:61], v42 offset:9408
 ds_read_b64_tr_b16 v[62:63], v42 offset:14016
 v_mfma_f32_16x16x32_bf16 v[208:211], v[84:87], a[204:207], v[208:211]
 v_mfma_f32_16x16x32_bf16 v[212:215], v[72:75], a[208:211], v[212:215]
 ds_read_b64_tr_b16 v[64:65], v42 offset:18624
 ds_read_b64_tr_b16 v[66:67], v42 offset:23232
 v_mfma_f32_16x16x32_bf16 v[212:215], v[76:79], a[212:215], v[212:215]
 buffer_load_dwordx4 v2, s[12:15], s87 offen offset:1024 sc1 lds
 v_mfma_f32_16x16x32_bf16 v[212:215], v[80:83], a[216:219], v[212:215]
 ds_read_b64_tr_b16 v[68:69], v42 offset:27840
 ds_read_b64_tr_b16 v[70:71], v42 offset:32448
 v_mfma_f32_16x16x32_bf16 v[212:215], v[84:87], a[220:223], v[212:215]
 s_waitcnt lgkmcnt(8)
 v_mfma_f32_16x16x32_bf16 v[216:219], v[88:91], a[192:195], v[216:219]
 ds_read_b64_tr_b16 v[72:73], v42 offset:224
 ds_read_b64_tr_b16 v[74:75], v42 offset:4832
 v_mfma_f32_16x16x32_bf16 v[216:219], v[92:95], a[196:199], v[216:219]
 buffer_load_dwordx4 v2, s[12:15], s87 offen offset:2048 sc1 lds
 v_mfma_f32_16x16x32_bf16 v[216:219], v[96:99], a[200:203], v[216:219]
 ds_read_b64_tr_b16 v[76:77], v42 offset:9440
 ds_read_b64_tr_b16 v[78:79], v42 offset:14048
 v_mfma_f32_16x16x32_bf16 v[216:219], v[100:103], a[204:207], v[216:219]
 v_mfma_f32_16x16x32_bf16 v[220:223], v[88:91], a[208:211], v[220:223]
 ds_read_b64_tr_b16 v[80:81], v42 offset:18656
 ds_read_b64_tr_b16 v[82:83], v42 offset:23264
 v_mfma_f32_16x16x32_bf16 v[220:223], v[92:95], a[212:215], v[220:223]
 buffer_load_dwordx4 v2, s[12:15], s87 offen offset:3072 sc1 lds
 v_mfma_f32_16x16x32_bf16 v[220:223], v[96:99], a[216:219], v[220:223]
 s_mov_b32 s87, 450560
 ds_read_b64_tr_b16 v[84:85], v42 offset:27872
 ds_read_b64_tr_b16 v[86:87], v42 offset:32480
 v_mfma_f32_16x16x32_bf16 v[220:223], v[100:103], a[220:223], v[220:223]
 s_waitcnt lgkmcnt(8)
 v_mfma_f32_16x16x32_bf16 v[224:227], v[56:59], a[192:195], v[224:227]
 s_add_u32 m0, s60, 8192
 ds_read_b64_tr_b16 v[88:89], v42 offset:256
 ds_read_b64_tr_b16 v[90:91], v42 offset:4864
 v_mfma_f32_16x16x32_bf16 v[224:227], v[60:63], a[196:199], v[224:227]
 buffer_load_dwordx4 v2, s[12:15], s87 offen offset:0 sc1 lds
 v_mfma_f32_16x16x32_bf16 v[224:227], v[64:67], a[200:203], v[224:227]
 s_mov_b32 s88, 12288
 ds_read_b64_tr_b16 v[92:93], v42 offset:9472
 ds_read_b64_tr_b16 v[94:95], v42 offset:14080
 v_mfma_f32_16x16x32_bf16 v[224:227], v[68:71], a[204:207], v[224:227]
 v_mfma_f32_16x16x32_bf16 v[228:231], v[56:59], a[208:211], v[228:231]
 ds_read_b64_tr_b16 v[96:97], v42 offset:18688
 ds_read_b64_tr_b16 v[98:99], v42 offset:23296
 v_mfma_f32_16x16x32_bf16 v[228:231], v[60:63], a[212:215], v[228:231]
 buffer_load_dwordx4 a[128:131], v2, s[24:27], s88 offen offset:0 sc1
 v_mfma_f32_16x16x32_bf16 v[228:231], v[64:67], a[216:219], v[228:231]
 ds_read_b64_tr_b16 v[100:101], v42 offset:27904
 ds_read_b64_tr_b16 v[102:103], v42 offset:32512
 v_mfma_f32_16x16x32_bf16 v[228:231], v[68:71], a[220:223], v[228:231]
 s_waitcnt lgkmcnt(8)
 v_mfma_f32_16x16x32_bf16 v[232:235], v[72:75], a[192:195], v[232:235]
 buffer_load_dwordx4 a[132:135], v2, s[24:27], s88 offen offset:1024 sc1
 v_mfma_f32_16x16x32_bf16 v[232:235], v[76:79], a[196:199], v[232:235]
 v_mfma_f32_16x16x32_bf16 v[232:235], v[80:83], a[200:203], v[232:235]
 s_waitcnt vmcnt(15) lgkmcnt(0)
 v_mfma_f32_16x16x32_bf16 v[232:235], v[84:87], a[204:207], v[232:235]
 s_barrier
 buffer_load_dwordx4 a[136:139], v2, s[24:27], s88 offen offset:2048 sc1
 v_mfma_f32_16x16x32_bf16 v[236:239], v[72:75], a[208:211], v[236:239]
 ds_read_b64_tr_b16 v[56:57], v43 offset:0
 ds_read_b64_tr_b16 v[58:59], v43 offset:4608
 v_mfma_f32_16x16x32_bf16 v[236:239], v[76:79], a[212:215], v[236:239]
 ds_read_b64_tr_b16 v[60:61], v43 offset:9216
 ds_read_b64_tr_b16 v[62:63], v43 offset:13824
 v_mfma_f32_16x16x32_bf16 v[236:239], v[80:83], a[216:219], v[236:239]
 ds_read_b64_tr_b16 v[64:65], v43 offset:18432
 ds_read_b64_tr_b16 v[66:67], v43 offset:23040
 v_mfma_f32_16x16x32_bf16 v[236:239], v[84:87], a[220:223], v[236:239]
 ds_read_b64_tr_b16 v[68:69], v43 offset:27648
 ds_read_b64_tr_b16 v[70:71], v43 offset:32256
 v_mfma_f32_16x16x32_bf16 v[240:243], v[88:91], a[192:195], v[240:243]
 ds_read_b64_tr_b16 v[72:73], v43 offset:32
 ds_read_b64_tr_b16 v[74:75], v43 offset:4640
 v_mfma_f32_16x16x32_bf16 v[240:243], v[92:95], a[196:199], v[240:243]
 buffer_load_dwordx4 a[140:143], v2, s[24:27], s88 offen offset:3072 sc1
 v_mfma_f32_16x16x32_bf16 v[240:243], v[96:99], a[200:203], v[240:243]
 s_mov_b32 s89, 144640
 ds_read_b64_tr_b16 v[76:77], v43 offset:9248
 ds_read_b64_tr_b16 v[78:79], v43 offset:13856
 v_mfma_f32_16x16x32_bf16 v[240:243], v[100:103], a[204:207], v[240:243]
 v_mfma_f32_16x16x32_bf16 v[244:247], v[88:91], a[208:211], v[244:247]
 ds_read_b64_tr_b16 v[80:81], v43 offset:18464
 ds_read_b64_tr_b16 v[82:83], v43 offset:23072
 v_mfma_f32_16x16x32_bf16 v[244:247], v[92:95], a[212:215], v[244:247]
 buffer_load_dwordx4 a[144:147], v2, s[24:27], s89 offen offset:0 sc1
 v_mfma_f32_16x16x32_bf16 v[244:247], v[96:99], a[216:219], v[244:247]
 ds_read_b64_tr_b16 v[84:85], v43 offset:27680
 ds_read_b64_tr_b16 v[86:87], v43 offset:32288
 v_mfma_f32_16x16x32_bf16 v[244:247], v[100:103], a[220:223], v[244:247]
 s_waitcnt lgkmcnt(8)
 s_waitcnt vmcnt(17)
 v_cmp_ne_u32 vcc, s54, v255
 s_cbranch_vccnz L_spin_o1
L_ok_o1:
 v_mfma_f32_16x16x32_bf16 v[176:179], v[56:59], a[224:227], v[176:179]
 ds_read_b64_tr_b16 v[88:89], v43 offset:64
 ds_read_b64_tr_b16 v[90:91], v43 offset:4672
 v_and_b32 v254, 0x180, v254
 v_mfma_f32_16x16x32_bf16 v[176:179], v[60:63], a[228:231], v[176:179]
 s_andn2_b32 s66, s67, 0x1ff
 buffer_load_dwordx4 a[148:151], v2, s[24:27], s89 offen offset:1024 sc1
 v_mfma_f32_16x16x32_bf16 v[176:179], v[64:67], a[232:235], v[176:179]
 ds_read_b64_tr_b16 v[92:93], v43 offset:9280
 ds_read_b64_tr_b16 v[94:95], v43 offset:13888
 v_mfma_f32_16x16x32_bf16 v[176:179], v[68:71], a[236:239], v[176:179]
 v_mfma_f32_16x16x32_bf16 v[180:183], v[56:59], a[240:243], v[180:183]
 ds_read_b64_tr_b16 v[96:97], v43 offset:18496
 ds_read_b64_tr_b16 v[98:99], v43 offset:23104
 v_mfma_f32_16x16x32_bf16 v[180:183], v[60:63], a[244:247], v[180:183]
 buffer_load_dwordx4 a[152:155], v2, s[24:27], s89 offen offset:2048 sc1
 v_mfma_f32_16x16x32_bf16 v[180:183], v[64:67], a[248:251], v[180:183]
 ds_read_b64_tr_b16 v[100:101], v43 offset:27712
 ds_read_b64_tr_b16 v[102:103], v43 offset:32320
 v_mfma_f32_16x16x32_bf16 v[180:183], v[68:71], a[252:255], v[180:183]
 s_waitcnt lgkmcnt(8)
 v_mfma_f32_16x16x32_bf16 v[184:187], v[72:75], a[224:227], v[184:187]
 ds_read_b64_tr_b16 v[56:57], v43 offset:96
 ds_read_b64_tr_b16 v[58:59], v43 offset:4704
 v_mfma_f32_16x16x32_bf16 v[184:187], v[76:79], a[228:231], v[184:187]
 buffer_load_dwordx4 a[156:159], v2, s[24:27], s89 offen offset:3072 sc1
 v_mfma_f32_16x16x32_bf16 v[184:187], v[80:83], a[232:235], v[184:187]
 s_mov_b32 s87, 479232
 ds_read_b64_tr_b16 v[60:61], v43 offset:9312
 ds_read_b64_tr_b16 v[62:63], v43 offset:13920
 v_mfma_f32_16x16x32_bf16 v[184:187], v[84:87], a[236:239], v[184:187]
 s_add_u32 m0, s60, 126976
 v_mfma_f32_16x16x32_bf16 v[188:191], v[72:75], a[240:243], v[188:191]
 ds_read_b64_tr_b16 v[64:65], v43 offset:18528
 ds_read_b64_tr_b16 v[66:67], v43 offset:23136
 v_mfma_f32_16x16x32_bf16 v[188:191], v[76:79], a[244:247], v[188:191]
 buffer_load_dwordx4 v2, s[12:15], s87 offen offset:0 sc1 lds
 v_mfma_f32_16x16x32_bf16 v[188:191], v[80:83], a[248:251], v[188:191]
 ds_read_b64_tr_b16 v[68:69], v43 offset:27744
 ds_read_b64_tr_b16 v[70:71], v43 offset:32352
 v_mfma_f32_16x16x32_bf16 v[188:191], v[84:87], a[252:255], v[188:191]
 s_waitcnt lgkmcnt(8)
 v_mfma_f32_16x16x32_bf16 v[192:195], v[88:91], a[224:227], v[192:195]
 ds_read_b64_tr_b16 v[72:73], v43 offset:128
 ds_read_b64_tr_b16 v[74:75], v43 offset:4736
 v_mfma_f32_16x16x32_bf16 v[192:195], v[92:95], a[228:231], v[192:195]
 buffer_load_dwordx4 v2, s[12:15], s87 offen offset:1024 sc1 lds
 v_mfma_f32_16x16x32_bf16 v[192:195], v[96:99], a[232:235], v[192:195]
 ds_read_b64_tr_b16 v[76:77], v43 offset:9344
 ds_read_b64_tr_b16 v[78:79], v43 offset:13952
 v_mfma_f32_16x16x32_bf16 v[192:195], v[100:103], a[236:239], v[192:195]
 v_mfma_f32_16x16x32_bf16 v[196:199], v[88:91], a[240:243], v[196:199]
 ds_read_b64_tr_b16 v[80:81], v43 offset:18560
 ds_read_b64_tr_b16 v[82:83], v43 offset:23168
 v_mfma_f32_16x16x32_bf16 v[196:199], v[92:95], a[244:247], v[196:199]
 buffer_load_dwordx4 v2, s[12:15], s87 offen offset:2048 sc1 lds
 v_mfma_f32_16x16x32_bf16 v[196:199], v[96:99], a[248:251], v[196:199]
 ds_read_b64_tr_b16 v[84:85], v43 offset:27776
 ds_read_b64_tr_b16 v[86:87], v43 offset:32384
 v_mfma_f32_16x16x32_bf16 v[196:199], v[100:103], a[252:255], v[196:199]
 s_waitcnt lgkmcnt(8)
 v_mfma_f32_16x16x32_bf16 v[200:203], v[56:59], a[224:227], v[200:203]
 ds_read_b64_tr_b16 v[88:89], v43 offset:160
 ds_read_b64_tr_b16 v[90:91], v43 offset:4768
 v_mfma_f32_16x16x32_bf16 v[200:203], v[60:63], a[228:231], v[200:203]
 buffer_load_dwordx4 v2, s[12:15], s87 offen offset:3072 sc1 lds
 v_mfma_f32_16x16x32_bf16 v[200:203], v[64:67], a[232:235], v[200:203]
 s_mov_b32 s87, 483328
 ds_read_b64_tr_b16 v[92:93], v43 offset:9376
 ds_read_b64_tr_b16 v[94:95], v43 offset:13984
 v_mfma_f32_16x16x32_bf16 v[200:203], v[68:71], a[236:239], v[200:203]
 s_add_u32 m0, s60, 131072
 v_mfma_f32_16x16x32_bf16 v[204:207], v[56:59], a[240:243], v[204:207]
 ds_read_b64_tr_b16 v[96:97], v43 offset:18592
 ds_read_b64_tr_b16 v[98:99], v43 offset:23200
 v_mfma_f32_16x16x32_bf16 v[204:207], v[60:63], a[244:247], v[204:207]
 buffer_load_dwordx4 v2, s[12:15], s87 offen offset:0 sc1 lds
 v_mfma_f32_16x16x32_bf16 v[204:207], v[64:67], a[248:251], v[204:207]
 ds_read_b64_tr_b16 v[100:101], v43 offset:27808
 ds_read_b64_tr_b16 v[102:103], v43 offset:32416
 v_mfma_f32_16x16x32_bf16 v[204:207], v[68:71], a[252:255], v[204:207]
 s_waitcnt lgkmcnt(8)
 v_mfma_f32_16x16x32_bf16 v[208:211], v[72:75], a[224:227], v[208:211]
 ds_read_b64_tr_b16 v[56:57], v43 offset:192
 ds_read_b64_tr_b16 v[58:59], v43 offset:4800
 v_mfma_f32_16x16x32_bf16 v[208:211], v[76:79], a[228:231], v[208:211]
 buffer_load_dwordx4 v2, s[12:15], s87 offen offset:1024 sc1 lds
 v_mfma_f32_16x16x32_bf16 v[208:211], v[80:83], a[232:235], v[208:211]
 ds_read_b64_tr_b16 v[60:61], v43 offset:9408
 ds_read_b64_tr_b16 v[62:63], v43 offset:14016
 v_mfma_f32_16x16x32_bf16 v[208:211], v[84:87], a[236:239], v[208:211]
 v_mfma_f32_16x16x32_bf16 v[212:215], v[72:75], a[240:243], v[212:215]
 ds_read_b64_tr_b16 v[64:65], v43 offset:18624
 ds_read_b64_tr_b16 v[66:67], v43 offset:23232
 v_mfma_f32_16x16x32_bf16 v[212:215], v[76:79], a[244:247], v[212:215]
 buffer_load_dwordx4 v2, s[12:15], s87 offen offset:2048 sc1 lds
 v_mfma_f32_16x16x32_bf16 v[212:215], v[80:83], a[248:251], v[212:215]
 ds_read_b64_tr_b16 v[68:69], v43 offset:27840
 ds_read_b64_tr_b16 v[70:71], v43 offset:32448
 v_mfma_f32_16x16x32_bf16 v[212:215], v[84:87], a[252:255], v[212:215]
 s_waitcnt lgkmcnt(8)
 v_mfma_f32_16x16x32_bf16 v[216:219], v[88:91], a[224:227], v[216:219]
 ds_read_b64_tr_b16 v[72:73], v43 offset:224
 ds_read_b64_tr_b16 v[74:75], v43 offset:4832
 v_mfma_f32_16x16x32_bf16 v[216:219], v[92:95], a[228:231], v[216:219]
 buffer_load_dwordx4 v2, s[12:15], s87 offen offset:3072 sc1 lds
 v_mfma_f32_16x16x32_bf16 v[216:219], v[96:99], a[232:235], v[216:219]
 s_mov_b32 s87, 487424
 ds_read_b64_tr_b16 v[76:77], v43 offset:9440
 ds_read_b64_tr_b16 v[78:79], v43 offset:14048
 v_mfma_f32_16x16x32_bf16 v[216:219], v[100:103], a[236:239], v[216:219]
 s_add_u32 m0, s60, 135168
 v_mfma_f32_16x16x32_bf16 v[220:223], v[88:91], a[240:243], v[220:223]
 ds_read_b64_tr_b16 v[80:81], v43 offset:18656
 ds_read_b64_tr_b16 v[82:83], v43 offset:23264
 v_mfma_f32_16x16x32_bf16 v[220:223], v[92:95], a[244:247], v[220:223]
 buffer_load_dwordx4 v2, s[12:15], s87 offen offset:0 sc1 lds
 v_mfma_f32_16x16x32_bf16 v[220:223], v[96:99], a[248:251], v[220:223]
 s_mov_b32 s88, 16384
 ds_read_b64_tr_b16 v[84:85], v43 offset:27872
 ds_read_b64_tr_b16 v[86:87], v43 offset:32480
 v_mfma_f32_16x16x32_bf16 v[220:223], v[100:103], a[252:255], v[220:223]
 s_waitcnt lgkmcnt(8)
 v_mfma_f32_16x16x32_bf16 v[224:227], v[56:59], a[224:227], v[224:227]
 ds_read_b64_tr_b16 v[88:89], v43 offset:256
 ds_read_b64_tr_b16 v[90:91], v43 offset:4864
 v_mfma_f32_16x16x32_bf16 v[224:227], v[60:63], a[228:231], v[224:227]
 buffer_load_dwordx4 a[160:163], v2, s[24:27], s88 offen offset:0 sc1
 v_mfma_f32_16x16x32_bf16 v[224:227], v[64:67], a[232:235], v[224:227]
 ds_read_b64_tr_b16 v[92:93], v43 offset:9472
 ds_read_b64_tr_b16 v[94:95], v43 offset:14080
 v_mfma_f32_16x16x32_bf16 v[224:227], v[68:71], a[236:239], v[224:227]
 v_mfma_f32_16x16x32_bf16 v[228:231], v[56:59], a[240:243], v[228:231]
 ds_read_b64_tr_b16 v[96:97], v43 offset:18688
 ds_read_b64_tr_b16 v[98:99], v43 offset:23296
 v_mfma_f32_16x16x32_bf16 v[228:231], v[60:63], a[244:247], v[228:231]
 buffer_load_dwordx4 a[164:167], v2, s[24:27], s88 offen offset:1024 sc1
 v_mfma_f32_16x16x32_bf16 v[228:231], v[64:67], a[248:251], v[228:231]
 ds_read_b64_tr_b16 v[100:101], v43 offset:27904
 ds_read_b64_tr_b16 v[102:103], v43 offset:32512
 v_mfma_f32_16x16x32_bf16 v[228:231], v[68:71], a[252:255], v[228:231]
 s_waitcnt lgkmcnt(8)
 v_mfma_f32_16x16x32_bf16 v[232:235], v[72:75], a[224:227], v[232:235]
 buffer_load_dwordx4 a[168:171], v2, s[24:27], s88 offen offset:2048 sc1
 v_mfma_f32_16x16x32_bf16 v[232:235], v[76:79], a[228:231], v[232:235]
 v_mfma_f32_16x16x32_bf16 v[232:235], v[80:83], a[232:235], v[232:235]
 s_waitcnt vmcnt(20) lgkmcnt(0)
 v_mfma_f32_16x16x32_bf16 v[232:235], v[84:87], a[236:239], v[232:235]
 s_barrier
 buffer_load_dwordx4 a[172:175], v2, s[24:27], s88 offen offset:3072 sc1
 v_mfma_f32_16x16x32_bf16 v[236:239], v[72:75], a[240:243], v[236:239]
 s_mov_b32 s89, 148736
 ds_read_b64_tr_b16 v[56:57], v40 offset:0
 ds_read_b64_tr_b16 v[58:59], v40 offset:4608
 v_mfma_f32_16x16x32_bf16 v[236:239], v[76:79], a[244:247], v[236:239]
 ds_read_b64_tr_b16 v[60:61], v40 offset:9216
 ds_read_b64_tr_b16 v[62:63], v40 offset:13824
 v_mfma_f32_16x16x32_bf16 v[236:239], v[80:83], a[248:251], v[236:239]
 ds_read_b64_tr_b16 v[64:65], v40 offset:18432
 ds_read_b64_tr_b16 v[66:67], v40 offset:23040
 v_mfma_f32_16x16x32_bf16 v[236:239], v[84:87], a[252:255], v[236:239]
 ds_read_b64_tr_b16 v[68:69], v40 offset:27648
 ds_read_b64_tr_b16 v[70:71], v40 offset:32256
 v_mfma_f32_16x16x32_bf16 v[240:243], v[88:91], a[224:227], v[240:243]
 ds_read_b64_tr_b16 v[72:73], v40 offset:32
 ds_read_b64_tr_b16 v[74:75], v40 offset:4640
 v_mfma_f32_16x16x32_bf16 v[240:243], v[92:95], a[228:231], v[240:243]
 buffer_store_dword v253, v252, s[32:35], s67 offen sc1
 v_mfma_f32_16x16x32_bf16 v[240:243], v[96:99], a[232:235], v[240:243]
 ds_read_b64_tr_b16 v[76:77], v40 offset:9248
 ds_read_b64_tr_b16 v[78:79], v40 offset:13856
 v_mfma_f32_16x16x32_bf16 v[240:243], v[100:103], a[236:239], v[240:243]
 v_mfma_f32_16x16x32_bf16 v[244:247], v[88:91], a[240:243], v[244:247]
 ds_read_b64_tr_b16 v[80:81], v40 offset:18464
 ds_read_b64_tr_b16 v[82:83], v40 offset:23072
 v_mfma_f32_16x16x32_bf16 v[244:247], v[92:95], a[244:247], v[244:247]
 buffer_load_dwordx4 a[176:179], v2, s[24:27], s89 offen offset:0 sc1
 v_mfma_f32_16x16x32_bf16 v[244:247], v[96:99], a[248:251], v[244:247]
 ds_read_b64_tr_b16 v[84:85], v40 offset:27680
 ds_read_b64_tr_b16 v[86:87], v40 offset:32288
 v_mfma_f32_16x16x32_bf16 v[244:247], v[100:103], a[252:255], v[244:247]
 s_waitcnt vmcnt(15) lgkmcnt(8)
 buffer_load_dwordx4 a[180:183], v2, s[24:27], s89 offen offset:1024 sc1
 buffer_load_dwordx4 a[184:187], v2, s[24:27], s89 offen offset:2048 sc1
 buffer_load_dwordx4 a[188:191], v2, s[24:27], s89 offen offset:3072 sc1
 s_bitcmp1_b32 s69, 0
 s_cbranch_scc1 L_dskip
 v_mfma_f32_16x16x32_bf16 v[176:179], v[56:59], a[128:131], v[176:179]
 s_mov_b32 s87, 516096
 ds_read_b64_tr_b16 v[88:89], v40 offset:64
 ds_read_b64_tr_b16 v[90:91], v40 offset:4672
 v_mfma_f32_16x16x32_bf16 v[176:179], v[60:63], a[132:135], v[176:179]
 s_add_u32 m0, s60, 36864
 v_mfma_f32_16x16x32_bf16 v[176:179], v[64:67], a[136:139], v[176:179]
 ds_read_b64_tr_b16 v[92:93], v40 offset:9280
 ds_read_b64_tr_b16 v[94:95], v40 offset:13888
 v_mfma_f32_16x16x32_bf16 v[176:179], v[68:71], a[140:143], v[176:179]
 buffer_load_dwordx4 v2, s[12:15], s87 offen offset:0 sc1 lds
 v_mfma_f32_16x16x32_bf16 v[180:183], v[56:59], a[144:147], v[180:183]
 ds_read_b64_tr_b16 v[96:97], v40 offset:18496
 ds_read_b64_tr_b16 v[98:99], v40 offset:23104
 v_mfma_f32_16x16x32_bf16 v[180:183], v[60:63], a[148:151], v[180:183]
 v_mfma_f32_16x16x32_bf16 v[180:183], v[64:67], a[152:155], v[180:183]
 ds_read_b64_tr_b16 v[100:101], v40 offset:27712
 ds_read_b64_tr_b16 v[102:103], v40 offset:32320
 v_mfma_f32_16x16x32_bf16 v[180:183], v[68:71], a[156:159], v[180:183]
 s_waitcnt lgkmcnt(8)
 buffer_load_dwordx4 v2, s[12:15], s87 offen offset:1024 sc1 lds
 v_mfma_f32_16x16x32_bf16 v[184:187], v[72:75], a[128:131], v[184:187]
 ds_read_b64_tr_b16 v[56:57], v40 offset:96
 ds_read_b64_tr_b16 v[58:59], v40 offset:4704
 v_mfma_f32_16x16x32_bf16 v[184:187], v[76:79], a[132:135], v[184:187]
 v_mfma_f32_16x16x32_bf16 v[184:187], v[80:83], a[136:139], v[184:187]
 ds_read_b64_tr_b16 v[60:61], v40 offset:9312
 ds_read_b64_tr_b16 v[62:63], v40 offset:13920
 v_mfma_f32_16x16x32_bf16 v[184:187], v[84:87], a[140:143], v[184:187]
 buffer_load_dwordx4 v2, s[12:15], s87 offen offset:2048 sc1 lds
 v_mfma_f32_16x16x32_bf16 v[188:191], v[72:75], a[144:147], v[188:191]
 ds_read_b64_tr_b16 v[64:65], v40 offset:18528
 ds_read_b64_tr_b16 v[66:67], v40 offset:23136
 v_mfma_f32_16x16x32_bf16 v[188:191], v[76:79], a[148:151], v[188:191]
 v_mfma_f32_16x16x32_bf16 v[188:191], v[80:83], a[152:155], v[188:191]
 ds_read_b64_tr_b16 v[68:69], v40 offset:27744
 ds_read_b64_tr_b16 v[70:71], v40 offset:32352
 v_mfma_f32_16x16x32_bf16 v[188:191], v[84:87], a[156:159], v[188:191]
 s_waitcnt lgkmcnt(8)
 buffer_load_dwordx4 v2, s[12:15], s87 offen offset:3072 sc1 lds
 v_mfma_f32_16x16x32_bf16 v[192:195], v[88:91], a[128:131], v[192:195]
 s_mov_b32 s87, 520192
 ds_read_b64_tr_b16 v[72:73], v40 offset:128
 ds_read_b64_tr_b16 v[74:75], v40 offset:4736
 v_mfma_f32_16x16x32_bf16 v[192:195], v[92:95], a[132:135], v[192:195]
 s_add_u32 m0, s60, 40960
 v_mfma_f32_16x16x32_bf16 v[192:195], v[96:99], a[136:139], v[192:195]
 ds_read_b64_tr_b16 v[76:77], v40 offset:9344
 ds_read_b64_tr_b16 v[78:79], v40 offset:13952
 v_mfma_f32_16x16x32_bf16 v[192:195], v[100:103], a[140:143], v[192:195]
 buffer_load_dwordx4 v2, s[12:15], s87 offen offset:0 sc1 lds
 v_mfma_f32_16x16x32_bf16 v[196:199], v[88:91], a[144:147], v[196:199]
 ds_read_b64_tr_b16 v[80:81], v40 offset:18560
 ds_read_b64_tr_b16 v[82:83], v40 offset:23168
 v_mfma_f32_16x16x32_bf16 v[196:199], v[92:95], a[148:151], v[196:199]
 v_mfma_f32_16x16x32_bf16 v[196:199], v[96:99], a[152:155], v[196:199]
 ds_read_b64_tr_b16 v[84:85], v40 offset:27776
 ds_read_b64_tr_b16 v[86:87], v40 offset:32384
 v_mfma_f32_16x16x32_bf16 v[196:199], v[100:103], a[156:159], v[196:199]
 s_waitcnt lgkmcnt(8)
 buffer_load_dwordx4 v2, s[12:15], s87 offen offset:1024 sc1 lds
 v_mfma_f32_16x16x32_bf16 v[200:203], v[56:59], a[128:131], v[200:203]
 ds_read_b64_tr_b16 v[88:89], v40 offset:160
 ds_read_b64_tr_b16 v[90:91], v40 offset:4768
 v_mfma_f32_16x16x32_bf16 v[200:203], v[60:63], a[132:135], v[200:203]
 v_mfma_f32_16x16x32_bf16 v[200:203], v[64:67], a[136:139], v[200:203]
 ds_read_b64_tr_b16 v[92:93], v40 offset:9376
 ds_read_b64_tr_b16 v[94:95], v40 offset:13984
 v_mfma_f32_16x16x32_bf16 v[200:203], v[68:71], a[140:143], v[200:203]
 buffer_load_dwordx4 v2, s[12:15], s87 offen offset:2048 sc1 lds
 v_mfma_f32_16x16x32_bf16 v[204:207], v[56:59], a[144:147], v[204:207]
 ds_read_b64_tr_b16 v[96:97], v40 offset:18592
 ds_read_b64_tr_b16 v[98:99], v40 offset:23200
 v_mfma_f32_16x16x32_bf16 v[204:207], v[60:63], a[148:151], v[204:207]
 v_mfma_f32_16x16x32_bf16 v[204:207], v[64:67], a[152:155], v[204:207]
 ds_read_b64_tr_b16 v[100:101], v40 offset:27808
 ds_read_b64_tr_b16 v[102:103], v40 offset:32416
 v_mfma_f32_16x16x32_bf16 v[204:207], v[68:71], a[156:159], v[204:207]
 s_waitcnt lgkmcnt(8)
 buffer_load_dwordx4 v2, s[12:15], s87 offen offset:3072 sc1 lds
 v_mfma_f32_16x16x32_bf16 v[208:211], v[72:75], a[128:131], v[208:211]
 s_mov_b32 s87, 524288
 ds_read_b64_tr_b16 v[56:57], v40 offset:192
 ds_read_b64_tr_b16 v[58:59], v40 offset:4800
 v_mfma_f32_16x16x32_bf16 v[208:211], v[76:79], a[132:135], v[208:211]
 s_add_u32 m0, s60, 45056
 v_mfma_f32_16x16x32_bf16 v[208:211], v[80:83], a[136:139], v[208:211]
 ds_read_b64_tr_b16 v[60:61], v40 offset:9408
 ds_read_b64_tr_b16 v[62:63], v40 offset:14016
 v_mfma_f32_16x16x32_bf16 v[208:211], v[84:87], a[140:143], v[208:211]
 buffer_load_dwordx4 v2, s[12:15], s87 offen offset:0 sc1 lds
 v_mfma_f32_16x16x32_bf16 v[212:215], v[72:75], a[144:147], v[212:215]
 s_mov_b32 s88, 20480
 ds_read_b64_tr_b16 v[64:65], v40 offset:18624
 ds_read_b64_tr_b16 v[66:67], v40 offset:23232
 v_mfma_f32_16x16x32_bf16 v[212:215], v[76:79], a[148:151], v[212:215]
 v_mfma_f32_16x16x32_bf16 v[212:215], v[80:83], a[152:155], v[212:215]
 ds_read_b64_tr_b16 v[68:69], v40 offset:27840
 ds_read_b64_tr_b16 v[70:71], v40 offset:32448
 v_mfma_f32_16x16x32_bf16 v[212:215], v[84:87], a[156:159], v[212:215]
 s_waitcnt lgkmcnt(8)
 buffer_load_dwordx4 a[192:195], v2, s[24:27], s88 offen offset:0 sc1
 v_mfma_f32_16x16x32_bf16 v[216:219], v[88:91], a[128:131], v[216:219]
 ds_read_b64_tr_b16 v[72:73], v40 offset:224
 ds_read_b64_tr_b16 v[74:75], v40 offset:4832
 v_mfma_f32_16x16x32_bf16 v[216:219], v[92:95], a[132:135], v[216:219]
 v_mfma_f32_16x16x32_bf16 v[216:219], v[96:99], a[136:139], v[216:219]
 ds_read_b64_tr_b16 v[76:77], v40 offset:9440
 ds_read_b64_tr_b16 v[78:79], v40 offset:14048
 v_mfma_f32_16x16x32_bf16 v[216:219], v[100:103], a[140:143], v[216:219]
 buffer_load_dwordx4 a[196:199], v2, s[24:27], s88 offen offset:1024 sc1
 v_mfma_f32_16x16x32_bf16 v[220:223], v[88:91], a[144:147], v[220:223]
 ds_read_b64_tr_b16 v[80:81], v40 offset:18656
 ds_read_b64_tr_b16 v[82:83], v40 offset:23264
 v_mfma_f32_16x16x32_bf16 v[220:223], v[92:95], a[148:151], v[220:223]
 v_mfma_f32_16x16x32_bf16 v[220:223], v[96:99], a[152:155], v[220:223]
 ds_read_b64_tr_b16 v[84:85], v40 offset:27872
 ds_read_b64_tr_b16 v[86:87], v40 offset:32480
 v_mfma_f32_16x16x32_bf16 v[220:223], v[100:103], a[156:159], v[220:223]
 s_waitcnt lgkmcnt(8)
 buffer_load_dwordx4 a[200:203], v2, s[24:27], s88 offen offset:2048 sc1
 v_mfma_f32_16x16x32_bf16 v[224:227], v[56:59], a[128:131], v[224:227]
 ds_read_b64_tr_b16 v[88:89], v40 offset:256
 ds_read_b64_tr_b16 v[90:91], v40 offset:4864
 v_mfma_f32_16x16x32_bf16 v[224:227], v[60:63], a[132:135], v[224:227]
 v_mfma_f32_16x16x32_bf16 v[224:227], v[64:67], a[136:139], v[224:227]
 ds_read_b64_tr_b16 v[92:93], v40 offset:9472
 ds_read_b64_tr_b16 v[94:95], v40 offset:14080
 v_mfma_f32_16x16x32_bf16 v[224:227], v[68:71], a[140:143], v[224:227]
 buffer_load_dwordx4 a[204:207], v2, s[24:27], s88 offen offset:3072 sc1
 v_mfma_f32_16x16x32_bf16 v[228:231], v[56:59], a[144:147], v[228:231]
 s_mov_b32 s89, 152832
 ds_read_b64_tr_b16 v[96:97], v40 offset:18688
 ds_read_b64_tr_b16 v[98:99], v40 offset:23296
 v_mfma_f32_16x16x32_bf16 v[228:231], v[60:63], a[148:151], v[228:231]
 v_mfma_f32_16x16x32_bf16 v[228:231], v[64:67], a[152:155], v[228:231]
 ds_read_b64_tr_b16 v[100:101], v40 offset:27904
 ds_read_b64_tr_b16 v[102:103], v40 offset:32512
 v_mfma_f32_16x16x32_bf16 v[228:231], v[68:71], a[156:159], v[228:231]
 s_waitcnt lgkmcnt(8)
 buffer_load_dwordx4 a[208:211], v2, s[24:27], s89 offen offset:0 sc1
 v_mfma_f32_16x16x32_bf16 v[232:235], v[72:75], a[128:131], v[232:235]
 v_mfma_f32_16x16x32_bf16 v[232:235], v[76:79], a[132:135], v[232:235]
 v_mfma_f32_16x16x32_bf16 v[232:235], v[80:83], a[136:139], v[232:235]
 s_waitcnt vmcnt(23) lgkmcnt(0)
 v_mfma_f32_16x16x32_bf16 v[232:235], v[84:87], a[140:143], v[232:235]
 s_barrier
 buffer_load_dwordx4 a[212:215], v2, s[24:27], s89 offen offset:1024 sc1
 v_mfma_f32_16x16x32_bf16 v[236:239], v[72:75], a[144:147], v[236:239]
 ds_read_b64_tr_b16 v[56:57], v41 offset:0
 ds_read_b64_tr_b16 v[58:59], v41 offset:4608
 v_mfma_f32_16x16x32_bf16 v[236:239], v[76:79], a[148:151], v[236:239]
 ds_read_b64_tr_b16 v[60:61], v41 offset:9216
 ds_read_b64_tr_b16 v[62:63], v41 offset:13824
 v_mfma_f32_16x16x32_bf16 v[236:239], v[80:83], a[152:155], v[236:239]
 ds_read_b64_tr_b16 v[64:65], v41 offset:18432
 ds_read_b64_tr_b16 v[66:67], v41 offset:23040
 v_mfma_f32_16x16x32_bf16 v[236:239], v[84:87], a[156:159], v[236:239]
 ds_read_b64_tr_b16 v[68:69], v41 offset:27648
 ds_read_b64_tr_b16 v[70:71], v41 offset:32256
 v_mfma_f32_16x16x32_bf16 v[240:243], v[88:91], a[128:131], v[240:243]
 ds_read_b64_tr_b16 v[72:73], v41 offset:32
 ds_read_b64_tr_b16 v[74:75], v41 offset:4640
 v_mfma_f32_16x16x32_bf16 v[240:243], v[92:95], a[132:135], v[240:243]
 buffer_load_dwordx4 a[216:219], v2, s[24:27], s89 offen offset:2048 sc1
 v_mfma_f32_16x16x32_bf16 v[240:243], v[96:99], a[136:139], v[240:243]
 ds_read_b64_tr_b16 v[76:77], v41 offset:9248
 ds_read_b64_tr_b16 v[78:79], v41 offset:13856
 v_mfma_f32_16x16x32_bf16 v[240:243], v[100:103], a[140:143], v[240:243]
 v_mfma_f32_16x16x32_bf16 v[244:247], v[88:91], a[144:147], v[244:247]
 ds_read_b64_tr_b16 v[80:81], v41 offset:18464
 ds_read_b64_tr_b16 v[82:83], v41 offset:23072
 v_mfma_f32_16x16x32_bf16 v[244:247], v[92:95], a[148:151], v[244:247]
 buffer_load_dwordx4 a[220:223], v2, s[24:27], s89 offen offset:3072 sc1
 v_mfma_f32_16x16x32_bf16 v[244:247], v[96:99], a[152:155], v[244:247]
 ds_read_b64_tr_b16 v[84:85], v41 offset:27680
 ds_read_b64_tr_b16 v[86:87], v41 offset:32288
 v_mfma_f32_16x16x32_bf16 v[244:247], v[100:103], a[156:159], v[244:247]
 s_waitcnt vmcnt(17) lgkmcnt(8)
 v_mfma_f32_16x16x32_bf16 v[176:179], v[56:59], a[160:163], v[176:179]
 s_mov_b32 s87, 552960
 ds_read_b64_tr_b16 v[88:89], v41 offset:64
 ds_read_b64_tr_b16 v[90:91], v41 offset:4672
 v_mfma_f32_16x16x32_bf16 v[176:179], v[60:63], a[164:167], v[176:179]
 s_add_u32 m0, s60, 73728
 v_mfma_f32_16x16x32_bf16 v[176:179], v[64:67], a[168:171], v[176:179]
 ds_read_b64_tr_b16 v[92:93], v41 offset:9280
 ds_read_b64_tr_b16 v[94:95], v41 offset:13888
 v_mfma_f32_16x16x32_bf16 v[176:179], v[68:71], a[172:175], v[176:179]
 buffer_load_dwordx4 v2, s[12:15], s87 offen offset:0 sc1 lds
 v_mfma_f32_16x16x32_bf16 v[180:183], v[56:59], a[176:179], v[180:183]
 ds_read_b64_tr_b16 v[96:97], v41 offset:18496
 ds_read_b64_tr_b16 v[98:99], v41 offset:23104
 v_mfma_f32_16x16x32_bf16 v[180:183], v[60:63], a[180:183], v[180:183]
 v_mfma_f32_16x16x32_bf16 v[180:183], v[64:67], a[184:187], v[180:183]
 ds_read_b64_tr_b16 v[100:101], v41 offset:27712
 ds_read_b64_tr_b16 v[102:103], v41 offset:32320
 v_mfma_f32_16x16x32_bf16 v[180:183], v[68:71], a[188:191], v[180:183]
 s_waitcnt lgkmcnt(8)
 buffer_load_dwordx4 v2, s[12:15], s87 offen offset:1024 sc1 lds
 v_mfma_f32_16x16x32_bf16 v[184:187], v[72:75], a[160:163], v[184:187]
 ds_read_b64_tr_b16 v[56:57], v41 offset:96
 ds_read_b64_tr_b16 v[58:59], v41 offset:4704
 v_mfma_f32_16x16x32_bf16 v[184:187], v[76:79], a[164:167], v[184:187]
 v_mfma_f32_16x16x32_bf16 v[184:187], v[80:83], a[168:171], v[184:187]
 ds_read_b64_tr_b16 v[60:61], v41 offset:9312
 ds_read_b64_tr_b16 v[62:63], v41 offset:13920
 v_mfma_f32_16x16x32_bf16 v[184:187], v[84:87], a[172:175], v[184:187]
 buffer_load_dwordx4 v2, s[12:15], s87 offen offset:2048 sc1 lds
 v_mfma_f32_16x16x32_bf16 v[188:191], v[72:75], a[176:179], v[188:191]
 ds_read_b64_tr_b16 v[64:65], v41 offset:18528
 ds_read_b64_tr_b16 v[66:67], v41 offset:23136
 v_mfma_f32_16x16x32_bf16 v[188:191], v[76:79], a[180:183], v[188:191]
 v_mfma_f32_16x16x32_bf16 v[188:191], v[80:83], a[184:187], v[188:191]
 ds_read_b64_tr_b16 v[68:69], v41 offset:27744
 ds_read_b64_tr_b16 v[70:71], v41 offset:32352
 v_mfma_f32_16x16x32_bf16 v[188:191], v[84:87], a[188:191], v[188:191]
 s_waitcnt lgkmcnt(8)
 buffer_load_dwordx4 v2, s[12:15], s87 offen offset:3072 sc1 lds
 v_mfma_f32_16x16x32_bf16 v[192:195], v[88:91], a[160:163], v[192:195]
 s_mov_b32 s87, 557056
 ds_read_b64_tr_b16 v[72:73], v41 offset:128
 ds_read_b64_tr_b16 v[74:75], v41 offset:4736
 v_mfma_f32_16x16x32_bf16 v[192:195], v[92:95], a[164:167], v[192:195]
 s_add_u32 m0, s60, 77824
 v_mfma_f32_16x16x32_bf16 v[192:195], v[96:99], a[168:171], v[192:195]
 ds_read_b64_tr_b16 v[76:77], v41 offset:9344
 ds_read_b64_tr_b16 v[78:79], v41 offset:13952
 v_mfma_f32_16x16x32_bf16 v[192:195], v[100:103], a[172:175], v[192:195]
 buffer_load_dwordx4 v2, s[12:15], s87 offen offset:0 sc1 lds
 v_mfma_f32_16x16x32_bf16 v[196:199], v[88:91], a[176:179], v[196:199]
 ds_read_b64_tr_b16 v[80:81], v41 offset:18560
 ds_read_b64_tr_b16 v[82:83], v41 offset:23168
 v_mfma_f32_16x16x32_bf16 v[196:199], v[92:95], a[180:183], v[196:199]
 v_mfma_f32_16x16x32_bf16 v[196:199], v[96:99], a[184:187], v[196:199]
 ds_read_b64_tr_b16 v[84:85], v41 offset:27776
 ds_read_b64_tr_b16 v[86:87], v41 offset:32384
 v_mfma_f32_16x16x32_bf16 v[196:199], v[100:103], a[188:191], v[196:199]
 s_waitcnt lgkmcnt(8)
 buffer_load_dwordx4 v2, s[12:15], s87 offen offset:1024 sc1 lds
 v_mfma_f32_16x16x32_bf16 v[200:203], v[56:59], a[160:163], v[200:203]
 ds_read_b64_tr_b16 v[88:89], v41 offset:160
 ds_read_b64_tr_b16 v[90:91], v41 offset:4768
 v_mfma_f32_16x16x32_bf16 v[200:203], v[60:63], a[164:167], v[200:203]
 v_mfma_f32_16x16x32_bf16 v[200:203], v[64:67], a[168:171], v[200:203]
 ds_read_b64_tr_b16 v[92:93], v41 offset:9376
 ds_read_b64_tr_b16 v[94:95], v41 offset:13984
 v_mfma_f32_16x16x32_bf16 v[200:203], v[68:71], a[172:175], v[200:203]
 buffer_load_dwordx4 v2, s[12:15], s87 offen offset:2048 sc1 lds
 v_mfma_f32_16x16x32_bf16 v[204:207], v[56:59], a[176:179], v[204:207]
 ds_read_b64_tr_b16 v[96:97], v41 offset:18592
 ds_read_b64_tr_b16 v[98:99], v41 offset:23200
 v_mfma_f32_16x16x32_bf16 v[204:207], v[60:63], a[180:183], v[204:207]
 v_mfma_f32_16x16x32_bf16 v[204:207], v[64:67], a[184:187], v[204:207]
 ds_read_b64_tr_b16 v[100:101], v41 offset:27808
 ds_read_b64_tr_b16 v[102:103], v41 offset:32416
 v_mfma_f32_16x16x32_bf16 v[204:207], v[68:71], a[188:191], v[204:207]
 s_waitcnt lgkmcnt(8)
 buffer_load_dwordx4 v2, s[12:15], s87 offen offset:3072 sc1 lds
 v_mfma_f32_16x16x32_bf16 v[208:211], v[72:75], a[160:163], v[208:211]
 s_mov_b32 s87, 561152
 ds_read_b64_tr_b16 v[56:57], v41 offset:192
 ds_read_b64_tr_b16 v[58:59], v41 offset:4800
 v_mfma_f32_16x16x32_bf16 v[208:211], v[76:79], a[164:167], v[208:211]
 s_add_u32 m0, s60, 81920
 v_mfma_f32_16x16x32_bf16 v[208:211], v[80:83], a[168:171], v[208:211]
 ds_read_b64_tr_b16 v[60:61], v41 offset:9408
 ds_read_b64_tr_b16 v[62:63], v41 offset:14016
 v_mfma_f32_16x16x32_bf16 v[208:211], v[84:87], a[172:175], v[208:211]
 buffer_load_dwordx4 v2, s[12:15], s87 offen offset:0 sc1 lds
 v_mfma_f32_16x16x32_bf16 v[212:215], v[72:75], a[176:179], v[212:215]
 s_mov_b32 s88, 24576
 ds_read_b64_tr_b16 v[64:65], v41 offset:18624
 ds_read_b64_tr_b16 v[66:67], v41 offset:23232
 v_mfma_f32_16x16x32_bf16 v[212:215], v[76:79], a[180:183], v[212:215]
 v_mfma_f32_16x16x32_bf16 v[212:215], v[80:83], a[184:187], v[212:215]
 ds_read_b64_tr_b16 v[68:69], v41 offset:27840
 ds_read_b64_tr_b16 v[70:71], v41 offset:32448
 v_mfma_f32_16x16x32_bf16 v[212:215], v[84:87], a[188:191], v[212:215]
 s_waitcnt lgkmcnt(8)
 buffer_load_dwordx4 a[224:227], v2, s[24:27], s88 offen offset:0 sc1
 v_mfma_f32_16x16x32_bf16 v[216:219], v[88:91], a[160:163], v[216:219]
 ds_read_b64_tr_b16 v[72:73], v41 offset:224
 ds_read_b64_tr_b16 v[74:75], v41 offset:4832
 v_mfma_f32_16x16x32_bf16 v[216:219], v[92:95], a[164:167], v[216:219]
 v_mfma_f32_16x16x32_bf16 v[216:219], v[96:99], a[168:171], v[216:219]
 ds_read_b64_tr_b16 v[76:77], v41 offset:9440
 ds_read_b64_tr_b16 v[78:79], v41 offset:14048
 v_mfma_f32_16x16x32_bf16 v[216:219], v[100:103], a[172:175], v[216:219]
 buffer_load_dwordx4 a[228:231], v2, s[24:27], s88 offen offset:1024 sc1
 v_mfma_f32_16x16x32_bf16 v[220:223], v[88:91], a[176:179], v[220:223]
 ds_read_b64_tr_b16 v[80:81], v41 offset:18656
 ds_read_b64_tr_b16 v[82:83], v41 offset:23264
 v_mfma_f32_16x16x32_bf16 v[220:223], v[92:95], a[180:183], v[220:223]
 v_mfma_f32_16x16x32_bf16 v[220:223], v[96:99], a[184:187], v[220:223]
 ds_read_b64_tr_b16 v[84:85], v41 offset:27872
 ds_read_b64_tr_b16 v[86:87], v41 offset:32480
 v_mfma_f32_16x16x32_bf16 v[220:223], v[100:103], a[188:191], v[220:223]
 s_waitcnt lgkmcnt(8)
 buffer_load_dwordx4 a[232:235], v2, s[24:27], s88 offen offset:2048 sc1
 v_mfma_f32_16x16x32_bf16 v[224:227], v[56:59], a[160:163], v[224:227]
 ds_read_b64_tr_b16 v[88:89], v41 offset:256
 ds_read_b64_tr_b16 v[90:91], v41 offset:4864
 v_mfma_f32_16x16x32_bf16 v[224:227], v[60:63], a[164:167], v[224:227]
 v_mfma_f32_16x16x32_bf16 v[224:227], v[64:67], a[168:171], v[224:227]
 ds_read_b64_tr_b16 v[92:93], v41 offset:9472
 ds_read_b64_tr_b16 v[94:95], v41 offset:14080
 v_mfma_f32_16x16x32_bf16 v[224:227], v[68:71], a[172:175], v[224:227]
 buffer_load_dwordx4 a[236:239], v2, s[24:27], s88 offen offset:3072 sc1
 v_mfma_f32_16x16x32_bf16 v[228:231], v[56:59], a[176:179], v[228:231]
 s_mov_b32 s89, 156928
 ds_read_b64_tr_b16 v[96:97], v41 offset:18688
 ds_read_b64_tr_b16 v[98:99], v41 offset:23296
 v_mfma_f32_16x16x32_bf16 v[228:231], v[60:63], a[180:183], v[228:231]
 v_mfma_f32_16x16x32_bf16 v[228:231], v[64:67], a[184:187], v[228:231]
 ds_read_b64_tr_b16 v[100:101], v41 offset:27904
 ds_read_b64_tr_b16 v[102:103], v41 offset:32512
 v_mfma_f32_16x16x32_bf16 v[228:231], v[68:71], a[188:191], v[228:231]
 s_waitcnt lgkmcnt(8)
 buffer_load_dwordx4 a[240:243], v2, s[24:27], s89 offen offset:0 sc1
 v_mfma_f32_16x16x32_bf16 v[232:235], v[72:75], a[160:163], v[232:235]
 v_mfma_f32_16x16x32_bf16 v[232:235], v[76:79], a[164:167], v[232:235]
 v_mfma_f32_16x16x32_bf16 v[232:235], v[80:83], a[168:171], v[232:235]
 s_waitcnt vmcnt(22) lgkmcnt(0)
 v_mfma_f32_16x16x32_bf16 v[232:235], v[84:87], a[172:175], v[232:235]
 s_barrier
 buffer_load_dwordx4 a[244:247], v2, s[24:27], s89 offen offset:1024 sc1
 v_mfma_f32_16x16x32_bf16 v[236:239], v[72:75], a[176:179], v[236:239]
 ds_read_b64_tr_b16 v[56:57], v42 offset:0
 ds_read_b64_tr_b16 v[58:59], v42 offset:4608
 v_mfma_f32_16x16x32_bf16 v[236:239], v[76:79], a[180:183], v[236:239]
 ds_read_b64_tr_b16 v[60:61], v42 offset:9216
 ds_read_b64_tr_b16 v[62:63], v42 offset:13824
 v_mfma_f32_16x16x32_bf16 v[236:239], v[80:83], a[184:187], v[236:239]
 ds_read_b64_tr_b16 v[64:65], v42 offset:18432
 ds_read_b64_tr_b16 v[66:67], v42 offset:23040
 v_mfma_f32_16x16x32_bf16 v[236:239], v[84:87], a[188:191], v[236:239]
 ds_read_b64_tr_b16 v[68:69], v42 offset:27648
 ds_read_b64_tr_b16 v[70:71], v42 offset:32256
 v_mfma_f32_16x16x32_bf16 v[240:243], v[88:91], a[160:163], v[240:243]
 ds_read_b64_tr_b16 v[72:73], v42 offset:32
 ds_read_b64_tr_b16 v[74:75], v42 offset:4640
 v_mfma_f32_16x16x32_bf16 v[240:243], v[92:95], a[164:167], v[240:243]
 buffer_load_dwordx4 a[248:251], v2, s[24:27], s89 offen offset:2048 sc1
 v_mfma_f32_16x16x32_bf16 v[240:243], v[96:99], a[168:171], v[240:243]
 ds_read_b64_tr_b16 v[76:77], v42 offset:9248
 ds_read_b64_tr_b16 v[78:79], v42 offset:13856
 v_mfma_f32_16x16x32_bf16 v[240:243], v[100:103], a[172:175], v[240:243]
 v_mfma_f32_16x16x32_bf16 v[244:247], v[88:91], a[176:179], v[244:247]
 ds_read_b64_tr_b16 v[80:81], v42 offset:18464
 ds_read_b64_tr_b16 v[82:83], v42 offset:23072
 v_mfma_f32_16x16x32_bf16 v[244:247], v[92:95], a[180:183], v[244:247]
 buffer_load_dwordx4 a[252:255], v2, s[24:27], s89 offen offset:3072 sc1
 v_mfma_f32_16x16x32_bf16 v[244:247], v[96:99], a[184:187], v[244:247]
 ds_read_b64_tr_b16 v[84:85], v42 offset:27680
 ds_read_b64_tr_b16 v[86:87], v42 offset:32288
 v_mfma_f32_16x16x32_bf16 v[244:247], v[100:103], a[188:191], v[244:247]
 s_waitcnt vmcnt(17) lgkmcnt(8)
 v_mfma_f32_16x16x32_bf16 v[176:179], v[56:59], a[192:195], v[176:179]
 s_mov_b32 s87, 589824
 ds_read_b64_tr_b16 v[88:89], v42 offset:64
 ds_read_b64_tr_b16 v[90:91], v42 offset:4672
 v_mfma_f32_16x16x32_bf16 v[176:179], v[60:63], a[196:199], v[176:179]
 s_add_u32 m0, s60, 0
 buffer_load_dword v255, v254, s[32:35], s61 offen sc1
 v_mfma_f32_16x16x32_bf16 v[176:179], v[64:67], a[200:203], v[176:179]
 ds_read_b64_tr_b16 v[92:93], v42 offset:9280
 ds_read_b64_tr_b16 v[94:95], v42 offset:13888
 v_mfma_f32_16x16x32_bf16 v[176:179], v[68:71], a[204:207], v[176:179]
 v_mfma_f32_16x16x32_bf16 v[180:183], v[56:59], a[208:211], v[180:183]
 ds_read_b64_tr_b16 v[96:97], v42 offset:18496
 ds_read_b64_tr_b16 v[98:99], v42 offset:23104
 v_mfma_f32_16x16x32_bf16 v[180:183], v[60:63], a[212:215], v[180:183]
 buffer_load_dwordx4 v2, s[12:15], s87 offen offset:0 sc1 lds
 v_mfma_f32_16x16x32_bf16 v[180:183], v[64:67], a[216:219], v[180:183]
 ds_read_b64_tr_b16 v[100:101], v42 offset:27712
 ds_read_b64_tr_b16 v[102:103], v42 offset:32320
 v_mfma_f32_16x16x32_bf16 v[180:183], v[68:71], a[220:223], v[180:183]
 s_waitcnt lgkmcnt(8)
 v_mfma_f32_16x16x32_bf16 v[184:187], v[72:75], a[192:195], v[184:187]
 ds_read_b64_tr_b16 v[56:57], v42 offset:96
 ds_read_b64_tr_b16 v[58:59], v42 offset:4704
 v_mfma_f32_16x16x32_bf16 v[184:187], v[76:79], a[196:199], v[184:187]
 buffer_load_dwordx4 v2, s[12:15], s87 offen offset:1024 sc1 lds
 v_mfma_f32_16x16x32_bf16 v[184:187], v[80:83], a[200:203], v[184:187]
 ds_read_b64_tr_b16 v[60:61], v42 offset:9312
 ds_read_b64_tr_b16 v[62:63], v42 offset:13920
 v_mfma_f32_16x16x32_bf16 v[184:187], v[84:87], a[204:207], v[184:187]
 v_mfma_f32_16x16x32_bf16 v[188:191], v[72:75], a[208:211], v[188:191]
 ds_read_b64_tr_b16 v[64:65], v42 offset:18528
 ds_read_b64_tr_b16 v[66:67], v42 offset:23136
 v_mfma_f32_16x16x32_bf16 v[188:191], v[76:79], a[212:215], v[188:191]
 buffer_load_dwordx4 v2, s[12:15], s87 offen offset:2048 sc1 lds
 v_mfma_f32_16x16x32_bf16 v[188:191], v[80:83], a[216:219], v[188:191]
 ds_read_b64_tr_b16 v[68:69], v42 offset:27744
 ds_read_b64_tr_b16 v[70:71], v42 offset:32352
 v_mfma_f32_16x16x32_bf16 v[188:191], v[84:87], a[220:223], v[188:191]
 s_waitcnt lgkmcnt(8)
 v_mfma_f32_16x16x32_bf16 v[192:195], v[88:91], a[192:195], v[192:195]
 ds_read_b64_tr_b16 v[72:73], v42 offset:128
 ds_read_b64_tr_b16 v[74:75], v42 offset:4736
 v_mfma_f32_16x16x32_bf16 v[192:195], v[92:95], a[196:199], v[192:195]
 buffer_load_dwordx4 v2, s[12:15], s87 offen offset:3072 sc1 lds
 v_mfma_f32_16x16x32_bf16 v[192:195], v[96:99], a[200:203], v[192:195]
 s_mov_b32 s87, 593920
 ds_read_b64_tr_b16 v[76:77], v42 offset:9344
 ds_read_b64_tr_b16 v[78:79], v42 offset:13952
 v_mfma_f32_16x16x32_bf16 v[192:195], v[100:103], a[204:207], v[192:195]
 s_add_u32 m0, s60, 4096
 v_mfma_f32_16x16x32_bf16 v[196:199], v[88:91], a[208:211], v[196:199]
 ds_read_b64_tr_b16 v[80:81], v42 offset:18560
 ds_read_b64_tr_b16 v[82:83], v42 offset:23168
 v_mfma_f32_16x16x32_bf16 v[196:199], v[92:95], a[212:215], v[196:199]
 buffer_load_dwordx4 v2, s[12:15], s87 offen offset:0 sc1 lds
 v_mfma_f32_16x16x32_bf16 v[196:199], v[96:99], a[216:219], v[196:199]
 ds_read_b64_tr_b16 v[84:85], v42 offset:27776
 ds_read_b64_tr_b16 v[86:87], v42 offset:32384
 v_mfma_f32_16x16x32_bf16 v[196:199], v[100:103], a[220:223], v[196:199]
 s_waitcnt lgkmcnt(8)
 v_mfma_f32_16x16x32_bf16 v[200:203], v[56:59], a[192:195], v[200:203]
 ds_read_b64_tr_b16 v[88:89], v42 offset:160
 ds_read_b64_tr_b16 v[90:91], v42 offset:4768
 v_mfma_f32_16x16x32_bf16 v[200:203], v[60:63], a[196:199], v[200:203]
 buffer_load_dwordx4 v2, s[12:15], s87 offen offset:1024 sc1 lds
 v_mfma_f32_16x16x32_bf16 v[200:203], v[64:67], a[200:203], v[200:203]
 ds_read_b64_tr_b16 v[92:93], v42 offset:9376
 ds_read_b64_tr_b16 v[94:95], v42 offset:13984
 v_mfma_f32_16x16x32_bf16 v[200:203], v[68:71], a[204:207], v[200:203]
 v_mfma_f32_16x16x32_bf16 v[204:207], v[56:59], a[208:211], v[204:207]
 ds_read_b64_tr_b16 v[96:97], v42 offset:18592
 ds_read_b64_tr_b16 v[98:99], v42 offset:23200
 v_mfma_f32_16x16x32_bf16 v[204:207], v[60:63], a[212:215], v[204:207]
 buffer_load_dwordx4 v2, s[12:15], s87 offen offset:2048 sc1 lds
 v_mfma_f32_16x16x32_bf16 v[204:207], v[64:67], a[216:219], v[204:207]
 ds_read_b64_tr_b16 v[100:101], v42 offset:27808
 ds_read_b64_tr_b16 v[102:103], v42 offset:32416
 v_mfma_f32_16x16x32_bf16 v[204:207], v[68:71], a[220:223], v[204:207]
 s_waitcnt lgkmcnt(8)
 v_mfma_f32_16x16x32_bf16 v[208:211], v[72:75], a[192:195], v[208:211]
 ds_read_b64_tr_b16 v[56:57], v42 offset:192
 ds_read_b64_tr_b16 v[58:59], v42 offset:4800
 v_mfma_f32_16x16x32_bf16 v[208:211], v[76:79], a[196:199], v[208:211]
 buffer_load_dwordx4 v2, s[12:15], s87 offen offset:3072 sc1 lds
 v_mfma_f32_16x16x32_bf16 v[208:211], v[80:83], a[200:203], v[208:211]
 s_mov_b32 s87, 598016
 ds_read_b64_tr_b16 v[60:61], v42 offset:9408
 ds_read_b64_tr_b16 v[62:63], v42 offset:14016
 v_mfma_f32_16x16x32_bf16 v[208:211], v[84:87], a[204:207], v[208:211]
 s_add_u32 m0, s60, 8192
 v_mfma_f32_16x16x32_bf16 v[212:215], v[72:75], a[208:211], v[212:215]
 ds_read_b64_tr_b16 v[64:65], v42 offset:18624
 ds_read_b64_tr_b16 v[66:67], v42 offset:23232
 v_mfma_f32_16x16x32_bf16 v[212:215], v[76:79], a[212:215], v[212:215]
 buffer_load_dwordx4 v2, s[12:15], s87 offen offset:0 sc1 lds
 v_mfma_f32_16x16x32_bf16 v[212:215], v[80:83], a[216:219], v[212:215]
 s_mov_b32 s88, 28672
 ds_read_b64_tr_b16 v[68:69], v42 offset:27840
 ds_read_b64_tr_b16 v[70:71], v42 offset:32448
 v_mfma_f32_16x16x32_bf16 v[212:215], v[84:87], a[220:223], v[212:215]
 s_waitcnt lgkmcnt(8)
 v_mfma_f32_16x16x32_bf16 v[216:219], v[88:91], a[192:195], v[216:219]
 ds_read_b64_tr_b16 v[72:73], v42 offset:224
 ds_read_b64_tr_b16 v[74:75], v42 offset:4832
 v_mfma_f32_16x16x32_bf16 v[216:219], v[92:95], a[196:199], v[216:219]
 buffer_load_dwordx4 a[128:131], v2, s[24:27], s88 offen offset:0 sc1
 v_mfma_f32_16x16x32_bf16 v[216:219], v[96:99], a[200:203], v[216:219]
 ds_read_b64_tr_b16 v[76:77], v42 offset:9440
 ds_read_b64_tr_b16 v[78:79], v42 offset:14048
 v_mfma_f32_16x16x32_bf16 v[216:219], v[100:103], a[204:207], v[216:219]
 v_mfma_f32_16x16x32_bf16 v[220:223], v[88:91], a[208:211], v[220:223]
 ds_read_b64_tr_b16 v[80:81], v42 offset:18656
 ds_read_b64_tr_b16 v[82:83], v42 offset:23264
 v_mfma_f32_16x16x32_bf16 v[220:223], v[92:95], a[212:215], v[220:223]
 buffer_load_dwordx4 a[132:135], v2, s[24:27], s88 offen offset:1024 sc1
 v_mfma_f32_16x16x32_bf16 v[220:223], v[96:99], a[216:219], v[220:223]
 ds_read_b64_tr_b16 v[84:85], v42 offset:27872
 ds_read_b64_tr_b16 v[86:87], v42 offset:32480
 v_mfma_f32_16x16x32_bf16 v[220:223], v[100:103], a[220:223], v[220:223]
 s_waitcnt lgkmcnt(8)
 v_mfma_f32_16x16x32_bf16 v[224:227], v[56:59], a[192:195], v[224:227]
 ds_read_b64_tr_b16 v[88:89], v42 offset:256
 ds_read_b64_tr_b16 v[90:91], v42 offset:4864
 v_mfma_f32_16x16x32_bf16 v[224:227], v[60:63], a[196:199], v[224:227]
 buffer_load_dwordx4 a[136:139], v2, s[24:27], s88 offen offset:2048 sc1
 v_mfma_f32_16x16x32_bf16 v[224:227], v[64:67], a[200:203], v[224:227]
 ds_read_b64_tr_b16 v[92:93], v42 offset:9472
 ds_read_b64_tr_b16 v[94:95], v42 offset:14080
 v_mfma_f32_16x16x32_bf16 v[224:227], v[68:71], a[204:207], v[224:227]
 v_mfma_f32_16x16x32_bf16 v[228:231], v[56:59], a[208:211], v[228:231]
 ds_read_b64_tr_b16 v[96:97], v42 offset:18688
 ds_read_b64_tr_b16 v[98:99], v42 offset:23296
 v_mfma_f32_16x16x32_bf16 v[228:231], v[60:63], a[212:215], v[228:231]
 buffer_load_dwordx4 a[140:143], v2, s[24:27], s88 offen offset:3072 sc1
 v_mfma_f32_16x16x32_bf16 v[228:231], v[64:67], a[216:219], v[228:231]
 s_mov_b32 s89, 161024
 ds_read_b64_tr_b16 v[100:101], v42 offset:27904
 ds_read_b64_tr_b16 v[102:103], v42 offset:32512
 v_mfma_f32_16x16x32_bf16 v[228:231], v[68:71], a[220:223], v[228:231]
 s_waitcnt lgkmcnt(8)
 v_mfma_f32_16x16x32_bf16 v[232:235], v[72:75], a[192:195], v[232:235]
 v_mfma_f32_16x16x32_bf16 v[232:235], v[76:79], a[196:199], v[232:235]
 buffer_load_dwordx4 a[144:147], v2, s[24:27], s89 offen offset:0 sc1
 v_mfma_f32_16x16x32_bf16 v[232:235], v[80:83], a[200:203], v[232:235]
 s_waitcnt vmcnt(23) lgkmcnt(0)
 v_mfma_f32_16x16x32_bf16 v[232:235], v[84:87], a[204:207], v[232:235]
 s_barrier
 v_mfma_f32_16x16x32_bf16 v[236:239], v[72:75], a[208:211], v[236:239]
 ds_read_b64_tr_b16 v[56:57], v43 offset:0
 ds_read_b64_tr_b16 v[58:59], v43 offset:4608
 v_mfma_f32_16x16x32_bf16 v[236:239], v[76:79], a[212:215], v[236:239]
 ds_read_b64_tr_b16 v[60:61], v43 offset:9216
 ds_read_b64_tr_b16 v[62:63], v43 offset:13824
 v_mfma_f32_16x16x32_bf16 v[236:239], v[80:83], a[216:219], v[236:239]
 ds_read_b64_tr_b16 v[64:65], v43 offset:18432
 ds_read_b64_tr_b16 v[66:67], v43 offset:23040
 v_mfma_f32_16x16x32_bf16 v[236:239], v[84:87], a[220:223], v[236:239]
 ds_read_b64_tr_b16 v[68:69], v43 offset:27648
 ds_read_b64_tr_b16 v[70:71], v43 offset:32256
 v_mfma_f32_16x16x32_bf16 v[240:243], v[88:91], a[192:195], v[240:243]
 ds_read_b64_tr_b16 v[72:73], v43 offset:32
 ds_read_b64_tr_b16 v[74:75], v43 offset:4640
 v_mfma_f32_16x16x32_bf16 v[240:243], v[92:95], a[196:199], v[240:243]
 buffer_load_dwordx4 a[148:151], v2, s[24:27], s89 offen offset:1024 sc1
 v_mfma_f32_16x16x32_bf16 v[240:243], v[96:99], a[200:203], v[240:243]
 ds_read_b64_tr_b16 v[76:77], v43 offset:9248
 ds_read_b64_tr_b16 v[78:79], v43 offset:13856
 v_mfma_f32_16x16x32_bf16 v[240:243], v[100:103], a[204:207], v[240:243]
 v_mfma_f32_16x16x32_bf16 v[244:247], v[88:91], a[208:211], v[244:247]
 ds_read_b64_tr_b16 v[80:81], v43 offset:18464
 ds_read_b64_tr_b16 v[82:83], v43 offset:23072
 v_mfma_f32_16x16x32_bf16 v[244:247], v[92:95], a[212:215], v[244:247]
 buffer_load_dwordx4 a[152:155], v2, s[24:27], s89 offen offset:2048 sc1
 v_mfma_f32_16x16x32_bf16 v[244:247], v[96:99], a[216:219], v[244:247]
 ds_read_b64_tr_b16 v[84:85], v43 offset:27680
 ds_read_b64_tr_b16 v[86:87], v43 offset:32288
 v_mfma_f32_16x16x32_bf16 v[244:247], v[100:103], a[220:223], v[244:247]
 s_waitcnt vmcnt(17) lgkmcnt(8)
 s_waitcnt vmcnt(16)
 v_cmp_ne_u32 vcc, s54, v255
 s_cbranch_vccnz L_spin_o2
L_ok_o2:
 v_mfma_f32_16x16x32_bf16 v[176:179], v[56:59], a[224:227], v[176:179]
 ds_read_b64_tr_b16 v[88:89], v43 offset:64
 ds_read_b64_tr_b16 v[90:91], v43 offset:4672
 v_mfma_f32_16x16x32_bf16 v[176:179], v[60:63], a[228:231], v[176:179]
 buffer_load_dwordx4 a[156:159], v2, s[24:27], s89 offen offset:3072 sc1
 v_mfma_f32_16x16x32_bf16 v[176:179], v[64:67], a[232:235], v[176:179]
 s_mov_b32 s87, 626688
 ds_read_b64_tr_b16 v[92:93], v43 offset:9280
 ds_read_b64_tr_b16 v[94:95], v43 offset:13888
 v_mfma_f32_16x16x32_bf16 v[176:179], v[68:71], a[236:239], v[176:179]
 s_add_u32 m0, s60, 126976
 v_mfma_f32_16x16x32_bf16 v[180:183], v[56:59], a[240:243], v[180:183]
 ds_read_b64_tr_b16 v[96:97], v43 offset:18496
 ds_read_b64_tr_b16 v[98:99], v43 offset:23104
 v_mfma_f32_16x16x32_bf16 v[180:183], v[60:63], a[244:247], v[180:183]
 buffer_load_dwordx4 v2, s[12:15], s87 offen offset:0 sc1 lds
 v_mfma_f32_16x16x32_bf16 v[180:183], v[64:67], a[248:251], v[180:183]
 ds_read_b64_tr_b16 v[100:101], v43 offset:27712
 ds_read_b64_tr_b16 v[102:103], v43 offset:32320
 v_mfma_f32_16x16x32_bf16 v[180:183], v[68:71], a[252:255], v[180:183]
 s_waitcnt lgkmcnt(8)
 v_mfma_f32_16x16x32_bf16 v[184:187], v[72:75], a[224:227], v[184:187]
 ds_read_b64_tr_b16 v[56:57], v43 offset:96
 ds_read_b64_tr_b16 v[58:59], v43 offset:4704
 v_mfma_f32_16x16x32_bf16 v[184:187], v[76:79], a[228:231], v[184:187]
 buffer_load_dwordx4 v2, s[12:15], s87 offen offset:1024 sc1 lds
 v_mfma_f32_16x16x32_bf16 v[184:187], v[80:83], a[232:235], v[184:187]
 ds_read_b64_tr_b16 v[60:61], v43 offset:9312
 ds_read_b64_tr_b16 v[62:63], v43 offset:13920
 v_mfma_f32_16x16x32_bf16 v[184:187], v[84:87], a[236:239], v[184:187]
 v_mfma_f32_16x16x32_bf16 v[188:191], v[72:75], a[240:243], v[188:191]
 ds_read_b64_tr_b16 v[64:65], v43 offset:18528
 ds_read_b64_tr_b16 v[66:67], v43 offset:23136
 v_mfma_f32_16x16x32_bf16 v[188:191], v[76:79], a[244:247], v[188:191]
 buffer_load_dwordx4 v2, s[12:15], s87 offen offset:2048 sc1 lds
 v_mfma_f32_16x16x32_bf16 v[188:191], v[80:83], a[248:251], v[188:191]
 ds_read_b64_tr_b16 v[68:69], v43 offset:27744
 ds_read_b64_tr_b16 v[70:71], v43 offset:32352
 v_mfma_f32_16x16x32_bf16 v[188:191], v[84:87], a[252:255], v[188:191]
 s_waitcnt lgkmcnt(8)
 v_mfma_f32_16x16x32_bf16 v[192:195], v[88:91], a[224:227], v[192:195]
 ds_read_b64_tr_b16 v[72:73], v43 offset:128
 ds_read_b64_tr_b16 v[74:75], v43 offset:4736
 v_mfma_f32_16x16x32_bf16 v[192:195], v[92:95], a[228:231], v[192:195]
 buffer_load_dwordx4 v2, s[12:15], s87 offen offset:3072 sc1 lds
 v_mfma_f32_16x16x32_bf16 v[192:195], v[96:99], a[232:235], v[192:195]
 s_mov_b32 s87, 630784
 ds_read_b64_tr_b16 v[76:77], v43 offset:9344
 ds_read_b64_tr_b16 v[78:79], v43 offset:13952
 v_mfma_f32_16x16x32_bf16 v[192:195], v[100:103], a[236:239], v[192:195]
 s_add_u32 m0, s60, 131072
 v_mfma_f32_16x16x32_bf16 v[196:199], v[88:91], a[240:243], v[196:199]
 ds_read_b64_tr_b16 v[80:81], v43 offset:18560
 ds_read_b64_tr_b16 v[82:83], v43 offset:23168
 v_mfma_f32_16x16x32_bf16 v[196:199], v[92:95], a[244:247], v[196:199]
 buffer_load_dwordx4 v2, s[12:15], s87 offen offset:0 sc1 lds
 v_mfma_f32_16x16x32_bf16 v[196:199], v[96:99], a[248:251], v[196:199]
 ds_read_b64_tr_b16 v[84:85], v43 offset:27776
 ds_read_b64_tr_b16 v[86:87], v43 offset:32384
 v_mfma_f32_16x16x32_bf16 v[196:199], v[100:103], a[252:255], v[196:199]
 s_waitcnt lgkmcnt(8)
 v_mfma_f32_16x16x32_bf16 v[200:203], v[56:59], a[224:227], v[200:203]
 ds_read_b64_tr_b16 v[88:89], v43 offset:160
 ds_read_b64_tr_b16 v[90:91], v43 offset:4768
 v_mfma_f32_16x16x32_bf16 v[200:203], v[60:63], a[228:231], v[200:203]
 buffer_load_dwordx4 v2, s[12:15], s87 offen offset:1024 sc1 lds
 v_mfma_f32_16x16x32_bf16 v[200:203], v[64:67], a[232:235], v[200:203]
 ds_read_b64_tr_b16 v[92:93], v43 offset:9376
 ds_read_b64_tr_b16 v[94:95], v43 offset:13984
 v_mfma_f32_16x16x32_bf16 v[200:203], v[68:71], a[236:239], v[200:203]
 v_mfma_f32_16x16x32_bf16 v[204:207], v[56:59], a[240:243], v[204:207]
 ds_read_b64_tr_b16 v[96:97], v43 offset:18592
 ds_read_b64_tr_b16 v[98:99], v43 offset:23200
 v_mfma_f32_16x16x32_bf16 v[204:207], v[60:63], a[244:247], v[204:207]
 buffer_load_dwordx4 v2, s[12:15], s87 offen offset:2048 sc1 lds
 v_mfma_f32_16x16x32_bf16 v[204:207], v[64:67], a[248:251], v[204:207]
 ds_read_b64_tr_b16 v[100:101], v43 offset:27808
 ds_read_b64_tr_b16 v[102:103], v43 offset:32416
 v_mfma_f32_16x16x32_bf16 v[204:207], v[68:71], a[252:255], v[204:207]
 s_waitcnt lgkmcnt(8)
 v_mfma_f32_16x16x32_bf16 v[208:211], v[72:75], a[224:227], v[208:211]
 ds_read_b64_tr_b16 v[56:57], v43 offset:192
 ds_read_b64_tr_b16 v[58:59], v43 offset:4800
 v_mfma_f32_16x16x32_bf16 v[208:211], v[76:79], a[228:231], v[208:211]
 buffer_load_dwordx4 v2, s[12:15], s87 offen offset:3072 sc1 lds
 v_mfma_f32_16x16x32_bf16 v[208:211], v[80:83], a[232:235], v[208:211]
 s_mov_b32 s87, 634880
 ds_read_b64_tr_b16 v[60:61], v43 offset:9408
 ds_read_b64_tr_b16 v[62:63], v43 offset:14016
 v_mfma_f32_16x16x32_bf16 v[208:211], v[84:87], a[236:239], v[208:211]
 s_add_u32 m0, s60, 135168
 v_mfma_f32_16x16x32_bf16 v[212:215], v[72:75], a[240:243], v[212:215]
 ds_read_b64_tr_b16 v[64:65], v43 offset:18624
 ds_read_b64_tr_b16 v[66:67], v43 offset:23232
 v_mfma_f32_16x16x32_bf16 v[212:215], v[76:79], a[244:247], v[212:215]
 buffer_load_dwordx4 v2, s[12:15], s87 offen offset:0 sc1 lds
 v_mfma_f32_16x16x32_bf16 v[212:215], v[80:83], a[248:251], v[212:215]
 s_mov_b32 s88, 32768
 ds_read_b64_tr_b16 v[68:69], v43 offset:27840
 ds_read_b64_tr_b16 v[70:71], v43 offset:32448
 v_mfma_f32_16x16x32_bf16 v[212:215], v[84:87], a[252:255], v[212:215]
 s_waitcnt lgkmcnt(8)
 v_mfma_f32_16x16x32_bf16 v[216:219], v[88:91], a[224:227], v[216:219]
 ds_read_b64_tr_b16 v[72:73], v43 offset:224
 ds_read_b64_tr_b16 v[74:75], v43 offset:4832
 v_mfma_f32_16x16x32_bf16 v[216:219], v[92:95], a[228:231], v[216:219]
 buffer_load_dwordx4 a[160:163], v2, s[24:27], s88 offen offset:0 sc1
 v_mfma_f32_16x16x32_bf16 v[216:219], v[96:99], a[232:235], v[216:219]
 ds_read_b64_tr_b16 v[76:77], v43 offset:9440
 ds_read_b64_tr_b16 v[78:79], v43 offset:14048
 v_mfma_f32_16x16x32_bf16 v[216:219], v[100:103], a[236:239], v[216:219]
 v_mfma_f32_16x16x32_bf16 v[220:223], v[88:91], a[240:243], v[220:223]
 ds_read_b64_tr_b16 v[80:81], v43 offset:18656
 ds_read_b64_tr_b16 v[82:83], v43 offset:23264
 v_mfma_f32_16x16x32_bf16 v[220:223], v[92:95], a[244:247], v[220:223]
 buffer_load_dwordx4 a[164:167], v2, s[24:27], s88 offen offset:1024 sc1
 v_mfma_f32_16x16x32_bf16 v[220:223], v[96:99], a[248:251], v[220:223]
 ds_read_b64_tr_b16 v[84:85], v43 offset:27872
 ds_read_b64_tr_b16 v[86:87], v43 offset:32480
 v_mfma_f32_16x16x32_bf16 v[220:223], v[100:103], a[252:255], v[220:223]
 s_waitcnt lgkmcnt(8)
 v_mfma_f32_16x16x32_bf16 v[224:227], v[56:59], a[224:227], v[224:227]
 ds_read_b64_tr_b16 v[88:89], v43 offset:256
 ds_read_b64_tr_b16 v[90:91], v43 offset:4864
 v_mfma_f32_16x16x32_bf16 v[224:227], v[60:63], a[228:231], v[224:227]
 buffer_load_dwordx4 a[168:171], v2, s[24:27], s88 offen offset:2048 sc1
 v_mfma_f32_16x16x32_bf16 v[224:227], v[64:67], a[232:235], v[224:227]
 ds_read_b64_tr_b16 v[92:93], v43 offset:9472
 ds_read_b64_tr_b16 v[94:95], v43 offset:14080
 v_mfma_f32_16x16x32_bf16 v[224:227], v[68:71], a[236:239], v[224:227]
 v_mfma_f32_16x16x32_bf16 v[228:231], v[56:59], a[240:243], v[228:231]
 ds_read_b64_tr_b16 v[96:97], v43 offset:18688
 ds_read_b64_tr_b16 v[98:99], v43 offset:23296
 v_mfma_f32_16x16x32_bf16 v[228:231], v[60:63], a[244:247], v[228:231]
 buffer_load_dwordx4 a[172:175], v2, s[24:27], s88 offen offset:3072 sc1
 v_mfma_f32_16x16x32_bf16 v[228:231], v[64:67], a[248:251], v[228:231]
 s_mov_b32 s89, 165120
 ds_read_b64_tr_b16 v[100:101], v43 offset:27904
 ds_read_b64_tr_b16 v[102:103], v43 offset:32512
 v_mfma_f32_16x16x32_bf16 v[228:231], v[68:71], a[252:255], v[228:231]
 s_waitcnt lgkmcnt(8)
 v_mfma_f32_16x16x32_bf16 v[232:235], v[72:75], a[224:227], v[232:235]
 buffer_load_dwordx4 a[176:179], v2, s[24:27], s89 offen offset:0 sc1
 v_mfma_f32_16x16x32_bf16 v[232:235], v[76:79], a[228:231], v[232:235]
 v_mfma_f32_16x16x32_bf16 v[232:235], v[80:83], a[232:235], v[232:235]
 s_waitcnt vmcnt(22) lgkmcnt(0)
 v_mfma_f32_16x16x32_bf16 v[232:235], v[84:87], a[236:239], v[232:235]
 s_barrier
 buffer_load_dwordx4 a[180:183], v2, s[24:27], s89 offen offset:1024 sc1
 v_mfma_f32_16x16x32_bf16 v[236:239], v[72:75], a[240:243], v[236:239]
 ds_read_b64_tr_b16 v[56:57], v40 offset:0
 ds_read_b64_tr_b16 v[58:59], v40 offset:4608
 v_mfma_f32_16x16x32_bf16 v[236:239], v[76:79], a[244:247], v[236:239]
 ds_read_b64_tr_b16 v[60:61], v40 offset:9216
 ds_read_b64_tr_b16 v[62:63], v40 offset:13824
 v_mfma_f32_16x16x32_bf16 v[236:239], v[80:83], a[248:251], v[236:239]
 ds_read_b64_tr_b16 v[64:65], v40 offset:18432
 ds_read_b64_tr_b16 v[66:67], v40 offset:23040
 v_mfma_f32_16x16x32_bf16 v[236:239], v[84:87], a[252:255], v[236:239]
 ds_read_b64_tr_b16 v[68:69], v40 offset:27648
 ds_read_b64_tr_b16 v[70:71], v40 offset:32256
 v_mfma_f32_16x16x32_bf16 v[240:243], v[88:91], a[224:227], v[240:243]
 ds_read_b64_tr_b16 v[72:73], v40 offset:32
 ds_read_b64_tr_b16 v[74:75], v40 offset:4640
 v_mfma_f32_16x16x32_bf16 v[240:243], v[92:95], a[228:231], v[240:243]
 buffer_load_dwordx4 a[184:187], v2, s[24:27], s89 offen offset:2048 sc1
 v_mfma_f32_16x16x32_bf16 v[240:243], v[96:99], a[232:235], v[240:243]
 ds_read_b64_tr_b16 v[76:77], v40 offset:9248
 ds_read_b64_tr_b16 v[78:79], v40 offset:13856
 v_mfma_f32_16x16x32_bf16 v[240:243], v[100:103], a[236:239], v[240:243]
 v_mfma_f32_16x16x32_bf16 v[244:247], v[88:91], a[240:243], v[244:247]
 ds_read_b64_tr_b16 v[80:81], v40 offset:18464
 ds_read_b64_tr_b16 v[82:83], v40 offset:23072
 v_mfma_f32_16x16x32_bf16 v[244:247], v[92:95], a[244:247], v[244:247]
 buffer_load_dwordx4 a[188:191], v2, s[24:27], s89 offen offset:3072 sc1
 v_mfma_f32_16x16x32_bf16 v[244:247], v[96:99], a[248:251], v[244:247]
 ds_read_b64_tr_b16 v[84:85], v40 offset:27680
 ds_read_b64_tr_b16 v[86:87], v40 offset:32288
 v_mfma_f32_16x16x32_bf16 v[244:247], v[100:103], a[252:255], v[244:247]
 s_waitcnt vmcnt(17) lgkmcnt(8)
L_dskip:
 v_mfma_f32_16x16x32_bf16 v[176:179], v[56:59], a[128:131], v[176:179]
 s_add_u32 s87, s55, 663552
 ds_read_b64_tr_b16 v[88:89], v40 offset:64
 ds_read_b64_tr_b16 v[90:91], v40 offset:4672
 v_mfma_f32_16x16x32_bf16 v[176:179], v[60:63], a[132:135], v[176:179]
 s_add_u32 m0, s60, 36864
 buffer_load_dword v255, v254, s[32:35], s66 offen sc1
 v_mfma_f32_16x16x32_bf16 v[176:179], v[64:67], a[136:139], v[176:179]
 ds_read_b64_tr_b16 v[92:93], v40 offset:9280
 ds_read_b64_tr_b16 v[94:95], v40 offset:13888
 v_mfma_f32_16x16x32_bf16 v[176:179], v[68:71], a[140:143], v[176:179]
 v_mfma_f32_16x16x32_bf16 v[180:183], v[56:59], a[144:147], v[180:183]
 ds_read_b64_tr_b16 v[96:97], v40 offset:18496
 ds_read_b64_tr_b16 v[98:99], v40 offset:23104
 v_mfma_f32_16x16x32_bf16 v[180:183], v[60:63], a[148:151], v[180:183]
 buffer_load_dwordx4 v2, s[12:15], s87 offen offset:0 sc1 lds
 v_mfma_f32_16x16x32_bf16 v[180:183], v[64:67], a[152:155], v[180:183]
 ds_read_b64_tr_b16 v[100:101], v40 offset:27712
 ds_read_b64_tr_b16 v[102:103], v40 offset:32320
 v_mfma_f32_16x16x32_bf16 v[180:183], v[68:71], a[156:159], v[180:183]
 s_waitcnt lgkmcnt(8)
 v_mfma_f32_16x16x32_bf16 v[184:187], v[72:75], a[128:131], v[184:187]
 ds_read_b64_tr_b16 v[56:57], v40 offset:96
 ds_read_b64_tr_b16 v[58:59], v40 offset:4704
 v_mfma_f32_16x16x32_bf16 v[184:187], v[76:79], a[132:135], v[184:187]
 buffer_load_dwordx4 v2, s[12:15], s87 offen offset:1024 sc1 lds
 v_mfma_f32_16x16x32_bf16 v[184:187], v[80:83], a[136:139], v[184:187]
 ds_read_b64_tr_b16 v[60:61], v40 offset:9312
 ds_read_b64_tr_b16 v[62:63], v40 offset:13920
 v_mfma_f32_16x16x32_bf16 v[184:187], v[84:87], a[140:143], v[184:187]
 v_mfma_f32_16x16x32_bf16 v[188:191], v[72:75], a[144:147], v[188:191]
 ds_read_b64_tr_b16 v[64:65], v40 offset:18528
 ds_read_b64_tr_b16 v[66:67], v40 offset:23136
 v_mfma_f32_16x16x32_bf16 v[188:191], v[76:79], a[148:151], v[188:191]
 buffer_load_dwordx4 v2, s[12:15], s87 offen offset:2048 sc1 lds
 v_mfma_f32_16x16x32_bf16 v[188:191], v[80:83], a[152:155], v[188:191]
 ds_read_b64_tr_b16 v[68:69], v40 offset:27744
 ds_read_b64_tr_b16 v[70:71], v40 offset:32352
 v_mfma_f32_16x16x32_bf16 v[188:191], v[84:87], a[156:159], v[188:191]
 s_waitcnt lgkmcnt(8)
 v_mfma_f32_16x16x32_bf16 v[192:195], v[88:91], a[128:131], v[192:195]
 ds_read_b64_tr_b16 v[72:73], v40 offset:128
 ds_read_b64_tr_b16 v[74:75], v40 offset:4736
 v_mfma_f32_16x16x32_bf16 v[192:195], v[92:95], a[132:135], v[192:195]
 buffer_load_dwordx4 v2, s[12:15], s87 offen offset:3072 sc1 lds
 v_mfma_f32_16x16x32_bf16 v[192:195], v[96:99], a[136:139], v[192:195]
 s_add_u32 s87, s55, 667648
 ds_read_b64_tr_b16 v[76:77], v40 offset:9344
 ds_read_b64_tr_b16 v[78:79], v40 offset:13952
 v_mfma_f32_16x16x32_bf16 v[192:195], v[100:103], a[140:143], v[192:195]
 s_add_u32 m0, s60, 40960
 v_mfma_f32_16x16x32_bf16 v[196:199], v[88:91], a[144:147], v[196:199]
 ds_read_b64_tr_b16 v[80:81], v40 offset:18560
 ds_read_b64_tr_b16 v[82:83], v40 offset:23168
 v_mfma_f32_16x16x32_bf16 v[196:199], v[92:95], a[148:151], v[196:199]
 buffer_load_dwordx4 v2, s[12:15], s87 offen offset:0 sc1 lds
 v_mfma_f32_16x16x32_bf16 v[196:199], v[96:99], a[152:155], v[196:199]
 ds_read_b64_tr_b16 v[84:85], v40 offset:27776
 ds_read_b64_tr_b16 v[86:87], v40 offset:32384
 v_mfma_f32_16x16x32_bf16 v[196:199], v[100:103], a[156:159], v[196:199]
 s_waitcnt lgkmcnt(8)
 v_mfma_f32_16x16x32_bf16 v[200:203], v[56:59], a[128:131], v[200:203]
 ds_read_b64_tr_b16 v[88:89], v40 offset:160
 ds_read_b64_tr_b16 v[90:91], v40 offset:4768
 v_mfma_f32_16x16x32_bf16 v[200:203], v[60:63], a[132:135], v[200:203]
 buffer_load_dwordx4 v2, s[12:15], s87 offen offset:1024 sc1 lds
 v_mfma_f32_16x16x32_bf16 v[200:203], v[64:67], a[136:139], v[200:203]
 ds_read_b64_tr_b16 v[92:93], v40 offset:9376
 ds_read_b64_tr_b16 v[94:95], v40 offset:13984
 v_mfma_f32_16x16x32_bf16 v[200:203], v[68:71], a[140:143], v[200:203]
 v_mfma_f32_16x16x32_bf16 v[204:207], v[56:59], a[144:147], v[204:207]
 ds_read_b64_tr_b16 v[96:97], v40 offset:18592
 ds_read_b64_tr_b16 v[98:99], v40 offset:23200
 v_mfma_f32_16x16x32_bf16 v[204:207], v[60:63], a[148:151], v[204:207]
 buffer_load_dwordx4 v2, s[12:15], s87 offen offset:2048 sc1 lds
 v_mfma_f32_16x16x32_bf16 v[204:207], v[64:67], a[152:155], v[204:207]
 ds_read_b64_tr_b16 v[100:101], v40 offset:27808
 ds_read_b64_tr_b16 v[102:103], v40 offset:32416
 v_mfma_f32_16x16x32_bf16 v[204:207], v[68:71], a[156:159], v[204:207]
 s_waitcnt lgkmcnt(8)
 v_mfma_f32_16x16x32_bf16 v[208:211], v[72:75], a[128:131], v[208:211]
 ds_read_b64_tr_b16 v[56:57], v40 offset:192
 ds_read_b64_tr_b16 v[58:59], v40 offset:4800
 v_mfma_f32_16x16x32_bf16 v[208:211], v[76:79], a[132:135], v[208:211]
 buffer_load_dwordx4 v2, s[12:15], s87 offen offset:3072 sc1 lds
 v_mfma_f32_16x16x32_bf16 v[208:211], v[80:83], a[136:139], v[208:211]
 s_add_u32 s87, s55, 671744
 ds_read_b64_tr_b16 v[60:61], v40 offset:9408
 ds_read_b64_tr_b16 v[62:63], v40 offset:14016
 v_mfma_f32_16x16x32_bf16 v[208:211], v[84:87], a[140:143], v[208:211]
 s_add_u32 m0, s60, 45056
 v_mfma_f32_16x16x32_bf16 v[212:215], v[72:75], a[144:147], v[212:215]
 ds_read_b64_tr_b16 v[64:65], v40 offset:18624
 ds_read_b64_tr_b16 v[66:67], v40 offset:23232
 v_mfma_f32_16x16x32_bf16 v[212:215], v[76:79], a[148:151], v[212:215]
 buffer_load_dwordx4 v2, s[12:15], s87 offen offset:0 sc1 lds
 v_mfma_f32_16x16x32_bf16 v[212:215], v[80:83], a[152:155], v[212:215]
 s_add_u32 s88, s56, 36864
 ds_read_b64_tr_b16 v[68:69], v40 offset:27840
 ds_read_b64_tr_b16 v[70:71], v40 offset:32448
 v_mfma_f32_16x16x32_bf16 v[212:215], v[84:87], a[156:159], v[212:215]
 s_waitcnt lgkmcnt(8)
 v_mfma_f32_16x16x32_bf16 v[216:219], v[88:91], a[128:131], v[216:219]
 ds_read_b64_tr_b16 v[72:73], v40 offset:224
 ds_read_b64_tr_b16 v[74:75], v40 offset:4832
 v_mfma_f32_16x16x32_bf16 v[216:219], v[92:95], a[132:135], v[216:219]
 buffer_load_dwordx4 a[192:195], v2, s[24:27], s88 offen offset:0 sc1
 v_mfma_f32_16x16x32_bf16 v[216:219], v[96:99], a[136:139], v[216:219]
 ds_read_b64_tr_b16 v[76:77], v40 offset:9440
 ds_read_b64_tr_b16 v[78:79], v40 offset:14048
 v_mfma_f32_16x16x32_bf16 v[216:219], v[100:103], a[140:143], v[216:219]
 v_mfma_f32_16x16x32_bf16 v[220:223], v[88:91], a[144:147], v[220:223]
 ds_read_b64_tr_b16 v[80:81], v40 offset:18656
 ds_read_b64_tr_b16 v[82:83], v40 offset:23264
 v_mfma_f32_16x16x32_bf16 v[220:223], v[92:95], a[148:151], v[220:223]
 buffer_load_dwordx4 a[196:199], v2, s[24:27], s88 offen offset:1024 sc1
 v_mfma_f32_16x16x32_bf16 v[220:223], v[96:99], a[152:155], v[220:223]
 ds_read_b64_tr_b16 v[84:85], v40 offset:27872
 ds_read_b64_tr_b16 v[86:87], v40 offset:32480
 v_mfma_f32_16x16x32_bf16 v[220:223], v[100:103], a[156:159], v[220:223]
 s_waitcnt lgkmcnt(8)
 v_mfma_f32_16x16x32_bf16 v[224:227], v[56:59], a[128:131], v[224:227]
 ds_read_b64_tr_b16 v[88:89], v40 offset:256
 ds_read_b64_tr_b16 v[90:91], v40 offset:4864
 v_mfma_f32_16x16x32_bf16 v[224:227], v[60:63], a[132:135], v[224:227]
 buffer_load_dwordx4 a[200:203], v2, s[24:27], s88 offen offset:2048 sc1
 v_mfma_f32_16x16x32_bf16 v[224:227], v[64:67], a[136:139], v[224:227]
 ds_read_b64_tr_b16 v[92:93], v40 offset:9472
 ds_read_b64_tr_b16 v[94:95], v40 offset:14080
 v_mfma_f32_16x16x32_bf16 v[224:227], v[68:71], a[140:143], v[224:227]
 v_mfma_f32_16x16x32_bf16 v[228:231], v[56:59], a[144:147], v[228:231]
 ds_read_b64_tr_b16 v[96:97], v40 offset:18688
 ds_read_b64_tr_b16 v[98:99], v40 offset:23296
 v_mfma_f32_16x16x32_bf16 v[228:231], v[60:63], a[148:151], v[228:231]
 buffer_load_dwordx4 a[204:207], v2, s[24:27], s88 offen offset:3072 sc1
 v_mfma_f32_16x16x32_bf16 v[228:231], v[64:67], a[152:155], v[228:231]
 s_add_u32 s89, s56, 169216
 ds_read_b64_tr_b16 v[100:101], v40 offset:27904
 ds_read_b64_tr_b16 v[102:103], v40 offset:32512
 v_mfma_f32_16x16x32_bf16 v[228:231], v[68:71], a[156:159], v[228:231]
 s_waitcnt lgkmcnt(8)
 v_mfma_f32_16x16x32_bf16 v[232:235], v[72:75], a[128:131], v[232:235]
 v_mfma_f32_16x16x32_bf16 v[232:235], v[76:79], a[132:135], v[232:235]
 buffer_load_dwordx4 a[208:211], v2, s[24:27], s89 offen offset:0 sc1
 v_mfma_f32_16x16x32_bf16 v[232:235], v[80:83], a[136:139], v[232:235]
 s_waitcnt vmcnt(23) lgkmcnt(0)
 v_mfma_f32_16x16x32_bf16 v[232:235], v[84:87], a[140:143], v[232:235]
 s_barrier
 v_mfma_f32_16x16x32_bf16 v[236:239], v[72:75], a[144:147], v[236:239]
 ds_read_b64_tr_b16 v[56:57], v41 offset:0
 ds_read_b64_tr_b16 v[58:59], v41 offset:4608
 v_mfma_f32_16x16x32_bf16 v[236:239], v[76:79], a[148:151], v[236:239]
 ds_read_b64_tr_b16 v[60:61], v41 offset:9216
 ds_read_b64_tr_b16 v[62:63], v41 offset:13824
 v_mfma_f32_16x16x32_bf16 v[236:239], v[80:83], a[152:155], v[236:239]
 ds_read_b64_tr_b16 v[64:65], v41 offset:18432
 ds_read_b64_tr_b16 v[66:67], v41 offset:23040
 v_mfma_f32_16x16x32_bf16 v[236:239], v[84:87], a[156:159], v[236:239]
 ds_read_b64_tr_b16 v[68:69], v41 offset:27648
 ds_read_b64_tr_b16 v[70:71], v41 offset:32256
 v_mfma_f32_16x16x32_bf16 v[240:243], v[88:91], a[128:131], v[240:243]
 ds_read_b64_tr_b16 v[72:73], v41 offset:32
 ds_read_b64_tr_b16 v[74:75], v41 offset:4640
 v_mfma_f32_16x16x32_bf16 v[240:243], v[92:95], a[132:135], v[240:243]
 buffer_load_dwordx4 a[212:215], v2, s[24:27], s89 offen offset:1024 sc1
 v_mfma_f32_16x16x32_bf16 v[240:243], v[96:99], a[136:139], v[240:243]
 ds_read_b64_tr_b16 v[76:77], v41 offset:9248
 ds_read_b64_tr_b16 v[78:79], v41 offset:13856
 v_mfma_f32_16x16x32_bf16 v[240:243], v[100:103], a[140:143], v[240:243]
 v_mfma_f32_16x16x32_bf16 v[244:247], v[88:91], a[144:147], v[244:247]
 ds_read_b64_tr_b16 v[80:81], v41 offset:18464
 ds_read_b64_tr_b16 v[82:83], v41 offset:23072
 v_mfma_f32_16x16x32_bf16 v[244:247], v[92:95], a[148:151], v[244:247]
 buffer_load_dwordx4 a[216:219], v2, s[24:27], s89 offen offset:2048 sc1
 v_mfma_f32_16x16x32_bf16 v[244:247], v[96:99], a[152:155], v[244:247]
 ds_read_b64_tr_b16 v[84:85], v41 offset:27680
 ds_read_b64_tr_b16 v[86:87], v41 offset:32288
 v_mfma_f32_16x16x32_bf16 v[244:247], v[100:103], a[156:159], v[244:247]
 s_waitcnt vmcnt(17) lgkmcnt(8)
 s_waitcnt vmcnt(16)
 v_cmp_ne_u32 vcc, s54, v255
 s_cbranch_vccnz L_spin_p2
L_ok_p2:
 v_mfma_f32_16x16x32_bf16 v[176:179], v[56:59], a[160:163], v[176:179]
 ds_read_b64_tr_b16 v[88:89], v41 offset:64
 ds_read_b64_tr_b16 v[90:91], v41 offset:4672
 v_mfma_f32_16x16x32_bf16 v[176:179], v[60:63], a[164:167], v[176:179]
 buffer_load_dwordx4 a[220:223], v2, s[24:27], s89 offen offset:3072 sc1
 v_mfma_f32_16x16x32_bf16 v[176:179], v[64:67], a[168:171], v[176:179]
 s_add_u32 s66, s66, 32768
 ds_read_b64_tr_b16 v[92:93], v41 offset:9280
 ds_read_b64_tr_b16 v[94:95], v41 offset:13888
 v_mfma_f32_16x16x32_bf16 v[176:179], v[68:71], a[172:175], v[176:179]
 s_add_u32 s67, s67, 32768
 v_mfma_f32_16x16x32_bf16 v[180:183], v[56:59], a[176:179], v[180:183]
 s_mov_b32 s83, 9437184
 ds_read_b64_tr_b16 v[96:97], v41 offset:18496
 ds_read_b64_tr_b16 v[98:99], v41 offset:23104
 v_mfma_f32_16x16x32_bf16 v[180:183], v[60:63], a[180:183], v[180:183]
 buffer_load_dwordx4 v[104:107], v2, s[40:43], s83 offen sc1
 v_mfma_f32_16x16x32_bf16 v[180:183], v[64:67], a[184:187], v[180:183]
 s_mov_b32 s84, 9474048
 ds_read_b64_tr_b16 v[100:101], v41 offset:27712
 ds_read_b64_tr_b16 v[102:103], v41 offset:32320
 v_mfma_f32_16x16x32_bf16 v[180:183], v[68:71], a[188:191], v[180:183]
 s_waitcnt lgkmcnt(8)
 v_mfma_f32_16x16x32_bf16 v[184:187], v[72:75], a[160:163], v[184:187]
 ds_read_b64_tr_b16 v[56:57], v41 offset:96
 ds_read_b64_tr_b16 v[58:59], v41 offset:4704
 v_mfma_f32_16x16x32_bf16 v[184:187], v[76:79], a[164:167], v[184:187]
 buffer_load_dwordx4 v[108:111], v2, s[40:43], s84 offen sc1
 v_mfma_f32_16x16x32_bf16 v[184:187], v[80:83], a[168:171], v[184:187]
 s_mov_b32 s83, 9510912
 ds_read_b64_tr_b16 v[60:61], v41 offset:9312
 ds_read_b64_tr_b16 v[62:63], v41 offset:13920
 v_mfma_f32_16x16x32_bf16 v[184:187], v[84:87], a[172:175], v[184:187]
 v_mfma_f32_16x16x32_bf16 v[188:191], v[72:75], a[176:179], v[188:191]
 ds_read_b64_tr_b16 v[64:65], v41 offset:18528
 ds_read_b64_tr_b16 v[66:67], v41 offset:23136
 v_mfma_f32_16x16x32_bf16 v[188:191], v[76:79], a[180:183], v[188:191]
 buffer_load_dwordx4 v[112:115], v2, s[40:43], s83 offen sc1
 v_mfma_f32_16x16x32_bf16 v[188:191], v[80:83], a[184:187], v[188:191]
 s_mov_b32 s84, 9547776
 ds_read_b64_tr_b16 v[68:69], v41 offset:27744
 ds_read_b64_tr_b16 v[70:71], v41 offset:32352
 v_mfma_f32_16x16x32_bf16 v[188:191], v[84:87], a[188:191], v[188:191]
 s_waitcnt lgkmcnt(8)
 v_mfma_f32_16x16x32_bf16 v[192:195], v[88:91], a[160:163], v[192:195]
 ds_read_b64_tr_b16 v[72:73], v41 offset:128
 ds_read_b64_tr_b16 v[74:75], v41 offset:4736
 v_mfma_f32_16x16x32_bf16 v[192:195], v[92:95], a[164:167], v[192:195]
 buffer_load_dwordx4 v[116:119], v2, s[40:43], s84 offen sc1
 v_mfma_f32_16x16x32_bf16 v[192:195], v[96:99], a[168:171], v[192:195]
 s_mov_b32 s83, 9441280
 ds_read_b64_tr_b16 v[76:77], v41 offset:9344
 ds_read_b64_tr_b16 v[78:79], v41 offset:13952
 v_mfma_f32_16x16x32_bf16 v[192:195], v[100:103], a[172:175], v[192:195]
 v_mfma_f32_16x16x32_bf16 v[196:199], v[88:91], a[176:179], v[196:199]
 ds_read_b64_tr_b16 v[80:81], v41 offset:18560
 ds_read_b64_tr_b16 v[82:83], v41 offset:23168
 v_mfma_f32_16x16x32_bf16 v[196:199], v[92:95], a[180:183], v[196:199]
 buffer_load_dwordx4 v[120:123], v2, s[40:43], s83 offen sc1
 v_mfma_f32_16x16x32_bf16 v[196:199], v[96:99], a[184:187], v[196:199]
 s_mov_b32 s84, 9478144
 ds_read_b64_tr_b16 v[84:85], v41 offset:27776
 ds_read_b64_tr_b16 v[86:87], v41 offset:32384
 v_mfma_f32_16x16x32_bf16 v[196:199], v[100:103], a[188:191], v[196:199]
 s_waitcnt lgkmcnt(8)
 v_mfma_f32_16x16x32_bf16 v[200:203], v[56:59], a[160:163], v[200:203]
 ds_read_b64_tr_b16 v[88:89], v41 offset:160
 ds_read_b64_tr_b16 v[90:91], v41 offset:4768
 v_mfma_f32_16x16x32_bf16 v[200:203], v[60:63], a[164:167], v[200:203]
 buffer_load_dwordx4 v[124:127], v2, s[40:43], s84 offen sc1
 v_mfma_f32_16x16x32_bf16 v[200:203], v[64:67], a[168:171], v[200:203]
 s_mov_b32 s83, 9515008
 ds_read_b64_tr_b16 v[92:93], v41 offset:9376
 ds_read_b64_tr_b16 v[94:95], v41 offset:13984
 v_mfma_f32_16x16x32_bf16 v[200:203], v[68:71], a[172:175], v[200:203]
 v_mfma_f32_16x16x32_bf16 v[204:207], v[56:59], a[176:179], v[204:207]
 ds_read_b64_tr_b16 v[96:97], v41 offset:18592
 ds_read_b64_tr_b16 v[98:99], v41 offset:23200
 v_mfma_f32_16x16x32_bf16 v[204:207], v[60:63], a[180:183], v[204:207]
 buffer_load_dwordx4 v[128:131], v2, s[40:43], s83 offen sc1
 v_mfma_f32_16x16x32_bf16 v[204:207], v[64:67], a[184:187], v[204:207]
 s_mov_b32 s84, 9551872
 ds_read_b64_tr_b16 v[100:101], v41 offset:27808
 ds_read_b64_tr_b16 v[102:103], v41 offset:32416
 v_mfma_f32_16x16x32_bf16 v[204:207], v[68:71], a[188:191], v[204:207]
 s_waitcnt lgkmcnt(8)
 v_mfma_f32_16x16x32_bf16 v[208:211], v[72:75], a[160:163], v[208:211]
 ds_read_b64_tr_b16 v[56:57], v41 offset:192
 ds_read_b64_tr_b16 v[58:59], v41 offset:4800
 v_mfma_f32_16x16x32_bf16 v[208:211], v[76:79], a[164:167], v[208:211]
 buffer_load_dwordx4 v[132:135], v2, s[40:43], s84 offen sc1
 v_mfma_f32_16x16x32_bf16 v[208:211], v[80:83], a[168:171], v[208:211]
 s_add_u32 s83, s62, 9445376
 ds_read_b64_tr_b16 v[60:61], v41 offset:9408
 ds_read_b64_tr_b16 v[62:63], v41 offset:14016
 v_mfma_f32_16x16x32_bf16 v[208:211], v[84:87], a[172:175], v[208:211]
 v_mfma_f32_16x16x32_bf16 v[212:215], v[72:75], a[176:179], v[212:215]
 ds_read_b64_tr_b16 v[64:65], v41 offset:18624
 ds_read_b64_tr_b16 v[66:67], v41 offset:23232
 v_mfma_f32_16x16x32_bf16 v[212:215], v[76:79], a[180:183], v[212:215]
 buffer_load_dwordx4 v[136:139], v2, s[40:43], s83 offen sc1
 v_mfma_f32_16x16x32_bf16 v[212:215], v[80:83], a[184:187], v[212:215]
 s_add_u32 s84, s62, 9482240
 ds_read_b64_tr_b16 v[68:69], v41 offset:27840
 ds_read_b64_tr_b16 v[70:71], v41 offset:32448
 v_mfma_f32_16x16x32_bf16 v[212:215], v[84:87], a[188:191], v[212:215]
 s_waitcnt lgkmcnt(8)
 v_mfma_f32_16x16x32_bf16 v[216:219], v[88:91], a[160:163], v[216:219]
 ds_read_b64_tr_b16 v[72:73], v41 offset:224
 ds_read_b64_tr_b16 v[74:75], v41 offset:4832
 v_mfma_f32_16x16x32_bf16 v[216:219], v[92:95], a[164:167], v[216:219]
 buffer_load_dwordx4 v[140:143], v2, s[40:43], s84 offen sc1
 v_mfma_f32_16x16x32_bf16 v[216:219], v[96:99], a[168:171], v[216:219]
 s_add_u32 s83, s62, 9519104
 ds_read_b64_tr_b16 v[76:77], v41 offset:9440
 ds_read_b64_tr_b16 v[78:79], v41 offset:14048
 v_mfma_f32_16x16x32_bf16 v[216:219], v[100:103], a[172:175], v[216:219]
 v_mfma_f32_16x16x32_bf16 v[220:223], v[88:91], a[176:179], v[220:223]
 ds_read_b64_tr_b16 v[80:81], v41 offset:18656
 ds_read_b64_tr_b16 v[82:83], v41 offset:23264
 v_mfma_f32_16x16x32_bf16 v[220:223], v[92:95], a[180:183], v[220:223]
 buffer_load_dwordx4 v[144:147], v2, s[40:43], s83 offen sc1
 v_mfma_f32_16x16x32_bf16 v[220:223], v[96:99], a[184:187], v[220:223]
 s_add_u32 s84, s62, 9555968
 ds_read_b64_tr_b16 v[84:85], v41 offset:27872
 ds_read_b64_tr_b16 v[86:87], v41 offset:32480
 v_mfma_f32_16x16x32_bf16 v[220:223], v[100:103], a[188:191], v[220:223]
 s_waitcnt lgkmcnt(8)
 v_mfma_f32_16x16x32_bf16 v[224:227], v[56:59], a[160:163], v[224:227]
 ds_read_b64_tr_b16 v[88:89], v41 offset:256
 ds_read_b64_tr_b16 v[90:91], v41 offset:4864
 v_mfma_f32_16x16x32_bf16 v[224:227], v[60:63], a[164:167], v[224:227]
 buffer_load_dwordx4 v[148:151], v2, s[40:43], s84 offen sc1
 v_mfma_f32_16x16x32_bf16 v[224:227], v[64:67], a[168:171], v[224:227]
 ds_read_b64_tr_b16 v[92:93], v41 offset:9472
 ds_read_b64_tr_b16 v[94:95], v41 offset:14080
 v_mfma_f32_16x16x32_bf16 v[224:227], v[68:71], a[172:175], v[224:227]
 v_mfma_f32_16x16x32_bf16 v[228:231], v[56:59], a[176:179], v[228:231]
 ds_read_b64_tr_b16 v[96:97], v41 offset:18688
 ds_read_b64_tr_b16 v[98:99], v41 offset:23296
 v_mfma_f32_16x16x32_bf16 v[228:231], v[60:63], a[180:183], v[228:231]
 v_mfma_f32_16x16x32_bf16 v[228:231], v[64:67], a[184:187], v[228:231]
 ds_read_b64_tr_b16 v[100:101], v41 offset:27904
 ds_read_b64_tr_b16 v[102:103], v41 offset:32512
 v_mfma_f32_16x16x32_bf16 v[228:231], v[68:71], a[188:191], v[228:231]
 s_waitcnt lgkmcnt(8)
 v_mfma_f32_16x16x32_bf16 v[232:235], v[72:75], a[160:163], v[232:235]
 v_mfma_f32_16x16x32_bf16 v[232:235], v[76:79], a[164:167], v[232:235]
 v_mfma_f32_16x16x32_bf16 v[232:235], v[80:83], a[168:171], v[232:235]
 s_waitcnt vmcnt(20) lgkmcnt(0)
 v_mfma_f32_16x16x32_bf16 v[232:235], v[84:87], a[172:175], v[232:235]
 s_barrier
 v_mfma_f32_16x16x32_bf16 v[236:239], v[72:75], a[176:179], v[236:239]
 ds_read_b64_tr_b16 v[56:57], v42 offset:0
 ds_read_b64_tr_b16 v[58:59], v42 offset:4608
 v_mfma_f32_16x16x32_bf16 v[236:239], v[76:79], a[180:183], v[236:239]
 ds_read_b64_tr_b16 v[60:61], v42 offset:9216
 ds_read_b64_tr_b16 v[62:63], v42 offset:13824
 v_mfma_f32_16x16x32_bf16 v[236:239], v[80:83], a[184:187], v[236:239]
 ds_read_b64_tr_b16 v[64:65], v42 offset:18432
 ds_read_b64_tr_b16 v[66:67], v42 offset:23040
 v_mfma_f32_16x16x32_bf16 v[236:239], v[84:87], a[188:191], v[236:239]
 ds_read_b64_tr_b16 v[68:69], v42 offset:27648
 ds_read_b64_tr_b16 v[70:71], v42 offset:32256
 v_mfma_f32_16x16x32_bf16 v[240:243], v[88:91], a[160:163], v[240:243]
 ds_read_b64_tr_b16 v[72:73], v42 offset:32
 ds_read_b64_tr_b16 v[74:75], v42 offset:4640
 v_mfma_f32_16x16x32_bf16 v[240:243], v[92:95], a[164:167], v[240:243]
 v_mfma_f32_16x16x32_bf16 v[240:243], v[96:99], a[168:171], v[240:243]
 ds_read_b64_tr_b16 v[76:77], v42 offset:9248
 ds_read_b64_tr_b16 v[78:79], v42 offset:13856
 v_mfma_f32_16x16x32_bf16 v[240:243], v[100:103], a[172:175], v[240:243]
 v_mfma_f32_16x16x32_bf16 v[244:247], v[88:91], a[176:179], v[244:247]
 ds_read_b64_tr_b16 v[80:81], v42 offset:18464
 ds_read_b64_tr_b16 v[82:83], v42 offset:23072
 v_mfma_f32_16x16x32_bf16 v[244:247], v[92:95], a[180:183], v[244:247]
 v_mfma_f32_16x16x32_bf16 v[244:247], v[96:99], a[184:187], v[244:247]
 ds_read_b64_tr_b16 v[84:85], v42 offset:27680
 ds_read_b64_tr_b16 v[86:87], v42 offset:32288
 v_mfma_f32_16x16x32_bf16 v[244:247], v[100:103], a[188:191], v[244:247]
 s_waitcnt vmcnt(12) lgkmcnt(8)
 v_mfma_f32_16x16x32_bf16 v[176:179], v[56:59], a[192:195], v[176:179]
 ds_read_b64_tr_b16 v[88:89], v42 offset:64
 ds_read_b64_tr_b16 v[90:91], v42 offset:4672
 v_mfma_f32_16x16x32_bf16 v[176:179], v[60:63], a[196:199], v[176:179]
 v_mfma_f32_16x16x32_bf16 v[176:179], v[64:67], a[200:203], v[176:179]
 ds_read_b64_tr_b16 v[92:93], v42 offset:9280
 ds_read_b64_tr_b16 v[94:95], v42 offset:13888
 v_mfma_f32_16x16x32_bf16 v[176:179], v[68:71], a[204:207], v[176:179]
 v_mfma_f32_16x16x32_bf16 v[180:183], v[56:59], a[208:211], v[180:183]
 ds_read_b64_tr_b16 v[96:97], v42 offset:18496
 ds_read_b64_tr_b16 v[98:99], v42 offset:23104
 v_mfma_f32_16x16x32_bf16 v[180:183], v[60:63], a[212:215], v[180:183]
 v_mfma_f32_16x16x32_bf16 v[180:183], v[64:67], a[216:219], v[180:183]
 ds_read_b64_tr_b16 v[100:101], v42 offset:27712
 ds_read_b64_tr_b16 v[102:103], v42 offset:32320
 v_mfma_f32_16x16x32_bf16 v[180:183], v[68:71], a[220:223], v[180:183]
 s_waitcnt lgkmcnt(8)
 v_mfma_f32_16x16x32_bf16 v[184:187], v[72:75], a[192:195], v[184:187]
 ds_read_b64_tr_b16 v[56:57], v42 offset:96
 ds_read_b64_tr_b16 v[58:59], v42 offset:4704
 v_mfma_f32_16x16x32_bf16 v[184:187], v[76:79], a[196:199], v[184:187]
 v_mfma_f32_16x16x32_bf16 v[184:187], v[80:83], a[200:203], v[184:187]
 ds_read_b64_tr_b16 v[60:61], v42 offset:9312
 ds_read_b64_tr_b16 v[62:63], v42 offset:13920
 v_mfma_f32_16x16x32_bf16 v[184:187], v[84:87], a[204:207], v[184:187]
 v_mfma_f32_16x16x32_bf16 v[188:191], v[72:75], a[208:211], v[188:191]
 ds_read_b64_tr_b16 v[64:65], v42 offset:18528
 ds_read_b64_tr_b16 v[66:67], v42 offset:23136
 v_mfma_f32_16x16x32_bf16 v[188:191], v[76:79], a[212:215], v[188:191]
 v_mfma_f32_16x16x32_bf16 v[188:191], v[80:83], a[216:219], v[188:191]
 ds_read_b64_tr_b16 v[68:69], v42 offset:27744
 ds_read_b64_tr_b16 v[70:71], v42 offset:32352
 v_mfma_f32_16x16x32_bf16 v[188:191], v[84:87], a[220:223], v[188:191]
 s_waitcnt lgkmcnt(8)
 v_mfma_f32_16x16x32_bf16 v[192:195], v[88:91], a[192:195], v[192:195]
 s_mov_b32 s79, 0
 ds_read_b64_tr_b16 v[72:73], v42 offset:128
 ds_read_b64_tr_b16 v[74:75], v42 offset:4736
 v_mfma_f32_16x16x32_bf16 v[192:195], v[92:95], a[196:199], v[192:195]
 v_cvt_pk_bf16_f32 v4, v176, v177
 v_cvt_pk_bf16_f32 v5, v178, v179
 v_mfma_f32_16x16x32_bf16 v[192:195], v[96:99], a[200:203], v[192:195]
 ds_read_b64_tr_b16 v[76:77], v42 offset:9344
 ds_read_b64_tr_b16 v[78:79], v42 offset:13952
 v_mfma_f32_16x16x32_bf16 v[192:195], v[100:103], a[204:207], v[192:195]
 v_cvt_pk_bf16_f32 v6, v180, v181
 v_cvt_pk_bf16_f32 v7, v182, v183
 v_mfma_f32_16x16x32_bf16 v[196:199], v[88:91], a[208:211], v[196:199]
 ds_read_b64_tr_b16 v[80:81], v42 offset:18560
 ds_read_b64_tr_b16 v[82:83], v42 offset:23168
 v_mfma_f32_16x16x32_bf16 v[196:199], v[92:95], a[212:215], v[196:199]
 buffer_store_dwordx4 v[4:7], v2, s[36:39], s79 offen offset:0 sc1
 v_mfma_f32_16x16x32_bf16 v[196:199], v[96:99], a[216:219], v[196:199]
 ds_read_b64_tr_b16 v[84:85], v42 offset:27776
 ds_read_b64_tr_b16 v[86:87], v42 offset:32384
 v_mfma_f32_16x16x32_bf16 v[196:199], v[100:103], a[220:223], v[196:199]
 s_waitcnt lgkmcnt(8)
 v_mfma_f32_16x16x32_bf16 v[200:203], v[56:59], a[192:195], v[200:203]
 ds_read_b64_tr_b16 v[88:89], v42 offset:160
 ds_read_b64_tr_b16 v[90:91], v42 offset:4768
 v_mfma_f32_16x16x32_bf16 v[200:203], v[60:63], a[196:199], v[200:203]
 v_cvt_pk_bf16_f32 v8, v184, v185
 v_cvt_pk_bf16_f32 v9, v186, v187
 v_mfma_f32_16x16x32_bf16 v[200:203], v[64:67], a[200:203], v[200:203]
 ds_read_b64_tr_b16 v[92:93], v42 offset:9376
 ds_read_b64_tr_b16 v[94:95], v42 offset:13984
 v_mfma_f32_16x16x32_bf16 v[200:203], v[68:71], a[204:207], v[200:203]
 v_cvt_pk_bf16_f32 v10, v188, v189
 v_cvt_pk_bf16_f32 v11, v190, v191
 v_mfma_f32_16x16x32_bf16 v[204:207], v[56:59], a[208:211], v[204:207]
 ds_read_b64_tr_b16 v[96:97], v42 offset:18592
 ds_read_b64_tr_b16 v[98:99], v42 offset:23200
 v_mfma_f32_16x16x32_bf16 v[204:207], v[60:63], a[212:215], v[204:207]
 buffer_store_dwordx4 v[8:11], v2, s[36:39], s79 offen offset:1024 sc1
 v_mfma_f32_16x16x32_bf16 v[204:207], v[64:67], a[216:219], v[204:207]
 ds_read_b64_tr_b16 v[100:101], v42 offset:27808
 ds_read_b64_tr_b16 v[102:103], v42 offset:32416
 v_mfma_f32_16x16x32_bf16 v[204:207], v[68:71], a[220:223], v[204:207]
 s_waitcnt lgkmcnt(8)
 v_mfma_f32_16x16x32_bf16 v[208:211], v[72:75], a[192:195], v[208:211]
 ds_read_b64_tr_b16 v[56:57], v42 offset:192
 ds_read_b64_tr_b16 v[58:59], v42 offset:4800
 v_mfma_f32_16x16x32_bf16 v[208:211], v[76:79], a[196:199], v[208:211]
 v_cvt_pk_bf16_f32 v12, v192, v193
 v_cvt_pk_bf16_f32 v13, v194, v195
 v_mfma_f32_16x16x32_bf16 v[208:211], v[80:83], a[200:203], v[208:211]
 ds_read_b64_tr_b16 v[60:61], v42 offset:9408
 ds_read_b64_tr_b16 v[62:63], v42 offset:14016
 v_mfma_f32_16x16x32_bf16 v[208:211], v[84:87], a[204:207], v[208:211]
 v_cvt_pk_bf16_f32 v14, v196, v197
 v_cvt_pk_bf16_f32 v15, v198, v199
 v_mfma_f32_16x16x32_bf16 v[212:215], v[72:75], a[208:211], v[212:215]
 ds_read_b64_tr_b16 v[64:65], v42 offset:18624
 ds_read_b64_tr_b16 v[66:67], v42 offset:23232
 v_mfma_f32_16x16x32_bf16 v[212:215], v[76:79], a[212:215], v[212:215]
 buffer_store_dwordx4 v[12:15], v2, s[36:39], s79 offen offset:2048 sc1
 v_mfma_f32_16x16x32_bf16 v[212:215], v[80:83], a[216:219], v[212:215]
 ds_read_b64_tr_b16 v[68:69], v42 offset:27840
 ds_read_b64_tr_b16 v[70:71], v42 offset:32448
 v_mfma_f32_16x16x32_bf16 v[212:215], v[84:87], a[220:223], v[212:215]
 s_waitcnt lgkmcnt(8)
 v_mfma_f32_16x16x32_bf16 v[216:219], v[88:91], a[192:195], v[216:219]
 ds_read_b64_tr_b16 v[72:73], v42 offset:224
 ds_read_b64_tr_b16 v[74:75], v42 offset:4832
 v_mfma_f32_16x16x32_bf16 v[216:219], v[92:95], a[196:199], v[216:219]
 v_cvt_pk_bf16_f32 v4, v200, v201
 v_cvt_pk_bf16_f32 v5, v202, v203
 v_mfma_f32_16x16x32_bf16 v[216:219], v[96:99], a[200:203], v[216:219]
 ds_read_b64_tr_b16 v[76:77], v42 offset:9440
 ds_read_b64_tr_b16 v[78:79], v42 offset:14048
 v_mfma_f32_16x16x32_bf16 v[216:219], v[100:103], a[204:207], v[216:219]
 v_cvt_pk_bf16_f32 v6, v204, v205
 v_cvt_pk_bf16_f32 v7, v206, v207
 v_mfma_f32_16x16x32_bf16 v[220:223], v[88:91], a[208:211], v[220:223]
 ds_read_b64_tr_b16 v[80:81], v42 offset:18656
 ds_read_b64_tr_b16 v[82:83], v42 offset:23264
 v_mfma_f32_16x16x32_bf16 v[220:223], v[92:95], a[212:215], v[220:223]
 buffer_store_dwordx4 v[4:7], v2, s[36:39], s79 offen offset:3072 sc1
 v_mfma_f32_16x16x32_bf16 v[220:223], v[96:99], a[216:219], v[220:223]
 ds_read_b64_tr_b16 v[84:85], v42 offset:27872
 ds_read_b64_tr_b16 v[86:87], v42 offset:32480
 v_mfma_f32_16x16x32_bf16 v[220:223], v[100:103], a[220:223], v[220:223]
 s_waitcnt lgkmcnt(8)
 v_mfma_f32_16x16x32_bf16 v[224:227], v[56:59], a[192:195], v[224:227]
 s_mov_b32 s80, 4096
 ds_read_b64_tr_b16 v[88:89], v42 offset:256
 ds_read_b64_tr_b16 v[90:91], v42 offset:4864
 v_mfma_f32_16x16x32_bf16 v[224:227], v[60:63], a[196:199], v[224:227]
 v_cvt_pk_bf16_f32 v8, v208, v209
 v_cvt_pk_bf16_f32 v9, v210, v211
 v_mfma_f32_16x16x32_bf16 v[224:227], v[64:67], a[200:203], v[224:227]
 ds_read_b64_tr_b16 v[92:93], v42 offset:9472
 ds_read_b64_tr_b16 v[94:95], v42 offset:14080
 v_mfma_f32_16x16x32_bf16 v[224:227], v[68:71], a[204:207], v[224:227]
 v_cvt_pk_bf16_f32 v10, v212, v213
 v_cvt_pk_bf16_f32 v11, v214, v215
 v_mfma_f32_16x16x32_bf16 v[228:231], v[56:59], a[208:211], v[228:231]
 ds_read_b64_tr_b16 v[96:97], v42 offset:18688
 ds_read_b64_tr_b16 v[98:99], v42 offset:23296
 v_mfma_f32_16x16x32_bf16 v[228:231], v[60:63], a[212:215], v[228:231]
 buffer_store_dwordx4 v[8:11], v2, s[36:39], s80 offen offset:0 sc1
 v_mfma_f32_16x16x32_bf16 v[228:231], v[64:67], a[216:219], v[228:231]
 ds_read_b64_tr_b16 v[100:101], v42 offset:27904
 ds_read_b64_tr_b16 v[102:103], v42 offset:32512
 v_mfma_f32_16x16x32_bf16 v[228:231], v[68:71], a[220:223], v[228:231]
 s_waitcnt lgkmcnt(8)
 v_mfma_f32_16x16x32_bf16 v[232:235], v[72:75], a[192:195], v[232:235]
 v_cvt_pk_bf16_f32 v12, v216, v217
 v_cvt_pk_bf16_f32 v13, v218, v219
 v_mfma_f32_16x16x32_bf16 v[232:235], v[76:79], a[196:199], v[232:235]
 v_cvt_pk_bf16_f32 v14, v220, v221
 v_cvt_pk_bf16_f32 v15, v222, v223
 v_mfma_f32_16x16x32_bf16 v[232:235], v[80:83], a[200:203], v[232:235]
 buffer_store_dwordx4 v[12:15], v2, s[36:39], s80 offen offset:1024 sc1
 v_mfma_f32_16x16x32_bf16 v[232:235], v[84:87], a[204:207], v[232:235]
 v_mfma_f32_16x16x32_bf16 v[236:239], v[72:75], a[208:211], v[236:239]
 v_mfma_f32_16x16x32_bf16 v[236:239], v[76:79], a[212:215], v[236:239]
 v_mfma_f32_16x16x32_bf16 v[236:239], v[80:83], a[216:219], v[236:239]
 v_mfma_f32_16x16x32_bf16 v[236:239], v[84:87], a[220:223], v[236:239]
 s_waitcnt lgkmcnt(0)
 v_mfma_f32_16x16x32_bf16 v[240:243], v[88:91], a[192:195], v[240:243]
 v_cvt_pk_bf16_f32 v4, v224, v225
 v_cvt_pk_bf16_f32 v5, v226, v227
 v_mfma_f32_16x16x32_bf16 v[240:243], v[92:95], a[196:199], v[240:243]
 v_cvt_pk_bf16_f32 v6, v228, v229
 v_cvt_pk_bf16_f32 v7, v230, v231
 v_mfma_f32_16x16x32_bf16 v[240:243], v[96:99], a[200:203], v[240:243]
 buffer_store_dwordx4 v[4:7], v2, s[36:39], s80 offen offset:2048 sc1
 v_mfma_f32_16x16x32_bf16 v[240:243], v[100:103], a[204:207], v[240:243]
 v_mfma_f32_16x16x32_bf16 v[244:247], v[88:91], a[208:211], v[244:247]
 v_mfma_f32_16x16x32_bf16 v[244:247], v[92:95], a[212:215], v[244:247]
 v_mfma_f32_16x16x32_bf16 v[244:247], v[96:99], a[216:219], v[244:247]
 v_mfma_f32_16x16x32_bf16 v[244:247], v[100:103], a[220:223], v[244:247]
 v_cvt_pk_bf16_f32 v8, v232, v233
 v_cvt_pk_bf16_f32 v9, v234, v235
 v_cvt_pk_bf16_f32 v10, v236, v237
 v_cvt_pk_bf16_f32 v11, v238, v239
 buffer_store_dwordx4 v[8:11], v2, s[36:39], s80 offen offset:3072 sc1
 s_mov_b32 s81, 8192
 v_cvt_pk_bf16_f32 v12, v240, v241
 v_cvt_pk_bf16_f32 v13, v242, v243
 v_cvt_pk_bf16_f32 v14, v244, v245
 v_cvt_pk_bf16_f32 v15, v246, v247
 buffer_store_dwordx4 v[12:15], v2, s[36:39], s81 offen offset:0 sc1
 s_waitcnt vmcnt(20)
 v_lshlrev_b32 v152, 16, v104
 v_and_b32 v153, 0xffff0000, v104
 s_waitcnt vmcnt(19)
 v_lshlrev_b32 v34, 16, v108
 v_and_b32 v35, 0xffff0000, v108
 v_add_f32 v152, v152, v34
 v_add_f32 v153, v153, v35
 s_waitcnt vmcnt(18)
 v_lshlrev_b32 v34, 16, v112
 v_and_b32 v35, 0xffff0000, v112
 v_add_f32 v152, v152, v34
 v_add_f32 v153, v153, v35
 s_waitcnt vmcnt(17)
 v_lshlrev_b32 v34, 16, v116
 v_and_b32 v35, 0xffff0000, v116
 v_add_f32 v152, v152, v34
 v_add_f32 v153, v153, v35
 v_lshlrev_b32 v154, 16, v105
 v_and_b32 v155, 0xffff0000, v105
 v_lshlrev_b32 v34, 16, v109
 v_and_b32 v35, 0xffff0000, v109
 v_add_f32 v154, v154, v34
 v_add_f32 v155, v155, v35
 v_lshlrev_b32 v34, 16, v113
 v_and_b32 v35, 0xffff0000, v113
 v_add_f32 v154, v154, v34
 v_add_f32 v155, v155, v35
 v_lshlrev_b32 v34, 16, v117
 v_and_b32 v35, 0xffff0000, v117
 v_add_f32 v154, v154, v34
 v_add_f32 v155, v155, v35
 v_lshlrev_b32 v156, 16, v106
 v_and_b32 v157, 0xffff0000, v106
 v_lshlrev_b32 v34, 16, v110
 v_and_b32 v35, 0xffff0000, v110
 v_add_f32 v156, v156, v34
 v_add_f32 v157, v157, v35
 v_lshlrev_b32 v34, 16, v114
 v_and_b32 v35, 0xffff0000, v114
 v_add_f32 v156, v156, v34
 v_add_f32 v157, v157, v35
 v_lshlrev_b32 v34, 16, v118
 v_and_b32 v35, 0xffff0000, v118
 v_add_f32 v156, v156, v34
 v_add_f32 v157, v157, v35
 v_lshlrev_b32 v158, 16, v107
 v_and_b32 v159, 0xffff0000, v107
 v_lshlrev_b32 v34, 16, v111
 v_and_b32 v35, 0xffff0000, v111
 v_add_f32 v158, v158, v34
 v_add_f32 v159, v159, v35
 v_lshlrev_b32 v34, 16, v115
 v_and_b32 v35, 0xffff0000, v115
 v_add_f32 v158, v158, v34
 v_add_f32 v159, v159, v35
 v_lshlrev_b32 v34, 16, v119
 v_and_b32 v35, 0xffff0000, v119
 v_add_f32 v158, v158, v34
 v_add_f32 v159, v159, v35
 v_mul_f32 v34, s64, v152
 v_mul_f32 v35, s64, v153
 v_exp_f32 v34, v34
 v_exp_f32 v35, v35
 v_add_f32 v34, 1.0, v34
 v_add_f32 v35, 1.0, v35
 v_rcp_f32 v34, v34
 v_rcp_f32 v35, v35
 v_mul_f32 v152, v152, v34
 v_mul_f32 v153, v153, v35
 v_mul_f32 v34, s64, v154
 v_mul_f32 v35, s64, v155
 v_exp_f32 v34, v34
 v_exp_f32 v35, v35
 v_add_f32 v34, 1.0, v34
 v_add_f32 v35, 1.0, v35
 v_rcp_f32 v34, v34
 v_rcp_f32 v35, v35
 v_mul_f32 v154, v154, v34
 v_mul_f32 v155, v155, v35
 v_mul_f32 v34, s64, v156
 v_mul_f32 v35, s64, v157
 v_exp_f32 v34, v34
 v_exp_f32 v35, v35
 v_add_f32 v34, 1.0, v34
 v_add_f32 v35, 1.0, v35
 v_rcp_f32 v34, v34
 v_rcp_f32 v35, v35
 v_mul_f32 v156, v156, v34
 v_mul_f32 v157, v157, v35
 v_mul_f32 v34, s64, v158
 v_mul_f32 v35, s64, v159
 v_exp_f32 v34, v34
 v_exp_f32 v35, v35
 v_add_f32 v34, 1.0, v34
 v_add_f32 v35, 1.0, v35
 v_rcp_f32 v34, v34
 v_rcp_f32 v35, v35
 v_mul_f32 v158, v158, v34
 v_mul_f32 v159, v159, v35
 s_waitcnt vmcnt(16)
 v_lshlrev_b32 v160, 16, v120
 v_and_b32 v161, 0xffff0000, v120
 s_waitcnt vmcnt(15)
 v_lshlrev_b32 v34, 16, v124
 v_and_b32 v35, 0xffff0000, v124
 v_add_f32 v160, v160, v34
 v_add_f32 v161, v161, v35
 s_waitcnt vmcnt(14)
 v_lshlrev_b32 v34, 16, v128
 v_and_b32 v35, 0xffff0000, v128
 v_add_f32 v160, v160, v34
 v_add_f32 v161, v161, v35
 s_waitcnt vmcnt(13)
 v_lshlrev_b32 v34, 16, v132
 v_and_b32 v35, 0xffff0000, v132
 v_add_f32 v160, v160, v34
 v_add_f32 v161, v161, v35
 v_lshlrev_b32 v162, 16, v121
 v_and_b32 v163, 0xffff0000, v121
 v_lshlrev_b32 v34, 16, v125
 v_and_b32 v35, 0xffff0000, v125
 v_add_f32 v162, v162, v34
 v_add_f32 v163, v163, v35
 v_lshlrev_b32 v34, 16, v129
 v_and_b32 v35, 0xffff0000, v129
 v_add_f32 v162, v162, v34
 v_add_f32 v163, v163, v35
 v_lshlrev_b32 v34, 16, v133
 v_and_b32 v35, 0xffff0000, v133
 v_add_f32 v162, v162, v34
 v_add_f32 v163, v163, v35
 v_lshlrev_b32 v164, 16, v122
 v_and_b32 v165, 0xffff0000, v122
 v_lshlrev_b32 v34, 16, v126
 v_and_b32 v35, 0xffff0000, v126
 v_add_f32 v164, v164, v34
 v_add_f32 v165, v165, v35
 v_lshlrev_b32 v34, 16, v130
 v_and_b32 v35, 0xffff0000, v130
 v_add_f32 v164, v164, v34
 v_add_f32 v165, v165, v35
 v_lshlrev_b32 v34, 16, v134
 v_and_b32 v35, 0xffff0000, v134
 v_add_f32 v164, v164, v34
 v_add_f32 v165, v165, v35
 v_lshlrev_b32 v166, 16, v123
 v_and_b32 v167, 0xffff0000, v123
 v_lshlrev_b32 v34, 16, v127
 v_and_b32 v35, 0xffff0000, v127
 v_add_f32 v166, v166, v34
 v_add_f32 v167, v167, v35
 s_waitcnt vmcnt(0)
 s_barrier
 buffer_store_dword v253, v252, s[32:35], s67 offen sc1
 buffer_load_dword v255, v254, s[32:35], s66 offen sc1
 v_lshlrev_b32 v34, 16, v131
 v_and_b32 v35, 0xffff0000, v131
 v_add_f32 v166, v166, v34
 v_add_f32 v167, v167, v35
 v_lshlrev_b32 v34, 16, v135
 v_and_b32 v35, 0xffff0000, v135
 v_add_f32 v166, v166, v34
 v_add_f32 v167, v167, v35
 v_mul_f32 v34, s64, v160
 v_mul_f32 v35, s64, v161
 v_exp_f32 v34, v34
 v_exp_f32 v35, v35
 v_add_f32 v34, 1.0, v34
 v_add_f32 v35, 1.0, v35
 v_rcp_f32 v34, v34
 v_rcp_f32 v35, v35
 v_mul_f32 v160, v160, v34
 v_mul_f32 v161, v161, v35
 v_mul_f32 v34, s64, v162
 v_mul_f32 v35, s64, v163
 v_exp_f32 v34, v34
 v_exp_f32 v35, v35
 v_add_f32 v34, 1.0, v34
 v_add_f32 v35, 1.0, v35
 v_rcp_f32 v34, v34
 v_rcp_f32 v35, v35
 v_mul_f32 v162, v162, v34
 v_mul_f32 v163, v163, v35
 v_mul_f32 v34, s64, v164
 v_mul_f32 v35, s64, v165
 v_exp_f32 v34, v34
 v_exp_f32 v35, v35
 v_add_f32 v34, 1.0, v34
 v_add_f32 v35, 1.0, v35
 v_rcp_f32 v34, v34
 v_rcp_f32 v35, v35
 v_mul_f32 v164, v164, v34
 v_mul_f32 v165, v165, v35
 v_mul_f32 v34, s64, v166
 v_mul_f32 v35, s64, v167
 v_exp_f32 v34, v34
 v_exp_f32 v35, v35
 v_add_f32 v34, 1.0, v34
 v_add_f32 v35, 1.0, v35
 v_rcp_f32 v34, v34
 v_rcp_f32 v35, v35
 v_mul_f32 v166, v166, v34
 v_mul_f32 v167, v167, v35
 v_lshlrev_b32 v168, 16, v136
 v_and_b32 v169, 0xffff0000, v136
 v_lshlrev_b32 v34, 16, v140
 v_and_b32 v35, 0xffff0000, v140
 v_add_f32 v168, v168, v34
 v_add_f32 v169, v169, v35
 v_lshlrev_b32 v34, 16, v144
 v_and_b32 v35, 0xffff0000, v144
 v_add_f32 v168, v168, v34
 v_add_f32 v169, v169, v35
 v_lshlrev_b32 v34, 16, v148
 v_and_b32 v35, 0xffff0000, v148
 v_add_f32 v168, v168, v34
 v_add_f32 v169, v169, v35
 v_lshlrev_b32 v170, 16, v137
 v_and_b32 v171, 0xffff0000, v137
 v_lshlrev_b32 v34, 16, v141
 v_and_b32 v35, 0xffff0000, v141
 v_add_f32 v170, v170, v34
 v_add_f32 v171, v171, v35
 v_lshlrev_b32 v34, 16, v145
 v_and_b32 v35, 0xffff0000, v145
 v_add_f32 v170, v170, v34
 v_add_f32 v171, v171, v35
 v_lshlrev_b32 v34, 16, v149
 v_and_b32 v35, 0xffff0000, v149
 v_add_f32 v170, v170, v34
 v_add_f32 v171, v171, v35
 v_lshlrev_b32 v172, 16, v138
 v_and_b32 v173, 0xffff0000, v138
 v_lshlrev_b32 v34, 16, v142
 v_and_b32 v35, 0xffff0000, v142
 v_add_f32 v172, v172, v34
 v_add_f32 v173, v173, v35
 v_lshlrev_b32 v34, 16, v146
 v_and_b32 v35, 0xffff0000, v146
 v_add_f32 v172, v172, v34
 v_add_f32 v173, v173, v35
 v_lshlrev_b32 v34, 16, v150
 v_and_b32 v35, 0xffff0000, v150
 v_add_f32 v172, v172, v34
 v_add_f32 v173, v173, v35
 v_lshlrev_b32 v174, 16, v139
 v_and_b32 v175, 0xffff0000, v139
 v_lshlrev_b32 v34, 16, v143
 v_and_b32 v35, 0xffff0000, v143
 v_add_f32 v174, v174, v34
 v_add_f32 v175, v175, v35
 v_lshlrev_b32 v34, 16, v147
 v_and_b32 v35, 0xffff0000, v147
 v_add_f32 v174, v174, v34
 v_add_f32 v175, v175, v35
 v_lshlrev_b32 v34, 16, v151
 v_and_b32 v35, 0xffff0000, v151
 v_add_f32 v174, v174, v34
 v_add_f32 v175, v175, v35
 v_mul_f32 v34, s64, v168
 v_mul_f32 v35, s64, v169
 v_exp_f32 v34, v34
 v_exp_f32 v35, v35
 v_add_f32 v34, 1.0, v34
 v_add_f32 v35, 1.0, v35
 v_rcp_f32 v34, v34
 v_rcp_f32 v35, v35
 v_mul_f32 v168, v168, v34
 v_mul_f32 v169, v169, v35
 v_mul_f32 v34, s64, v170
 v_mul_f32 v35, s64, v171
 v_exp_f32 v34, v34
 v_exp_f32 v35, v35
 v_add_f32 v34, 1.0, v34
 v_add_f32 v35, 1.0, v35
 v_rcp_f32 v34, v34
 v_rcp_f32 v35, v35
 v_mul_f32 v170, v170, v34
 v_mul_f32 v171, v171, v35
 v_mul_f32 v34, s64, v172
 v_mul_f32 v35, s64, v173
 v_exp_f32 v34, v34
 v_exp_f32 v35, v35
 v_add_f32 v34, 1.0, v34
 v_add_f32 v35, 1.0, v35
 v_rcp_f32 v34, v34
 v_rcp_f32 v35, v35
 v_mul_f32 v172, v172, v34
 v_mul_f32 v173, v173, v35
 v_mul_f32 v34, s64, v174
 v_mul_f32 v35, s64, v175
 v_exp_f32 v34, v34
 v_exp_f32 v35, v35
 v_add_f32 v34, 1.0, v34
 v_add_f32 v35, 1.0, v35
 v_rcp_f32 v34, v34
 v_rcp_f32 v35, v35
 v_mul_f32 v174, v174, v34
 v_mul_f32 v175, v175, v35
 s_waitcnt vmcnt(0)
 v_cmp_ne_u32 vcc, s54, v255
 s_cbranch_vccnz L_spin_p1
L_ok_p1:
 s_mov_b32 s83, 0
 buffer_load_dwordx4 v[104:107], v2, s[40:43], s83 offen sc1
 s_mov_b32 s84, 36864
 buffer_load_dwordx4 v[108:111], v2, s[40:43], s84 offen sc1
 s_mov_b32 s83, 73728
 buffer_load_dwordx4 v[112:115], v2, s[40:43], s83 offen sc1
 s_mov_b32 s84, 110592
 buffer_load_dwordx4 v[116:119], v2, s[40:43], s84 offen sc1
 s_mov_b32 s83, 4096
 buffer_load_dwordx4 v[120:123], v2, s[40:43], s83 offen sc1
 s_mov_b32 s84, 40960
 buffer_load_dwordx4 v[124:127], v2, s[40:43], s84 offen sc1
 s_mov_b32 s83, 77824
 buffer_load_dwordx4 v[128:131], v2, s[40:43], s83 offen sc1
 s_mov_b32 s84, 114688
 buffer_load_dwordx4 v[132:135], v2, s[40:43], s84 offen sc1
 s_add_u32 s83, s62, 8192
 buffer_load_dwordx4 v[136:139], v2, s[40:43], s83 offen sc1
 s_add_u32 s84, s62, 45056
 buffer_load_dwordx4 v[140:143], v2, s[40:43], s84 offen sc1
 s_add_u32 s83, s62, 81920
 buffer_load_dwordx4 v[144:147], v2, s[40:43], s83 offen sc1
 s_add_u32 s84, s62, 118784
 buffer_load_dwordx4 v[148:151], v2, s[40:43], s84 offen sc1
 s_waitcnt vmcnt(11)
 v_lshlrev_b32 v176, 16, v104
 v_and_b32 v177, 0xffff0000, v104
 s_waitcnt vmcnt(10)
 v_lshlrev_b32 v34, 16, v108
 v_and_b32 v35, 0xffff0000, v108
 v_add_f32 v176, v176, v34
 v_add_f32 v177, v177, v35
 s_waitcnt vmcnt(9)
 v_lshlrev_b32 v34, 16, v112
 v_and_b32 v35, 0xffff0000, v112
 v_add_f32 v176, v176, v34
 v_add_f32 v177, v177, v35
 s_waitcnt vmcnt(8)
 v_lshlrev_b32 v34, 16, v116
 v_and_b32 v35, 0xffff0000, v116
 v_add_f32 v176, v176, v34
 v_add_f32 v177, v177, v35
 v_lshlrev_b32 v178, 16, v105
 v_and_b32 v179, 0xffff0000, v105
 v_lshlrev_b32 v34, 16, v109
 v_and_b32 v35, 0xffff0000, v109
 v_add_f32 v178, v178, v34
 v_add_f32 v179, v179, v35
 v_lshlrev_b32 v34, 16, v113
 v_and_b32 v35, 0xffff0000, v113
 v_add_f32 v178, v178, v34
 v_add_f32 v179, v179, v35
 v_lshlrev_b32 v34, 16, v117
 v_and_b32 v35, 0xffff0000, v117
 v_add_f32 v178, v178, v34
 v_add_f32 v179, v179, v35
 v_lshlrev_b32 v180, 16, v106
 v_and_b32 v181, 0xffff0000, v106
 v_lshlrev_b32 v34, 16, v110
 v_and_b32 v35, 0xffff0000, v110
 v_add_f32 v180, v180, v34
 v_add_f32 v181, v181, v35
 v_lshlrev_b32 v34, 16, v114
 v_and_b32 v35, 0xffff0000, v114
 v_add_f32 v180, v180, v34
 v_add_f32 v181, v181, v35
 v_lshlrev_b32 v34, 16, v118
 v_and_b32 v35, 0xffff0000, v118
 v_add_f32 v180, v180, v34
 v_add_f32 v181, v181, v35
 v_lshlrev_b32 v182, 16, v107
 v_and_b32 v183, 0xffff0000, v107
 v_lshlrev_b32 v34, 16, v111
 v_and_b32 v35, 0xffff0000, v111
 v_add_f32 v182, v182, v34
 v_add_f32 v183, v183, v35
 v_lshlrev_b32 v34, 16, v115
 v_and_b32 v35, 0xffff0000, v115
 v_add_f32 v182, v182, v34
 v_add_f32 v183, v183, v35
 v_lshlrev_b32 v34, 16, v119
 v_and_b32 v35, 0xffff0000, v119
 v_add_f32 v182, v182, v34
 v_add_f32 v183, v183, v35
 v_lshlrev_b32 v184, 16, v44
 v_fma_f32 v184, v176, v152, v184
 v_and_b32 v185, 0xffff0000, v44
 v_fma_f32 v185, v177, v153, v185
 v_lshlrev_b32 v186, 16, v45
 v_fma_f32 v186, v178, v154, v186
 v_and_b32 v187, 0xffff0000, v45
 v_fma_f32 v187, v179, v155, v187
 v_cvt_pk_bf16_f32 v188, v184, v185
 v_cvt_pk_bf16_f32 v189, v186, v187
 buffer_store_dwordx2 v[188:189], v39, s[48:51], s75 offen offset:0
 v_lshlrev_b32 v184, 16, v46
 v_fma_f32 v184, v180, v156, v184
 v_and_b32 v185, 0xffff0000, v46
 v_fma_f32 v185, v181, v157, v185
 v_lshlrev_b32 v186, 16, v47
 v_fma_f32 v186, v182, v158, v186
 v_and_b32 v187, 0xffff0000, v47
 v_fma_f32 v187, v183, v159, v187
 v_cvt_pk_bf16_f32 v190, v184, v185
 v_cvt_pk_bf16_f32 v191, v186, v187
 buffer_store_dwordx2 v[190:191], v39, s[48:51], s76 offen offset:0
 s_waitcnt vmcnt(9)
 v_lshlrev_b32 v192, 16, v120
 v_and_b32 v193, 0xffff0000, v120
 s_waitcnt vmcnt(8)
 v_lshlrev_b32 v34, 16, v124
 v_and_b32 v35, 0xffff0000, v124
 v_add_f32 v192, v192, v34
 v_add_f32 v193, v193, v35
 s_waitcnt vmcnt(7)
 v_lshlrev_b32 v34, 16, v128
 v_and_b32 v35, 0xffff0000, v128
 v_add_f32 v192, v192, v34
 v_add_f32 v193, v193, v35
 s_waitcnt vmcnt(6)
 v_lshlrev_b32 v34, 16, v132
 v_and_b32 v35, 0xffff0000, v132
 v_add_f32 v192, v192, v34
 v_add_f32 v193, v193, v35
 v_lshlrev_b32 v194, 16, v121
 v_and_b32 v195, 0xffff0000, v121
 v_lshlrev_b32 v34, 16, v125
 v_and_b32 v35, 0xffff0000, v125
 v_add_f32 v194, v194, v34
 v_add_f32 v195, v195, v35
 v_lshlrev_b32 v34, 16, v129
 v_and_b32 v35, 0xffff0000, v129
 v_add_f32 v194, v194, v34
 v_add_f32 v195, v195, v35
 v_lshlrev_b32 v34, 16, v133
 v_and_b32 v35, 0xffff0000, v133
 v_add_f32 v194, v194, v34
 v_add_f32 v195, v195, v35
 v_lshlrev_b32 v196, 16, v122
 v_and_b32 v197, 0xffff0000, v122
 v_lshlrev_b32 v34, 16, v126
 v_and_b32 v35, 0xffff0000, v126
 v_add_f32 v196, v196, v34
 v_add_f32 v197, v197, v35
 v_lshlrev_b32 v34, 16, v130
 v_and_b32 v35, 0xffff0000, v130
 v_add_f32 v196, v196, v34
 v_add_f32 v197, v197, v35
 v_lshlrev_b32 v34, 16, v134
 v_and_b32 v35, 0xffff0000, v134
 v_add_f32 v196, v196, v34
 v_add_f32 v197, v197, v35
 v_lshlrev_b32 v198, 16, v123
 v_and_b32 v199, 0xffff0000, v123
 v_lshlrev_b32 v34, 16, v127
 v_and_b32 v35, 0xffff0000, v127
 v_add_f32 v198, v198, v34
 v_add_f32 v199, v199, v35
 v_lshlrev_b32 v34, 16, v131
 v_and_b32 v35, 0xffff0000, v131
 v_add_f32 v198, v198, v34
 v_add_f32 v199, v199, v35
 v_lshlrev_b32 v34, 16, v135
 v_and_b32 v35, 0xffff0000, v135
 v_add_f32 v198, v198, v34
 v_add_f32 v199, v199, v35
 v_lshlrev_b32 v200, 16, v48
 v_fma_f32 v200, v192, v160, v200
 v_and_b32 v201, 0xffff0000, v48
 v_fma_f32 v201, v193, v161, v201
 v_lshlrev_b32 v202, 16, v49
 v_fma_f32 v202, v194, v162, v202
 v_and_b32 v203, 0xffff0000, v49
 v_fma_f32 v203, v195, v163, v203
 v_cvt_pk_bf16_f32 v204, v200, v201
 v_cvt_pk_bf16_f32 v205, v202, v203
 buffer_store_dwordx2 v[204:205], v39, s[48:51], s75 offen offset:128
 v_lshlrev_b32 v200, 16, v50
 v_fma_f32 v200, v196, v164, v200
 v_and_b32 v201, 0xffff0000, v50
 v_fma_f32 v201, v197, v165, v201
 v_lshlrev_b32 v202, 16, v51
 v_fma_f32 v202, v198, v166, v202
 v_and_b32 v203, 0xffff0000, v51
 v_fma_f32 v203, v199, v167, v203
 v_cvt_pk_bf16_f32 v206, v200, v201
 v_cvt_pk_bf16_f32 v207, v202, v203
 buffer_store_dwordx2 v[206:207], v39, s[48:51], s76 offen offset:128
 s_waitcnt vmcnt(7)
 v_lshlrev_b32 v208, 16, v136
 v_and_b32 v209, 0xffff0000, v136
 s_waitcnt vmcnt(6)
 v_lshlrev_b32 v34, 16, v140
 v_and_b32 v35, 0xffff0000, v140
 v_add_f32 v208, v208, v34
 v_add_f32 v209, v209, v35
 s_waitcnt vmcnt(5)
 v_lshlrev_b32 v34, 16, v144
 v_and_b32 v35, 0xffff0000, v144
 v_add_f32 v208, v208, v34
 v_add_f32 v209, v209, v35
 s_waitcnt vmcnt(4)
 v_lshlrev_b32 v34, 16, v148
 v_and_b32 v35, 0xffff0000, v148
 v_add_f32 v208, v208, v34
 v_add_f32 v209, v209, v35
 v_lshlrev_b32 v210, 16, v137
 v_and_b32 v211, 0xffff0000, v137
 v_lshlrev_b32 v34, 16, v141
 v_and_b32 v35, 0xffff0000, v141
 v_add_f32 v210, v210, v34
 v_add_f32 v211, v211, v35
 v_lshlrev_b32 v34, 16, v145
 v_and_b32 v35, 0xffff0000, v145
 v_add_f32 v210, v210, v34
 v_add_f32 v211, v211, v35
 v_lshlrev_b32 v34, 16, v149
 v_and_b32 v35, 0xffff0000, v149
 v_add_f32 v210, v210, v34
 v_add_f32 v211, v211, v35
 v_lshlrev_b32 v212, 16, v138
 v_and_b32 v213, 0xffff0000, v138
 v_lshlrev_b32 v34, 16, v142
 v_and_b32 v35, 0xffff0000, v142
 v_add_f32 v212, v212, v34
 v_add_f32 v213, v213, v35
 v_lshlrev_b32 v34, 16, v146
 v_and_b32 v35, 0xffff0000, v146
 v_add_f32 v212, v212, v34
 v_add_f32 v213, v213, v35
 v_lshlrev_b32 v34, 16, v150
 v_and_b32 v35, 0xffff0000, v150
 v_add_f32 v212, v212, v34
 v_add_f32 v213, v213, v35
 v_lshlrev_b32 v214, 16, v139
 v_and_b32 v215, 0xffff0000, v139
 v_lshlrev_b32 v34, 16, v143
 v_and_b32 v35, 0xffff0000, v143
 v_add_f32 v214, v214, v34
 v_add_f32 v215, v215, v35
 v_lshlrev_b32 v34, 16, v147
 v_and_b32 v35, 0xffff0000, v147
 v_add_f32 v214, v214, v34
 v_add_f32 v215, v215, v35
 v_lshlrev_b32 v34, 16, v151
 v_and_b32 v35, 0xffff0000, v151
 v_add_f32 v214, v214, v34
 v_add_f32 v215, v215, v35
 v_lshlrev_b32 v216, 16, v52
 v_fma_f32 v216, v208, v168, v216
 v_and_b32 v217, 0xffff0000, v52
 v_fma_f32 v217, v209, v169, v217
 v_lshlrev_b32 v218, 16, v53
 v_fma_f32 v218, v210, v170, v218
 v_and_b32 v219, 0xffff0000, v53
 v_fma_f32 v219, v211, v171, v219
 v_cvt_pk_bf16_f32 v220, v216, v217
 v_cvt_pk_bf16_f32 v221, v218, v219
 buffer_store_dwordx2 v[220:221], v39, s[48:51], s77 offen offset:256
 v_lshlrev_b32 v216, 16, v54
 v_fma_f32 v216, v212, v172, v216
 v_and_b32 v217, 0xffff0000, v54
 v_fma_f32 v217, v213, v173, v217
 v_lshlrev_b32 v218, 16, v55
 v_fma_f32 v218, v214, v174, v218
 v_and_b32 v219, 0xffff0000, v55
 v_fma_f32 v219, v215, v175, v219
 v_cvt_pk_bf16_f32 v222, v216, v217
 v_cvt_pk_bf16_f32 v223, v218, v219
 buffer_store_dwordx2 v[222:223], v39, s[48:51], s78 offen offset:256
L_end:
 s_endpgm
L_lnp:
 s_mov_b32 s3, 0
L_lnp_l:
 buffer_load_dword v150, v147, s[32:35], s57 offen sc1
 s_add_u32 s3, s3, 1
 s_cmp_gt_u32 s3, 0x40000
 s_cbranch_scc1 L_lnp_ok
 s_waitcnt vmcnt(0)
 v_cmp_ne_u32 vcc, v149, v150
 s_cbranch_vccnz L_lnp_l
 s_branch L_lnp_ok
L_spin_h:
 s_mov_b32 s3, 0
L_spin_h_l:
 s_sleep 4
 buffer_load_dword v255, v254, s[32:35], s66 offen sc1
 s_add_u32 s3, s3, 1
 s_cmp_gt_u32 s3, 0x40000
 s_cbranch_scc1 L_ok_h
 s_waitcnt vmcnt(0)
 v_cmp_ne_u32 vcc, s54, v255
 s_cbranch_vccnz L_spin_h_l
 s_branch L_ok_h
L_slow:
 s_waitcnt vmcnt(0) lgkmcnt(0)
 s_nop 15
 s_add_u32 s79, s53, 114688
 s_cmp_eq_u32 s52, 3
 s_cselect_b32 s79, 73728, s79
 s_sub_u32 s80, s79, 0x10000
 v_add_u32 v120, s79, v4
 v_subrev_u32 v132, s53, v22
 v_add_u32 v121, s79, v5
 v_subrev_u32 v133, s53, v23
 v_add_u32 v122, s79, v6
 v_subrev_u32 v134, s53, v24
 v_add_u32 v123, s79, v7
 v_subrev_u32 v135, s53, v25
 v_add_u32 v124, s80, v8
 v_add_u32 v125, s80, v9
 v_add_u32 v126, s80, v10
 v_add_u32 v127, s80, v11
 v_add_u32 v128, s80, v12
 v_add_u32 v129, s80, v13
 v_add_u32 v130, s80, v14
 v_add_u32 v131, s80, v15
 v_subrev_u32 v32, s53, v26
 v_subrev_u32 v33, s53, v27
 v_mov_b32 v36, 0xff7fffff
 v_mov_b32 v37, 0xff7fffff
 v_mov_b32 v38, 0xff7fffff
 v_mov_b32 v39, 0xff7fffff
 s_mov_b32 s82, 0
L_slow1:
 s_mov_b32 s81, s82
 s_mov_b32 m0, s79
 s_nop 0
 buffer_load_dwordx4 v132, s[4:7], s81 offen offset:0 lds
 buffer_load_dwordx4 v133, s[4:7], s81 offen offset:1024 lds
 buffer_load_dwordx4 v134, s[4:7], s81 offen offset:2048 lds
 buffer_load_dwordx4 v135, s[4:7], s81 offen offset:3072 lds
 s_add_u32 s81, s81, 4096
 s_waitcnt vmcnt(0)
 ds_read_b128 a[192:195], v120
 ds_read_b128 a[196:199], v121
 ds_read_b128 a[200:203], v122
 ds_read_b128 a[204:207], v123
 s_waitcnt lgkmcnt(0)
 s_mov_b32 m0, s79
 s_nop 0
 buffer_load_dwordx4 v132, s[4:7], s81 offen offset:0 lds
 buffer_load_dwordx4 v133, s[4:7], s81 offen offset:1024 lds
 buffer_load_dwordx4 v134, s[4:7], s81 offen offset:2048 lds
 buffer_load_dwordx4 v135, s[4:7], s81 offen offset:3072 lds
 s_add_u32 s81, s81, 4096
 s_waitcnt vmcnt(0)
 ds_read_b128 a[208:211], v120
 ds_read_b128 a[212:215], v121
 ds_read_b128 a[216:219], v122
 ds_read_b128 a[220:223], v123
 s_waitcnt lgkmcnt(0)
 s_mov_b32 m0, s79
 s_nop 0
 buffer_load_dwordx4 v132, s[4:7], s81 offen offset:0 lds
 buffer_load_dwordx4 v133, s[4:7], s81 offen offset:1024 lds
 buffer_load_dwordx4 v134, s[4:7], s81 offen offset:2048 lds
 buffer_load_dwordx4 v135, s[4:7], s81 offen offset:3072 lds
 s_add_u32 s81, s81, 4096
 s_waitcnt vmcnt(0)
 ds_read_b128 a[224:227], v120
 ds_read_b128 a[228:231], v121
 ds_read_b128 a[232:235], v122
 ds_read_b128 a[236:239], v123
 s_waitcnt lgkmcnt(0)
 s_mov_b32 m0, s79
 s_nop 0
 buffer_load_dwordx4 v132, s[4:7], s81 offen offset:0 lds
 buffer_load_dwordx4 v133, s[4:7], s81 offen offset:1024 lds
 buffer_load_dwordx4 v134, s[4:7], s81 offen offset:2048 lds
 buffer_load_dwordx4 v135, s[4:7], s81 offen offset:3072 lds
 s_add_u32 s81, s81, 4096
 s_waitcnt vmcnt(0)
 ds_read_b128 a[240:243], v120
 ds_read_b128 a[244:247], v121
 ds_read_b128 a[248:251], v122
 ds_read_b128 a[252:255], v123
 s_waitcnt lgkmcnt(0)
 v_mfma_f32_16x16x32_bf16 v[56:59], a[192:195], v[184:187], 0
 v_mfma_f32_16x16x32_bf16 v[56:59], a[196:199], v[188:191], v[56:59]
 v_mfma_f32_16x16x32_bf16 v[56:59], a[200:203], v[192:195], v[56:59]
 v_mfma_f32_16x16x32_bf16 v[56:59], a[204:207], v[196:199], v[56:59]
 v_mfma_f32_16x16x32_bf16 v[60:63], a[192:195], v[200:203], 0
 v_mfma_f32_16x16x32_bf16 v[60:63], a[196:199], v[204:207], v[60:63]
 v_mfma_f32_16x16x32_bf16 v[60:63], a[200:203], v[208:211], v[60:63]
 v_mfma_f32_16x16x32_bf16 v[60:63], a[204:207], v[212:215], v[60:63]
 v_mfma_f32_16x16x32_bf16 v[64:67], a[192:195], v[216:219], 0
 v_mfma_f32_16x16x32_bf16 v[64:67], a[196:199], v[220:223], v[64:67]
 v_mfma_f32_16x16x32_bf16 v[64:67], a[200:203], v[224:227], v[64:67]
 v_mfma_f32_16x16x32_bf16 v[64:67], a[204:207], v[228:231], v[64:67]
 v_mfma_f32_16x16x32_bf16 v[68:71], a[192:195], v[232:235], 0
 v_mfma_f32_16x16x32_bf16 v[68:71], a[196:199], v[236:239], v[68:71]
 v_mfma_f32_16x16x32_bf16 v[68:71], a[200:203], v[240:243], v[68:71]
 v_mfma_f32_16x16x32_bf16 v[68:71], a[204:207], v[244:247], v[68:71]
 v_mfma_f32_16x16x32_bf16 v[72:75], a[208:211], v[184:187], 0
 v_mfma_f32_16x16x32_bf16 v[72:75], a[212:215], v[188:191], v[72:75]
 v_mfma_f32_16x16x32_bf16 v[72:75], a[216:219], v[192:195], v[72:75]
 v_mfma_f32_16x16x32_bf16 v[72:75], a[220:223], v[196:199], v[72:75]
 v_mfma_f32_16x16x32_bf16 v[76:79], a[208:211], v[200:203], 0
 v_mfma_f32_16x16x32_bf16 v[76:79], a[212:215], v[204:207], v[76:79]
 v_mfma_f32_16x16x32_bf16 v[76:79], a[216:219], v[208:211], v[76:79]
 v_mfma_f32_16x16x32_bf16 v[76:79], a[220:223], v[212:215], v[76:79]
 v_mfma_f32_16x16x32_bf16 v[80:83], a[208:211], v[216:219], 0
 v_mfma_f32_16x16x32_bf16 v[80:83], a[212:215], v[220:223], v[80:83]
 v_mfma_f32_16x16x32_bf16 v[80:83], a[216:219], v[224:227], v[80:83]
 v_mfma_f32_16x16x32_bf16 v[80:83], a[220:223], v[228:231], v[80:83]
 v_mfma_f32_16x16x32_bf16 v[84:87], a[208:211], v[232:235], 0
 v_mfma_f32_16x16x32_bf16 v[84:87], a[212:215], v[236:239], v[84:87]
 v_mfma_f32_16x16x32_bf16 v[84:87], a[216:219], v[240:243], v[84:87]
 v_mfma_f32_16x16x32_bf16 v[84:87], a[220:223], v[244:247], v[84:87]
 v_mfma_f32_16x16x32_bf16 v[88:91], a[224:227], v[184:187], 0
 v_mfma_f32_16x16x32_bf16 v[88:91], a[228:231], v[188:191], v[88:91]
 v_mfma_f32_16x16x32_bf16 v[88:91], a[232:235], v[192:195], v[88:91]
 v_mfma_f32_16x16x32_bf16 v[88:91], a[236:239], v[196:199], v[88:91]
 v_mfma_f32_16x16x32_bf16 v[92:95], a[224:227], v[200:203], 0
 v_mfma_f32_16x16x32_bf16 v[92:95], a[228:231], v[204:207], v[92:95]
 v_mfma_f32_16x16x32_bf16 v[92:95], a[232:235], v[208:211], v[92:95]
 v_mfma_f32_16x16x32_bf16 v[92:95], a[236:239], v[212:215], v[92:95]
 v_mfma_f32_16x16x32_bf16 v[96:99], a[224:227], v[216:219], 0
 v_mfma_f32_16x16x32_bf16 v[96:99], a[228:231], v[220:223], v[96:99]
 v_mfma_f32_16x16x32_bf16 v[96:99], a[232:235], v[224:227], v[96:99]
 v_mfma_f32_16x16x32_bf16 v[96:99], a[236:239], v[228:231], v[96:99]
 v_mfma_f32_16x16x32_bf16 v[100:103], a[224:227], v[232:235], 0
 v_mfma_f32_16x16x32_bf16 v[100:103], a[228:231], v[236:239], v[100:103]
 v_mfma_f32_16x16x32_bf16 v[100:103], a[232:235], v[240:243], v[100:103]
 v_mfma_f32_16x16x32_bf16 v[100:103], a[236:239], v[244:247], v[100:103]
 v_mfma_f32_16x16x32_bf16 v[104:107], a[240:243], v[184:187], 0
 v_mfma_f32_16x16x32_bf16 v[104:107], a[244:247], v[188:191], v[104:107]
 v_mfma_f32_16x16x32_bf16 v[104:107], a[248:251], v[192:195], v[104:107]
 v_mfma_f32_16x16x32_bf16 v[104:107], a[252:255], v[196:199], v[104:107]
 v_mfma_f32_16x16x32_bf16 v[108:111], a[240:243], v[200:203], 0
 v_mfma_f32_16x16x32_bf16 v[108:111], a[244:247], v[204:207], v[108:111]
 v_mfma_f32_16x16x32_bf16 v[108:111], a[248:251], v[208:211], v[108:111]
 v_mfma_f32_16x16x32_bf16 v[108:111], a[252:255], v[212:215], v[108:111]
 v_mfma_f32_16x16x32_bf16 v[112:115], a[240:243], v[216:219], 0
 v_mfma_f32_16x16x32_bf16 v[112:115], a[244:247], v[220:223], v[112:115]
 v_mfma_f32_16x16x32_bf16 v[112:115], a[248:251], v[224:227], v[112:115]
 v_mfma_f32_16x16x32_bf16 v[112:115], a[252:255], v[228:231], v[112:115]
 v_mfma_f32_16x16x32_bf16 v[116:119], a[240:243], v[232:235], 0
 v_mfma_f32_16x16x32_bf16 v[116:119], a[244:247], v[236:239], v[116:119]
 v_mfma_f32_16x16x32_bf16 v[116:119], a[248:251], v[240:243], v[116:119]
 v_mfma_f32_16x16x32_bf16 v[116:119], a[252:255], v[244:247], v[116:119]
 v_max3_f32 v36, v36, v56, v57
 v_max3_f32 v36, v36, v58, v59
 v_max3_f32 v36, v36, v72, v73
 v_max3_f32 v36, v36, v74, v75
 v_max3_f32 v36, v36, v88, v89
 v_max3_f32 v36, v36, v90, v91
 v_max3_f32 v36, v36, v104, v105
 v_max3_f32 v36, v36, v106, v107
 v_max3_f32 v37, v37, v60, v61
 v_max3_f32 v37, v37, v62, v63
 v_max3_f32 v37, v37, v76, v77
 v_max3_f32 v37, v37, v78, v79
 v_max3_f32 v37, v37, v92, v93
 v_max3_f32 v37, v37, v94, v95
 v_max3_f32 v37, v37, v108, v109
 v_max3_f32 v37, v37, v110, v111
 v_max3_f32 v38, v38, v64, v65
 v_max3_f32 v38, v38, v66, v67
 v_max3_f32 v38, v38, v80, v81
 v_max3_f32 v38, v38, v82, v83
 v_max3_f32 v38, v38, v96, v97
 v_max3_f32 v38, v38, v98, v99
 v_max3_f32 v38, v38, v112, v113
 v_max3_f32 v38, v38, v114, v115
 v_max3_f32 v39, v39, v68, v69
 v_max3_f32 v39, v39, v70, v71
 v_max3_f32 v39, v39, v84, v85
 v_max3_f32 v39, v39, v86, v87
 v_max3_f32 v39, v39, v100, v101
 v_max3_f32 v39, v39, v102, v103
 v_max3_f32 v39, v39, v116, v117
 v_max3_f32 v39, v39, v118, v119
 s_add_u32 s82, s82, 16384
 s_cmp_lt_u32 s82, 0x80000
 s_cbranch_scc1 L_slow1
 v_mov_b32 v28, v36
 v_mov_b32 v29, v37
 v_mov_b32 v30, v38
 v_mov_b32 v31, v39
 v_permlane32_swap_b32 v36, v28
 v_permlane32_swap_b32 v37, v29
 v_permlane32_swap_b32 v38, v30
 v_permlane32_swap_b32 v39, v31
 v_max_f32 v36, v36, v28
 v_max_f32 v37, v37, v29
 v_max_f32 v38, v38, v30
 v_max_f32 v39, v39, v31
 v_mov_b32 v28, v36
 v_mov_b32 v29, v37
 v_mov_b32 v30, v38
 v_mov_b32 v31, v39
 v_permlane16_swap_b32 v36, v28
 v_permlane16_swap_b32 v37, v29
 v_permlane16_swap_b32 v38, v30
 v_permlane16_swap_b32 v39, v31
 v_max_f32 v36, v36, v28
 v_max_f32 v37, v37, v29
 v_max_f32 v38, v38, v30
 v_max_f32 v39, v39, v31
 v_sub_f32 v136, 0, v36
 v_sub_f32 v137, 0, v36
 v_sub_f32 v138, 0, v36
 v_sub_f32 v139, 0, v36
 v_mov_b32 v16, 0
 v_sub_f32 v140, 0, v37
 v_sub_f32 v141, 0, v37
 v_sub_f32 v142, 0, v37
 v_sub_f32 v143, 0, v37
 v_mov_b32 v17, 0
 v_sub_f32 v144, 0, v38
 v_sub_f32 v145, 0, v38
 v_sub_f32 v146, 0, v38
 v_sub_f32 v147, 0, v38
 v_mov_b32 v18, 0
 v_sub_f32 v148, 0, v39
 v_sub_f32 v149, 0, v39
 v_sub_f32 v150, 0, v39
 v_sub_f32 v151, 0, v39
 v_mov_b32 v19, 0
 v_accvgpr_write_b32 a0, 0
 v_accvgpr_write_b32 a1, 0
 v_accvgpr_write_b32 a2, 0
 v_accvgpr_write_b32 a3, 0
 v_accvgpr_write_b32 a4, 0
 v_accvgpr_write_b32 a5, 0
 v_accvgpr_write_b32 a6, 0
 v_accvgpr_write_b32 a7, 0
 v_accvgpr_write_b32 a8, 0
 v_accvgpr_write_b32 a9, 0
 v_accvgpr_write_b32 a10, 0
 v_accvgpr_write_b32 a11, 0
 v_accvgpr_write_b32 a12, 0
 v_accvgpr_write_b32 a13, 0
 v_accvgpr_write_b32 a14, 0
 v_accvgpr_write_b32 a15, 0
 v_accvgpr_write_b32 a16, 0
 v_accvgpr_write_b32 a17, 0
 v_accvgpr_write_b32 a18, 0
 v_accvgpr_write_b32 a19, 0
 v_accvgpr_write_b32 a20, 0
 v_accvgpr_write_b32 a21, 0
 v_accvgpr_write_b32 a22, 0
 v_accvgpr_write_b32 a23, 0
 v_accvgpr_write_b32 a24, 0
 v_accvgpr_write_b32 a25, 0
 v_accvgpr_write_b32 a26, 0
 v_accvgpr_write_b32 a27, 0
 v_accvgpr_write_b32 a28, 0
 v_accvgpr_write_b32 a29, 0
 v_accvgpr_write_b32 a30, 0
 v_accvgpr_write_b32 a31, 0
 v_accvgpr_write_b32 a32, 0
 v_accvgpr_write_b32 a33, 0
 v_accvgpr_write_b32 a34, 0
 v_accvgpr_write_b32 a35, 0
 v_accvgpr_write_b32 a36, 0
 v_accvgpr_write_b32 a37, 0
 v_accvgpr_write_b32 a38, 0
 v_accvgpr_write_b32 a39, 0
 v_accvgpr_write_b32 a40, 0
 v_accvgpr_write_b32 a41, 0
 v_accvgpr_write_b32 a42, 0
 v_accvgpr_write_b32 a43, 0
 v_accvgpr_write_b32 a44, 0
 v_accvgpr_write_b32 a45, 0
 v_accvgpr_write_b32 a46, 0
 v_accvgpr_write_b32 a47, 0
 v_accvgpr_write_b32 a48, 0
 v_accvgpr_write_b32 a49, 0
 v_accvgpr_write_b32 a50, 0
 v_accvgpr_write_b32 a51, 0
 v_accvgpr_write_b32 a52, 0
 v_accvgpr_write_b32 a53, 0
 v_accvgpr_write_b32 a54, 0
 v_accvgpr_write_b32 a55, 0
 v_accvgpr_write_b32 a56, 0
 v_accvgpr_write_b32 a57, 0
 v_accvgpr_write_b32 a58, 0
 v_accvgpr_write_b32 a59, 0
 v_accvgpr_write_b32 a60, 0
 v_accvgpr_write_b32 a61, 0
 v_accvgpr_write_b32 a62, 0
 v_accvgpr_write_b32 a63, 0
 v_accvgpr_write_b32 a64, 0
 v_accvgpr_write_b32 a65, 0
 v_accvgpr_write_b32 a66, 0
 v_accvgpr_write_b32 a67, 0
 v_accvgpr_write_b32 a68, 0
 v_accvgpr_write_b32 a69, 0
 v_accvgpr_write_b32 a70, 0
 v_accvgpr_write_b32 a71, 0
 v_accvgpr_write_b32 a72, 0
 v_accvgpr_write_b32 a73, 0
 v_accvgpr_write_b32 a74, 0
 v_accvgpr_write_b32 a75, 0
 v_accvgpr_write_b32 a76, 0
 v_accvgpr_write_b32 a77, 0
 v_accvgpr_write_b32 a78, 0
 v_accvgpr_write_b32 a79, 0
 v_accvgpr_write_b32 a80, 0
 v_accvgpr_write_b32 a81, 0
 v_accvgpr_write_b32 a82, 0
 v_accvgpr_write_b32 a83, 0
 v_accvgpr_write_b32 a84, 0
 v_accvgpr_write_b32 a85, 0
 v_accvgpr_write_b32 a86, 0
 v_accvgpr_write_b32 a87, 0
 v_accvgpr_write_b32 a88, 0
 v_accvgpr_write_b32 a89, 0
 v_accvgpr_write_b32 a90, 0
 v_accvgpr_write_b32 a91, 0
 v_accvgpr_write_b32 a92, 0
 v_accvgpr_write_b32 a93, 0
 v_accvgpr_write_b32 a94, 0
 v_accvgpr_write_b32 a95, 0
 v_accvgpr_write_b32 a96, 0
 v_accvgpr_write_b32 a97, 0
 v_accvgpr_write_b32 a98, 0
 v_accvgpr_write_b32 a99, 0
 v_accvgpr_write_b32 a100, 0
 v_accvgpr_write_b32 a101, 0
 v_accvgpr_write_b32 a102, 0
 v_accvgpr_write_b32 a103, 0
 v_accvgpr_write_b32 a104, 0
 v_accvgpr_write_b32 a105, 0
 v_accvgpr_write_b32 a106, 0
 v_accvgpr_write_b32 a107, 0
 v_accvgpr_write_b32 a108, 0
 v_accvgpr_write_b32 a109, 0
 v_accvgpr_write_b32 a110, 0
 v_accvgpr_write_b32 a111, 0
 v_accvgpr_write_b32 a112, 0
 v_accvgpr_write_b32 a113, 0
 v_accvgpr_write_b32 a114, 0
 v_accvgpr_write_b32 a115, 0
 v_accvgpr_write_b32 a116, 0
 v_accvgpr_write_b32 a117, 0
 v_accvgpr_write_b32 a118, 0
 v_accvgpr_write_b32 a119, 0
 v_accvgpr_write_b32 a120, 0
 v_accvgpr_write_b32 a121, 0
 v_accvgpr_write_b32 a122, 0
 v_accvgpr_write_b32 a123, 0
 v_accvgpr_write_b32 a124, 0
 v_accvgpr_write_b32 a125, 0
 v_accvgpr_write_b32 a126, 0
 v_accvgpr_write_b32 a127, 0
 s_mov_b32 s82, 0
L_slow2:
 s_mov_b32 s81, s82
 s_mov_b32 m0, s79
 s_nop 0
 buffer_load_dwordx4 v132, s[4:7], s81 offen offset:0 lds
 buffer_load_dwordx4 v133, s[4:7], s81 offen offset:1024 lds
 buffer_load_dwordx4 v134, s[4:7], s81 offen offset:2048 lds
 buffer_load_dwordx4 v135, s[4:7], s81 offen offset:3072 lds
 s_add_u32 s81, s81, 4096
 s_waitcnt vmcnt(0)
 ds_read_b128 a[192:195], v120
 ds_read_b128 a[196:199], v121
 ds_read_b128 a[200:203], v122
 ds_read_b128 a[204:207], v123
 s_waitcnt lgkmcnt(0)
 s_mov_b32 m0, s79
 s_nop 0
 buffer_load_dwordx4 v132, s[4:7], s81 offen offset:0 lds
 buffer_load_dwordx4 v133, s[4:7], s81 offen offset:1024 lds
 buffer_load_dwordx4 v134, s[4:7], s81 offen offset:2048 lds
 buffer_load_dwordx4 v135, s[4:7], s81 offen offset:3072 lds
 s_add_u32 s81, s81, 4096
 s_waitcnt vmcnt(0)
 ds_read_b128 a[208:211], v120
 ds_read_b128 a[212:215], v121
 ds_read_b128 a[216:219], v122
 ds_read_b128 a[220:223], v123
 s_waitcnt lgkmcnt(0)
 s_mov_b32 m0, s79
 s_nop 0
 buffer_load_dwordx4 v132, s[4:7], s81 offen offset:0 lds
 buffer_load_dwordx4 v133, s[4:7], s81 offen offset:1024 lds
 buffer_load_dwordx4 v134, s[4:7], s81 offen offset:2048 lds
 buffer_load_dwordx4 v135, s[4:7], s81 offen offset:3072 lds
 s_add_u32 s81, s81, 4096
 s_waitcnt vmcnt(0)
 ds_read_b128 a[224:227], v120
 ds_read_b128 a[228:231], v121
 ds_read_b128 a[232:235], v122
 ds_read_b128 a[236:239], v123
 s_waitcnt lgkmcnt(0)
 s_mov_b32 m0, s79
 s_nop 0
 buffer_load_dwordx4 v132, s[4:7], s81 offen offset:0 lds
 buffer_load_dwordx4 v133, s[4:7], s81 offen offset:1024 lds
 buffer_load_dwordx4 v134, s[4:7], s81 offen offset:2048 lds
 buffer_load_dwordx4 v135, s[4:7], s81 offen offset:3072 lds
 s_add_u32 s81, s81, 4096
 s_waitcnt vmcnt(0)
 ds_read_b128 a[240:243], v120
 ds_read_b128 a[244:247], v121
 ds_read_b128 a[248:251], v122
 ds_read_b128 a[252:255], v123
 s_waitcnt lgkmcnt(0)
 v_mfma_f32_16x16x32_bf16 v[56:59], a[192:195], v[184:187], v[136:139]
 v_mfma_f32_16x16x32_bf16 v[56:59], a[196:199], v[188:191], v[56:59]
 v_mfma_f32_16x16x32_bf16 v[56:59], a[200:203], v[192:195], v[56:59]
 v_mfma_f32_16x16x32_bf16 v[56:59], a[204:207], v[196:199], v[56:59]
 v_mfma_f32_16x16x32_bf16 v[60:63], a[192:195], v[200:203], v[140:143]
 v_mfma_f32_16x16x32_bf16 v[60:63], a[196:199], v[204:207], v[60:63]
 v_mfma_f32_16x16x32_bf16 v[60:63], a[200:203], v[208:211], v[60:63]
 v_mfma_f32_16x16x32_bf16 v[60:63], a[204:207], v[212:215], v[60:63]
 v_mfma_f32_16x16x32_bf16 v[64:67], a[192:195], v[216:219], v[144:147]
 v_mfma_f32_16x16x32_bf16 v[64:67], a[196:199], v[220:223], v[64:67]
 v_mfma_f32_16x16x32_bf16 v[64:67], a[200:203], v[224:227], v[64:67]
 v_mfma_f32_16x16x32_bf16 v[64:67], a[204:207], v[228:231], v[64:67]
 v_mfma_f32_16x16x32_bf16 v[68:71], a[192:195], v[232:235], v[148:151]
 v_mfma_f32_16x16x32_bf16 v[68:71], a[196:199], v[236:239], v[68:71]
 v_mfma_f32_16x16x32_bf16 v[68:71], a[200:203], v[240:243], v[68:71]
 v_mfma_f32_16x16x32_bf16 v[68:71], a[204:207], v[244:247], v[68:71]
 v_mfma_f32_16x16x32_bf16 v[72:75], a[208:211], v[184:187], v[136:139]
 v_mfma_f32_16x16x32_bf16 v[72:75], a[212:215], v[188:191], v[72:75]
 v_mfma_f32_16x16x32_bf16 v[72:75], a[216:219], v[192:195], v[72:75]
 v_mfma_f32_16x16x32_bf16 v[72:75], a[220:223], v[196:199], v[72:75]
 v_mfma_f32_16x16x32_bf16 v[76:79], a[208:211], v[200:203], v[140:143]
 v_mfma_f32_16x16x32_bf16 v[76:79], a[212:215], v[204:207], v[76:79]
 v_mfma_f32_16x16x32_bf16 v[76:79], a[216:219], v[208:211], v[76:79]
 v_mfma_f32_16x16x32_bf16 v[76:79], a[220:223], v[212:215], v[76:79]
 v_mfma_f32_16x16x32_bf16 v[80:83], a[208:211], v[216:219], v[144:147]
 v_mfma_f32_16x16x32_bf16 v[80:83], a[212:215], v[220:223], v[80:83]
 v_mfma_f32_16x16x32_bf16 v[80:83], a[216:219], v[224:227], v[80:83]
 v_mfma_f32_16x16x32_bf16 v[80:83], a[220:223], v[228:231], v[80:83]
 v_mfma_f32_16x16x32_bf16 v[84:87], a[208:211], v[232:235], v[148:151]
 v_mfma_f32_16x16x32_bf16 v[84:87], a[212:215], v[236:239], v[84:87]
 v_mfma_f32_16x16x32_bf16 v[84:87], a[216:219], v[240:243], v[84:87]
 v_mfma_f32_16x16x32_bf16 v[84:87], a[220:223], v[244:247], v[84:87]
 v_mfma_f32_16x16x32_bf16 v[88:91], a[224:227], v[184:187], v[136:139]
 v_mfma_f32_16x16x32_bf16 v[88:91], a[228:231], v[188:191], v[88:91]
 v_mfma_f32_16x16x32_bf16 v[88:91], a[232:235], v[192:195], v[88:91]
 v_mfma_f32_16x16x32_bf16 v[88:91], a[236:239], v[196:199], v[88:91]
 v_mfma_f32_16x16x32_bf16 v[92:95], a[224:227], v[200:203], v[140:143]
 v_mfma_f32_16x16x32_bf16 v[92:95], a[228:231], v[204:207], v[92:95]
 v_mfma_f32_16x16x32_bf16 v[92:95], a[232:235], v[208:211], v[92:95]
 v_mfma_f32_16x16x32_bf16 v[92:95], a[236:239], v[212:215], v[92:95]
 v_mfma_f32_16x16x32_bf16 v[96:99], a[224:227], v[216:219], v[144:147]
 v_mfma_f32_16x16x32_bf16 v[96:99], a[228:231], v[220:223], v[96:99]
 v_mfma_f32_16x16x32_bf16 v[96:99], a[232:235], v[224:227], v[96:99]
 v_mfma_f32_16x16x32_bf16 v[96:99], a[236:239], v[228:231], v[96:99]
 v_mfma_f32_16x16x32_bf16 v[100:103], a[224:227], v[232:235], v[148:151]
 v_mfma_f32_16x16x32_bf16 v[100:103], a[228:231], v[236:239], v[100:103]
 v_mfma_f32_16x16x32_bf16 v[100:103], a[232:235], v[240:243], v[100:103]
 v_mfma_f32_16x16x32_bf16 v[100:103], a[236:239], v[244:247], v[100:103]
 v_mfma_f32_16x16x32_bf16 v[104:107], a[240:243], v[184:187], v[136:139]
 v_mfma_f32_16x16x32_bf16 v[104:107], a[244:247], v[188:191], v[104:107]
 v_mfma_f32_16x16x32_bf16 v[104:107], a[248:251], v[192:195], v[104:107]
 v_mfma_f32_16x16x32_bf16 v[104:107], a[252:255], v[196:199], v[104:107]
 v_mfma_f32_16x16x32_bf16 v[108:111], a[240:243], v[200:203], v[140:143]
 v_mfma_f32_16x16x32_bf16 v[108:111], a[244:247], v[204:207], v[108:111]
 v_mfma_f32_16x16x32_bf16 v[108:111], a[248:251], v[208:211], v[108:111]
 v_mfma_f32_16x16x32_bf16 v[108:111], a[252:255], v[212:215], v[108:111]
 v_mfma_f32_16x16x32_bf16 v[112:115], a[240:243], v[216:219], v[144:147]
 v_mfma_f32_16x16x32_bf16 v[112:115], a[244:247], v[220:223], v[112:115]
 v_mfma_f32_16x16x32_bf16 v[112:115], a[248:251], v[224:227], v[112:115]
 v_mfma_f32_16x16x32_bf16 v[112:115], a[252:255], v[228:231], v[112:115]
 v_mfma_f32_16x16x32_bf16 v[116:119], a[240:243], v[232:235], v[148:151]
 v_mfma_f32_16x16x32_bf16 v[116:119], a[244:247], v[236:239], v[116:119]
 v_mfma_f32_16x16x32_bf16 v[116:119], a[248:251], v[240:243], v[116:119]
 v_mfma_f32_16x16x32_bf16 v[116:119], a[252:255], v[244:247], v[116:119]
 v_exp_f32 v28, v56
 s_nop 0
 v_add_f32 v16, v16, v28
 v_exp_f32 v29, v57
 s_nop 0
 v_add_f32 v16, v16, v29
 v_cvt_pk_bf16_f32 v152, v28, v29
 v_exp_f32 v30, v58
 s_nop 0
 v_add_f32 v16, v16, v30
 v_exp_f32 v31, v59
 s_nop 0
 v_add_f32 v16, v16, v31
 v_cvt_pk_bf16_f32 v153, v30, v31
 v_exp_f32 v28, v60
 s_nop 0
 v_add_f32 v17, v17, v28
 v_exp_f32 v29, v61
 s_nop 0
 v_add_f32 v17, v17, v29
 v_cvt_pk_bf16_f32 v160, v28, v29
 v_exp_f32 v30, v62
 s_nop 0
 v_add_f32 v17, v17, v30
 v_exp_f32 v31, v63
 s_nop 0
 v_add_f32 v17, v17, v31
 v_cvt_pk_bf16_f32 v161, v30, v31
 v_exp_f32 v28, v64
 s_nop 0
 v_add_f32 v18, v18, v28
 v_exp_f32 v29, v65
 s_nop 0
 v_add_f32 v18, v18, v29
 v_cvt_pk_bf16_f32 v168, v28, v29
 v_exp_f32 v30, v66
 s_nop 0
 v_add_f32 v18, v18, v30
 v_exp_f32 v31, v67
 s_nop 0
 v_add_f32 v18, v18, v31
 v_cvt_pk_bf16_f32 v169, v30, v31
 v_exp_f32 v28, v68
 s_nop 0
 v_add_f32 v19, v19, v28
 v_exp_f32 v29, v69
 s_nop 0
 v_add_f32 v19, v19, v29
 v_cvt_pk_bf16_f32 v176, v28, v29
 v_exp_f32 v30, v70
 s_nop 0
 v_add_f32 v19, v19, v30
 v_exp_f32 v31, v71
 s_nop 0
 v_add_f32 v19, v19, v31
 v_cvt_pk_bf16_f32 v177, v30, v31
 v_exp_f32 v28, v72
 s_nop 0
 v_add_f32 v16, v16, v28
 v_exp_f32 v29, v73
 s_nop 0
 v_add_f32 v16, v16, v29
 v_cvt_pk_bf16_f32 v154, v28, v29
 v_exp_f32 v30, v74
 s_nop 0
 v_add_f32 v16, v16, v30
 v_exp_f32 v31, v75
 s_nop 0
 v_add_f32 v16, v16, v31
 v_cvt_pk_bf16_f32 v155, v30, v31
 v_exp_f32 v28, v76
 s_nop 0
 v_add_f32 v17, v17, v28
 v_exp_f32 v29, v77
 s_nop 0
 v_add_f32 v17, v17, v29
 v_cvt_pk_bf16_f32 v162, v28, v29
 v_exp_f32 v30, v78
 s_nop 0
 v_add_f32 v17, v17, v30
 v_exp_f32 v31, v79
 s_nop 0
 v_add_f32 v17, v17, v31
 v_cvt_pk_bf16_f32 v163, v30, v31
 v_exp_f32 v28, v80
 s_nop 0
 v_add_f32 v18, v18, v28
 v_exp_f32 v29, v81
 s_nop 0
 v_add_f32 v18, v18, v29
 v_cvt_pk_bf16_f32 v170, v28, v29
 v_exp_f32 v30, v82
 s_nop 0
 v_add_f32 v18, v18, v30
 v_exp_f32 v31, v83
 s_nop 0
 v_add_f32 v18, v18, v31
 v_cvt_pk_bf16_f32 v171, v30, v31
 v_exp_f32 v28, v84
 s_nop 0
 v_add_f32 v19, v19, v28
 v_exp_f32 v29, v85
 s_nop 0
 v_add_f32 v19, v19, v29
 v_cvt_pk_bf16_f32 v178, v28, v29
 v_exp_f32 v30, v86
 s_nop 0
 v_add_f32 v19, v19, v30
 v_exp_f32 v31, v87
 s_nop 0
 v_add_f32 v19, v19, v31
 v_cvt_pk_bf16_f32 v179, v30, v31
 v_exp_f32 v28, v88
 s_nop 0
 v_add_f32 v16, v16, v28
 v_exp_f32 v29, v89
 s_nop 0
 v_add_f32 v16, v16, v29
 v_cvt_pk_bf16_f32 v156, v28, v29
 v_exp_f32 v30, v90
 s_nop 0
 v_add_f32 v16, v16, v30
 v_exp_f32 v31, v91
 s_nop 0
 v_add_f32 v16, v16, v31
 v_cvt_pk_bf16_f32 v157, v30, v31
 v_exp_f32 v28, v92
 s_nop 0
 v_add_f32 v17, v17, v28
 v_exp_f32 v29, v93
 s_nop 0
 v_add_f32 v17, v17, v29
 v_cvt_pk_bf16_f32 v164, v28, v29
 v_exp_f32 v30, v94
 s_nop 0
 v_add_f32 v17, v17, v30
 v_exp_f32 v31, v95
 s_nop 0
 v_add_f32 v17, v17, v31
 v_cvt_pk_bf16_f32 v165, v30, v31
 v_exp_f32 v28, v96
 s_nop 0
 v_add_f32 v18, v18, v28
 v_exp_f32 v29, v97
 s_nop 0
 v_add_f32 v18, v18, v29
 v_cvt_pk_bf16_f32 v172, v28, v29
 v_exp_f32 v30, v98
 s_nop 0
 v_add_f32 v18, v18, v30
 v_exp_f32 v31, v99
 s_nop 0
 v_add_f32 v18, v18, v31
 v_cvt_pk_bf16_f32 v173, v30, v31
 v_exp_f32 v28, v100
 s_nop 0
 v_add_f32 v19, v19, v28
 v_exp_f32 v29, v101
 s_nop 0
 v_add_f32 v19, v19, v29
 v_cvt_pk_bf16_f32 v180, v28, v29
 v_exp_f32 v30, v102
 s_nop 0
 v_add_f32 v19, v19, v30
 v_exp_f32 v31, v103
 s_nop 0
 v_add_f32 v19, v19, v31
 v_cvt_pk_bf16_f32 v181, v30, v31
 v_exp_f32 v28, v104
 s_nop 0
 v_add_f32 v16, v16, v28
 v_exp_f32 v29, v105
 s_nop 0
 v_add_f32 v16, v16, v29
 v_cvt_pk_bf16_f32 v158, v28, v29
 v_exp_f32 v30, v106
 s_nop 0
 v_add_f32 v16, v16, v30
 v_exp_f32 v31, v107
 s_nop 0
 v_add_f32 v16, v16, v31
 v_cvt_pk_bf16_f32 v159, v30, v31
 v_exp_f32 v28, v108
 s_nop 0
 v_add_f32 v17, v17, v28
 v_exp_f32 v29, v109
 s_nop 0
 v_add_f32 v17, v17, v29
 v_cvt_pk_bf16_f32 v166, v28, v29
 v_exp_f32 v30, v110
 s_nop 0
 v_add_f32 v17, v17, v30
 v_exp_f32 v31, v111
 s_nop 0
 v_add_f32 v17, v17, v31
 v_cvt_pk_bf16_f32 v167, v30, v31
 v_exp_f32 v28, v112
 s_nop 0
 v_add_f32 v18, v18, v28
 v_exp_f32 v29, v113
 s_nop 0
 v_add_f32 v18, v18, v29
 v_cvt_pk_bf16_f32 v174, v28, v29
 v_exp_f32 v30, v114
 s_nop 0
 v_add_f32 v18, v18, v30
 v_exp_f32 v31, v115
 s_nop 0
 v_add_f32 v18, v18, v31
 v_cvt_pk_bf16_f32 v175, v30, v31
 v_exp_f32 v28, v116
 s_nop 0
 v_add_f32 v19, v19, v28
 v_exp_f32 v29, v117
 s_nop 0
 v_add_f32 v19, v19, v29
 v_cvt_pk_bf16_f32 v182, v28, v29
 v_exp_f32 v30, v118
 s_nop 0
 v_add_f32 v19, v19, v30
 v_exp_f32 v31, v119
 s_nop 0
 v_add_f32 v19, v19, v31
 v_cvt_pk_bf16_f32 v183, v30, v31
 s_cmp_eq_u32 s82, 0x7c000
 s_cbranch_scc1 L_slow_done
 s_mov_b32 s81, s82
 s_mov_b32 m0, s79
 s_nop 0
 buffer_load_dwordx4 v32, s[8:11], s81 offen offset:0 lds
 buffer_load_dwordx4 v33, s[8:11], s81 offen offset:1024 lds
 buffer_load_dwordx4 v32, s[8:11], s81 offen offset:2048 lds
 buffer_load_dwordx4 v33, s[8:11], s81 offen offset:3072 lds
 s_add_u32 s81, s81, 4096
 s_waitcnt vmcnt(0)
 ds_read_b64_tr_b16 a[192:193], v124
 ds_read_b64_tr_b16 a[200:201], v125
 ds_read_b64_tr_b16 a[208:209], v126
 ds_read_b64_tr_b16 a[216:217], v127
 ds_read_b64_tr_b16 a[224:225], v128
 ds_read_b64_tr_b16 a[232:233], v129
 ds_read_b64_tr_b16 a[240:241], v130
 ds_read_b64_tr_b16 a[248:249], v131
 s_waitcnt lgkmcnt(0)
 s_mov_b32 m0, s79
 s_nop 0
 buffer_load_dwordx4 v32, s[8:11], s81 offen offset:0 lds
 buffer_load_dwordx4 v33, s[8:11], s81 offen offset:1024 lds
 buffer_load_dwordx4 v32, s[8:11], s81 offen offset:2048 lds
 buffer_load_dwordx4 v33, s[8:11], s81 offen offset:3072 lds
 s_add_u32 s81, s81, 4096
 s_waitcnt vmcnt(0)
 ds_read_b64_tr_b16 a[194:195], v124
 ds_read_b64_tr_b16 a[202:203], v125
 ds_read_b64_tr_b16 a[210:211], v126
 ds_read_b64_tr_b16 a[218:219], v127
 ds_read_b64_tr_b16 a[226:227], v128
 ds_read_b64_tr_b16 a[234:235], v129
 ds_read_b64_tr_b16 a[242:243], v130
 ds_read_b64_tr_b16 a[250:251], v131
 s_waitcnt lgkmcnt(0)
 s_mov_b32 m0, s79
 s_nop 0
 buffer_load_dwordx4 v32, s[8:11], s81 offen offset:0 lds
 buffer_load_dwordx4 v33, s[8:11], s81 offen offset:1024 lds
 buffer_load_dwordx4 v32, s[8:11], s81 offen offset:2048 lds
 buffer_load_dwordx4 v33, s[8:11], s81 offen offset:3072 lds
 s_add_u32 s81, s81, 4096
 s_waitcnt vmcnt(0)
 ds_read_b64_tr_b16 a[196:197], v124
 ds_read_b64_tr_b16 a[204:205], v125
 ds_read_b64_tr_b16 a[212:213], v126
 ds_read_b64_tr_b16 a[220:221], v127
 ds_read_b64_tr_b16 a[228:229], v128
 ds_read_b64_tr_b16 a[236:237], v129
 ds_read_b64_tr_b16 a[244:245], v130
 ds_read_b64_tr_b16 a[252:253], v131
 s_waitcnt lgkmcnt(0)
 s_mov_b32 m0, s79
 s_nop 0
 buffer_load_dwordx4 v32, s[8:11], s81 offen offset:0 lds
 buffer_load_dwordx4 v33, s[8:11], s81 offen offset:1024 lds
 buffer_load_dwordx4 v32, s[8:11], s81 offen offset:2048 lds
 buffer_load_dwordx4 v33, s[8:11], s81 offen offset:3072 lds
 s_add_u32 s81, s81, 4096
 s_waitcnt vmcnt(0)
 ds_read_b64_tr_b16 a[198:199], v124
 ds_read_b64_tr_b16 a[206:207], v125
 ds_read_b64_tr_b16 a[214:215], v126
 ds_read_b64_tr_b16 a[222:223], v127
 ds_read_b64_tr_b16 a[230:231], v128
 ds_read_b64_tr_b16 a[238:239], v129
 ds_read_b64_tr_b16 a[246:247], v130
 ds_read_b64_tr_b16 a[254:255], v131
 s_waitcnt lgkmcnt(0)
 v_mfma_f32_16x16x32_bf16 a[0:3], a[192:195], v[152:155], a[0:3]
 v_mfma_f32_16x16x32_bf16 a[0:3], a[196:199], v[156:159], a[0:3]
 v_mfma_f32_16x16x32_bf16 a[4:7], a[192:195], v[160:163], a[4:7]
 v_mfma_f32_16x16x32_bf16 a[4:7], a[196:199], v[164:167], a[4:7]
 v_mfma_f32_16x16x32_bf16 a[8:11], a[192:195], v[168:171], a[8:11]
 v_mfma_f32_16x16x32_bf16 a[8:11], a[196:199], v[172:175], a[8:11]
 v_mfma_f32_16x16x32_bf16 a[12:15], a[192:195], v[176:179], a[12:15]
 v_mfma_f32_16x16x32_bf16 a[12:15], a[196:199], v[180:183], a[12:15]
 v_mfma_f32_16x16x32_bf16 a[16:19], a[200:203], v[152:155], a[16:19]
 v_mfma_f32_16x16x32_bf16 a[16:19], a[204:207], v[156:159], a[16:19]
 v_mfma_f32_16x16x32_bf16 a[20:23], a[200:203], v[160:163], a[20:23]
 v_mfma_f32_16x16x32_bf16 a[20:23], a[204:207], v[164:167], a[20:23]
 v_mfma_f32_16x16x32_bf16 a[24:27], a[200:203], v[168:171], a[24:27]
 v_mfma_f32_16x16x32_bf16 a[24:27], a[204:207], v[172:175], a[24:27]
 v_mfma_f32_16x16x32_bf16 a[28:31], a[200:203], v[176:179], a[28:31]
 v_mfma_f32_16x16x32_bf16 a[28:31], a[204:207], v[180:183], a[28:31]
 v_mfma_f32_16x16x32_bf16 a[32:35], a[208:211], v[152:155], a[32:35]
 v_mfma_f32_16x16x32_bf16 a[32:35], a[212:215], v[156:159], a[32:35]
 v_mfma_f32_16x16x32_bf16 a[36:39], a[208:211], v[160:163], a[36:39]
 v_mfma_f32_16x16x32_bf16 a[36:39], a[212:215], v[164:167], a[36:39]
 v_mfma_f32_16x16x32_bf16 a[40:43], a[208:211], v[168:171], a[40:43]
 v_mfma_f32_16x16x32_bf16 a[40:43], a[212:215], v[172:175], a[40:43]
 v_mfma_f32_16x16x32_bf16 a[44:47], a[208:211], v[176:179], a[44:47]
 v_mfma_f32_16x16x32_bf16 a[44:47], a[212:215], v[180:183], a[44:47]
 v_mfma_f32_16x16x32_bf16 a[48:51], a[216:219], v[152:155], a[48:51]
 v_mfma_f32_16x16x32_bf16 a[48:51], a[220:223], v[156:159], a[48:51]
 v_mfma_f32_16x16x32_bf16 a[52:55], a[216:219], v[160:163], a[52:55]
 v_mfma_f32_16x16x32_bf16 a[52:55], a[220:223], v[164:167], a[52:55]
 v_mfma_f32_16x16x32_bf16 a[56:59], a[216:219], v[168:171], a[56:59]
 v_mfma_f32_16x16x32_bf16 a[56:59], a[220:223], v[172:175], a[56:59]
 v_mfma_f32_16x16x32_bf16 a[60:63], a[216:219], v[176:179], a[60:63]
 v_mfma_f32_16x16x32_bf16 a[60:63], a[220:223], v[180:183], a[60:63]
 v_mfma_f32_16x16x32_bf16 a[64:67], a[224:227], v[152:155], a[64:67]
 v_mfma_f32_16x16x32_bf16 a[64:67], a[228:231], v[156:159], a[64:67]
 v_mfma_f32_16x16x32_bf16 a[68:71], a[224:227], v[160:163], a[68:71]
 v_mfma_f32_16x16x32_bf16 a[68:71], a[228:231], v[164:167], a[68:71]
 v_mfma_f32_16x16x32_bf16 a[72:75], a[224:227], v[168:171], a[72:75]
 v_mfma_f32_16x16x32_bf16 a[72:75], a[228:231], v[172:175], a[72:75]
 v_mfma_f32_16x16x32_bf16 a[76:79], a[224:227], v[176:179], a[76:79]
 v_mfma_f32_16x16x32_bf16 a[76:79], a[228:231], v[180:183], a[76:79]
 v_mfma_f32_16x16x32_bf16 a[80:83], a[232:235], v[152:155], a[80:83]
 v_mfma_f32_16x16x32_bf16 a[80:83], a[236:239], v[156:159], a[80:83]
 v_mfma_f32_16x16x32_bf16 a[84:87], a[232:235], v[160:163], a[84:87]
 v_mfma_f32_16x16x32_bf16 a[84:87], a[236:239], v[164:167], a[84:87]
 v_mfma_f32_16x16x32_bf16 a[88:91], a[232:235], v[168:171], a[88:91]
 v_mfma_f32_16x16x32_bf16 a[88:91], a[236:239], v[172:175], a[88:91]
 v_mfma_f32_16x16x32_bf16 a[92:95], a[232:235], v[176:179], a[92:95]
 v_mfma_f32_16x16x32_bf16 a[92:95], a[236:239], v[180:183], a[92:95]
 v_mfma_f32_16x16x32_bf16 a[96:99], a[240:243], v[152:155], a[96:99]
 v_mfma_f32_16x16x32_bf16 a[96:99], a[244:247], v[156:159], a[96:99]
 v_mfma_f32_16x16x32_bf16 a[100:103], a[240:243], v[160:163], a[100:103]
 v_mfma_f32_16x16x32_bf16 a[100:103], a[244:247], v[164:167], a[100:103]
 v_mfma_f32_16x16x32_bf16 a[104:107], a[240:243], v[168:171], a[104:107]
 v_mfma_f32_16x16x32_bf16 a[104:107], a[244:247], v[172:175], a[104:107]
 v_mfma_f32_16x16x32_bf16 a[108:111], a[240:243], v[176:179], a[108:111]
 v_mfma_f32_16x16x32_bf16 a[108:111], a[244:247], v[180:183], a[108:111]
 v_mfma_f32_16x16x32_bf16 a[112:115], a[248:251], v[152:155], a[112:115]
 v_mfma_f32_16x16x32_bf16 a[112:115], a[252:255], v[156:159], a[112:115]
 v_mfma_f32_16x16x32_bf16 a[116:119], a[248:251], v[160:163], a[116:119]
 v_mfma_f32_16x16x32_bf16 a[116:119], a[252:255], v[164:167], a[116:119]
 v_mfma_f32_16x16x32_bf16 a[120:123], a[248:251], v[168:171], a[120:123]
 v_mfma_f32_16x16x32_bf16 a[120:123], a[252:255], v[172:175], a[120:123]
 v_mfma_f32_16x16x32_bf16 a[124:127], a[248:251], v[176:179], a[124:127]
 v_mfma_f32_16x16x32_bf16 a[124:127], a[252:255], v[180:183], a[124:127]
 s_add_u32 s82, s82, 16384
 s_branch L_slow2
L_slow_done:
 ds_read_b64_tr_b16 a[192:193], v8 offset:32768
 ds_read_b64_tr_b16 a[194:195], v8 offset:36864
 ds_read_b64_tr_b16 a[196:197], v8 offset:40960
 ds_read_b64_tr_b16 a[198:199], v8 offset:45056
 ds_read_b64_tr_b16 a[200:201], v9 offset:32768
 ds_read_b64_tr_b16 a[202:203], v9 offset:36864
 ds_read_b64_tr_b16 a[204:205], v9 offset:40960
 ds_read_b64_tr_b16 a[206:207], v9 offset:45056
 ds_read_b64_tr_b16 a[208:209], v10 offset:32768
 ds_read_b64_tr_b16 a[210:211], v10 offset:36864
 ds_read_b64_tr_b16 a[212:213], v10 offset:40960
 ds_read_b64_tr_b16 a[214:215], v10 offset:45056
 ds_read_b64_tr_b16 a[216:217], v11 offset:32768
 ds_read_b64_tr_b16 a[218:219], v11 offset:36864
 ds_read_b64_tr_b16 a[220:221], v11 offset:40960
 ds_read_b64_tr_b16 a[222:223], v11 offset:45056
 s_waitcnt vmcnt(0) lgkmcnt(0)
 s_nop 15
 s_branch L_slow_ret
L_spin_o:
 s_mov_b32 s3, 0
L_spin_o_l:
 s_sleep 4
 buffer_load_dword v255, v250, s[32:35], s66 offen sc1
 s_add_u32 s3, s3, 1
 s_cmp_gt_u32 s3, 0x40000
 s_cbranch_scc1 L_ok_o
 s_waitcnt vmcnt(0)
 v_cmp_ne_u32 vcc, s54, v255
 s_cbranch_vccnz L_spin_o_l
 s_branch L_ok_o
L_spin_o1:
 s_mov_b32 s3, 0
L_spin_o1_l:
 s_sleep 4
 buffer_load_dword v255, v254, s[32:35], s66 offen sc1
 s_add_u32 s3, s3, 1
 s_cmp_gt_u32 s3, 0x40000
 s_cbranch_scc1 L_ok_o1
 s_waitcnt vmcnt(0)
 v_cmp_ne_u32 vcc, s54, v255
 s_cbranch_vccnz L_spin_o1_l
 s_branch L_ok_o1
L_spin_o2:
 s_mov_b32 s3, 0
L_spin_o2_l:
 s_sleep 4
 buffer_load_dword v255, v254, s[32:35], s61 offen sc1
 s_add_u32 s3, s3, 1
 s_cmp_gt_u32 s3, 0x40000
 s_cbranch_scc1 L_ok_o2
 s_waitcnt vmcnt(0)
 v_cmp_ne_u32 vcc, s54, v255
 s_cbranch_vccnz L_spin_o2_l
 s_branch L_ok_o2
L_spin_p2:
 s_mov_b32 s3, 0
L_spin_p2_l:
 s_sleep 4
 buffer_load_dword v255, v254, s[32:35], s66 offen sc1
 s_add_u32 s3, s3, 1
 s_cmp_gt_u32 s3, 0x40000
 s_cbranch_scc1 L_ok_p2
 s_waitcnt vmcnt(0)
 v_cmp_ne_u32 vcc, s54, v255
 s_cbranch_vccnz L_spin_p2_l
 s_branch L_ok_p2
L_spin_p1:
 s_mov_b32 s3, 0
L_spin_p1_l:
 s_sleep 4
 buffer_load_dword v255, v254, s[32:35], s66 offen sc1
 s_add_u32 s3, s3, 1
 s_cmp_gt_u32 s3, 0x40000
 s_cbranch_scc1 L_ok_p1
 s_waitcnt vmcnt(0)
 v_cmp_ne_u32 vcc, s54, v255
 s_cbranch_vccnz L_spin_p1_l
 s_branch L_ok_p1
L_code_end:
.section .rodata,"a"
.p2align 6
.amdhsa_kernel recurrent_scan__mha_block_cached__glu_gated_swiglu__prompt_kernel
  .amdhsa_next_free_vgpr 512
  .amdhsa_next_free_sgpr 102
  .amdhsa_accum_offset 256
  .amdhsa_group_segment_fixed_size 0
  .amdhsa_kernarg_size 96
  .amdhsa_user_sgpr_count 2
  .amdhsa_user_sgpr_kernarg_segment_ptr 1
  .amdhsa_system_sgpr_workgroup_id_x 1
.end_amdhsa_kernel
```
